```python
import torch

def _softmax(x, axis=-1):
    return torch.softmax(x, dim=axis)

def _gelu(x):
    return torch.nn.functional.gelu(x, approximate='tanh')

def _silu(x):
    return torch.nn.functional.silu(x)

def _sigmoid(x):
    return torch.sigmoid(x)

def _layernorm(x, axis=-1, eps=1e-05):
    m = x.mean(dim=axis, keepdim=True)
    v = x.var(dim=axis, keepdim=True, unbiased=False)
    return (x - m) / torch.sqrt(v + eps)

def _scatter_add(tgt, idx, src, axis=0):
    return tgt.clone().index_add_(axis, idx, src)

def _segment_sum(src, seg, n):
    out = torch.zeros((n,) + src.shape[1:], dtype=src.dtype)
    return out.index_add_(0, seg, src)

def _pad(x, pw):
    flat = tuple((v for pair in reversed(pw) for v in pair))
    return torch.nn.functional.pad(x, flat)
kernel_name = 'adaLN_cond__sliding_block_cached__glu_gated_glu__prompt'

def setup_inputs():

    _w = lambda a: (lambda t: t.to(torch.bfloat16) if t.is_floating_point() else t)(torch.as_tensor(a))

    def _A_setup():
        B, Sq, D = (1, 2048, 576)
        Hq, Hkv, Sk, Dh = (32, 16, 2048, 128)
        assert Hq % Hkv == 0, (Hq, Hkv)
        return {'x': _w((lambda *s: torch.randn(*s, dtype=torch.bfloat16) * 0.05)(B, Sq, D)), 'k_cache': _w((lambda *s: torch.randn(*s, dtype=torch.bfloat16) * 3.2)(B, Hkv, Sk, Dh)), 'v_cache': _w((lambda *s: torch.randn(*s, dtype=torch.bfloat16) * 0.4)(B, Hkv, Sk, Dh)), 'wq': _w((lambda *s: torch.randn(*s, dtype=torch.bfloat16) * 3.2)(D, Hq * Dh) * D ** (-0.5)), 'wo': _w((lambda *s: torch.randn(*s, dtype=torch.bfloat16) * 0.4)(Hq * Dh, D) * (Hq * Dh) ** (-0.5))}
    _A_in = _A_setup()

    def _B_setup():
        B, S, D, F = (1, 2048, 576, 4608)
        return {'x': _w((lambda *s: torch.randn(*s, dtype=torch.bfloat16) * 0.05)(B, S, D)), 'w_gate': _w((lambda *s: torch.randn(*s, dtype=torch.bfloat16) * 0.05)(D, F)), 'w_up': _w((lambda *s: torch.randn(*s, dtype=torch.bfloat16) * 0.05)(D, F)), 'w_down': _w((lambda *s: torch.randn(*s, dtype=torch.bfloat16) * 0.05)(F, D))}
    _B_in = _B_setup()
    return {'A_x': _A_in['x'], 'A_k_cache': _A_in['k_cache'], 'A_v_cache': _A_in['v_cache'], 'A_wq': _A_in['wq'], 'A_wo': _A_in['wo'], 'B_x': _B_in['x'], 'B_w_gate': _B_in['w_gate'], 'B_w_up': _B_in['w_up'], 'B_w_down': _B_in['w_down'], 'c': _w((lambda *s: torch.randn(*s, dtype=torch.bfloat16) * 0.1)(1, 576) * 8.0), 'w_mod': _w((lambda *s: torch.randn(*s, dtype=torch.bfloat16) * 0.1)(576, 6 * 576) * 576 ** (-0.5) * 8.0)}

def reference(A_x, A_k_cache, A_v_cache, A_wq, A_wo, B_x, B_w_gate, B_w_up, B_w_down, c, w_mod):

    def _A_ref(x, k_cache, v_cache, wq, wo):
        B, Sq, D = x.shape
        Hq, Dh = (32, 128)
        Hkv, Sk = (k_cache.shape[1], k_cache.shape[2])
        W = min(4096, max(256, Sk // 4))
        rep = Hq // Hkv
        q = (lambda x, *d: x.permute(*d))((x @ wq).reshape(B, Sq, Hq, Dh), 0, 2, 1, 3)
        k = (lambda x, n, axis: torch.repeat_interleave(x, n, dim=axis))(k_cache[:, :, Sk - W:, :], rep, axis=1)
        v = (lambda x, n, axis: torch.repeat_interleave(x, n, dim=axis))(v_cache[:, :, Sk - W:, :], rep, axis=1)
        scores = torch.einsum('bhqd,bhkd->bhqk', q, k) * Dh ** (-0.5)
        p = _softmax(scores, axis=-1)
        o = torch.einsum('bhqk,bhkd->bhqd', p, v)
        return (lambda x, *d: x.permute(*d))(o, 0, 2, 1, 3).reshape(B, Sq, Hq * Dh) @ wo

    def _B_ref(x, w_gate, w_up, w_down):
        g = torch.einsum('bsd,df->bsf', x, w_gate)
        u = torch.einsum('bsd,df->bsf', x, w_up)
        h = _sigmoid(g) * u
        return torch.einsum('bsf,fd->bsd', h, w_down)
    x = A_x
    mod = (_silu(c) @ w_mod).reshape(c.shape[0], 6, 1, -1)
    sa, ca, ga, sb, cb, gb = (mod[:, 0].clone(), mod[:, 1].clone(), mod[:, 2].clone(), mod[:, 3].clone(), mod[:, 4].clone(), mod[:, 5].clone())
    h = _layernorm(x, axis=-1) * (1 + ca) + sa
    x = x + ga * _A_ref(h, A_k_cache, A_v_cache, A_wq, A_wo)
    h = _layernorm(x, axis=-1) * (1 + cb) + sb
    x = x + gb * _B_ref(h, B_w_gate, B_w_up, B_w_down)
    return x
```

```asm
; @launch kernel=k0_kernel grid=(256,1,1) block=(192,1,1) lds=2048
; @launch kernel=k1_kernel grid=(256,1,1) block=(256,1,1) lds=159488
.amdgcn_target "amdgcn-amd-amdhsa--gfx950"
.text
.globl k0_kernel
.p2align 8
.type k0_kernel,@function
k0_kernel:
s_cmp_ge_u32 s2, 256
s_cbranch_scc1 k0_end
s_load_dwordx2 s[8:9], s[0:1], 0
s_load_dwordx4 s[28:31], s[0:1], 72
s_load_dwordx2 s[6:7], s[0:1], 104
s_load_dwordx2 s[48:49], s[0:1], 24
s_lshr_b32 s33, s2, 3
v_and_b32 v62, 63, v0
s_getpc_b64 s[44:45]
s_mov_b32 s46, k1_end-k0_kernel-256
s_mov_b32 s47, 0x20000
s_lshl_b32 s32, s33, 12
v_lshlrev_b32 v61, 6, v62
v_cmp_gt_u32_e64 vcc, 64, v0
s_nop 0
s_cbranch_vccz k0_c
buffer_load_dword v63, v61, s[44:47], s32 offen
k0_c:
v_and_b32_e64 v1, 7, v0
v_bfe_u32 v2, v0, 3, 2
v_bfe_u32 v3, v0, 5, 1
v_lshrrev_b32 v5, 6, v0
s_mul_i32 s4, s2, 9216
v_readfirstlane_b32 s3, v5
v_mul_u32_u24 v4, 1152, v1
v_mad_u32_u24 v3, v5, 6, v3
v_lshl_add_u32 v4, v3, 6, v4
v_lshl_add_u32 v4, v2, 3, v4
v_add_u32 v4, s4, v4
v_lshlrev_b32 v6, 5, v1
v_lshrrev_b32_e64 v9, 3, v62
v_mad_u32_u24 v9, v5, 24, v9
v_lshl_add_u32 v5, v5, 3, v6
s_cmp_lt_u32 s2, 216
s_cselect_b32 s35, 0, 1073741824
s_cselect_b32 s34, s2, 0
s_and_b32 s37, s34, 3
s_lshr_b32 s34, s34, 2
s_mul_i32 s36, s37, 995328
s_lshl_b32 s43, s34, 7
s_add_u32 s54, s36, s43
s_add_u32 s55, s54, 55296
s_add_u32 s56, s54, 110592
s_add_u32 s57, s54, 497664
s_add_u32 s58, s54, 552960
s_add_u32 s59, s54, 608256
s_mul_i32 s38, s37, 288
s_mul_i32 s39, s37, 13824
s_lshl_b32 s40, s34, 8
s_add_u32 s39, s39, s40
v_mul_u32_u24 v8, 6912, v9
v_lshl_add_u32 v8, v1, 4, v8
v_add_u32_e64 v8, s35, v8
v_lshlrev_b32 v9, 1, v9
s_waitcnt lgkmcnt(0)
s_mov_b32 s10, 2359296
s_mov_b32 s11, 0x20000
buffer_load_dwordx2 v[10:11], v4, s[8:11], 0 offen offset:0
buffer_load_dwordx2 v[12:13], v4, s[8:11], 0 offen offset:32
buffer_load_dwordx2 v[14:15], v4, s[8:11], 0 offen offset:128
buffer_load_dwordx2 v[16:17], v4, s[8:11], 0 offen offset:160
buffer_load_dwordx2 v[18:19], v4, s[8:11], 0 offen offset:256
buffer_load_dwordx2 v[20:21], v4, s[8:11], 0 offen offset:288
s_mov_b32 s12, s28
s_mov_b32 s13, s29
s_movk_i32 s14, 1152
s_mov_b32 s15, 0x20000
s_mov_b32 s16, s30
s_mov_b32 s17, s31
s_mov_b32 s18, 3981312
s_mov_b32 s19, 0x20000
s_barrier
buffer_load_ushort v88, v9, s[12:15], s38 offen offset:0
buffer_load_ushort v89, v9, s[12:15], s38 offen offset:16
buffer_load_ushort v90, v9, s[12:15], s38 offen offset:32
buffer_load_ushort v91, v9, s[12:15], s38 offen offset:144
buffer_load_ushort v92, v9, s[12:15], s38 offen offset:160
buffer_load_ushort v93, v9, s[12:15], s38 offen offset:176
buffer_load_dwordx4 v[64:67], v8, s[16:19], s54 offen
buffer_load_dwordx4 v[68:71], v8, s[16:19], s55 offen
buffer_load_dwordx4 v[72:75], v8, s[16:19], s56 offen
buffer_load_dwordx4 v[76:79], v8, s[16:19], s57 offen
buffer_load_dwordx4 v[80:83], v8, s[16:19], s58 offen
buffer_load_dwordx4 v[84:87], v8, s[16:19], s59 offen
s_add_u32 s20, s6, 65536
s_addc_u32 s21, s7, 0
s_mov_b32 s22, 2359296
s_mov_b32 s23, 0x20000
s_mov_b32 s24, s6
s_mov_b32 s25, s7
s_mov_b32 s26, 3538944
s_mov_b32 s27, 0x20000
s_mov_b32 s50, 4718592
s_mov_b32 s51, 0x20000
s_and_b32 s52, s2, 7
s_lshl_b32 s52, s52, 9
s_mul_i32 s53, s33, 73728
s_add_u32 s52, s52, s53
v_min_u32 v60, 23, v62
s_mul_i32 s53, s3, 24
v_add_u32 v60, s53, v60
v_lshrrev_b32 v61, 2, v60
v_and_b32 v60, 3, v60
v_lshlrev_b32 v60, 7, v60
v_lshl_add_u32 v60, v61, 12, v60
buffer_load_dword v59, v60, s[48:51], s52 offen
v_lshrrev_b32 v56, 2, v1
v_lshlrev_b32 v56, 7, v56
v_and_b32_e64 v57, 1, v0
v_lshl_add_u32 v56, v57, 6, v56
v_and_or_b32 v56, v0, 32, v56
v_bfe_u32 v57, v0, 1, 1
v_lshl_add_u32 v56, v57, 4, v56
v_bfe_u32 v57, v0, 4, 1
v_lshl_add_u32 v56, v57, 3, v56
v_lshl_add_u32 v56, s3, 8, v56
s_lshr_b32 s4, s2, 2
s_mul_i32 s4, s4, 36864
s_and_b32 s5, s2, 2
s_lshl_b32 s5, s5, 9
s_add_u32 s4, s4, s5
s_and_b32 s5, s2, 1
s_lshl_b32 s5, s5, 7
s_add_u32 s60, s4, s5
s_add_u32 s61, s60, 4096
s_add_u32 s62, s60, 8192
v_lshlrev_b32 v7, 11, v3
v_lshl_add_u32 v7, v2, 8, v7
v_lshl_add_u32 v7, v1, 4, v7
s_waitcnt vmcnt(18)
v_and_b32 v25, 0xffff0000, v10
v_lshlrev_b32 v24, 16, v10
v_and_b32 v27, 0xffff0000, v11
v_lshlrev_b32 v26, 16, v11
s_waitcnt vmcnt(17)
v_and_b32 v29, 0xffff0000, v12
v_lshlrev_b32_e64 v28, 16, v12
v_and_b32 v31, 0xffff0000, v13
v_lshlrev_b32_e64 v30, 16, v13
v_pk_add_f32 v[50:51], v[24:25], v[26:27]
v_pk_add_f32 v[52:53], v[28:29], v[30:31]
s_waitcnt vmcnt(16)
v_and_b32 v33, 0xffff0000, v14
v_lshlrev_b32 v32, 16, v14
v_and_b32 v35, 0xffff0000, v15
v_lshlrev_b32 v34, 16, v15
s_waitcnt vmcnt(15)
v_and_b32 v37, 0xffff0000, v16
v_lshlrev_b32_e64 v36, 16, v16
v_and_b32 v39, 0xffff0000, v17
v_lshlrev_b32_e64 v38, 16, v17
v_pk_add_f32 v[50:51], v[50:51], v[32:33]
v_pk_add_f32 v[50:51], v[50:51], v[34:35]
v_pk_add_f32 v[52:53], v[52:53], v[36:37]
v_pk_add_f32 v[52:53], v[52:53], v[38:39]
s_waitcnt vmcnt(14)
v_and_b32 v41, 0xffff0000, v18
v_lshlrev_b32 v40, 16, v18
v_and_b32 v43, 0xffff0000, v19
v_lshlrev_b32 v42, 16, v19
s_waitcnt vmcnt(13)
v_and_b32 v45, 0xffff0000, v20
v_lshlrev_b32_e64 v44, 16, v20
v_and_b32 v47, 0xffff0000, v21
v_lshlrev_b32_e64 v46, 16, v21
v_pk_add_f32 v[50:51], v[50:51], v[40:41]
v_pk_add_f32 v[50:51], v[50:51], v[42:43]
v_pk_add_f32 v[52:53], v[52:53], v[44:45]
v_pk_add_f32 v[52:53], v[52:53], v[46:47]
v_pk_add_f32 v[50:51], v[50:51], v[52:53]
v_add_f32 v48, v50, v51
s_nop 1
v_add_f32_dpp v48, v48, v48 row_ror:8 row_mask:0xf bank_mask:0xf
v_mov_b32 v50, v48
s_nop 1
v_permlane16_swap_b32 v50, v48
v_add_f32 v48, v48, v50
v_mov_b32 v50, v48
s_nop 1
v_permlane32_swap_b32 v50, v48
v_add_f32 v48, v48, v50
v_mul_f32 v48, 0xbbaaaaab, v48
v_pk_add_f32 v[24:25], v[24:25], v[48:49] op_sel:[0,0] op_sel_hi:[1,0]
v_pk_add_f32 v[26:27], v[26:27], v[48:49] op_sel:[0,0] op_sel_hi:[1,0]
v_pk_add_f32 v[28:29], v[28:29], v[48:49] op_sel:[0,0] op_sel_hi:[1,0]
v_pk_add_f32 v[30:31], v[30:31], v[48:49] op_sel:[0,0] op_sel_hi:[1,0]
v_pk_add_f32 v[32:33], v[32:33], v[48:49] op_sel:[0,0] op_sel_hi:[1,0]
v_pk_add_f32 v[34:35], v[34:35], v[48:49] op_sel:[0,0] op_sel_hi:[1,0]
v_pk_add_f32 v[36:37], v[36:37], v[48:49] op_sel:[0,0] op_sel_hi:[1,0]
v_pk_add_f32 v[38:39], v[38:39], v[48:49] op_sel:[0,0] op_sel_hi:[1,0]
v_pk_add_f32 v[40:41], v[40:41], v[48:49] op_sel:[0,0] op_sel_hi:[1,0]
v_pk_add_f32 v[42:43], v[42:43], v[48:49] op_sel:[0,0] op_sel_hi:[1,0]
v_pk_add_f32 v[44:45], v[44:45], v[48:49] op_sel:[0,0] op_sel_hi:[1,0]
v_pk_add_f32 v[46:47], v[46:47], v[48:49] op_sel:[0,0] op_sel_hi:[1,0]
v_pk_mul_f32 v[50:51], v[24:25], v[24:25]
v_pk_mul_f32 v[52:53], v[26:27], v[26:27]
v_pk_fma_f32 v[50:51], v[28:29], v[28:29], v[50:51]
v_pk_fma_f32 v[52:53], v[30:31], v[30:31], v[52:53]
v_pk_fma_f32 v[50:51], v[32:33], v[32:33], v[50:51]
v_pk_fma_f32 v[52:53], v[34:35], v[34:35], v[52:53]
v_pk_fma_f32 v[50:51], v[36:37], v[36:37], v[50:51]
v_pk_fma_f32 v[52:53], v[38:39], v[38:39], v[52:53]
v_pk_fma_f32 v[50:51], v[40:41], v[40:41], v[50:51]
v_pk_fma_f32 v[52:53], v[42:43], v[42:43], v[52:53]
v_pk_fma_f32 v[50:51], v[44:45], v[44:45], v[50:51]
v_pk_fma_f32 v[52:53], v[46:47], v[46:47], v[52:53]
v_pk_add_f32 v[50:51], v[50:51], v[52:53]
v_add_f32 v49, v50, v51
s_nop 1
v_add_f32_dpp v49, v49, v49 row_ror:8 row_mask:0xf bank_mask:0xf
v_mov_b32 v50, v49
s_nop 1
v_permlane16_swap_b32 v50, v49
v_add_f32 v49, v49, v50
v_mov_b32 v50, v49
s_nop 1
v_permlane32_swap_b32 v50, v49
v_add_f32 v49, v49, v50
ds_write_b64 v5, v[48:49]
s_waitcnt lgkmcnt(0)
s_barrier
ds_read_b128 v[50:53], v6
ds_read_b64 v[54:55], v6 offset:16
s_waitcnt vmcnt(12)
v_lshlrev_b32 v88, 16, v88
s_waitcnt vmcnt(11)
v_lshlrev_b32 v89, 16, v89
s_waitcnt vmcnt(10)
v_lshlrev_b32 v90, 16, v90
s_waitcnt vmcnt(9)
v_lshlrev_b32 v91, 16, v91
s_waitcnt vmcnt(8)
v_lshlrev_b32 v92, 16, v92
s_waitcnt vmcnt(7)
v_lshlrev_b32 v93, 16, v93
v_mul_f32 v94, 0xbfb8aa3b, v88
v_mul_f32 v95, 0xbfb8aa3b, v89
v_mul_f32 v96, 0xbfb8aa3b, v90
v_mul_f32 v97, 0xbfb8aa3b, v91
v_mul_f32 v98, 0xbfb8aa3b, v92
v_mul_f32 v99, 0xbfb8aa3b, v93
v_exp_f32 v94, v94
v_exp_f32 v95, v95
v_exp_f32 v96, v96
v_exp_f32 v97, v97
v_exp_f32 v98, v98
v_exp_f32 v99, v99
v_add_f32 v94, 1.0, v94
v_add_f32 v95, 1.0, v95
v_add_f32 v96, 1.0, v96
v_add_f32 v97, 1.0, v97
v_add_f32 v98, 1.0, v98
v_add_f32 v99, 1.0, v99
v_rcp_f32 v94, v94
v_rcp_f32 v95, v95
v_rcp_f32 v96, v96
v_rcp_f32 v97, v97
v_rcp_f32 v98, v98
v_rcp_f32 v99, v99
v_mul_f32 v88, v88, v94
v_mul_f32 v89, v89, v95
v_mul_f32 v90, v90, v96
v_mul_f32 v91, v91, v97
v_mul_f32 v92, v92, v98
v_mul_f32 v93, v93, v99
v_cvt_pk_bf16_f32 v88, v88, v89
v_cvt_pk_bf16_f32 v90, v90, v91
v_cvt_pk_bf16_f32 v92, v92, v93
v_and_b32 v89, 0xffff0000, v88
v_lshlrev_b32_e64 v88, 16, v88
v_and_b32 v91, 0xffff0000, v90
v_lshlrev_b32_e64 v90, 16, v90
v_and_b32 v93, 0xffff0000, v92
v_lshlrev_b32_e64 v92, 16, v92
s_waitcnt lgkmcnt(1)
v_pk_add_f32 v[22:23], v[50:51], v[52:53]
s_waitcnt lgkmcnt(0)
v_pk_add_f32 v[22:23], v[22:23], v[54:55]
v_mul_f32 v22, 0x3eaaaaab, v22
v_sub_f32 v50, v50, v22
v_sub_f32 v52, v52, v22
v_sub_f32 v54, v54, v22
v_mul_f32 v50, v50, v50
v_fmac_f32_e64 v50, v52, v52
v_mov_b32 v51, 0x3727c5ac
v_fmac_f32 v50, v54, v54
v_sub_f32 v49, v22, v48
v_fmac_f32 v23, 0x43400000, v50
v_fmac_f32 v51, 0x3ae38e39, v23
v_rsq_f32 v48, v51
s_nop 0
v_mul_f32_e64 v49, v49, v48
v_pk_fma_f32 v[24:25], v[24:25], v[48:49], v[48:49] op_sel:[0,0,1] op_sel_hi:[1,0,1]
v_pk_fma_f32 v[26:27], v[26:27], v[48:49], v[48:49] op_sel:[0,0,1] op_sel_hi:[1,0,1]
v_pk_fma_f32 v[28:29], v[28:29], v[48:49], v[48:49] op_sel:[0,0,1] op_sel_hi:[1,0,1]
v_pk_fma_f32 v[30:31], v[30:31], v[48:49], v[48:49] op_sel:[0,0,1] op_sel_hi:[1,0,1]
v_cvt_pk_f16_f32 v24, v24, v25
v_cvt_pk_f16_f32 v25, v26, v27
v_cvt_pk_f16_f32 v26, v28, v29
v_cvt_pk_f16_f32 v27, v30, v31
buffer_store_dwordx4 v[24:27], v7, s[20:23], s60 offen sc1
v_pk_fma_f32 v[32:33], v[32:33], v[48:49], v[48:49] op_sel:[0,0,1] op_sel_hi:[1,0,1]
v_pk_fma_f32 v[34:35], v[34:35], v[48:49], v[48:49] op_sel:[0,0,1] op_sel_hi:[1,0,1]
v_pk_fma_f32 v[36:37], v[36:37], v[48:49], v[48:49] op_sel:[0,0,1] op_sel_hi:[1,0,1]
v_pk_fma_f32 v[38:39], v[38:39], v[48:49], v[48:49] op_sel:[0,0,1] op_sel_hi:[1,0,1]
v_cvt_pk_f16_f32 v32, v32, v33
v_cvt_pk_f16_f32 v33, v34, v35
v_cvt_pk_f16_f32 v34, v36, v37
v_cvt_pk_f16_f32 v35, v38, v39
buffer_store_dwordx4 v[32:35], v7, s[20:23], s61 offen sc1
v_pk_fma_f32 v[40:41], v[40:41], v[48:49], v[48:49] op_sel:[0,0,1] op_sel_hi:[1,0,1]
v_pk_fma_f32 v[42:43], v[42:43], v[48:49], v[48:49] op_sel:[0,0,1] op_sel_hi:[1,0,1]
v_pk_fma_f32 v[44:45], v[44:45], v[48:49], v[48:49] op_sel:[0,0,1] op_sel_hi:[1,0,1]
v_pk_fma_f32 v[46:47], v[46:47], v[48:49], v[48:49] op_sel:[0,0,1] op_sel_hi:[1,0,1]
v_cvt_pk_f16_f32 v40, v40, v41
v_cvt_pk_f16_f32 v41, v42, v43
v_cvt_pk_f16_f32 v42, v44, v45
v_cvt_pk_f16_f32 v43, v46, v47
buffer_store_dwordx4 v[40:43], v7, s[20:23], s62 offen sc1
s_waitcnt vmcnt(9)
v_and_b32 v109, 0xffff0000, v64
v_lshlrev_b32 v108, 16, v64
v_and_b32 v111, 0xffff0000, v65
v_lshlrev_b32_e64 v110, 16, v65
v_and_b32 v113, 0xffff0000, v66
v_lshlrev_b32_e64 v112, 16, v66
v_and_b32 v115, 0xffff0000, v67
v_lshlrev_b32_e64 v114, 16, v67
v_pk_mul_f32 v[100:101], v[108:109], v[88:89] op_sel:[0,0] op_sel_hi:[1,0]
v_pk_mul_f32 v[102:103], v[110:111], v[88:89] op_sel:[0,0] op_sel_hi:[1,0]
v_pk_mul_f32 v[104:105], v[112:113], v[88:89] op_sel:[0,0] op_sel_hi:[1,0]
v_pk_mul_f32 v[106:107], v[114:115], v[88:89] op_sel:[0,0] op_sel_hi:[1,0]
s_waitcnt vmcnt(8)
v_and_b32 v117, 0xffff0000, v68
v_lshlrev_b32 v116, 16, v68
v_and_b32 v119, 0xffff0000, v69
v_lshlrev_b32_e64 v118, 16, v69
v_and_b32 v121, 0xffff0000, v70
v_lshlrev_b32_e64 v120, 16, v70
v_and_b32 v123, 0xffff0000, v71
v_lshlrev_b32_e64 v122, 16, v71
v_pk_fma_f32 v[100:101], v[116:117], v[88:89], v[100:101] op_sel:[0,1,0] op_sel_hi:[1,1,1]
v_pk_fma_f32 v[102:103], v[118:119], v[88:89], v[102:103] op_sel:[0,1,0] op_sel_hi:[1,1,1]
v_pk_fma_f32 v[104:105], v[120:121], v[88:89], v[104:105] op_sel:[0,1,0] op_sel_hi:[1,1,1]
v_pk_fma_f32 v[106:107], v[122:123], v[88:89], v[106:107] op_sel:[0,1,0] op_sel_hi:[1,1,1]
s_waitcnt vmcnt(7)
v_and_b32 v109, 0xffff0000, v72
v_lshlrev_b32 v108, 16, v72
v_and_b32 v111, 0xffff0000, v73
v_lshlrev_b32_e64 v110, 16, v73
v_and_b32 v113, 0xffff0000, v74
v_lshlrev_b32_e64 v112, 16, v74
v_and_b32 v115, 0xffff0000, v75
v_lshlrev_b32_e64 v114, 16, v75
v_pk_fma_f32 v[100:101], v[108:109], v[90:91], v[100:101] op_sel:[0,0,0] op_sel_hi:[1,0,1]
v_pk_fma_f32 v[102:103], v[110:111], v[90:91], v[102:103] op_sel:[0,0,0] op_sel_hi:[1,0,1]
v_pk_fma_f32 v[104:105], v[112:113], v[90:91], v[104:105] op_sel:[0,0,0] op_sel_hi:[1,0,1]
v_pk_fma_f32 v[106:107], v[114:115], v[90:91], v[106:107] op_sel:[0,0,0] op_sel_hi:[1,0,1]
s_waitcnt vmcnt(6)
v_and_b32 v117, 0xffff0000, v76
v_lshlrev_b32 v116, 16, v76
v_and_b32 v119, 0xffff0000, v77
v_lshlrev_b32_e64 v118, 16, v77
v_and_b32 v121, 0xffff0000, v78
v_lshlrev_b32_e64 v120, 16, v78
v_and_b32 v123, 0xffff0000, v79
v_lshlrev_b32_e64 v122, 16, v79
v_pk_fma_f32 v[100:101], v[116:117], v[90:91], v[100:101] op_sel:[0,1,0] op_sel_hi:[1,1,1]
v_pk_fma_f32 v[102:103], v[118:119], v[90:91], v[102:103] op_sel:[0,1,0] op_sel_hi:[1,1,1]
v_pk_fma_f32 v[104:105], v[120:121], v[90:91], v[104:105] op_sel:[0,1,0] op_sel_hi:[1,1,1]
v_pk_fma_f32 v[106:107], v[122:123], v[90:91], v[106:107] op_sel:[0,1,0] op_sel_hi:[1,1,1]
s_waitcnt vmcnt(5)
v_and_b32 v109, 0xffff0000, v80
v_lshlrev_b32 v108, 16, v80
v_and_b32 v111, 0xffff0000, v81
v_lshlrev_b32_e64 v110, 16, v81
v_and_b32 v113, 0xffff0000, v82
v_lshlrev_b32_e64 v112, 16, v82
v_and_b32 v115, 0xffff0000, v83
v_lshlrev_b32_e64 v114, 16, v83
v_pk_fma_f32 v[100:101], v[108:109], v[92:93], v[100:101] op_sel:[0,0,0] op_sel_hi:[1,0,1]
v_pk_fma_f32 v[102:103], v[110:111], v[92:93], v[102:103] op_sel:[0,0,0] op_sel_hi:[1,0,1]
v_pk_fma_f32 v[104:105], v[112:113], v[92:93], v[104:105] op_sel:[0,0,0] op_sel_hi:[1,0,1]
v_pk_fma_f32 v[106:107], v[114:115], v[92:93], v[106:107] op_sel:[0,0,0] op_sel_hi:[1,0,1]
s_waitcnt vmcnt(4)
v_and_b32 v117, 0xffff0000, v84
v_lshlrev_b32 v116, 16, v84
v_and_b32 v119, 0xffff0000, v85
v_lshlrev_b32_e64 v118, 16, v85
v_and_b32 v121, 0xffff0000, v86
v_lshlrev_b32_e64 v120, 16, v86
v_and_b32 v123, 0xffff0000, v87
v_lshlrev_b32_e64 v122, 16, v87
v_pk_fma_f32 v[100:101], v[116:117], v[92:93], v[100:101] op_sel:[0,1,0] op_sel_hi:[1,1,1]
v_pk_fma_f32 v[102:103], v[118:119], v[92:93], v[102:103] op_sel:[0,1,0] op_sel_hi:[1,1,1]
v_pk_fma_f32 v[104:105], v[120:121], v[92:93], v[104:105] op_sel:[0,1,0] op_sel_hi:[1,1,1]
v_pk_fma_f32 v[106:107], v[122:123], v[92:93], v[106:107] op_sel:[0,1,0] op_sel_hi:[1,1,1]
s_nop 0
v_permlane32_swap_b32 v100, v104
v_permlane32_swap_b32 v101, v105
v_permlane32_swap_b32 v102, v106
v_permlane32_swap_b32 v103, v107
v_add_f32 v100, v100, v104
v_add_f32 v101, v101, v105
v_add_f32 v102, v102, v106
v_add_f32 v103, v103, v107
s_nop 0
v_permlane16_swap_b32 v100, v102
v_permlane16_swap_b32 v101, v103
v_add_f32_e64 v100, v100, v102
v_add_f32 v101, v101, v103
s_nop 0
v_add_f32_dpp v100, v100, v100 row_ror:8 row_mask:0xf bank_mask:0xf
v_add_f32_dpp v101, v101, v101 row_ror:8 row_mask:0xf bank_mask:0xf
ds_write_b64 v56, v[100:101] offset:1024
s_waitcnt lgkmcnt(0)
s_barrier
s_cmp_lg_u32 s3, 1
s_cbranch_scc1 k0_g
v_lshlrev_b32_e64 v57, 2, v62
ds_read2st64_b32 v[54:55], v57 offset0:4 offset1:5
ds_read_b32 v53, v57 offset:1536
v_add_u32 v57, s35, v57
s_waitcnt lgkmcnt(0)
v_add_f32_e64 v54, v54, v55
v_add_f32 v54, v54, v53
buffer_store_dword v54, v57, s[24:27], s39 offen sc1
k0_g:
s_cmp_lg_u32 s3, 2
s_cbranch_scc1 k0_z
s_lshl_b32 s4, s2, 9
s_add_u32 s4, s4, 3145728
s_add_u32 s5, s4, 0x20000
v_lshlrev_b32 v56, 3, v62
v_mov_b32 v22, 0
v_mov_b32_e64 v23, 0
buffer_store_dwordx2 v[22:23], v56, s[24:27], s4 offen sc1
s_add_u32 s4, s4, 0x40000
buffer_store_dwordx2 v[22:23], v56, s[24:27], s5 offen sc1
buffer_store_dwordx2 v[22:23], v56, s[24:27], s4 offen sc1
k0_z:
k0_end:
s_endpgm
.section .rodata,"a"
.p2align 6
.amdhsa_kernel k0_kernel
  .amdhsa_next_free_vgpr 128
  .amdhsa_next_free_sgpr 102
  .amdhsa_accum_offset 128
  .amdhsa_group_segment_fixed_size 0
  .amdhsa_kernarg_size 112
  .amdhsa_user_sgpr_count 2
  .amdhsa_user_sgpr_kernarg_segment_ptr 1
  .amdhsa_system_sgpr_workgroup_id_x 1
  .amdhsa_float_denorm_mode_32 3
.end_amdhsa_kernel

.text
.globl k1_kernel
.p2align 8
.type k1_kernel,@function
k1_kernel:
s_cmp_ge_u32 s2, 256
s_cbranch_scc1 k1_end
s_mov_b32 s60, 0
v_lshrrev_b32 v1, 6, v0
s_and_b32 s6, s2, 15
v_readfirstlane_b32 s3, v1
s_lshr_b32 s7, s2, 4
k1_restart:
s_load_dwordx2 s[8:9], s[0:1], 24
s_load_dwordx2 s[32:33], s[0:1], 104
s_load_dwordx2 s[12:13], s[0:1], 8
s_load_dwordx2 s[16:17], s[0:1], 16
s_load_dwordx2 s[20:21], s[0:1], 32
s_load_dwordx4 s[92:95], s[0:1], 48
s_load_dwordx2 s[90:91], s[0:1], 64
s_load_dwordx2 s[100:101], s[0:1], 0
v_mbcnt_lo_u32_b32 v60, -1, 0
v_mbcnt_hi_u32_b32 v60, -1, v60
v_and_b32 v61, 15, v60
v_lshrrev_b32 v62, 4, v60
v_lshrrev_b32 v63, 3, v60
v_and_b32 v65, 3, v63
s_lshl_b32 s72, s3, 3
v_add_u32 v63, s72, v63
v_lshlrev_b32 v64, 1, v62
v_and_b32 v66, 7, v60
v_xor_b32 v64, v64, v66
v_lshlrev_b32 v64, 4, v64
v_lshrrev_b32 v66, 2, v60
v_lshlrev_b32 v66, 7, v66
v_lshl_add_u32 v66, v65, 5, v66
v_and_b32 v65, 3, v60
v_lshl_add_u32 v0, v65, 3, v66
s_lshl_b32 s4, s3, 10
s_lshl_b32 s5, s3, 11
s_lshl_b32 s72, s6, 9
v_lshl_add_u32 v21, v63, 13, v64
v_add_u32 v21, s72, v21
s_lshl2_add_u32 s72, s7, s3
s_mul_i32 s72, s72, 36864
v_lshlrev_b32 v25, 4, v60
v_add_u32 v22, s72, v25
v_add_u32_e64 v25, s4, v25
s_mov_b32 s10, 4718592
s_mov_b32 s11, 0x20000
s_mov_b32 s26, 2359296
s_mov_b32 s27, 0x20000
s_mov_b32 s30, 75497472
s_mov_b32 s31, 0x20000
s_mov_b32 s34, 55296
s_mov_b32 s35, 0x20000
s_mov_b32 s40, 0
s_movk_i32 s41, 4096
s_movk_i32 s42, 8192
s_movk_i32 s43, 12288
s_movk_i32 s44, 16384
s_movk_i32 s45, 20480
s_movk_i32 s46, 24576
s_movk_i32 s47, 28672
s_mov_b32 s48, 32768
v_lshrrev_b32_e64 v26, 2, v25
v_and_b32 v26, 0x1fc, v26
v_or_b32 v26, 0x1000, v26
s_mov_b32 s62, 13824
s_movk_i32 s63, 27648
s_mov_b32 s64, 41472
s_getpc_b64 s[36:37]
s_mov_b32 s38, k1_end-k1_kernel-1024
s_mov_b32 s39, 0x20000
s_waitcnt lgkmcnt(0)
buffer_load_dwordx4 v[128:131], v25, s[32:35], 0 offen
s_add_u32 s24, s32, 65536
s_addc_u32 s25, s33, 0
buffer_load_dwordx4 v[132:135], v25, s[32:35], s62 offen
buffer_load_dwordx4 v[136:139], v25, s[32:35], s63 offen
buffer_load_dwordx4 v[140:143], v25, s[32:35], s64 offen
buffer_load_dword v144, v26, s[32:35], 0 offen
buffer_load_dword v145, v26, s[32:35], s62 offen
buffer_load_dword v146, v26, s[32:35], s63 offen
buffer_load_dword v147, v26, s[32:35], s64 offen
buffer_load_dwordx4 v[80:83], v22, s[24:27], s40 offen offset:0
s_mov_b32 s14, 8388608
s_mov_b32 s15, 0x20000
s_mov_b32 s18, 8388608
s_mov_b32 s19, 0x20000
s_mov_b32 s22, 4718592
s_mov_b32 s23, 0x20000
v_xor_b32 v1, 32, v0
v_xor_b32 v2, 64, v0
v_xor_b32 v3, 96, v0
v_add_u32 v4, 0x10000, v0
buffer_load_dwordx4 v[84:87], v22, s[24:27], s40 offen offset:1024
v_add_u32 v5, 0x10000, v1
v_add_u32 v6, 0x10000, v2
v_add_u32 v7, 0x10000, v3
v_lshrrev_b32 v65, 5, v60
v_lshrrev_b32 v66, 3, v60
v_and_b32 v66, 2, v66
v_or_b32 v65, v65, v66
v_xor_b32 v65, v65, v61
v_lshlrev_b32 v65, 4, v65
v_lshl_add_u32 v8, v61, 8, v65
s_add_u32 m0, s4, 0
s_mov_b32 s57, 0
buffer_load_dwordx4 v21, s[8:11], s57 offen lds
v_xor_b32_e64 v9, 64, v8
v_xor_b32 v10, 128, v8
v_xor_b32 v11, 192, v8
v_add_u32 v12, 0x10000, v8
v_add_u32 v13, 0x10000, v9
v_add_u32 v14, 0x10000, v10
v_add_u32 v15, 0x10000, v11
s_lshl_b32 s61, s6, 19
s_add_u32 s61, s61, 393216
v_lshl_add_u32 v18, v63, 8, v64
s_add_u32 m0, s4, 8192
s_movk_i32 s58, 256
buffer_load_dwordx4 v21, s[8:11], s58 offen lds
v_add_u32 v18, s61, v18
s_lshl_b32 s72, s3, 3
v_add_u32 v65, s72, v62
v_and_b32 v66, 15, v65
v_xor_b32 v66, v66, v61
v_lshlrev_b32 v66, 4, v66
v_lshl_add_u32 v16, v65, 8, v66
v_add_u32_e64 v16, s61, v16
v_xor_b32 v17, 64, v16
s_lshl_b32 s72, s6, 8
s_add_u32 m0, s4, 4096
s_mov_b32 s59, 128
buffer_load_dwordx4 v21, s[8:11], s59 offen lds
v_add_u32_e64 v65, s72, v63
v_mul_u32_u24 v65, 1152, v65
v_add_u32_e64 v19, v65, v64
s_lshl2_add_u32 s72, s7, s3
s_lshl_b32 s72, s72, 2
v_bfe_u32 v65, v60, 3, 1
v_add_u32_e64 v65, s72, v65
v_mul_u32_u24 v65, 147456, v65
s_mul_i32 s72, s6, 9216
v_add_u32_e64 v65, s72, v65
s_add_u32 m0, s4, 12288
s_mov_b32 s56, 384
buffer_load_dwordx4 v21, s[8:11], s56 offen lds
v_lshl_add_u32 v65, v62, 7, v65
v_and_b32_e64 v66, 7, v60
v_lshl_add_u32 v20, v66, 4, v65
v_lshlrev_b32 v23, 5, v62
v_add_u32 v23, 131072, v23
s_mov_b32 s66, 0x7f800000
s_mov_b32 s67, 0x7b800000
s_lshl_b32 s68, s3, 2
s_add_u32 s68, s68, 155904
v_mov_b32 v65, 0x3f803f80
buffer_load_dwordx4 v[88:91], v22, s[24:27], s40 offen offset:2048
v_accvgpr_write_b32 a80, v65
v_accvgpr_write_b32 a132, -1
v_accvgpr_write_b32 a81, v65
v_accvgpr_write_b32 a133, -1
v_accvgpr_write_b32 a82, v65
v_accvgpr_write_b32 a134, -1
v_accvgpr_write_b32 a83, v65
v_accvgpr_write_b32 a135, -1
s_mul_i32 s49, s6, 294912
s_mul_i32 s72, s7, 18432
buffer_load_dwordx4 v[92:95], v22, s[24:27], s40 offen offset:3072
s_add_u32 s49, s49, s72
s_lshl_b32 s73, s7, 13
s_add_u32 s73, s73, s61
s_mov_b32 s50, 0
s_movk_i32 s51, 4096
s_movk_i32 s52, 8192
s_mov_b32 s53, 294912
s_mov_b32 s54, 299008
s_mov_b32 s55, 303104
s_add_u32 m0, s4, 16384
s_mov_b32 s57, 262144
buffer_load_dwordx4 v21, s[8:11], s57 offen lds
s_add_u32 m0, s4, 24576
s_mov_b32 s58, 262400
buffer_load_dwordx4 v21, s[8:11], s58 offen lds
s_add_u32 s28, s32, 16777216
s_addc_u32 s29, s33, 0
s_mov_b64 s[62:63], 0
v_cmp_lt_u32 vcc, 2303, v25
s_nop 1
v_cndmask_b32_e64 v27, 0, 1.0, vcc
v_add_u32 v25, 131072, v25
v_add_u32 v26, 131072, v26
s_waitcnt vmcnt(16)
v_add_f32 v128, v128, v132
s_waitcnt vmcnt(14)
v_add_f32 v136, v136, v140
v_add_f32 v129, v129, v133
v_add_f32_e64 v137, v137, v141
s_add_u32 m0, s4, 20480
s_mov_b32 s59, 262272
buffer_load_dwordx4 v21, s[8:11], s59 offen lds
v_add_f32 v130, v130, v134
v_add_f32 v138, v138, v142
v_add_f32 v131, v131, v135
v_add_f32 v139, v139, v143
v_add_f32 v128, v128, v136
v_add_f32 v129, v129, v137
v_add_f32 v130, v130, v138
v_add_f32 v131, v131, v139
v_cvt_pk_bf16_f32 v128, v128, v129
v_and_b32 v129, 0xffff0000, v128
s_add_u32 m0, s4, 28672
s_mov_b32 s56, 262528
buffer_load_dwordx4 v21, s[8:11], s56 offen lds
v_lshlrev_b32_e64 v128, 16, v128
v_cvt_pk_bf16_f32 v130, v130, v131
v_and_b32 v131, 0xffff0000, v130
v_lshlrev_b32 v130, 16, v130
v_add_f32 v128, v27, v128
v_add_f32 v129, v27, v129
v_add_f32 v130, v27, v130
v_add_f32_e64 v131, v27, v131
v_cvt_pk_bf16_f32 v128, v128, v129
v_and_b32 v129, 0xffff0000, v128
buffer_load_dwordx4 v[96:99], v22, s[24:27], s41 offen offset:0
v_lshlrev_b32_e64 v128, 16, v128
v_cvt_pk_bf16_f32 v130, v130, v131
v_and_b32 v131, 0xffff0000, v130
v_lshlrev_b32_e64 v130, 16, v130
v_mul_f32 v128, 0x3e0293ee, v128
v_mul_f32 v129, 0x3e0293ee, v129
v_mul_f32 v130, 0x3e0293ee, v130
v_mul_f32 v131, 0x3e0293ee, v131
ds_write_b128 v25, v[128:131]
s_waitcnt vmcnt(15)
v_add_f32 v144, v144, v145
buffer_load_dwordx4 v[100:103], v22, s[24:27], s41 offen offset:1024
s_waitcnt vmcnt(14)
v_add_f32 v146, v146, v147
v_add_f32_e64 v144, v144, v146
v_cvt_pk_bf16_f32 v144, v144, v144
v_lshlrev_b32 v144, 16, v144
v_add_f32 v144, 1.0, v144
v_cvt_pk_bf16_f32 v144, v144, v144
v_lshlrev_b32_e64 v144, 16, v144
v_mul_f32 v144, 0x3e0293ee, v144
ds_write_b32 v26, v144
s_add_u32 m0, s4, 32768
s_mov_b32 s57, 524288
buffer_load_dwordx4 v21, s[8:11], s57 offen lds
s_add_u32 m0, s4, 40960
s_mov_b32 s58, 524544
buffer_load_dwordx4 v21, s[8:11], s58 offen lds
s_add_u32 m0, s4, 36864
s_mov_b32 s59, 524416
buffer_load_dwordx4 v21, s[8:11], s59 offen lds
s_add_u32 m0, s4, 45056
s_mov_b32 s56, 524672
buffer_load_dwordx4 v21, s[8:11], s56 offen lds
s_add_u32 m0, s4, 49152
s_mov_b32 s57, 786432
s_mov_b32 s58, 786688
s_mov_b32 s59, 786560
s_mov_b32 s56, 786816
s_waitcnt vmcnt(12) lgkmcnt(0)
s_barrier
ds_read_b128 v[24:27], v23 offset:0
ds_read_b128 v[28:31], v23 offset:16
ds_read_b128 v[32:35], v23 offset:2304
buffer_load_dwordx4 v21, s[8:11], s57 offen lds
s_add_u32 m0, s4, 57344
s_mov_b32 s57, 1048576
ds_read_b128 v[36:39], v23 offset:2320
ds_read_b64_tr_b16 a[84:85], v0 offset:0
ds_read_b64_tr_b16 a[86:87], v0 offset:2048
s_mul_i32 s72, s7, 331776
ds_read_b64_tr_b16 a[88:89], v1 offset:0
ds_read_b64_tr_b16 a[90:91], v1 offset:2048
ds_read_b64_tr_b16 a[92:93], v2 offset:0
buffer_load_dwordx4 v21, s[8:11], s58 offen lds
s_add_u32 m0, s4, 53248
s_mov_b32 s58, 1048832
ds_read_b64_tr_b16 a[94:95], v2 offset:2048
ds_read_b64_tr_b16 a[96:97], v3 offset:0
ds_read_b64_tr_b16 a[98:99], v3 offset:2048
s_mul_i32 s73, s6, 576
ds_read_b64_tr_b16 a[100:101], v0 offset:8192
ds_read_b64_tr_b16 a[102:103], v0 offset:10240
ds_read_b64_tr_b16 a[104:105], v1 offset:8192
buffer_load_dwordx4 v21, s[8:11], s59 offen lds
s_add_u32 m0, s4, 61440
s_mov_b32 s59, 1048704
ds_read_b64_tr_b16 a[106:107], v1 offset:10240
ds_read_b64_tr_b16 a[108:109], v2 offset:8192
ds_read_b64_tr_b16 a[110:111], v2 offset:10240
s_add_u32 s73, s73, s72
ds_read_b64_tr_b16 a[112:113], v3 offset:8192
ds_read_b64_tr_b16 a[114:115], v3 offset:10240
ds_read_b64_tr_b16 a[116:117], v0 offset:4096
buffer_load_dwordx4 v21, s[8:11], s56 offen lds
s_add_u32 m0, s4, 65536
s_mov_b32 s56, 1048960
s_waitcnt lgkmcnt(15)
v_fma_mix_f32 v72, v80, v32, v24 op_sel:[0,0,0] op_sel_hi:[1,0,0]
v_fma_mix_f32 v73, v80, v33, v25 op_sel:[1,0,0] op_sel_hi:[1,0,0]
v_fma_mix_f32 v74, v81, v34, v26 op_sel:[0,0,0] op_sel_hi:[1,0,0]
s_mul_i32 s72, s7, 20736
v_fma_mix_f32 v75, v81, v35, v27 op_sel:[1,0,0] op_sel_hi:[1,0,0]
v_fma_mix_f32 v76, v82, v36, v28 op_sel:[0,0,0] op_sel_hi:[1,0,0]
v_fma_mix_f32 v77, v82, v37, v29 op_sel:[1,0,0] op_sel_hi:[1,0,0]
v_fma_mix_f32 v78, v83, v38, v30 op_sel:[0,0,0] op_sel_hi:[1,0,0]
s_mov_b32 s38, k1_end-k1_kernel-1024
v_cvt_pk_bf16_f32 v56, v72, v73
v_cvt_pk_bf16_f32 v57, v74, v75
v_cvt_pk_bf16_f32 v58, v76, v77
v_fma_mix_f32 v79, v83, v39, v31 op_sel:[1,0,0] op_sel_hi:[1,0,0]
buffer_load_dwordx4 v[80:83], v22, s[24:27], s43 offen offset:0
v_cvt_pk_bf16_f32 v59, v78, v79
v_fma_mix_f32 v72, v84, v32, v24 op_sel:[0,0,0] op_sel_hi:[1,0,0]
v_fma_mix_f32 v73, v84, v33, v25 op_sel:[1,0,0] op_sel_hi:[1,0,0]
v_fma_mix_f32 v74, v85, v34, v26 op_sel:[0,0,0] op_sel_hi:[1,0,0]
v_fma_mix_f32 v75, v85, v35, v27 op_sel:[1,0,0] op_sel_hi:[1,0,0]
v_fma_mix_f32 v76, v86, v36, v28 op_sel:[0,0,0] op_sel_hi:[1,0,0]
v_fma_mix_f32 v77, v86, v37, v29 op_sel:[1,0,0] op_sel_hi:[1,0,0]
v_mfma_f32_16x16x32_bf16 v[128:131], a[84:87], v[56:59], 0
v_fma_mix_f32 v78, v87, v38, v30 op_sel:[0,0,0] op_sel_hi:[1,0,0]
v_fma_mix_f32 v79, v87, v39, v31 op_sel:[1,0,0] op_sel_hi:[1,0,0]
buffer_load_dwordx4 v[84:87], v22, s[24:27], s43 offen offset:1024
v_cvt_pk_bf16_f32 v60, v72, v73
v_cvt_pk_bf16_f32 v61, v74, v75
v_cvt_pk_bf16_f32 v62, v76, v77
ds_read_b64_tr_b16 a[118:119], v0 offset:6144
ds_read_b64_tr_b16 a[120:121], v1 offset:4096
ds_read_b64_tr_b16 a[122:123], v1 offset:6144
v_cvt_pk_bf16_f32 v63, v78, v79
ds_read_b64_tr_b16 a[124:125], v2 offset:4096
ds_read_b64_tr_b16 a[126:127], v2 offset:6144
ds_read_b64_tr_b16 a[128:129], v3 offset:4096
ds_read_b64_tr_b16 a[130:131], v3 offset:6144
v_mfma_f32_16x16x32_bf16 v[132:135], a[84:87], v[60:63], 0
s_waitcnt lgkmcnt(15)
ds_read_b64_tr_b16 a[84:85], v0 offset:12288
ds_read_b64_tr_b16 a[86:87], v0 offset:14336
v_mfma_f32_16x16x32_bf16 v[140:143], a[88:91], v[60:63], 0
ds_read_b128 v[40:43], v23 offset:128
buffer_load_dwordx4 v[104:107], v22, s[24:27], s41 offen offset:2048
v_mfma_f32_16x16x32_bf16 v[136:139], a[88:91], v[56:59], 0
ds_read_b64_tr_b16 a[88:89], v1 offset:12288
ds_read_b64_tr_b16 a[90:91], v1 offset:14336
v_mfma_f32_16x16x32_bf16 v[144:147], a[92:95], v[56:59], 0
ds_read_b128 v[44:47], v23 offset:144
ds_read_b128 v[48:51], v23 offset:2432
v_mfma_f32_16x16x32_bf16 v[148:151], a[92:95], v[60:63], 0
ds_read_b64_tr_b16 a[92:93], v2 offset:12288
ds_read_b64_tr_b16 a[94:95], v2 offset:14336
v_mfma_f32_16x16x32_bf16 v[156:159], a[96:99], v[60:63], 0
ds_read_b128 v[52:55], v23 offset:2448
buffer_load_dwordx4 v[108:111], v22, s[24:27], s41 offen offset:3072
v_mfma_f32_16x16x32_bf16 v[152:155], a[96:99], v[56:59], 0
s_waitcnt lgkmcnt(15)
ds_read_b64_tr_b16 a[96:97], v3 offset:12288
ds_read_b64_tr_b16 a[98:99], v3 offset:14336
v_mfma_f32_16x16x32_bf16 v[192:195], a[100:103], v[56:59], 0
ds_read_b128 v[24:27], v23 offset:256
ds_read_b128 v[28:31], v23 offset:272
v_mfma_f32_16x16x32_bf16 v[196:199], a[100:103], v[60:63], 0
ds_read_b128 v[32:35], v23 offset:2560
ds_read_b128 v[36:39], v23 offset:2576
v_mfma_f32_16x16x32_bf16 v[204:207], a[104:107], v[60:63], 0
buffer_load_dwordx4 v[112:115], v22, s[24:27], s42 offen offset:0
v_mfma_f32_16x16x32_bf16 v[200:203], a[104:107], v[56:59], 0
s_waitcnt vmcnt(20) lgkmcnt(9)
v_fma_mix_f32 v72, v88, v48, v40 op_sel:[0,0,0] op_sel_hi:[1,0,0]
v_fma_mix_f32 v73, v88, v49, v41 op_sel:[1,0,0] op_sel_hi:[1,0,0]
v_mfma_f32_16x16x32_bf16 v[208:211], a[108:111], v[56:59], 0
v_fma_mix_f32 v74, v89, v50, v42 op_sel:[0,0,0] op_sel_hi:[1,0,0]
v_mfma_f32_16x16x32_bf16 v[212:215], a[108:111], v[60:63], 0
s_waitcnt lgkmcnt(6)
v_fma_mix_f32 v75, v89, v51, v43 op_sel:[1,0,0] op_sel_hi:[1,0,0]
v_fma_mix_f32 v76, v90, v52, v44 op_sel:[0,0,0] op_sel_hi:[1,0,0]
v_mfma_f32_16x16x32_bf16 v[220:223], a[112:115], v[60:63], 0
buffer_load_dwordx4 v[116:119], v22, s[24:27], s42 offen offset:1024
v_fma_mix_f32 v77, v90, v53, v45 op_sel:[1,0,0] op_sel_hi:[1,0,0]
v_mfma_f32_16x16x32_bf16 v[216:219], a[112:115], v[56:59], 0
v_fma_mix_f32 v78, v91, v54, v46 op_sel:[0,0,0] op_sel_hi:[1,0,0]
v_fma_mix_f32 v79, v91, v55, v47 op_sel:[1,0,0] op_sel_hi:[1,0,0]
v_mfma_f32_16x16x32_bf16 v[160:163], a[116:119], v[56:59], 0
s_waitcnt vmcnt(16)
s_barrier
ds_read_b64_tr_b16 a[100:101], v0 offset:16384
v_cvt_pk_bf16_f32 v64, v72, v73
v_mfma_f32_16x16x32_bf16 v[164:167], a[116:119], v[60:63], 0
v_cvt_pk_bf16_f32 v65, v74, v75
v_cvt_pk_bf16_f32 v66, v76, v77
v_mfma_f32_16x16x32_bf16 v[172:175], a[120:123], v[60:63], 0
buffer_load_dwordx4 v[120:123], v22, s[24:27], s42 offen offset:2048
v_cvt_pk_bf16_f32 v67, v78, v79
v_mfma_f32_16x16x32_bf16 v[168:171], a[120:123], v[56:59], 0
v_fma_mix_f32 v72, v92, v48, v40 op_sel:[0,0,0] op_sel_hi:[1,0,0]
v_fma_mix_f32 v73, v92, v49, v41 op_sel:[1,0,0] op_sel_hi:[1,0,0]
v_mfma_f32_16x16x32_bf16 v[176:179], a[124:127], v[56:59], 0
ds_read_b64_tr_b16 a[102:103], v0 offset:18432
v_fma_mix_f32 v74, v93, v50, v42 op_sel:[0,0,0] op_sel_hi:[1,0,0]
v_mfma_f32_16x16x32_bf16 v[180:183], a[124:127], v[60:63], 0
v_fma_mix_f32 v75, v93, v51, v43 op_sel:[1,0,0] op_sel_hi:[1,0,0]
v_fma_mix_f32 v76, v94, v52, v44 op_sel:[0,0,0] op_sel_hi:[1,0,0]
v_mfma_f32_16x16x32_bf16 v[188:191], a[128:131], v[60:63], 0
buffer_load_dwordx4 v[124:127], v22, s[24:27], s42 offen offset:3072
v_fma_mix_f32 v77, v94, v53, v45 op_sel:[1,0,0] op_sel_hi:[1,0,0]
v_mfma_f32_16x16x32_bf16 v[184:187], a[128:131], v[56:59], 0
ds_read_b64_tr_b16 a[104:105], v1 offset:16384
ds_read_b64_tr_b16 a[106:107], v1 offset:18432
v_mfma_f32_16x16x32_bf16 v[224:227], a[84:87], v[56:59], 0
v_fma_mix_f32 v78, v95, v54, v46 op_sel:[0,0,0] op_sel_hi:[1,0,0]
v_fma_mix_f32 v79, v95, v55, v47 op_sel:[1,0,0] op_sel_hi:[1,0,0]
v_mfma_f32_16x16x32_bf16 v[228:231], a[84:87], v[60:63], 0
ds_read_b64_tr_b16 a[108:109], v2 offset:16384
ds_read_b64_tr_b16 a[110:111], v2 offset:18432
v_mfma_f32_16x16x32_bf16 v[236:239], a[88:91], v[60:63], 0
ds_read_b64_tr_b16 a[112:113], v3 offset:16384
buffer_load_dwordx4 v21, s[8:11], s57 offen lds
v_mfma_f32_16x16x32_bf16 v[232:235], a[88:91], v[56:59], 0
s_add_u32 m0, s4, 73728
s_mov_b32 s57, 1310720
ds_read_b64_tr_b16 a[114:115], v3 offset:18432
v_mfma_f32_16x16x32_bf16 v[240:243], a[92:95], v[56:59], 0
v_cvt_pk_bf16_f32 v68, v72, v73
v_cvt_pk_bf16_f32 v69, v74, v75
v_mfma_f32_16x16x32_bf16 v[244:247], a[92:95], v[60:63], 0
s_waitcnt lgkmcnt(6)
v_cvt_pk_bf16_f32 v70, v76, v77
v_cvt_pk_bf16_f32 v71, v78, v79
v_mfma_f32_16x16x32_bf16 v[252:255], a[96:99], v[60:63], 0
ds_read_b64_tr_b16 a[116:117], v0 offset:24576
buffer_load_dwordx4 v21, s[8:11], s58 offen lds
v_mfma_f32_16x16x32_bf16 v[248:251], a[96:99], v[56:59], 0
s_add_u32 m0, s4, 69632
s_mov_b32 s58, 1310976
ds_read_b64_tr_b16 a[118:119], v0 offset:26624
v_mfma_f32_16x16x32_bf16 v[128:131], a[100:103], v[64:67], v[128:131]
ds_read_b64_tr_b16 a[120:121], v1 offset:24576
ds_read_b64_tr_b16 a[122:123], v1 offset:26624
v_mfma_f32_16x16x32_bf16 v[132:135], a[100:103], v[68:71], v[132:135]
s_waitcnt lgkmcnt(8)
ds_read_b64_tr_b16 a[124:125], v2 offset:24576
ds_read_b64_tr_b16 a[126:127], v2 offset:26624
v_mfma_f32_16x16x32_bf16 v[140:143], a[104:107], v[68:71], v[140:143]
s_waitcnt vmcnt(19)
buffer_load_dwordx4 v21, s[8:11], s59 offen lds
v_fma_mix_f32 v72, v96, v32, v24 op_sel:[0,0,0] op_sel_hi:[1,0,0]
v_mfma_f32_16x16x32_bf16 v[136:139], a[104:107], v[64:67], v[136:139]
s_waitcnt lgkmcnt(7)
s_add_u32 m0, s4, 77824
s_mov_b32 s59, 1310848
ds_read_b64_tr_b16 a[128:129], v3 offset:24576
v_mfma_f32_16x16x32_bf16 v[144:147], a[108:111], v[64:67], v[144:147]
ds_read_b64_tr_b16 a[130:131], v3 offset:26624
v_fma_mix_f32 v73, v96, v33, v25 op_sel:[1,0,0] op_sel_hi:[1,0,0]
v_mfma_f32_16x16x32_bf16 v[148:151], a[108:111], v[68:71], v[148:151]
s_waitcnt lgkmcnt(8)
ds_read_b64_tr_b16 a[84:85], v0 offset:20480
ds_read_b64_tr_b16 a[86:87], v0 offset:22528
v_mfma_f32_16x16x32_bf16 v[156:159], a[112:115], v[68:71], v[156:159]
ds_read_b64_tr_b16 a[88:89], v1 offset:20480
buffer_load_dwordx4 v21, s[8:11], s56 offen lds
v_mfma_f32_16x16x32_bf16 v[152:155], a[112:115], v[64:67], v[152:155]
s_waitcnt lgkmcnt(9)
s_add_u32 m0, s4, 81920
s_mov_b32 s56, 1311104
ds_read_b64_tr_b16 a[90:91], v1 offset:22528
v_mfma_f32_16x16x32_bf16 v[192:195], a[116:119], v[64:67], v[192:195]
ds_read_b64_tr_b16 a[92:93], v2 offset:20480
v_fma_mix_f32 v74, v97, v34, v26 op_sel:[0,0,0] op_sel_hi:[1,0,0]
v_mfma_f32_16x16x32_bf16 v[196:199], a[116:119], v[68:71], v[196:199]
s_waitcnt lgkmcnt(9)
ds_read_b64_tr_b16 a[94:95], v2 offset:22528
v_fma_mix_f32 v75, v97, v35, v27 op_sel:[1,0,0] op_sel_hi:[1,0,0]
v_mfma_f32_16x16x32_bf16 v[204:207], a[120:123], v[68:71], v[204:207]
ds_read_b64_tr_b16 a[96:97], v3 offset:20480
buffer_load_dwordx4 v21, s[8:11], s57 offen lds
v_mfma_f32_16x16x32_bf16 v[200:203], a[120:123], v[64:67], v[200:203]
s_waitcnt lgkmcnt(9)
s_add_u32 m0, s4, 90112
s_mov_b32 s57, 1572864
ds_read_b64_tr_b16 a[98:99], v3 offset:22528
v_mfma_f32_16x16x32_bf16 v[208:211], a[124:127], v[64:67], v[208:211]
ds_read_b64_tr_b16 a[100:101], v0 offset:28672
v_fma_mix_f32 v76, v98, v36, v28 op_sel:[0,0,0] op_sel_hi:[1,0,0]
v_mfma_f32_16x16x32_bf16 v[212:215], a[124:127], v[68:71], v[212:215]
s_waitcnt lgkmcnt(9)
ds_read_b64_tr_b16 a[102:103], v0 offset:30720
v_fma_mix_f32 v77, v98, v37, v29 op_sel:[1,0,0] op_sel_hi:[1,0,0]
v_mfma_f32_16x16x32_bf16 v[220:223], a[128:131], v[68:71], v[220:223]
ds_read_b64_tr_b16 a[104:105], v1 offset:28672
buffer_load_dwordx4 v21, s[8:11], s58 offen lds
v_mfma_f32_16x16x32_bf16 v[216:219], a[128:131], v[64:67], v[216:219]
s_waitcnt lgkmcnt(8)
s_add_u32 m0, s4, 86016
s_mov_b32 s58, 1573120
ds_read_b64_tr_b16 a[106:107], v1 offset:30720
v_mfma_f32_16x16x32_bf16 v[160:163], a[84:87], v[64:67], v[160:163]
s_waitcnt vmcnt(18)
s_barrier
ds_read_b64_tr_b16 a[108:109], v2 offset:28672
v_fma_mix_f32 v78, v99, v38, v30 op_sel:[0,0,0] op_sel_hi:[1,0,0]
v_mfma_f32_16x16x32_bf16 v[164:167], a[84:87], v[68:71], v[164:167]
s_waitcnt lgkmcnt(8)
ds_read_b64_tr_b16 a[110:111], v2 offset:30720
v_fma_mix_f32 v79, v99, v39, v31 op_sel:[1,0,0] op_sel_hi:[1,0,0]
v_mfma_f32_16x16x32_bf16 v[172:175], a[88:91], v[68:71], v[172:175]
ds_read_b64_tr_b16 a[112:113], v3 offset:28672
buffer_load_dwordx4 v21, s[8:11], s59 offen lds
v_mfma_f32_16x16x32_bf16 v[168:171], a[88:91], v[64:67], v[168:171]
s_waitcnt lgkmcnt(8)
s_add_u32 m0, s4, 94208
s_mov_b32 s59, 1572992
ds_read_b64_tr_b16 a[114:115], v3 offset:30720
v_mfma_f32_16x16x32_bf16 v[176:179], a[92:95], v[64:67], v[176:179]
ds_read_b64_tr_b16 a[116:117], v0 offset:32768
v_cvt_pk_bf16_f32 v56, v72, v73
v_mfma_f32_16x16x32_bf16 v[180:183], a[92:95], v[68:71], v[180:183]
s_waitcnt lgkmcnt(8)
ds_read_b64_tr_b16 a[118:119], v0 offset:34816
v_cvt_pk_bf16_f32 v57, v74, v75
v_mfma_f32_16x16x32_bf16 v[188:191], a[96:99], v[68:71], v[188:191]
ds_read_b64_tr_b16 a[120:121], v1 offset:32768
buffer_load_dwordx4 v21, s[8:11], s56 offen lds
v_mfma_f32_16x16x32_bf16 v[184:187], a[96:99], v[64:67], v[184:187]
s_waitcnt lgkmcnt(8)
s_add_u32 m0, s4, 98304
s_mov_b32 s56, 1573248
ds_read_b64_tr_b16 a[122:123], v1 offset:34816
v_mfma_f32_16x16x32_bf16 v[224:227], a[100:103], v[64:67], v[224:227]
ds_read_b64_tr_b16 a[124:125], v2 offset:32768
v_cvt_pk_bf16_f32 v58, v76, v77
v_mfma_f32_16x16x32_bf16 v[228:231], a[100:103], v[68:71], v[228:231]
s_waitcnt lgkmcnt(8)
ds_read_b64_tr_b16 a[126:127], v2 offset:34816
v_cvt_pk_bf16_f32 v59, v78, v79
v_mfma_f32_16x16x32_bf16 v[236:239], a[104:107], v[68:71], v[236:239]
ds_read_b64_tr_b16 a[128:129], v3 offset:32768
buffer_load_dwordx4 v[88:91], v22, s[24:27], s43 offen offset:2048
v_mfma_f32_16x16x32_bf16 v[232:235], a[104:107], v[64:67], v[232:235]
s_waitcnt lgkmcnt(8)
ds_read_b64_tr_b16 a[130:131], v3 offset:34816
v_fma_mix_f32 v72, v100, v32, v24 op_sel:[0,0,0] op_sel_hi:[1,0,0]
v_mfma_f32_16x16x32_bf16 v[240:243], a[108:111], v[64:67], v[240:243]
v_fma_mix_f32 v73, v100, v33, v25 op_sel:[1,0,0] op_sel_hi:[1,0,0]
v_fma_mix_f32 v74, v101, v34, v26 op_sel:[0,0,0] op_sel_hi:[1,0,0]
v_mfma_f32_16x16x32_bf16 v[244:247], a[108:111], v[68:71], v[244:247]
s_waitcnt lgkmcnt(7)
v_fma_mix_f32 v75, v101, v35, v27 op_sel:[1,0,0] op_sel_hi:[1,0,0]
v_fma_mix_f32 v76, v102, v36, v28 op_sel:[0,0,0] op_sel_hi:[1,0,0]
v_mfma_f32_16x16x32_bf16 v[252:255], a[112:115], v[68:71], v[252:255]
buffer_load_dwordx4 v[92:95], v22, s[24:27], s43 offen offset:3072
v_fma_mix_f32 v77, v102, v37, v29 op_sel:[1,0,0] op_sel_hi:[1,0,0]
v_mfma_f32_16x16x32_bf16 v[248:251], a[112:115], v[64:67], v[248:251]
s_waitcnt lgkmcnt(5)
v_fma_mix_f32 v78, v103, v38, v30 op_sel:[0,0,0] op_sel_hi:[1,0,0]
v_fma_mix_f32 v79, v103, v39, v31 op_sel:[1,0,0] op_sel_hi:[1,0,0]
v_mfma_f32_16x16x32_bf16 v[128:131], a[116:119], v[56:59], v[128:131]
v_cvt_pk_bf16_f32 v60, v72, v73
v_cvt_pk_bf16_f32 v61, v74, v75
buffer_load_dwordx4 v21, s[8:11], s57 offen lds
buffer_load_dwordx4 v[96:99], v22, s[24:27], s44 offen offset:0
buffer_load_dwordx4 v[100:103], v22, s[24:27], s44 offen offset:1024
v_cvt_pk_bf16_f32 v62, v76, v77
s_add_u32 m0, s4, 106496
s_mov_b32 s57, 1835008
ds_read_b64_tr_b16 a[84:85], v0 offset:40960
ds_read_b64_tr_b16 a[86:87], v0 offset:43008
v_cvt_pk_bf16_f32 v63, v78, v79
ds_read_b64_tr_b16 a[88:89], v1 offset:40960
ds_read_b64_tr_b16 a[90:91], v1 offset:43008
ds_read_b64_tr_b16 a[92:93], v2 offset:40960
buffer_load_dwordx4 v21, s[8:11], s58 offen lds
v_mfma_f32_16x16x32_bf16 v[132:135], a[116:119], v[60:63], v[132:135]
s_waitcnt lgkmcnt(8)
s_add_u32 m0, s4, 102400
s_mov_b32 s58, 1835264
ds_read_b64_tr_b16 a[94:95], v2 offset:43008
v_mfma_f32_16x16x32_bf16 v[140:143], a[120:123], v[60:63], v[140:143]
ds_read_b64_tr_b16 a[96:97], v3 offset:40960
ds_read_b64_tr_b16 a[98:99], v3 offset:43008
v_mfma_f32_16x16x32_bf16 v[136:139], a[120:123], v[56:59], v[136:139]
s_waitcnt lgkmcnt(9)
ds_read_b64_tr_b16 a[100:101], v0 offset:36864
ds_read_b64_tr_b16 a[102:103], v0 offset:38912
v_mfma_f32_16x16x32_bf16 v[144:147], a[124:127], v[56:59], v[144:147]
ds_read_b64_tr_b16 a[104:105], v1 offset:36864
buffer_load_dwordx4 v21, s[8:11], s59 offen lds
v_mfma_f32_16x16x32_bf16 v[148:151], a[124:127], v[60:63], v[148:151]
s_waitcnt lgkmcnt(11)
s_add_u32 m0, s4, 110592
s_mov_b32 s59, 1835136
ds_read_b64_tr_b16 a[106:107], v1 offset:38912
v_mfma_f32_16x16x32_bf16 v[156:159], a[128:131], v[60:63], v[156:159]
ds_read_b64_tr_b16 a[108:109], v2 offset:36864
ds_read_b64_tr_b16 a[110:111], v2 offset:38912
v_mfma_f32_16x16x32_bf16 v[152:155], a[128:131], v[56:59], v[152:155]
s_waitcnt lgkmcnt(12)
ds_read_b64_tr_b16 a[112:113], v3 offset:36864
ds_read_b64_tr_b16 a[114:115], v3 offset:38912
v_mfma_f32_16x16x32_bf16 v[192:195], a[84:87], v[56:59], v[192:195]
ds_read_b64_tr_b16 a[116:117], v0 offset:45056
buffer_load_dwordx4 v21, s[8:11], s56 offen lds
v_mfma_f32_16x16x32_bf16 v[196:199], a[84:87], v[60:63], v[196:199]
s_waitcnt lgkmcnt(12)
s_add_u32 m0, s4, 114688
s_mov_b32 s56, 1835392
ds_read_b64_tr_b16 a[118:119], v0 offset:47104
v_mfma_f32_16x16x32_bf16 v[204:207], a[88:91], v[60:63], v[204:207]
ds_read_b64_tr_b16 a[120:121], v1 offset:45056
ds_read_b64_tr_b16 a[122:123], v1 offset:47104
v_mfma_f32_16x16x32_bf16 v[200:203], a[88:91], v[56:59], v[200:203]
s_waitcnt lgkmcnt(12)
ds_read_b64_tr_b16 a[124:125], v2 offset:45056
ds_read_b64_tr_b16 a[126:127], v2 offset:47104
v_mfma_f32_16x16x32_bf16 v[208:211], a[92:95], v[56:59], v[208:211]
ds_read_b64_tr_b16 a[128:129], v3 offset:45056
ds_read_b64_tr_b16 a[130:131], v3 offset:47104
v_mfma_f32_16x16x32_bf16 v[212:215], a[92:95], v[60:63], v[212:215]
ds_read_b128 v[40:43], v23 offset:384
ds_read_b128 v[44:47], v23 offset:400
v_mfma_f32_16x16x32_bf16 v[220:223], a[96:99], v[60:63], v[220:223]
ds_read_b128 v[48:51], v23 offset:2688
ds_read_b128 v[52:55], v23 offset:2704
v_mfma_f32_16x16x32_bf16 v[216:219], a[96:99], v[56:59], v[216:219]
s_waitcnt lgkmcnt(14)
ds_read_b128 v[24:27], v23 offset:512
ds_read_b128 v[28:31], v23 offset:528
v_mfma_f32_16x16x32_bf16 v[160:163], a[100:103], v[56:59], v[160:163]
s_waitcnt vmcnt(24)
s_barrier
ds_read_b64_tr_b16 a[84:85], v0 offset:49152
ds_read_b64_tr_b16 a[86:87], v0 offset:51200
v_mfma_f32_16x16x32_bf16 v[164:167], a[100:103], v[60:63], v[164:167]
ds_read_b64_tr_b16 a[88:89], v1 offset:49152
ds_read_b64_tr_b16 a[90:91], v1 offset:51200
v_mfma_f32_16x16x32_bf16 v[172:175], a[104:107], v[60:63], v[172:175]
ds_read_b64_tr_b16 a[92:93], v2 offset:49152
ds_read_b64_tr_b16 a[94:95], v2 offset:51200
v_mfma_f32_16x16x32_bf16 v[168:171], a[104:107], v[56:59], v[168:171]
ds_read_b64_tr_b16 a[96:97], v3 offset:49152
ds_read_b64_tr_b16 a[98:99], v3 offset:51200
v_mfma_f32_16x16x32_bf16 v[176:179], a[108:111], v[56:59], v[176:179]
ds_read_b64_tr_b16 a[100:101], v0 offset:57344
ds_read_b64_tr_b16 a[102:103], v0 offset:59392
v_mfma_f32_16x16x32_bf16 v[180:183], a[108:111], v[60:63], v[180:183]
s_waitcnt vmcnt(21) lgkmcnt(13)
v_fma_mix_f32 v72, v104, v48, v40 op_sel:[0,0,0] op_sel_hi:[1,0,0]
v_fma_mix_f32 v73, v104, v49, v41 op_sel:[1,0,0] op_sel_hi:[1,0,0]
v_mfma_f32_16x16x32_bf16 v[188:191], a[112:115], v[60:63], v[188:191]
ds_read_b64_tr_b16 a[104:105], v1 offset:57344
v_fma_mix_f32 v74, v105, v50, v42 op_sel:[0,0,0] op_sel_hi:[1,0,0]
v_mfma_f32_16x16x32_bf16 v[184:187], a[112:115], v[56:59], v[184:187]
s_waitcnt lgkmcnt(13)
v_fma_mix_f32 v75, v105, v51, v43 op_sel:[1,0,0] op_sel_hi:[1,0,0]
v_fma_mix_f32 v76, v106, v52, v44 op_sel:[0,0,0] op_sel_hi:[1,0,0]
v_mfma_f32_16x16x32_bf16 v[224:227], a[116:119], v[56:59], v[224:227]
ds_read_b64_tr_b16 a[106:107], v1 offset:59392
v_fma_mix_f32 v77, v106, v53, v45 op_sel:[1,0,0] op_sel_hi:[1,0,0]
v_mfma_f32_16x16x32_bf16 v[228:231], a[116:119], v[60:63], v[228:231]
v_fma_mix_f32 v78, v107, v54, v46 op_sel:[0,0,0] op_sel_hi:[1,0,0]
v_fma_mix_f32 v79, v107, v55, v47 op_sel:[1,0,0] op_sel_hi:[1,0,0]
v_mfma_f32_16x16x32_bf16 v[236:239], a[120:123], v[60:63], v[236:239]
buffer_load_dwordx4 v[104:107], v22, s[24:27], s44 offen offset:2048
v_cvt_pk_bf16_f32 v64, v72, v73
v_mfma_f32_16x16x32_bf16 v[232:235], a[120:123], v[56:59], v[232:235]
v_cvt_pk_bf16_f32 v65, v74, v75
v_cvt_pk_bf16_f32 v66, v76, v77
v_mfma_f32_16x16x32_bf16 v[240:243], a[124:127], v[56:59], v[240:243]
s_waitcnt vmcnt(21)
v_cvt_pk_bf16_f32 v67, v78, v79
v_fma_mix_f32 v72, v108, v48, v40 op_sel:[0,0,0] op_sel_hi:[1,0,0]
v_mfma_f32_16x16x32_bf16 v[244:247], a[124:127], v[60:63], v[244:247]
v_fma_mix_f32 v73, v108, v49, v41 op_sel:[1,0,0] op_sel_hi:[1,0,0]
v_fma_mix_f32 v74, v109, v50, v42 op_sel:[0,0,0] op_sel_hi:[1,0,0]
v_mfma_f32_16x16x32_bf16 v[252:255], a[128:131], v[60:63], v[252:255]
v_fma_mix_f32 v75, v109, v51, v43 op_sel:[1,0,0] op_sel_hi:[1,0,0]
v_fma_mix_f32 v76, v110, v52, v44 op_sel:[0,0,0] op_sel_hi:[1,0,0]
v_mfma_f32_16x16x32_bf16 v[248:251], a[128:131], v[56:59], v[248:251]
s_waitcnt lgkmcnt(1)
buffer_load_dwordx4 v21, s[8:11], s57 offen lds
v_fma_mix_f32 v77, v110, v53, v45 op_sel:[1,0,0] op_sel_hi:[1,0,0]
v_mfma_f32_16x16x32_bf16 v[128:131], a[84:87], v[64:67], v[128:131]
s_add_u32 m0, s4, 122880
s_mov_b32 s57, 2097152
v_fma_mix_f32 v78, v111, v54, v46 op_sel:[0,0,0] op_sel_hi:[1,0,0]
buffer_load_dwordx4 v21, s[8:11], s58 offen lds
v_cvt_pk_bf16_f32 v68, v72, v73
v_cvt_pk_bf16_f32 v69, v74, v75
v_fma_mix_f32 v79, v111, v55, v47 op_sel:[1,0,0] op_sel_hi:[1,0,0]
s_add_u32 m0, s4, 118784
s_mov_b32 s58, 2097408
buffer_load_dwordx4 v[108:111], v22, s[24:27], s44 offen offset:3072
v_cvt_pk_bf16_f32 v70, v76, v77
v_cvt_pk_bf16_f32 v71, v78, v79
ds_read_b64_tr_b16 a[108:109], v2 offset:57344
ds_read_b64_tr_b16 a[110:111], v2 offset:59392
ds_read_b64_tr_b16 a[112:113], v3 offset:57344
buffer_load_dwordx4 v21, s[8:11], s59 offen lds
v_mfma_f32_16x16x32_bf16 v[132:135], a[84:87], v[68:71], v[132:135]
s_add_u32 m0, s4, 126976
s_mov_b32 s59, 2097280
ds_read_b64_tr_b16 a[114:115], v3 offset:59392
v_mfma_f32_16x16x32_bf16 v[140:143], a[88:91], v[68:71], v[140:143]
ds_read_b64_tr_b16 a[116:117], v0 offset:53248
ds_read_b64_tr_b16 a[118:119], v0 offset:55296
v_mfma_f32_16x16x32_bf16 v[136:139], a[88:91], v[64:67], v[136:139]
ds_read_b64_tr_b16 a[120:121], v1 offset:53248
ds_read_b64_tr_b16 a[122:123], v1 offset:55296
v_mfma_f32_16x16x32_bf16 v[144:147], a[92:95], v[64:67], v[144:147]
ds_read_b64_tr_b16 a[124:125], v2 offset:53248
buffer_load_dwordx4 v21, s[8:11], s56 offen lds
v_mfma_f32_16x16x32_bf16 v[148:151], a[92:95], v[68:71], v[148:151]
s_add_u32 m0, s4, 0
s_mov_b32 s56, 2097536
ds_read_b64_tr_b16 a[126:127], v2 offset:55296
v_mfma_f32_16x16x32_bf16 v[156:159], a[96:99], v[68:71], v[156:159]
ds_read_b64_tr_b16 a[128:129], v3 offset:53248
ds_read_b64_tr_b16 a[130:131], v3 offset:55296
v_mfma_f32_16x16x32_bf16 v[152:155], a[96:99], v[64:67], v[152:155]
ds_read_b64_tr_b16 a[84:85], v0 offset:61440
ds_read_b64_tr_b16 a[86:87], v0 offset:63488
v_mfma_f32_16x16x32_bf16 v[192:195], a[100:103], v[64:67], v[192:195]
ds_read_b64_tr_b16 a[88:89], v1 offset:61440
ds_read_b64_tr_b16 a[90:91], v1 offset:63488
v_mfma_f32_16x16x32_bf16 v[196:199], a[100:103], v[68:71], v[196:199]
s_waitcnt lgkmcnt(13)
ds_read_b64_tr_b16 a[92:93], v2 offset:61440
ds_read_b64_tr_b16 a[94:95], v2 offset:63488
v_mfma_f32_16x16x32_bf16 v[204:207], a[104:107], v[68:71], v[204:207]
ds_read_b64_tr_b16 a[96:97], v3 offset:61440
ds_read_b64_tr_b16 a[98:99], v3 offset:63488
v_mfma_f32_16x16x32_bf16 v[200:203], a[104:107], v[64:67], v[200:203]
ds_read_b128 v[32:35], v23 offset:2816
buffer_load_dwordx4 v21, s[8:11], s57 offen lds
v_mfma_f32_16x16x32_bf16 v[208:211], a[108:111], v[64:67], v[208:211]
s_add_u32 m0, s4, 8192
s_mov_b32 s57, 2359296
ds_read_b128 v[36:39], v23 offset:2832
v_mfma_f32_16x16x32_bf16 v[212:215], a[108:111], v[68:71], v[212:215]
s_waitcnt lgkmcnt(13)
ds_read_b128 v[40:43], v23 offset:640
ds_read_b128 v[44:47], v23 offset:656
v_mfma_f32_16x16x32_bf16 v[220:223], a[112:115], v[68:71], v[220:223]
ds_read_b128 v[48:51], v23 offset:2944
ds_read_b128 v[52:55], v23 offset:2960
v_mfma_f32_16x16x32_bf16 v[216:219], a[112:115], v[64:67], v[216:219]
buffer_load_dwordx4 v21, s[8:11], s58 offen lds
v_mfma_f32_16x16x32_bf16 v[160:163], a[116:119], v[64:67], v[160:163]
s_add_u32 m0, s4, 4096
s_mov_b32 s58, 2359552
v_mfma_f32_16x16x32_bf16 v[164:167], a[116:119], v[68:71], v[164:167]
v_mfma_f32_16x16x32_bf16 v[172:175], a[120:123], v[68:71], v[172:175]
s_waitcnt vmcnt(27) lgkmcnt(5)
v_fma_mix_f32 v72, v112, v32, v24 op_sel:[0,0,0] op_sel_hi:[1,0,0]
v_fma_mix_f32 v73, v112, v33, v25 op_sel:[1,0,0] op_sel_hi:[1,0,0]
v_mfma_f32_16x16x32_bf16 v[168:171], a[120:123], v[64:67], v[168:171]
buffer_load_dwordx4 v21, s[8:11], s59 offen lds
v_fma_mix_f32 v74, v113, v34, v26 op_sel:[0,0,0] op_sel_hi:[1,0,0]
v_mfma_f32_16x16x32_bf16 v[176:179], a[124:127], v[64:67], v[176:179]
s_add_u32 m0, s4, 12288
s_mov_b32 s59, 2359424
v_fma_mix_f32 v75, v113, v35, v27 op_sel:[1,0,0] op_sel_hi:[1,0,0]
v_mfma_f32_16x16x32_bf16 v[180:183], a[124:127], v[68:71], v[180:183]
s_waitcnt lgkmcnt(4)
v_fma_mix_f32 v76, v114, v36, v28 op_sel:[0,0,0] op_sel_hi:[1,0,0]
v_fma_mix_f32 v77, v114, v37, v29 op_sel:[1,0,0] op_sel_hi:[1,0,0]
v_mfma_f32_16x16x32_bf16 v[188:191], a[128:131], v[68:71], v[188:191]
v_fma_mix_f32 v78, v115, v38, v30 op_sel:[0,0,0] op_sel_hi:[1,0,0]
v_mfma_f32_16x16x32_bf16 v[184:187], a[128:131], v[64:67], v[184:187]
buffer_load_dwordx4 v21, s[8:11], s56 offen lds
v_fma_mix_f32 v79, v115, v39, v31 op_sel:[1,0,0] op_sel_hi:[1,0,0]
v_mfma_f32_16x16x32_bf16 v[224:227], a[84:87], v[64:67], v[224:227]
s_waitcnt vmcnt(18)
s_barrier
s_add_u32 m0, s4, 16384
s_mov_b32 s56, 2359680
v_mfma_f32_16x16x32_bf16 v[228:231], a[84:87], v[68:71], v[228:231]
ds_read_b64_tr_b16 a[100:101], v4 offset:0
ds_read_b64_tr_b16 a[102:103], v4 offset:2048
v_mfma_f32_16x16x32_bf16 v[236:239], a[88:91], v[68:71], v[236:239]
ds_read_b64_tr_b16 a[104:105], v5 offset:0
ds_read_b64_tr_b16 a[106:107], v5 offset:2048
v_mfma_f32_16x16x32_bf16 v[232:235], a[88:91], v[64:67], v[232:235]
ds_read_b64_tr_b16 a[108:109], v6 offset:0
buffer_load_dwordx4 v[112:115], v22, s[24:27], s45 offen offset:0
v_mfma_f32_16x16x32_bf16 v[240:243], a[92:95], v[64:67], v[240:243]
ds_read_b64_tr_b16 a[110:111], v6 offset:2048
v_cvt_pk_bf16_f32 v56, v72, v73
v_mfma_f32_16x16x32_bf16 v[244:247], a[92:95], v[68:71], v[244:247]
v_cvt_pk_bf16_f32 v57, v74, v75
v_cvt_pk_bf16_f32 v58, v76, v77
v_mfma_f32_16x16x32_bf16 v[252:255], a[96:99], v[68:71], v[252:255]
ds_read_b64_tr_b16 a[112:113], v7 offset:0
v_cvt_pk_bf16_f32 v59, v78, v79
v_mfma_f32_16x16x32_bf16 v[248:251], a[96:99], v[64:67], v[248:251]
ds_read_b64_tr_b16 a[114:115], v7 offset:2048
buffer_load_dwordx4 v21, s[8:11], s57 offen lds
s_add_u32 m0, s4, 24576
s_mov_b32 s57, 2621440
v_fma_mix_f32 v72, v116, v32, v24 op_sel:[0,0,0] op_sel_hi:[1,0,0]
v_fma_mix_f32 v73, v116, v33, v25 op_sel:[1,0,0] op_sel_hi:[1,0,0]
v_fma_mix_f32 v74, v117, v34, v26 op_sel:[0,0,0] op_sel_hi:[1,0,0]
s_waitcnt lgkmcnt(6)
v_mfma_f32_16x16x32_bf16 v[128:131], a[100:103], v[56:59], v[128:131]
v_fma_mix_f32 v75, v117, v35, v27 op_sel:[1,0,0] op_sel_hi:[1,0,0]
v_fma_mix_f32 v76, v118, v36, v28 op_sel:[0,0,0] op_sel_hi:[1,0,0]
buffer_load_dwordx4 v21, s[8:11], s58 offen lds
v_fma_mix_f32 v77, v118, v37, v29 op_sel:[1,0,0] op_sel_hi:[1,0,0]
v_fma_mix_f32 v78, v119, v38, v30 op_sel:[0,0,0] op_sel_hi:[1,0,0]
v_fma_mix_f32 v79, v119, v39, v31 op_sel:[1,0,0] op_sel_hi:[1,0,0]
s_add_u32 m0, s4, 20480
s_mov_b32 s58, 2621696
buffer_load_dwordx4 v[116:119], v22, s[24:27], s45 offen offset:1024
v_cvt_pk_bf16_f32 v60, v72, v73
v_cvt_pk_bf16_f32 v61, v74, v75
ds_read_b64_tr_b16 a[116:117], v4 offset:8192
buffer_load_dwordx4 v21, s[8:11], s59 offen lds
v_cvt_pk_bf16_f32 v62, v76, v77
v_cvt_pk_bf16_f32 v63, v78, v79
s_add_u32 m0, s4, 28672
s_mov_b32 s59, 2621568
ds_read_b64_tr_b16 a[118:119], v4 offset:10240
ds_read_b64_tr_b16 a[120:121], v5 offset:8192
ds_read_b64_tr_b16 a[122:123], v5 offset:10240
v_mfma_f32_16x16x32_bf16 v[132:135], a[100:103], v[60:63], v[132:135]
s_waitcnt lgkmcnt(8)
ds_read_b64_tr_b16 a[124:125], v6 offset:8192
ds_read_b64_tr_b16 a[126:127], v6 offset:10240
v_mfma_f32_16x16x32_bf16 v[140:143], a[104:107], v[60:63], v[140:143]
v_fma_mix_f32 v72, v120, v48, v40 op_sel:[0,0,0] op_sel_hi:[1,0,0]
v_fma_mix_f32 v73, v120, v49, v41 op_sel:[1,0,0] op_sel_hi:[1,0,0]
v_mfma_f32_16x16x32_bf16 v[136:139], a[104:107], v[56:59], v[136:139]
s_waitcnt lgkmcnt(8)
ds_read_b64_tr_b16 a[128:129], v7 offset:8192
buffer_load_dwordx4 v21, s[8:11], s56 offen lds
v_mfma_f32_16x16x32_bf16 v[144:147], a[108:111], v[56:59], v[144:147]
s_add_u32 m0, s4, 32768
s_mov_b32 s56, 2621824
ds_read_b64_tr_b16 a[130:131], v7 offset:10240
v_mfma_f32_16x16x32_bf16 v[148:151], a[108:111], v[60:63], v[148:151]
s_waitcnt lgkmcnt(8)
ds_read_b64_tr_b16 a[84:85], v4 offset:4096
ds_read_b64_tr_b16 a[86:87], v4 offset:6144
v_mfma_f32_16x16x32_bf16 v[156:159], a[112:115], v[60:63], v[156:159]
ds_read_b64_tr_b16 a[88:89], v5 offset:4096
v_fma_mix_f32 v74, v121, v50, v42 op_sel:[0,0,0] op_sel_hi:[1,0,0]
v_mfma_f32_16x16x32_bf16 v[152:155], a[112:115], v[56:59], v[152:155]
s_waitcnt lgkmcnt(9)
ds_read_b64_tr_b16 a[90:91], v5 offset:6144
v_fma_mix_f32 v75, v121, v51, v43 op_sel:[1,0,0] op_sel_hi:[1,0,0]
v_mfma_f32_16x16x32_bf16 v[192:195], a[116:119], v[56:59], v[192:195]
ds_read_b64_tr_b16 a[92:93], v6 offset:4096
v_fma_mix_f32 v76, v122, v52, v44 op_sel:[0,0,0] op_sel_hi:[1,0,0]
v_mfma_f32_16x16x32_bf16 v[196:199], a[116:119], v[60:63], v[196:199]
s_waitcnt lgkmcnt(9)
ds_read_b64_tr_b16 a[94:95], v6 offset:6144
v_fma_mix_f32 v77, v122, v53, v45 op_sel:[1,0,0] op_sel_hi:[1,0,0]
v_mfma_f32_16x16x32_bf16 v[204:207], a[120:123], v[60:63], v[204:207]
ds_read_b64_tr_b16 a[96:97], v7 offset:4096
v_fma_mix_f32 v78, v123, v54, v46 op_sel:[0,0,0] op_sel_hi:[1,0,0]
v_mfma_f32_16x16x32_bf16 v[200:203], a[120:123], v[56:59], v[200:203]
s_waitcnt lgkmcnt(9)
ds_read_b64_tr_b16 a[98:99], v7 offset:6144
v_fma_mix_f32 v79, v123, v55, v47 op_sel:[1,0,0] op_sel_hi:[1,0,0]
v_mfma_f32_16x16x32_bf16 v[208:211], a[124:127], v[56:59], v[208:211]
ds_read_b64_tr_b16 a[100:101], v4 offset:12288
buffer_load_dwordx4 v[120:123], v22, s[24:27], s45 offen offset:2048
v_mfma_f32_16x16x32_bf16 v[212:215], a[124:127], v[60:63], v[212:215]
s_waitcnt lgkmcnt(9)
ds_read_b64_tr_b16 a[102:103], v4 offset:14336
v_cvt_pk_bf16_f32 v64, v72, v73
v_mfma_f32_16x16x32_bf16 v[220:223], a[128:131], v[60:63], v[220:223]
ds_read_b64_tr_b16 a[104:105], v5 offset:12288
v_cvt_pk_bf16_f32 v65, v74, v75
v_mfma_f32_16x16x32_bf16 v[216:219], a[128:131], v[56:59], v[216:219]
s_waitcnt lgkmcnt(8)
ds_read_b64_tr_b16 a[106:107], v5 offset:14336
v_cvt_pk_bf16_f32 v66, v76, v77
v_mfma_f32_16x16x32_bf16 v[160:163], a[84:87], v[56:59], v[160:163]
ds_read_b64_tr_b16 a[108:109], v6 offset:12288
v_cvt_pk_bf16_f32 v67, v78, v79
v_mfma_f32_16x16x32_bf16 v[164:167], a[84:87], v[60:63], v[164:167]
s_waitcnt lgkmcnt(8)
ds_read_b64_tr_b16 a[110:111], v6 offset:14336
v_fma_mix_f32 v72, v124, v48, v40 op_sel:[0,0,0] op_sel_hi:[1,0,0]
v_mfma_f32_16x16x32_bf16 v[172:175], a[88:91], v[60:63], v[172:175]
ds_read_b64_tr_b16 a[112:113], v7 offset:12288
v_fma_mix_f32 v73, v124, v49, v41 op_sel:[1,0,0] op_sel_hi:[1,0,0]
v_mfma_f32_16x16x32_bf16 v[168:171], a[88:91], v[56:59], v[168:171]
s_waitcnt lgkmcnt(8)
ds_read_b64_tr_b16 a[114:115], v7 offset:14336
v_fma_mix_f32 v74, v125, v50, v42 op_sel:[0,0,0] op_sel_hi:[1,0,0]
v_mfma_f32_16x16x32_bf16 v[176:179], a[92:95], v[56:59], v[176:179]
ds_read_b64_tr_b16 a[116:117], v4 offset:16384
v_fma_mix_f32 v75, v125, v51, v43 op_sel:[1,0,0] op_sel_hi:[1,0,0]
v_mfma_f32_16x16x32_bf16 v[180:183], a[92:95], v[60:63], v[180:183]
s_waitcnt lgkmcnt(8)
ds_read_b64_tr_b16 a[118:119], v4 offset:18432
v_fma_mix_f32 v76, v126, v52, v44 op_sel:[0,0,0] op_sel_hi:[1,0,0]
v_mfma_f32_16x16x32_bf16 v[188:191], a[96:99], v[60:63], v[188:191]
ds_read_b64_tr_b16 a[120:121], v5 offset:16384
v_fma_mix_f32 v77, v126, v53, v45 op_sel:[1,0,0] op_sel_hi:[1,0,0]
v_mfma_f32_16x16x32_bf16 v[184:187], a[96:99], v[56:59], v[184:187]
s_waitcnt lgkmcnt(8)
ds_read_b64_tr_b16 a[122:123], v5 offset:18432
v_fma_mix_f32 v78, v127, v54, v46 op_sel:[0,0,0] op_sel_hi:[1,0,0]
v_mfma_f32_16x16x32_bf16 v[224:227], a[100:103], v[56:59], v[224:227]
ds_read_b64_tr_b16 a[124:125], v6 offset:16384
v_fma_mix_f32 v79, v127, v55, v47 op_sel:[1,0,0] op_sel_hi:[1,0,0]
v_mfma_f32_16x16x32_bf16 v[228:231], a[100:103], v[60:63], v[228:231]
s_waitcnt lgkmcnt(8)
ds_read_b64_tr_b16 a[126:127], v6 offset:18432
buffer_load_dwordx4 v[124:127], v22, s[24:27], s45 offen offset:3072
v_mfma_f32_16x16x32_bf16 v[236:239], a[104:107], v[60:63], v[236:239]
ds_read_b64_tr_b16 a[128:129], v7 offset:16384
v_cvt_pk_bf16_f32 v68, v72, v73
v_mfma_f32_16x16x32_bf16 v[232:235], a[104:107], v[56:59], v[232:235]
s_waitcnt lgkmcnt(8)
ds_read_b64_tr_b16 a[130:131], v7 offset:18432
v_cvt_pk_bf16_f32 v69, v74, v75
v_mfma_f32_16x16x32_bf16 v[240:243], a[108:111], v[56:59], v[240:243]
v_cvt_pk_bf16_f32 v70, v76, v77
v_cvt_pk_bf16_f32 v71, v78, v79
v_mfma_f32_16x16x32_bf16 v[244:247], a[108:111], v[60:63], v[244:247]
s_waitcnt lgkmcnt(7)
ds_read_b64_tr_b16 a[84:85], v4 offset:24576
ds_read_b64_tr_b16 a[86:87], v4 offset:26624
v_mfma_f32_16x16x32_bf16 v[252:255], a[112:115], v[60:63], v[252:255]
ds_read_b64_tr_b16 a[88:89], v5 offset:24576
ds_read_b64_tr_b16 a[90:91], v5 offset:26624
v_mfma_f32_16x16x32_bf16 v[248:251], a[112:115], v[56:59], v[248:251]
s_waitcnt lgkmcnt(9)
ds_read_b64_tr_b16 a[92:93], v6 offset:24576
buffer_load_dwordx4 v21, s[8:11], s57 offen lds
v_mfma_f32_16x16x32_bf16 v[128:131], a[116:119], v[64:67], v[128:131]
s_add_u32 m0, s4, 40960
s_mov_b32 s57, 2883584
ds_read_b64_tr_b16 a[94:95], v6 offset:26624
v_mfma_f32_16x16x32_bf16 v[132:135], a[116:119], v[68:71], v[132:135]
s_waitcnt lgkmcnt(9)
ds_read_b64_tr_b16 a[96:97], v7 offset:24576
ds_read_b64_tr_b16 a[98:99], v7 offset:26624
v_mfma_f32_16x16x32_bf16 v[140:143], a[120:123], v[68:71], v[140:143]
ds_read_b64_tr_b16 a[100:101], v4 offset:20480
ds_read_b64_tr_b16 a[102:103], v4 offset:22528
v_mfma_f32_16x16x32_bf16 v[136:139], a[120:123], v[64:67], v[136:139]
s_waitcnt lgkmcnt(11)
ds_read_b64_tr_b16 a[104:105], v5 offset:20480
buffer_load_dwordx4 v21, s[8:11], s58 offen lds
v_mfma_f32_16x16x32_bf16 v[144:147], a[124:127], v[64:67], v[144:147]
s_add_u32 m0, s4, 36864
s_mov_b32 s58, 2883840
ds_read_b64_tr_b16 a[106:107], v5 offset:22528
v_mfma_f32_16x16x32_bf16 v[148:151], a[124:127], v[68:71], v[148:151]
s_waitcnt lgkmcnt(12)
ds_read_b64_tr_b16 a[108:109], v6 offset:20480
ds_read_b64_tr_b16 a[110:111], v6 offset:22528
v_mfma_f32_16x16x32_bf16 v[156:159], a[128:131], v[68:71], v[156:159]
ds_read_b64_tr_b16 a[112:113], v7 offset:20480
ds_read_b64_tr_b16 a[114:115], v7 offset:22528
v_mfma_f32_16x16x32_bf16 v[152:155], a[128:131], v[64:67], v[152:155]
s_waitcnt lgkmcnt(12)
ds_read_b64_tr_b16 a[116:117], v4 offset:28672
buffer_load_dwordx4 v21, s[8:11], s59 offen lds
v_mfma_f32_16x16x32_bf16 v[192:195], a[84:87], v[64:67], v[192:195]
s_add_u32 m0, s4, 45056
s_mov_b32 s59, 2883712
ds_read_b64_tr_b16 a[118:119], v4 offset:30720
v_mfma_f32_16x16x32_bf16 v[196:199], a[84:87], v[68:71], v[196:199]
ds_read_b64_tr_b16 a[120:121], v5 offset:28672
ds_read_b64_tr_b16 a[122:123], v5 offset:30720
v_mfma_f32_16x16x32_bf16 v[204:207], a[88:91], v[68:71], v[204:207]
ds_read_b64_tr_b16 a[124:125], v6 offset:28672
ds_read_b64_tr_b16 a[126:127], v6 offset:30720
v_mfma_f32_16x16x32_bf16 v[200:203], a[88:91], v[64:67], v[200:203]
s_waitcnt lgkmcnt(12)
ds_read_b64_tr_b16 a[128:129], v7 offset:28672
buffer_load_dwordx4 v21, s[8:11], s56 offen lds
v_mfma_f32_16x16x32_bf16 v[208:211], a[92:95], v[64:67], v[208:211]
s_add_u32 m0, s4, 49152
s_mov_b32 s56, 2883968
ds_read_b64_tr_b16 a[130:131], v7 offset:30720
v_mfma_f32_16x16x32_bf16 v[212:215], a[92:95], v[68:71], v[212:215]
ds_read_b128 v[24:27], v23 offset:768
ds_read_b128 v[28:31], v23 offset:784
v_mfma_f32_16x16x32_bf16 v[220:223], a[96:99], v[68:71], v[220:223]
ds_read_b128 v[32:35], v23 offset:3072
ds_read_b128 v[36:39], v23 offset:3088
v_mfma_f32_16x16x32_bf16 v[216:219], a[96:99], v[64:67], v[216:219]
ds_read_b128 v[40:43], v23 offset:896
ds_read_b128 v[44:47], v23 offset:912
v_mfma_f32_16x16x32_bf16 v[160:163], a[100:103], v[64:67], v[160:163]
s_waitcnt vmcnt(16)
s_barrier
ds_read_b64_tr_b16 a[84:85], v4 offset:32768
ds_read_b64_tr_b16 a[86:87], v4 offset:34816
v_mfma_f32_16x16x32_bf16 v[164:167], a[100:103], v[68:71], v[164:167]
s_waitcnt lgkmcnt(14)
ds_read_b64_tr_b16 a[88:89], v5 offset:32768
ds_read_b64_tr_b16 a[90:91], v5 offset:34816
v_mfma_f32_16x16x32_bf16 v[172:175], a[104:107], v[68:71], v[172:175]
ds_read_b64_tr_b16 a[92:93], v6 offset:32768
ds_read_b64_tr_b16 a[94:95], v6 offset:34816
v_mfma_f32_16x16x32_bf16 v[168:171], a[104:107], v[64:67], v[168:171]
ds_read_b64_tr_b16 a[96:97], v7 offset:32768
ds_read_b64_tr_b16 a[98:99], v7 offset:34816
v_mfma_f32_16x16x32_bf16 v[176:179], a[108:111], v[64:67], v[176:179]
ds_read_b64_tr_b16 a[100:101], v4 offset:40960
ds_read_b64_tr_b16 a[102:103], v4 offset:43008
v_mfma_f32_16x16x32_bf16 v[180:183], a[108:111], v[68:71], v[180:183]
s_waitcnt lgkmcnt(13)
v_fma_mix_f32 v72, v80, v32, v24 op_sel:[0,0,0] op_sel_hi:[1,0,0]
v_fma_mix_f32 v73, v80, v33, v25 op_sel:[1,0,0] op_sel_hi:[1,0,0]
v_mfma_f32_16x16x32_bf16 v[188:191], a[112:115], v[68:71], v[188:191]
ds_read_b64_tr_b16 a[104:105], v5 offset:40960
v_fma_mix_f32 v74, v81, v34, v26 op_sel:[0,0,0] op_sel_hi:[1,0,0]
v_mfma_f32_16x16x32_bf16 v[184:187], a[112:115], v[64:67], v[184:187]
s_waitcnt lgkmcnt(13)
v_fma_mix_f32 v75, v81, v35, v27 op_sel:[1,0,0] op_sel_hi:[1,0,0]
v_fma_mix_f32 v76, v82, v36, v28 op_sel:[0,0,0] op_sel_hi:[1,0,0]
v_mfma_f32_16x16x32_bf16 v[224:227], a[116:119], v[64:67], v[224:227]
ds_read_b64_tr_b16 a[106:107], v5 offset:43008
v_fma_mix_f32 v77, v82, v37, v29 op_sel:[1,0,0] op_sel_hi:[1,0,0]
v_mfma_f32_16x16x32_bf16 v[228:231], a[116:119], v[68:71], v[228:231]
v_fma_mix_f32 v78, v83, v38, v30 op_sel:[0,0,0] op_sel_hi:[1,0,0]
v_fma_mix_f32 v79, v83, v39, v31 op_sel:[1,0,0] op_sel_hi:[1,0,0]
v_mfma_f32_16x16x32_bf16 v[236:239], a[120:123], v[68:71], v[236:239]
buffer_load_dwordx4 v[80:83], v22, s[24:27], s46 offen offset:0
v_cvt_pk_bf16_f32 v56, v72, v73
v_mfma_f32_16x16x32_bf16 v[232:235], a[120:123], v[64:67], v[232:235]
v_cvt_pk_bf16_f32 v57, v74, v75
v_cvt_pk_bf16_f32 v58, v76, v77
v_mfma_f32_16x16x32_bf16 v[240:243], a[124:127], v[64:67], v[240:243]
v_cvt_pk_bf16_f32 v59, v78, v79
v_fma_mix_f32 v72, v84, v32, v24 op_sel:[0,0,0] op_sel_hi:[1,0,0]
v_mfma_f32_16x16x32_bf16 v[244:247], a[124:127], v[68:71], v[244:247]
v_fma_mix_f32 v73, v84, v33, v25 op_sel:[1,0,0] op_sel_hi:[1,0,0]
v_fma_mix_f32 v74, v85, v34, v26 op_sel:[0,0,0] op_sel_hi:[1,0,0]
v_mfma_f32_16x16x32_bf16 v[252:255], a[128:131], v[68:71], v[252:255]
v_fma_mix_f32 v75, v85, v35, v27 op_sel:[1,0,0] op_sel_hi:[1,0,0]
v_fma_mix_f32 v76, v86, v36, v28 op_sel:[0,0,0] op_sel_hi:[1,0,0]
v_mfma_f32_16x16x32_bf16 v[248:251], a[128:131], v[64:67], v[248:251]
s_waitcnt lgkmcnt(1)
buffer_load_dwordx4 v21, s[8:11], s57 offen lds
v_fma_mix_f32 v77, v86, v37, v29 op_sel:[1,0,0] op_sel_hi:[1,0,0]
v_mfma_f32_16x16x32_bf16 v[128:131], a[84:87], v[56:59], v[128:131]
s_add_u32 m0, s4, 57344
s_mov_b32 s57, 3145728
v_fma_mix_f32 v78, v87, v38, v30 op_sel:[0,0,0] op_sel_hi:[1,0,0]
buffer_load_dwordx4 v21, s[8:11], s58 offen lds
v_cvt_pk_bf16_f32 v60, v72, v73
v_cvt_pk_bf16_f32 v61, v74, v75
v_fma_mix_f32 v79, v87, v39, v31 op_sel:[1,0,0] op_sel_hi:[1,0,0]
s_add_u32 m0, s4, 53248
s_mov_b32 s58, 3145984
buffer_load_dwordx4 v[84:87], v22, s[24:27], s46 offen offset:1024
v_cvt_pk_bf16_f32 v62, v76, v77
v_cvt_pk_bf16_f32 v63, v78, v79
ds_read_b64_tr_b16 a[108:109], v6 offset:40960
ds_read_b64_tr_b16 a[110:111], v6 offset:43008
ds_read_b64_tr_b16 a[112:113], v7 offset:40960
buffer_load_dwordx4 v21, s[8:11], s59 offen lds
v_mfma_f32_16x16x32_bf16 v[132:135], a[84:87], v[60:63], v[132:135]
s_add_u32 m0, s4, 61440
s_mov_b32 s59, 3145856
ds_read_b64_tr_b16 a[114:115], v7 offset:43008
v_mfma_f32_16x16x32_bf16 v[140:143], a[88:91], v[60:63], v[140:143]
ds_read_b64_tr_b16 a[116:117], v4 offset:36864
ds_read_b64_tr_b16 a[118:119], v4 offset:38912
v_mfma_f32_16x16x32_bf16 v[136:139], a[88:91], v[56:59], v[136:139]
ds_read_b64_tr_b16 a[120:121], v5 offset:36864
ds_read_b64_tr_b16 a[122:123], v5 offset:38912
v_mfma_f32_16x16x32_bf16 v[144:147], a[92:95], v[56:59], v[144:147]
ds_read_b64_tr_b16 a[124:125], v6 offset:36864
buffer_load_dwordx4 v21, s[8:11], s56 offen lds
v_mfma_f32_16x16x32_bf16 v[148:151], a[92:95], v[60:63], v[148:151]
s_add_u32 m0, s4, 65536
s_mov_b32 s56, 3146112
ds_read_b64_tr_b16 a[126:127], v6 offset:38912
v_mfma_f32_16x16x32_bf16 v[156:159], a[96:99], v[60:63], v[156:159]
ds_read_b64_tr_b16 a[128:129], v7 offset:36864
ds_read_b64_tr_b16 a[130:131], v7 offset:38912
v_mfma_f32_16x16x32_bf16 v[152:155], a[96:99], v[56:59], v[152:155]
ds_read_b64_tr_b16 a[84:85], v4 offset:45056
ds_read_b64_tr_b16 a[86:87], v4 offset:47104
v_mfma_f32_16x16x32_bf16 v[192:195], a[100:103], v[56:59], v[192:195]
ds_read_b64_tr_b16 a[88:89], v5 offset:45056
ds_read_b64_tr_b16 a[90:91], v5 offset:47104
v_mfma_f32_16x16x32_bf16 v[196:199], a[100:103], v[60:63], v[196:199]
s_waitcnt lgkmcnt(13)
ds_read_b64_tr_b16 a[92:93], v6 offset:45056
ds_read_b64_tr_b16 a[94:95], v6 offset:47104
v_mfma_f32_16x16x32_bf16 v[204:207], a[104:107], v[60:63], v[204:207]
ds_read_b64_tr_b16 a[96:97], v7 offset:45056
ds_read_b64_tr_b16 a[98:99], v7 offset:47104
v_mfma_f32_16x16x32_bf16 v[200:203], a[104:107], v[56:59], v[200:203]
ds_read_b128 v[48:51], v23 offset:3200
ds_read_b128 v[52:55], v23 offset:3216
v_mfma_f32_16x16x32_bf16 v[208:211], a[108:111], v[56:59], v[208:211]
ds_read_b64_tr_b16 a[100:101], v4 offset:49152
ds_read_b64_tr_b16 a[102:103], v4 offset:51200
v_mfma_f32_16x16x32_bf16 v[212:215], a[108:111], v[60:63], v[212:215]
s_waitcnt lgkmcnt(15)
ds_read_b64_tr_b16 a[104:105], v5 offset:49152
ds_read_b64_tr_b16 a[106:107], v5 offset:51200
v_mfma_f32_16x16x32_bf16 v[220:223], a[112:115], v[60:63], v[220:223]
ds_read_b64_tr_b16 a[108:109], v6 offset:49152
ds_read_b64_tr_b16 a[110:111], v6 offset:51200
v_mfma_f32_16x16x32_bf16 v[216:219], a[112:115], v[56:59], v[216:219]
ds_read_b64_tr_b16 a[112:113], v7 offset:49152
ds_read_b64_tr_b16 a[114:115], v7 offset:51200
v_mfma_f32_16x16x32_bf16 v[160:163], a[116:119], v[56:59], v[160:163]
ds_read_b128 v[24:27], v23 offset:1024
ds_read_b128 v[28:31], v23 offset:1040
v_mfma_f32_16x16x32_bf16 v[164:167], a[116:119], v[60:63], v[164:167]
ds_read_b64_tr_b16 a[116:117], v4 offset:57344
ds_read_b64_tr_b16 a[118:119], v4 offset:59392
v_mfma_f32_16x16x32_bf16 v[172:175], a[120:123], v[60:63], v[172:175]
s_waitcnt lgkmcnt(13)
v_fma_mix_f32 v72, v88, v48, v40 op_sel:[0,0,0] op_sel_hi:[1,0,0]
v_fma_mix_f32 v73, v88, v49, v41 op_sel:[1,0,0] op_sel_hi:[1,0,0]
v_mfma_f32_16x16x32_bf16 v[168:171], a[120:123], v[56:59], v[168:171]
ds_read_b64_tr_b16 a[120:121], v5 offset:57344
v_fma_mix_f32 v74, v89, v50, v42 op_sel:[0,0,0] op_sel_hi:[1,0,0]
v_mfma_f32_16x16x32_bf16 v[176:179], a[124:127], v[56:59], v[176:179]
s_waitcnt lgkmcnt(13)
v_fma_mix_f32 v75, v89, v51, v43 op_sel:[1,0,0] op_sel_hi:[1,0,0]
v_fma_mix_f32 v76, v90, v52, v44 op_sel:[0,0,0] op_sel_hi:[1,0,0]
v_mfma_f32_16x16x32_bf16 v[180:183], a[124:127], v[60:63], v[180:183]
ds_read_b64_tr_b16 a[122:123], v5 offset:59392
v_fma_mix_f32 v77, v90, v53, v45 op_sel:[1,0,0] op_sel_hi:[1,0,0]
v_mfma_f32_16x16x32_bf16 v[188:191], a[128:131], v[60:63], v[188:191]
v_fma_mix_f32 v78, v91, v54, v46 op_sel:[0,0,0] op_sel_hi:[1,0,0]
v_fma_mix_f32 v79, v91, v55, v47 op_sel:[1,0,0] op_sel_hi:[1,0,0]
v_mfma_f32_16x16x32_bf16 v[184:187], a[128:131], v[56:59], v[184:187]
buffer_load_dwordx4 v[88:91], v22, s[24:27], s46 offen offset:2048
v_cvt_pk_bf16_f32 v64, v72, v73
v_mfma_f32_16x16x32_bf16 v[224:227], a[84:87], v[56:59], v[224:227]
v_cvt_pk_bf16_f32 v65, v74, v75
v_cvt_pk_bf16_f32 v66, v76, v77
v_mfma_f32_16x16x32_bf16 v[228:231], a[84:87], v[60:63], v[228:231]
ds_read_b64_tr_b16 a[124:125], v6 offset:57344
v_cvt_pk_bf16_f32 v67, v78, v79
v_mfma_f32_16x16x32_bf16 v[236:239], a[88:91], v[60:63], v[236:239]
v_fma_mix_f32 v72, v92, v48, v40 op_sel:[0,0,0] op_sel_hi:[1,0,0]
v_fma_mix_f32 v73, v92, v49, v41 op_sel:[1,0,0] op_sel_hi:[1,0,0]
v_mfma_f32_16x16x32_bf16 v[232:235], a[88:91], v[56:59], v[232:235]
ds_read_b64_tr_b16 a[126:127], v6 offset:59392
v_fma_mix_f32 v74, v93, v50, v42 op_sel:[0,0,0] op_sel_hi:[1,0,0]
v_mfma_f32_16x16x32_bf16 v[240:243], a[92:95], v[56:59], v[240:243]
v_fma_mix_f32 v75, v93, v51, v43 op_sel:[1,0,0] op_sel_hi:[1,0,0]
v_fma_mix_f32 v76, v94, v52, v44 op_sel:[0,0,0] op_sel_hi:[1,0,0]
v_mfma_f32_16x16x32_bf16 v[244:247], a[92:95], v[60:63], v[244:247]
v_fma_mix_f32 v77, v94, v53, v45 op_sel:[1,0,0] op_sel_hi:[1,0,0]
v_fma_mix_f32 v78, v95, v54, v46 op_sel:[0,0,0] op_sel_hi:[1,0,0]
v_mfma_f32_16x16x32_bf16 v[252:255], a[96:99], v[60:63], v[252:255]
v_cvt_pk_bf16_f32 v68, v72, v73
v_fma_mix_f32 v79, v95, v55, v47 op_sel:[1,0,0] op_sel_hi:[1,0,0]
v_mfma_f32_16x16x32_bf16 v[248:251], a[96:99], v[56:59], v[248:251]
s_waitcnt lgkmcnt(2)
buffer_load_dwordx4 v21, s[8:11], s57 offen lds
v_cvt_pk_bf16_f32 v69, v74, v75
v_mfma_f32_16x16x32_bf16 v[128:131], a[100:103], v[64:67], v[128:131]
s_add_u32 m0, s4, 73728
s_mov_b32 s57, 3407872
v_cvt_pk_bf16_f32 v70, v76, v77
ds_read_b64_tr_b16 a[128:129], v7 offset:57344
buffer_load_dwordx4 v21, s[8:11], s58 offen lds
buffer_load_dwordx4 v[92:95], v22, s[24:27], s46 offen offset:3072
v_cvt_pk_bf16_f32 v71, v78, v79
s_add_u32 m0, s4, 69632
s_mov_b32 s58, 3408128
ds_read_b64_tr_b16 a[130:131], v7 offset:59392
ds_read_b64_tr_b16 a[84:85], v4 offset:53248
ds_read_b64_tr_b16 a[86:87], v4 offset:55296
v_mfma_f32_16x16x32_bf16 v[132:135], a[100:103], v[68:71], v[132:135]
ds_read_b64_tr_b16 a[88:89], v5 offset:53248
ds_read_b64_tr_b16 a[90:91], v5 offset:55296
v_mfma_f32_16x16x32_bf16 v[140:143], a[104:107], v[68:71], v[140:143]
ds_read_b64_tr_b16 a[92:93], v6 offset:53248
ds_read_b64_tr_b16 a[94:95], v6 offset:55296
v_mfma_f32_16x16x32_bf16 v[136:139], a[104:107], v[64:67], v[136:139]
ds_read_b64_tr_b16 a[96:97], v7 offset:53248
buffer_load_dwordx4 v21, s[8:11], s59 offen lds
v_mfma_f32_16x16x32_bf16 v[144:147], a[108:111], v[64:67], v[144:147]
s_add_u32 m0, s4, 77824
s_mov_b32 s59, 3408000
ds_read_b64_tr_b16 a[98:99], v7 offset:55296
v_mfma_f32_16x16x32_bf16 v[148:151], a[108:111], v[68:71], v[148:151]
ds_read_b64_tr_b16 a[100:101], v4 offset:61440
ds_read_b64_tr_b16 a[102:103], v4 offset:63488
v_mfma_f32_16x16x32_bf16 v[156:159], a[112:115], v[68:71], v[156:159]
ds_read_b64_tr_b16 a[104:105], v5 offset:61440
ds_read_b64_tr_b16 a[106:107], v5 offset:63488
v_mfma_f32_16x16x32_bf16 v[152:155], a[112:115], v[64:67], v[152:155]
ds_read_b64_tr_b16 a[108:109], v6 offset:61440
buffer_load_dwordx4 v21, s[8:11], s56 offen lds
v_mfma_f32_16x16x32_bf16 v[192:195], a[116:119], v[64:67], v[192:195]
s_add_u32 m0, s4, 81920
s_mov_b32 s56, 3408256
ds_read_b64_tr_b16 a[110:111], v6 offset:63488
v_mfma_f32_16x16x32_bf16 v[196:199], a[116:119], v[68:71], v[196:199]
ds_read_b64_tr_b16 a[112:113], v7 offset:61440
ds_read_b64_tr_b16 a[114:115], v7 offset:63488
v_mfma_f32_16x16x32_bf16 v[204:207], a[120:123], v[68:71], v[204:207]
ds_read_b128 v[32:35], v23 offset:3328
ds_read_b128 v[36:39], v23 offset:3344
v_mfma_f32_16x16x32_bf16 v[200:203], a[120:123], v[64:67], v[200:203]
s_waitcnt lgkmcnt(12)
ds_read_b128 v[40:43], v23 offset:1152
ds_read_b128 v[44:47], v23 offset:1168
v_mfma_f32_16x16x32_bf16 v[208:211], a[124:127], v[64:67], v[208:211]
ds_read_b128 v[48:51], v23 offset:3456
ds_read_b128 v[52:55], v23 offset:3472
v_mfma_f32_16x16x32_bf16 v[212:215], a[124:127], v[68:71], v[212:215]
v_mfma_f32_16x16x32_bf16 v[220:223], a[128:131], v[68:71], v[220:223]
v_mfma_f32_16x16x32_bf16 v[216:219], a[128:131], v[64:67], v[216:219]
v_mfma_f32_16x16x32_bf16 v[160:163], a[84:87], v[64:67], v[160:163]
s_waitcnt vmcnt(18)
s_barrier
ds_read_b64_tr_b16 a[116:117], v0 offset:0
ds_read_b64_tr_b16 a[118:119], v0 offset:2048
v_mfma_f32_16x16x32_bf16 v[164:167], a[84:87], v[68:71], v[164:167]
s_waitcnt lgkmcnt(7)
v_fma_mix_f32 v72, v96, v32, v24 op_sel:[0,0,0] op_sel_hi:[1,0,0]
v_fma_mix_f32 v73, v96, v33, v25 op_sel:[1,0,0] op_sel_hi:[1,0,0]
v_mfma_f32_16x16x32_bf16 v[172:175], a[88:91], v[68:71], v[172:175]
ds_read_b64_tr_b16 a[120:121], v1 offset:0
v_fma_mix_f32 v74, v97, v34, v26 op_sel:[0,0,0] op_sel_hi:[1,0,0]
v_mfma_f32_16x16x32_bf16 v[168:171], a[88:91], v[64:67], v[168:171]
s_waitcnt lgkmcnt(7)
v_fma_mix_f32 v75, v97, v35, v27 op_sel:[1,0,0] op_sel_hi:[1,0,0]
v_fma_mix_f32 v76, v98, v36, v28 op_sel:[0,0,0] op_sel_hi:[1,0,0]
v_mfma_f32_16x16x32_bf16 v[176:179], a[92:95], v[64:67], v[176:179]
ds_read_b64_tr_b16 a[122:123], v1 offset:2048
v_fma_mix_f32 v77, v98, v37, v29 op_sel:[1,0,0] op_sel_hi:[1,0,0]
v_mfma_f32_16x16x32_bf16 v[180:183], a[92:95], v[68:71], v[180:183]
v_fma_mix_f32 v78, v99, v38, v30 op_sel:[0,0,0] op_sel_hi:[1,0,0]
v_fma_mix_f32 v79, v99, v39, v31 op_sel:[1,0,0] op_sel_hi:[1,0,0]
v_mfma_f32_16x16x32_bf16 v[188:191], a[96:99], v[68:71], v[188:191]
ds_read_b64_tr_b16 a[124:125], v2 offset:0
buffer_load_dwordx4 v[96:99], v22, s[24:27], s47 offen offset:0
v_mfma_f32_16x16x32_bf16 v[184:187], a[96:99], v[64:67], v[184:187]
ds_read_b64_tr_b16 a[126:127], v2 offset:2048
v_cvt_pk_bf16_f32 v56, v72, v73
v_mfma_f32_16x16x32_bf16 v[224:227], a[100:103], v[64:67], v[224:227]
v_cvt_pk_bf16_f32 v57, v74, v75
v_cvt_pk_bf16_f32 v58, v76, v77
v_mfma_f32_16x16x32_bf16 v[228:231], a[100:103], v[68:71], v[228:231]
ds_read_b64_tr_b16 a[128:129], v3 offset:0
v_cvt_pk_bf16_f32 v59, v78, v79
v_mfma_f32_16x16x32_bf16 v[236:239], a[104:107], v[68:71], v[236:239]
ds_read_b64_tr_b16 a[130:131], v3 offset:2048
v_fma_mix_f32 v72, v100, v32, v24 op_sel:[0,0,0] op_sel_hi:[1,0,0]
v_mfma_f32_16x16x32_bf16 v[232:235], a[104:107], v[64:67], v[232:235]
v_fma_mix_f32 v73, v100, v33, v25 op_sel:[1,0,0] op_sel_hi:[1,0,0]
v_fma_mix_f32 v74, v101, v34, v26 op_sel:[0,0,0] op_sel_hi:[1,0,0]
v_mfma_f32_16x16x32_bf16 v[240:243], a[108:111], v[64:67], v[240:243]
v_fma_mix_f32 v75, v101, v35, v27 op_sel:[1,0,0] op_sel_hi:[1,0,0]
v_fma_mix_f32 v76, v102, v36, v28 op_sel:[0,0,0] op_sel_hi:[1,0,0]
v_mfma_f32_16x16x32_bf16 v[244:247], a[108:111], v[68:71], v[244:247]
v_fma_mix_f32 v77, v102, v37, v29 op_sel:[1,0,0] op_sel_hi:[1,0,0]
v_fma_mix_f32 v78, v103, v38, v30 op_sel:[0,0,0] op_sel_hi:[1,0,0]
v_mfma_f32_16x16x32_bf16 v[252:255], a[112:115], v[68:71], v[252:255]
v_cvt_pk_bf16_f32 v60, v72, v73
v_fma_mix_f32 v79, v103, v39, v31 op_sel:[1,0,0] op_sel_hi:[1,0,0]
v_mfma_f32_16x16x32_bf16 v[248:251], a[112:115], v[64:67], v[248:251]
s_waitcnt lgkmcnt(3)
buffer_load_dwordx4 v21, s[8:11], s57 offen lds
v_cvt_pk_bf16_f32 v61, v74, v75
v_mfma_f32_16x16x32_bf16 v[128:131], a[116:119], v[56:59], v[128:131]
s_add_u32 m0, s4, 90112
s_mov_b32 s57, 3670016
v_cvt_pk_bf16_f32 v62, v76, v77
ds_read_b64_tr_b16 a[84:85], v0 offset:8192
buffer_load_dwordx4 v21, s[8:11], s58 offen lds
buffer_load_dwordx4 v[100:103], v22, s[24:27], s47 offen offset:1024
v_cvt_pk_bf16_f32 v63, v78, v79
s_add_u32 m0, s4, 86016
s_mov_b32 s58, 3670272
ds_read_b64_tr_b16 a[86:87], v0 offset:10240
ds_read_b64_tr_b16 a[88:89], v1 offset:8192
ds_read_b64_tr_b16 a[90:91], v1 offset:10240
v_mfma_f32_16x16x32_bf16 v[132:135], a[116:119], v[60:63], v[132:135]
ds_read_b64_tr_b16 a[92:93], v2 offset:8192
ds_read_b64_tr_b16 a[94:95], v2 offset:10240
v_mfma_f32_16x16x32_bf16 v[140:143], a[120:123], v[60:63], v[140:143]
v_fma_mix_f32 v72, v104, v48, v40 op_sel:[0,0,0] op_sel_hi:[1,0,0]
v_fma_mix_f32 v73, v104, v49, v41 op_sel:[1,0,0] op_sel_hi:[1,0,0]
v_mfma_f32_16x16x32_bf16 v[136:139], a[120:123], v[56:59], v[136:139]
s_waitcnt lgkmcnt(6)
ds_read_b64_tr_b16 a[96:97], v3 offset:8192
buffer_load_dwordx4 v21, s[8:11], s59 offen lds
v_mfma_f32_16x16x32_bf16 v[144:147], a[124:127], v[56:59], v[144:147]
s_add_u32 m0, s4, 94208
s_mov_b32 s59, 3670144
ds_read_b64_tr_b16 a[98:99], v3 offset:10240
v_mfma_f32_16x16x32_bf16 v[148:151], a[124:127], v[60:63], v[148:151]
ds_read_b64_tr_b16 a[100:101], v0 offset:4096
ds_read_b64_tr_b16 a[102:103], v0 offset:6144
v_mfma_f32_16x16x32_bf16 v[156:159], a[128:131], v[60:63], v[156:159]
ds_read_b64_tr_b16 a[104:105], v1 offset:4096
v_fma_mix_f32 v74, v105, v50, v42 op_sel:[0,0,0] op_sel_hi:[1,0,0]
v_mfma_f32_16x16x32_bf16 v[152:155], a[128:131], v[56:59], v[152:155]
s_waitcnt lgkmcnt(9)
ds_read_b64_tr_b16 a[106:107], v1 offset:6144
buffer_load_dwordx4 v21, s[8:11], s56 offen lds
v_mfma_f32_16x16x32_bf16 v[192:195], a[84:87], v[56:59], v[192:195]
s_add_u32 m0, s4, 98304
s_mov_b32 s56, 3670400
ds_read_b64_tr_b16 a[108:109], v2 offset:4096
v_mfma_f32_16x16x32_bf16 v[196:199], a[84:87], v[60:63], v[196:199]
s_waitcnt lgkmcnt(9)
ds_read_b64_tr_b16 a[110:111], v2 offset:6144
v_fma_mix_f32 v75, v105, v51, v43 op_sel:[1,0,0] op_sel_hi:[1,0,0]
v_mfma_f32_16x16x32_bf16 v[204:207], a[88:91], v[60:63], v[204:207]
ds_read_b64_tr_b16 a[112:113], v3 offset:4096
v_fma_mix_f32 v76, v106, v52, v44 op_sel:[0,0,0] op_sel_hi:[1,0,0]
v_mfma_f32_16x16x32_bf16 v[200:203], a[88:91], v[56:59], v[200:203]
s_waitcnt lgkmcnt(9)
ds_read_b64_tr_b16 a[114:115], v3 offset:6144
v_fma_mix_f32 v77, v106, v53, v45 op_sel:[1,0,0] op_sel_hi:[1,0,0]
v_mfma_f32_16x16x32_bf16 v[208:211], a[92:95], v[56:59], v[208:211]
ds_read_b64_tr_b16 a[116:117], v0 offset:12288
v_fma_mix_f32 v78, v107, v54, v46 op_sel:[0,0,0] op_sel_hi:[1,0,0]
v_mfma_f32_16x16x32_bf16 v[212:215], a[92:95], v[60:63], v[212:215]
s_waitcnt lgkmcnt(9)
ds_read_b64_tr_b16 a[118:119], v0 offset:14336
v_fma_mix_f32 v79, v107, v55, v47 op_sel:[1,0,0] op_sel_hi:[1,0,0]
v_mfma_f32_16x16x32_bf16 v[220:223], a[96:99], v[60:63], v[220:223]
ds_read_b64_tr_b16 a[120:121], v1 offset:12288
buffer_load_dwordx4 v[104:107], v22, s[24:27], s47 offen offset:2048
v_mfma_f32_16x16x32_bf16 v[216:219], a[96:99], v[56:59], v[216:219]
s_waitcnt lgkmcnt(8)
ds_read_b64_tr_b16 a[122:123], v1 offset:14336
v_cvt_pk_bf16_f32 v64, v72, v73
v_mfma_f32_16x16x32_bf16 v[160:163], a[100:103], v[56:59], v[160:163]
ds_read_b64_tr_b16 a[124:125], v2 offset:12288
v_cvt_pk_bf16_f32 v65, v74, v75
v_mfma_f32_16x16x32_bf16 v[164:167], a[100:103], v[60:63], v[164:167]
s_waitcnt lgkmcnt(8)
ds_read_b64_tr_b16 a[126:127], v2 offset:14336
v_cvt_pk_bf16_f32 v66, v76, v77
v_mfma_f32_16x16x32_bf16 v[172:175], a[104:107], v[60:63], v[172:175]
ds_read_b64_tr_b16 a[128:129], v3 offset:12288
v_cvt_pk_bf16_f32 v67, v78, v79
v_mfma_f32_16x16x32_bf16 v[168:171], a[104:107], v[56:59], v[168:171]
s_waitcnt lgkmcnt(8)
ds_read_b64_tr_b16 a[130:131], v3 offset:14336
v_fma_mix_f32 v72, v108, v48, v40 op_sel:[0,0,0] op_sel_hi:[1,0,0]
v_mfma_f32_16x16x32_bf16 v[176:179], a[108:111], v[56:59], v[176:179]
ds_read_b64_tr_b16 a[84:85], v0 offset:16384
v_fma_mix_f32 v73, v108, v49, v41 op_sel:[1,0,0] op_sel_hi:[1,0,0]
v_mfma_f32_16x16x32_bf16 v[180:183], a[108:111], v[60:63], v[180:183]
s_waitcnt lgkmcnt(8)
ds_read_b64_tr_b16 a[86:87], v0 offset:18432
v_fma_mix_f32 v74, v109, v50, v42 op_sel:[0,0,0] op_sel_hi:[1,0,0]
v_mfma_f32_16x16x32_bf16 v[188:191], a[112:115], v[60:63], v[188:191]
ds_read_b64_tr_b16 a[88:89], v1 offset:16384
v_fma_mix_f32 v75, v109, v51, v43 op_sel:[1,0,0] op_sel_hi:[1,0,0]
v_mfma_f32_16x16x32_bf16 v[184:187], a[112:115], v[56:59], v[184:187]
s_waitcnt lgkmcnt(8)
ds_read_b64_tr_b16 a[90:91], v1 offset:18432
v_fma_mix_f32 v76, v110, v52, v44 op_sel:[0,0,0] op_sel_hi:[1,0,0]
v_mfma_f32_16x16x32_bf16 v[224:227], a[116:119], v[56:59], v[224:227]
ds_read_b64_tr_b16 a[92:93], v2 offset:16384
v_fma_mix_f32 v77, v110, v53, v45 op_sel:[1,0,0] op_sel_hi:[1,0,0]
v_mfma_f32_16x16x32_bf16 v[228:231], a[116:119], v[60:63], v[228:231]
s_waitcnt lgkmcnt(8)
ds_read_b64_tr_b16 a[94:95], v2 offset:18432
v_fma_mix_f32 v78, v111, v54, v46 op_sel:[0,0,0] op_sel_hi:[1,0,0]
v_mfma_f32_16x16x32_bf16 v[236:239], a[120:123], v[60:63], v[236:239]
ds_read_b64_tr_b16 a[96:97], v3 offset:16384
v_fma_mix_f32 v79, v111, v55, v47 op_sel:[1,0,0] op_sel_hi:[1,0,0]
v_mfma_f32_16x16x32_bf16 v[232:235], a[120:123], v[56:59], v[232:235]
s_waitcnt lgkmcnt(8)
ds_read_b64_tr_b16 a[98:99], v3 offset:18432
buffer_load_dwordx4 v[108:111], v22, s[24:27], s47 offen offset:3072
v_mfma_f32_16x16x32_bf16 v[240:243], a[124:127], v[56:59], v[240:243]
v_cvt_pk_bf16_f32 v68, v72, v73
v_cvt_pk_bf16_f32 v69, v74, v75
v_mfma_f32_16x16x32_bf16 v[244:247], a[124:127], v[60:63], v[244:247]
s_waitcnt lgkmcnt(7)
v_cvt_pk_bf16_f32 v70, v76, v77
v_cvt_pk_bf16_f32 v71, v78, v79
v_mfma_f32_16x16x32_bf16 v[252:255], a[128:131], v[60:63], v[252:255]
ds_read_b64_tr_b16 a[100:101], v0 offset:24576
ds_read_b64_tr_b16 a[102:103], v0 offset:26624
v_mfma_f32_16x16x32_bf16 v[248:251], a[128:131], v[56:59], v[248:251]
s_waitcnt lgkmcnt(7)
ds_read_b64_tr_b16 a[104:105], v1 offset:24576
buffer_load_dwordx4 v21, s[8:11], s57 offen lds
v_mfma_f32_16x16x32_bf16 v[128:131], a[84:87], v[64:67], v[128:131]
s_add_u32 m0, s4, 106496
s_mov_b32 s57, 3932160
ds_read_b64_tr_b16 a[106:107], v1 offset:26624
v_mfma_f32_16x16x32_bf16 v[132:135], a[84:87], v[68:71], v[132:135]
s_waitcnt lgkmcnt(7)
ds_read_b64_tr_b16 a[108:109], v2 offset:24576
ds_read_b64_tr_b16 a[110:111], v2 offset:26624
v_mfma_f32_16x16x32_bf16 v[140:143], a[88:91], v[68:71], v[140:143]
ds_read_b64_tr_b16 a[112:113], v3 offset:24576
ds_read_b64_tr_b16 a[114:115], v3 offset:26624
v_mfma_f32_16x16x32_bf16 v[136:139], a[88:91], v[64:67], v[136:139]
s_waitcnt lgkmcnt(9)
ds_read_b64_tr_b16 a[116:117], v0 offset:20480
buffer_load_dwordx4 v21, s[8:11], s58 offen lds
v_mfma_f32_16x16x32_bf16 v[144:147], a[92:95], v[64:67], v[144:147]
s_add_u32 m0, s4, 102400
s_mov_b32 s58, 3932416
ds_read_b64_tr_b16 a[118:119], v0 offset:22528
v_mfma_f32_16x16x32_bf16 v[148:151], a[92:95], v[68:71], v[148:151]
s_waitcnt lgkmcnt(10)
ds_read_b64_tr_b16 a[120:121], v1 offset:20480
ds_read_b64_tr_b16 a[122:123], v1 offset:22528
v_mfma_f32_16x16x32_bf16 v[156:159], a[96:99], v[68:71], v[156:159]
ds_read_b64_tr_b16 a[124:125], v2 offset:20480
ds_read_b64_tr_b16 a[126:127], v2 offset:22528
v_mfma_f32_16x16x32_bf16 v[152:155], a[96:99], v[64:67], v[152:155]
s_waitcnt lgkmcnt(12)
ds_read_b64_tr_b16 a[128:129], v3 offset:20480
buffer_load_dwordx4 v21, s[8:11], s59 offen lds
v_mfma_f32_16x16x32_bf16 v[192:195], a[100:103], v[64:67], v[192:195]
s_add_u32 m0, s4, 110592
s_mov_b32 s59, 3932288
ds_read_b64_tr_b16 a[130:131], v3 offset:22528
v_mfma_f32_16x16x32_bf16 v[196:199], a[100:103], v[68:71], v[196:199]
s_waitcnt lgkmcnt(12)
ds_read_b64_tr_b16 a[84:85], v0 offset:28672
ds_read_b64_tr_b16 a[86:87], v0 offset:30720
v_mfma_f32_16x16x32_bf16 v[204:207], a[104:107], v[68:71], v[204:207]
ds_read_b64_tr_b16 a[88:89], v1 offset:28672
ds_read_b64_tr_b16 a[90:91], v1 offset:30720
v_mfma_f32_16x16x32_bf16 v[200:203], a[104:107], v[64:67], v[200:203]
s_waitcnt lgkmcnt(12)
ds_read_b64_tr_b16 a[92:93], v2 offset:28672
buffer_load_dwordx4 v21, s[8:11], s56 offen lds
v_mfma_f32_16x16x32_bf16 v[208:211], a[108:111], v[64:67], v[208:211]
s_add_u32 m0, s4, 114688
s_mov_b32 s56, 3932544
ds_read_b64_tr_b16 a[94:95], v2 offset:30720
v_mfma_f32_16x16x32_bf16 v[212:215], a[108:111], v[68:71], v[212:215]
ds_read_b64_tr_b16 a[96:97], v3 offset:28672
ds_read_b64_tr_b16 a[98:99], v3 offset:30720
v_mfma_f32_16x16x32_bf16 v[220:223], a[112:115], v[68:71], v[220:223]
ds_read_b128 v[24:27], v23 offset:1280
ds_read_b128 v[28:31], v23 offset:1296
v_mfma_f32_16x16x32_bf16 v[216:219], a[112:115], v[64:67], v[216:219]
s_waitcnt lgkmcnt(12)
ds_read_b128 v[32:35], v23 offset:3584
ds_read_b128 v[36:39], v23 offset:3600
v_mfma_f32_16x16x32_bf16 v[160:163], a[116:119], v[64:67], v[160:163]
s_waitcnt vmcnt(18)
s_barrier
ds_read_b64_tr_b16 a[100:101], v0 offset:32768
ds_read_b64_tr_b16 a[102:103], v0 offset:34816
v_mfma_f32_16x16x32_bf16 v[164:167], a[116:119], v[68:71], v[164:167]
ds_read_b64_tr_b16 a[104:105], v1 offset:32768
ds_read_b64_tr_b16 a[106:107], v1 offset:34816
v_mfma_f32_16x16x32_bf16 v[172:175], a[120:123], v[68:71], v[172:175]
ds_read_b64_tr_b16 a[108:109], v2 offset:32768
ds_read_b64_tr_b16 a[110:111], v2 offset:34816
v_mfma_f32_16x16x32_bf16 v[168:171], a[120:123], v[64:67], v[168:171]
ds_read_b64_tr_b16 a[112:113], v3 offset:32768
ds_read_b64_tr_b16 a[114:115], v3 offset:34816
v_mfma_f32_16x16x32_bf16 v[176:179], a[124:127], v[64:67], v[176:179]
ds_read_b64_tr_b16 a[116:117], v0 offset:40960
ds_read_b64_tr_b16 a[118:119], v0 offset:43008
v_mfma_f32_16x16x32_bf16 v[180:183], a[124:127], v[68:71], v[180:183]
s_waitcnt lgkmcnt(15)
ds_read_b64_tr_b16 a[120:121], v1 offset:40960
ds_read_b64_tr_b16 a[122:123], v1 offset:43008
v_mfma_f32_16x16x32_bf16 v[188:191], a[128:131], v[68:71], v[188:191]
s_waitcnt lgkmcnt(13)
v_fma_mix_f32 v72, v112, v32, v24 op_sel:[0,0,0] op_sel_hi:[1,0,0]
v_fma_mix_f32 v73, v112, v33, v25 op_sel:[1,0,0] op_sel_hi:[1,0,0]
v_mfma_f32_16x16x32_bf16 v[184:187], a[128:131], v[64:67], v[184:187]
ds_read_b64_tr_b16 a[124:125], v2 offset:40960
v_fma_mix_f32 v74, v113, v34, v26 op_sel:[0,0,0] op_sel_hi:[1,0,0]
v_mfma_f32_16x16x32_bf16 v[224:227], a[84:87], v[64:67], v[224:227]
s_waitcnt lgkmcnt(13)
v_fma_mix_f32 v75, v113, v35, v27 op_sel:[1,0,0] op_sel_hi:[1,0,0]
v_fma_mix_f32 v76, v114, v36, v28 op_sel:[0,0,0] op_sel_hi:[1,0,0]
v_mfma_f32_16x16x32_bf16 v[228:231], a[84:87], v[68:71], v[228:231]
ds_read_b64_tr_b16 a[126:127], v2 offset:43008
v_fma_mix_f32 v77, v114, v37, v29 op_sel:[1,0,0] op_sel_hi:[1,0,0]
v_mfma_f32_16x16x32_bf16 v[236:239], a[88:91], v[68:71], v[236:239]
v_fma_mix_f32 v78, v115, v38, v30 op_sel:[0,0,0] op_sel_hi:[1,0,0]
v_fma_mix_f32 v79, v115, v39, v31 op_sel:[1,0,0] op_sel_hi:[1,0,0]
v_mfma_f32_16x16x32_bf16 v[232:235], a[88:91], v[64:67], v[232:235]
buffer_load_dwordx4 v[112:115], v22, s[24:27], s48 offen offset:0
v_cvt_pk_bf16_f32 v56, v72, v73
v_mfma_f32_16x16x32_bf16 v[240:243], a[92:95], v[64:67], v[240:243]
v_cvt_pk_bf16_f32 v57, v74, v75
v_cvt_pk_bf16_f32 v58, v76, v77
v_mfma_f32_16x16x32_bf16 v[244:247], a[92:95], v[68:71], v[244:247]
v_cvt_pk_bf16_f32 v59, v78, v79
v_fma_mix_f32 v72, v116, v32, v24 op_sel:[0,0,0] op_sel_hi:[1,0,0]
v_mfma_f32_16x16x32_bf16 v[252:255], a[96:99], v[68:71], v[252:255]
v_fma_mix_f32 v73, v116, v33, v25 op_sel:[1,0,0] op_sel_hi:[1,0,0]
v_fma_mix_f32 v74, v117, v34, v26 op_sel:[0,0,0] op_sel_hi:[1,0,0]
v_mfma_f32_16x16x32_bf16 v[248:251], a[96:99], v[64:67], v[248:251]
s_waitcnt lgkmcnt(2)
buffer_load_dwordx4 v21, s[8:11], s57 offen lds
v_fma_mix_f32 v75, v117, v35, v27 op_sel:[1,0,0] op_sel_hi:[1,0,0]
v_mfma_f32_16x16x32_bf16 v[128:131], a[100:103], v[56:59], v[128:131]
s_add_u32 m0, s4, 122880
s_mov_b32 s57, 4194304
v_fma_mix_f32 v76, v118, v36, v28 op_sel:[0,0,0] op_sel_hi:[1,0,0]
buffer_load_dwordx4 v21, s[8:11], s58 offen lds
v_fma_mix_f32 v77, v118, v37, v29 op_sel:[1,0,0] op_sel_hi:[1,0,0]
v_fma_mix_f32 v78, v119, v38, v30 op_sel:[0,0,0] op_sel_hi:[1,0,0]
v_fma_mix_f32 v79, v119, v39, v31 op_sel:[1,0,0] op_sel_hi:[1,0,0]
s_add_u32 m0, s4, 118784
s_mov_b32 s58, 4194560
buffer_load_dwordx4 v[116:119], v22, s[24:27], s48 offen offset:1024
v_cvt_pk_bf16_f32 v60, v72, v73
v_cvt_pk_bf16_f32 v61, v74, v75
ds_read_b64_tr_b16 a[128:129], v3 offset:40960
buffer_load_dwordx4 v21, s[8:11], s59 offen lds
v_cvt_pk_bf16_f32 v62, v76, v77
v_cvt_pk_bf16_f32 v63, v78, v79
s_add_u32 m0, s4, 126976
s_mov_b32 s59, 4194432
ds_read_b64_tr_b16 a[130:131], v3 offset:43008
ds_read_b64_tr_b16 a[84:85], v0 offset:36864
ds_read_b64_tr_b16 a[86:87], v0 offset:38912
v_mfma_f32_16x16x32_bf16 v[132:135], a[100:103], v[60:63], v[132:135]
ds_read_b64_tr_b16 a[88:89], v1 offset:36864
ds_read_b64_tr_b16 a[90:91], v1 offset:38912
v_mfma_f32_16x16x32_bf16 v[140:143], a[104:107], v[60:63], v[140:143]
ds_read_b64_tr_b16 a[92:93], v2 offset:36864
ds_read_b64_tr_b16 a[94:95], v2 offset:38912
v_mfma_f32_16x16x32_bf16 v[136:139], a[104:107], v[56:59], v[136:139]
ds_read_b64_tr_b16 a[96:97], v3 offset:36864
buffer_load_dwordx4 v21, s[8:11], s56 offen lds
v_mfma_f32_16x16x32_bf16 v[144:147], a[108:111], v[56:59], v[144:147]
s_add_u32 m0, s4, 0
s_mov_b32 s56, 4194688
ds_read_b64_tr_b16 a[98:99], v3 offset:38912
v_mfma_f32_16x16x32_bf16 v[148:151], a[108:111], v[60:63], v[148:151]
ds_read_b64_tr_b16 a[100:101], v0 offset:45056
ds_read_b64_tr_b16 a[102:103], v0 offset:47104
v_mfma_f32_16x16x32_bf16 v[156:159], a[112:115], v[60:63], v[156:159]
ds_read_b64_tr_b16 a[104:105], v1 offset:45056
ds_read_b64_tr_b16 a[106:107], v1 offset:47104
v_mfma_f32_16x16x32_bf16 v[152:155], a[112:115], v[56:59], v[152:155]
ds_read_b64_tr_b16 a[108:109], v2 offset:45056
ds_read_b64_tr_b16 a[110:111], v2 offset:47104
v_mfma_f32_16x16x32_bf16 v[192:195], a[116:119], v[56:59], v[192:195]
ds_read_b64_tr_b16 a[112:113], v3 offset:45056
ds_read_b64_tr_b16 a[114:115], v3 offset:47104
v_mfma_f32_16x16x32_bf16 v[196:199], a[116:119], v[60:63], v[196:199]
ds_read_b128 v[40:43], v23 offset:1408
ds_read_b128 v[44:47], v23 offset:1424
v_mfma_f32_16x16x32_bf16 v[204:207], a[120:123], v[60:63], v[204:207]
ds_read_b128 v[48:51], v23 offset:3712
ds_read_b128 v[52:55], v23 offset:3728
v_mfma_f32_16x16x32_bf16 v[200:203], a[120:123], v[56:59], v[200:203]
s_waitcnt lgkmcnt(14)
ds_read_b64_tr_b16 a[116:117], v0 offset:49152
ds_read_b64_tr_b16 a[118:119], v0 offset:51200
v_mfma_f32_16x16x32_bf16 v[208:211], a[124:127], v[56:59], v[208:211]
ds_read_b64_tr_b16 a[120:121], v1 offset:49152
ds_read_b64_tr_b16 a[122:123], v1 offset:51200
v_mfma_f32_16x16x32_bf16 v[212:215], a[124:127], v[60:63], v[212:215]
ds_read_b64_tr_b16 a[124:125], v2 offset:49152
ds_read_b64_tr_b16 a[126:127], v2 offset:51200
v_mfma_f32_16x16x32_bf16 v[220:223], a[128:131], v[60:63], v[220:223]
ds_read_b128 v[24:27], v23 offset:1536
ds_read_b128 v[28:31], v23 offset:1552
v_mfma_f32_16x16x32_bf16 v[216:219], a[128:131], v[56:59], v[216:219]
ds_read_b64_tr_b16 a[128:129], v3 offset:49152
ds_read_b64_tr_b16 a[130:131], v3 offset:51200
v_mfma_f32_16x16x32_bf16 v[160:163], a[84:87], v[56:59], v[160:163]
ds_read_b128 v[32:35], v23 offset:3840
ds_read_b128 v[36:39], v23 offset:3856
v_mfma_f32_16x16x32_bf16 v[164:167], a[84:87], v[60:63], v[164:167]
s_waitcnt lgkmcnt(13)
v_fma_mix_f32 v72, v120, v48, v40 op_sel:[0,0,0] op_sel_hi:[1,0,0]
v_fma_mix_f32 v73, v120, v49, v41 op_sel:[1,0,0] op_sel_hi:[1,0,0]
v_mfma_f32_16x16x32_bf16 v[172:175], a[88:91], v[60:63], v[172:175]
ds_read_b64_tr_b16 a[84:85], v0 offset:57344
v_fma_mix_f32 v74, v121, v50, v42 op_sel:[0,0,0] op_sel_hi:[1,0,0]
v_mfma_f32_16x16x32_bf16 v[168:171], a[88:91], v[56:59], v[168:171]
s_waitcnt lgkmcnt(13)
v_fma_mix_f32 v75, v121, v51, v43 op_sel:[1,0,0] op_sel_hi:[1,0,0]
v_fma_mix_f32 v76, v122, v52, v44 op_sel:[0,0,0] op_sel_hi:[1,0,0]
v_mfma_f32_16x16x32_bf16 v[176:179], a[92:95], v[56:59], v[176:179]
ds_read_b64_tr_b16 a[86:87], v0 offset:59392
v_fma_mix_f32 v77, v122, v53, v45 op_sel:[1,0,0] op_sel_hi:[1,0,0]
v_mfma_f32_16x16x32_bf16 v[180:183], a[92:95], v[60:63], v[180:183]
v_fma_mix_f32 v78, v123, v54, v46 op_sel:[0,0,0] op_sel_hi:[1,0,0]
v_fma_mix_f32 v79, v123, v55, v47 op_sel:[1,0,0] op_sel_hi:[1,0,0]
v_mfma_f32_16x16x32_bf16 v[188:191], a[96:99], v[60:63], v[188:191]
buffer_load_dwordx4 v[120:123], v22, s[24:27], s48 offen offset:2048
v_cvt_pk_bf16_f32 v64, v72, v73
v_mfma_f32_16x16x32_bf16 v[184:187], a[96:99], v[56:59], v[184:187]
v_cvt_pk_bf16_f32 v65, v74, v75
v_cvt_pk_bf16_f32 v66, v76, v77
v_mfma_f32_16x16x32_bf16 v[224:227], a[100:103], v[56:59], v[224:227]
ds_read_b64_tr_b16 a[88:89], v1 offset:57344
v_cvt_pk_bf16_f32 v67, v78, v79
v_mfma_f32_16x16x32_bf16 v[228:231], a[100:103], v[60:63], v[228:231]
v_fma_mix_f32 v72, v124, v48, v40 op_sel:[0,0,0] op_sel_hi:[1,0,0]
v_fma_mix_f32 v73, v124, v49, v41 op_sel:[1,0,0] op_sel_hi:[1,0,0]
v_mfma_f32_16x16x32_bf16 v[236:239], a[104:107], v[60:63], v[236:239]
ds_read_b64_tr_b16 a[90:91], v1 offset:59392
v_fma_mix_f32 v74, v125, v50, v42 op_sel:[0,0,0] op_sel_hi:[1,0,0]
v_mfma_f32_16x16x32_bf16 v[232:235], a[104:107], v[56:59], v[232:235]
v_fma_mix_f32 v75, v125, v51, v43 op_sel:[1,0,0] op_sel_hi:[1,0,0]
v_fma_mix_f32 v76, v126, v52, v44 op_sel:[0,0,0] op_sel_hi:[1,0,0]
v_mfma_f32_16x16x32_bf16 v[240:243], a[108:111], v[56:59], v[240:243]
v_fma_mix_f32 v77, v126, v53, v45 op_sel:[1,0,0] op_sel_hi:[1,0,0]
v_fma_mix_f32 v78, v127, v54, v46 op_sel:[0,0,0] op_sel_hi:[1,0,0]
v_mfma_f32_16x16x32_bf16 v[244:247], a[108:111], v[60:63], v[244:247]
v_cvt_pk_bf16_f32 v68, v72, v73
v_fma_mix_f32 v79, v127, v55, v47 op_sel:[1,0,0] op_sel_hi:[1,0,0]
v_mfma_f32_16x16x32_bf16 v[252:255], a[112:115], v[60:63], v[252:255]
buffer_load_dwordx4 v[124:127], v22, s[24:27], s48 offen offset:3072
v_cvt_pk_bf16_f32 v69, v74, v75
v_mfma_f32_16x16x32_bf16 v[248:251], a[112:115], v[56:59], v[248:251]
s_waitcnt lgkmcnt(2)
s_mov_b64 s[24:25], s[94:95]
v_cvt_pk_bf16_f32 v70, v76, v77
v_cvt_pk_bf16_f32 v71, v78, v79
v_mfma_f32_16x16x32_bf16 v[128:131], a[116:119], v[64:67], v[128:131]
s_mov_b32 s26, 5308416
ds_read_b64_tr_b16 a[92:93], v2 offset:57344
v_fma_mix_f32 v72, v80, v32, v24 op_sel:[0,0,0] op_sel_hi:[1,0,0]
v_mfma_f32_16x16x32_bf16 v[132:135], a[116:119], v[68:71], v[132:135]
ds_read_b64_tr_b16 a[94:95], v2 offset:59392
v_fma_mix_f32 v73, v80, v33, v25 op_sel:[1,0,0] op_sel_hi:[1,0,0]
v_mfma_f32_16x16x32_bf16 v[140:143], a[120:123], v[68:71], v[140:143]
ds_read_b64_tr_b16 a[96:97], v3 offset:57344
buffer_load_dwordx4 v21, s[8:11], s57 offen lds
v_mfma_f32_16x16x32_bf16 v[136:139], a[120:123], v[64:67], v[136:139]
s_add_u32 m0, s4, 8192
s_mov_b32 s57, 4456448
ds_read_b64_tr_b16 a[98:99], v3 offset:59392
v_mfma_f32_16x16x32_bf16 v[144:147], a[124:127], v[64:67], v[144:147]
ds_read_b64_tr_b16 a[100:101], v0 offset:53248
v_fma_mix_f32 v74, v81, v34, v26 op_sel:[0,0,0] op_sel_hi:[1,0,0]
v_mfma_f32_16x16x32_bf16 v[148:151], a[124:127], v[68:71], v[148:151]
ds_read_b64_tr_b16 a[102:103], v0 offset:55296
v_fma_mix_f32 v75, v81, v35, v27 op_sel:[1,0,0] op_sel_hi:[1,0,0]
v_mfma_f32_16x16x32_bf16 v[156:159], a[128:131], v[68:71], v[156:159]
ds_read_b64_tr_b16 a[104:105], v1 offset:53248
buffer_load_dwordx4 v21, s[8:11], s58 offen lds
v_mfma_f32_16x16x32_bf16 v[152:155], a[128:131], v[64:67], v[152:155]
s_add_u32 m0, s4, 4096
s_mov_b32 s58, 4456704
ds_read_b64_tr_b16 a[106:107], v1 offset:55296
v_mfma_f32_16x16x32_bf16 v[192:195], a[84:87], v[64:67], v[192:195]
ds_read_b64_tr_b16 a[108:109], v2 offset:53248
v_fma_mix_f32 v76, v82, v36, v28 op_sel:[0,0,0] op_sel_hi:[1,0,0]
v_mfma_f32_16x16x32_bf16 v[196:199], a[84:87], v[68:71], v[196:199]
s_waitcnt lgkmcnt(8)
ds_read_b64_tr_b16 a[110:111], v2 offset:55296
v_fma_mix_f32 v77, v82, v37, v29 op_sel:[1,0,0] op_sel_hi:[1,0,0]
v_mfma_f32_16x16x32_bf16 v[204:207], a[88:91], v[68:71], v[204:207]
ds_read_b64_tr_b16 a[112:113], v3 offset:53248
buffer_load_dwordx4 v21, s[8:11], s59 offen lds
v_mfma_f32_16x16x32_bf16 v[200:203], a[88:91], v[64:67], v[200:203]
s_waitcnt lgkmcnt(8)
s_add_u32 m0, s4, 12288
s_mov_b32 s59, 4456576
ds_read_b64_tr_b16 a[114:115], v3 offset:55296
v_mfma_f32_16x16x32_bf16 v[208:211], a[92:95], v[64:67], v[208:211]
ds_read_b64_tr_b16 a[116:117], v0 offset:61440
v_fma_mix_f32 v78, v83, v38, v30 op_sel:[0,0,0] op_sel_hi:[1,0,0]
v_mfma_f32_16x16x32_bf16 v[212:215], a[92:95], v[68:71], v[212:215]
s_waitcnt lgkmcnt(8)
ds_read_b64_tr_b16 a[118:119], v0 offset:63488
v_fma_mix_f32 v79, v83, v39, v31 op_sel:[1,0,0] op_sel_hi:[1,0,0]
v_mfma_f32_16x16x32_bf16 v[220:223], a[96:99], v[68:71], v[220:223]
ds_read_b64_tr_b16 a[120:121], v1 offset:61440
buffer_load_dwordx4 v21, s[8:11], s56 offen lds
v_mfma_f32_16x16x32_bf16 v[216:219], a[96:99], v[64:67], v[216:219]
s_waitcnt lgkmcnt(8)
s_add_u32 m0, s4, 16384
s_mov_b32 s56, 4456832
ds_read_b64_tr_b16 a[122:123], v1 offset:63488
v_mfma_f32_16x16x32_bf16 v[160:163], a[100:103], v[64:67], v[160:163]
s_waitcnt vmcnt(18)
s_barrier
ds_read_b64_tr_b16 a[124:125], v2 offset:61440
v_cvt_pk_bf16_f32 v56, v72, v73
v_mfma_f32_16x16x32_bf16 v[164:167], a[100:103], v[68:71], v[164:167]
s_waitcnt lgkmcnt(8)
ds_read_b64_tr_b16 a[126:127], v2 offset:63488
v_cvt_pk_bf16_f32 v57, v74, v75
v_mfma_f32_16x16x32_bf16 v[172:175], a[104:107], v[68:71], v[172:175]
ds_read_b64_tr_b16 a[128:129], v3 offset:61440
v_cvt_pk_bf16_f32 v58, v76, v77
v_mfma_f32_16x16x32_bf16 v[168:171], a[104:107], v[64:67], v[168:171]
s_waitcnt lgkmcnt(8)
ds_read_b64_tr_b16 a[130:131], v3 offset:63488
v_cvt_pk_bf16_f32 v59, v78, v79
v_mfma_f32_16x16x32_bf16 v[176:179], a[108:111], v[64:67], v[176:179]
ds_read_b64_tr_b16 a[84:85], v4 offset:0
v_fma_mix_f32 v72, v84, v32, v24 op_sel:[0,0,0] op_sel_hi:[1,0,0]
v_mfma_f32_16x16x32_bf16 v[180:183], a[108:111], v[68:71], v[180:183]
s_waitcnt lgkmcnt(8)
ds_read_b64_tr_b16 a[86:87], v4 offset:2048
v_fma_mix_f32 v73, v84, v33, v25 op_sel:[1,0,0] op_sel_hi:[1,0,0]
v_mfma_f32_16x16x32_bf16 v[188:191], a[112:115], v[68:71], v[188:191]
ds_read_b64_tr_b16 a[88:89], v5 offset:0
v_fma_mix_f32 v74, v85, v34, v26 op_sel:[0,0,0] op_sel_hi:[1,0,0]
v_mfma_f32_16x16x32_bf16 v[184:187], a[112:115], v[64:67], v[184:187]
s_waitcnt lgkmcnt(8)
ds_read_b64_tr_b16 a[90:91], v5 offset:2048
v_fma_mix_f32 v75, v85, v35, v27 op_sel:[1,0,0] op_sel_hi:[1,0,0]
v_mfma_f32_16x16x32_bf16 v[224:227], a[116:119], v[64:67], v[224:227]
ds_read_b64_tr_b16 a[92:93], v6 offset:0
v_fma_mix_f32 v76, v86, v36, v28 op_sel:[0,0,0] op_sel_hi:[1,0,0]
v_mfma_f32_16x16x32_bf16 v[228:231], a[116:119], v[68:71], v[228:231]
s_waitcnt lgkmcnt(8)
ds_read_b64_tr_b16 a[94:95], v6 offset:2048
v_fma_mix_f32 v77, v86, v37, v29 op_sel:[1,0,0] op_sel_hi:[1,0,0]
v_mfma_f32_16x16x32_bf16 v[236:239], a[120:123], v[68:71], v[236:239]
ds_read_b64_tr_b16 a[96:97], v7 offset:0
v_fma_mix_f32 v78, v87, v38, v30 op_sel:[0,0,0] op_sel_hi:[1,0,0]
v_mfma_f32_16x16x32_bf16 v[232:235], a[120:123], v[64:67], v[232:235]
s_waitcnt lgkmcnt(8)
ds_read_b64_tr_b16 a[98:99], v7 offset:2048
v_fma_mix_f32 v79, v87, v39, v31 op_sel:[1,0,0] op_sel_hi:[1,0,0]
v_mfma_f32_16x16x32_bf16 v[240:243], a[124:127], v[64:67], v[240:243]
v_cvt_pk_bf16_f32 v60, v72, v73
v_cvt_pk_bf16_f32 v61, v74, v75
v_mfma_f32_16x16x32_bf16 v[244:247], a[124:127], v[68:71], v[244:247]
s_waitcnt lgkmcnt(7)
v_cvt_pk_bf16_f32 v62, v76, v77
v_cvt_pk_bf16_f32 v63, v78, v79
v_mfma_f32_16x16x32_bf16 v[252:255], a[128:131], v[68:71], v[252:255]
ds_read_b64_tr_b16 a[100:101], v4 offset:8192
ds_read_b64_tr_b16 a[102:103], v4 offset:10240
v_mfma_f32_16x16x32_bf16 v[248:251], a[128:131], v[64:67], v[248:251]
s_waitcnt lgkmcnt(7)
ds_read_b64_tr_b16 a[104:105], v5 offset:8192
buffer_load_dwordx4 v21, s[8:11], s57 offen lds
v_mfma_f32_16x16x32_bf16 v[128:131], a[84:87], v[56:59], v[128:131]
s_add_u32 m0, s4, 24576
s_mov_b32 s57, 0
ds_read_b64_tr_b16 a[106:107], v5 offset:10240
v_mfma_f32_16x16x32_bf16 v[132:135], a[84:87], v[60:63], v[132:135]
s_waitcnt lgkmcnt(7)
ds_read_b64_tr_b16 a[108:109], v6 offset:8192
ds_read_b64_tr_b16 a[110:111], v6 offset:10240
v_mfma_f32_16x16x32_bf16 v[140:143], a[88:91], v[60:63], v[140:143]
ds_read_b64_tr_b16 a[112:113], v7 offset:8192
ds_read_b64_tr_b16 a[114:115], v7 offset:10240
v_mfma_f32_16x16x32_bf16 v[136:139], a[88:91], v[56:59], v[136:139]
s_waitcnt lgkmcnt(9)
ds_read_b64_tr_b16 a[116:117], v4 offset:4096
buffer_load_dwordx4 v21, s[8:11], s58 offen lds
v_mfma_f32_16x16x32_bf16 v[144:147], a[92:95], v[56:59], v[144:147]
s_add_u32 m0, s4, 20480
s_movk_i32 s58, 8192
ds_read_b64_tr_b16 a[118:119], v4 offset:6144
v_mfma_f32_16x16x32_bf16 v[148:151], a[92:95], v[60:63], v[148:151]
s_waitcnt lgkmcnt(10)
ds_read_b64_tr_b16 a[120:121], v5 offset:4096
ds_read_b64_tr_b16 a[122:123], v5 offset:6144
v_mfma_f32_16x16x32_bf16 v[156:159], a[96:99], v[60:63], v[156:159]
ds_read_b64_tr_b16 a[124:125], v6 offset:4096
ds_read_b64_tr_b16 a[126:127], v6 offset:6144
v_mfma_f32_16x16x32_bf16 v[152:155], a[96:99], v[56:59], v[152:155]
s_waitcnt lgkmcnt(12)
ds_read_b64_tr_b16 a[128:129], v7 offset:4096
buffer_load_dwordx4 v21, s[8:11], s59 offen lds
v_mfma_f32_16x16x32_bf16 v[192:195], a[100:103], v[56:59], v[192:195]
s_add_u32 m0, s4, 28672
s_mov_b32 s59, 0
ds_read_b64_tr_b16 a[130:131], v7 offset:6144
v_mfma_f32_16x16x32_bf16 v[196:199], a[100:103], v[60:63], v[196:199]
s_waitcnt lgkmcnt(12)
ds_read_b64_tr_b16 a[84:85], v4 offset:12288
ds_read_b64_tr_b16 a[86:87], v4 offset:14336
v_mfma_f32_16x16x32_bf16 v[204:207], a[104:107], v[60:63], v[204:207]
ds_read_b64_tr_b16 a[88:89], v5 offset:12288
ds_read_b64_tr_b16 a[90:91], v5 offset:14336
v_mfma_f32_16x16x32_bf16 v[200:203], a[104:107], v[56:59], v[200:203]
s_waitcnt lgkmcnt(12)
buffer_load_dwordx4 v21, s[8:11], s56 offen lds
v_mbcnt_lo_u32_b32 v21, -1, 0
v_mfma_f32_16x16x32_bf16 v[208:211], a[108:111], v[56:59], v[208:211]
s_add_u32 m0, s5, 32768
s_movk_i32 s56, 128
ds_read_b64_tr_b16 a[92:93], v6 offset:12288
v_mfma_f32_16x16x32_bf16 v[212:215], a[108:111], v[60:63], v[212:215]
s_mov_b64 s[8:9], s[92:93]
ds_read_b64_tr_b16 a[94:95], v6 offset:14336
v_mbcnt_hi_u32_b32 v21, -1, v21
v_mfma_f32_16x16x32_bf16 v[220:223], a[112:115], v[60:63], v[220:223]
s_mov_b32 s10, 5308416
ds_read_b64_tr_b16 a[96:97], v7 offset:12288
v_lshl_add_u32 v21, s3, 6, v21
v_mfma_f32_16x16x32_bf16 v[216:219], a[112:115], v[56:59], v[216:219]
s_waitcnt lgkmcnt(9)
ds_read_b64_tr_b16 a[98:99], v7 offset:14336
v_min_u32 v21, 179, v21
v_mfma_f32_16x16x32_bf16 v[160:163], a[116:119], v[56:59], v[160:163]
ds_read_b128 v[40:43], v23 offset:1664
v_lshlrev_b32_e64 v22, 7, v21
v_mfma_f32_16x16x32_bf16 v[164:167], a[116:119], v[60:63], v[164:167]
ds_read_b128 v[44:47], v23 offset:1680
v_mul_u32_u24 v21, 205, v21
v_mfma_f32_16x16x32_bf16 v[172:175], a[120:123], v[60:63], v[172:175]
v_lshrrev_b32_e64 v21, 10, v21
v_mul_u32_u24 v21, 8576, v21
v_mfma_f32_16x16x32_bf16 v[168:171], a[120:123], v[56:59], v[168:171]
ds_read_b128 v[48:51], v23 offset:3968
v_add_u32 v21, v21, v22
v_mfma_f32_16x16x32_bf16 v[176:179], a[124:127], v[56:59], v[176:179]
ds_read_b128 v[52:55], v23 offset:3984
ds_read_b64_tr_b16 a[100:101], v4 offset:16384
v_mfma_f32_16x16x32_bf16 v[180:183], a[124:127], v[60:63], v[180:183]
s_waitcnt lgkmcnt(8)
ds_read_b64_tr_b16 a[102:103], v4 offset:18432
ds_read_b64_tr_b16 a[104:105], v5 offset:16384
v_mfma_f32_16x16x32_bf16 v[188:191], a[128:131], v[60:63], v[188:191]
ds_read_b64_tr_b16 a[106:107], v5 offset:18432
ds_read_b64_tr_b16 a[108:109], v6 offset:16384
v_mfma_f32_16x16x32_bf16 v[184:187], a[128:131], v[56:59], v[184:187]
ds_read_b64_tr_b16 a[110:111], v6 offset:18432
ds_read_b64_tr_b16 a[112:113], v7 offset:16384
v_mfma_f32_16x16x32_bf16 v[224:227], a[84:87], v[56:59], v[224:227]
ds_read_b64_tr_b16 a[114:115], v7 offset:18432
ds_read_b64_tr_b16 a[116:117], v4 offset:24576
v_mfma_f32_16x16x32_bf16 v[228:231], a[84:87], v[60:63], v[228:231]
ds_read_b64_tr_b16 a[118:119], v4 offset:26624
ds_read_b64_tr_b16 a[120:121], v5 offset:24576
v_mfma_f32_16x16x32_bf16 v[236:239], a[88:91], v[60:63], v[236:239]
s_waitcnt lgkmcnt(12)
v_fma_mix_f32 v72, v88, v48, v40 op_sel:[0,0,0] op_sel_hi:[1,0,0]
v_fma_mix_f32 v73, v88, v49, v41 op_sel:[1,0,0] op_sel_hi:[1,0,0]
v_mfma_f32_16x16x32_bf16 v[232:235], a[88:91], v[56:59], v[232:235]
v_fma_mix_f32 v74, v89, v50, v42 op_sel:[0,0,0] op_sel_hi:[1,0,0]
v_fma_mix_f32 v75, v89, v51, v43 op_sel:[1,0,0] op_sel_hi:[1,0,0]
v_mfma_f32_16x16x32_bf16 v[240:243], a[92:95], v[56:59], v[240:243]
s_waitcnt lgkmcnt(11)
v_fma_mix_f32 v76, v90, v52, v44 op_sel:[0,0,0] op_sel_hi:[1,0,0]
v_fma_mix_f32 v77, v90, v53, v45 op_sel:[1,0,0] op_sel_hi:[1,0,0]
v_mfma_f32_16x16x32_bf16 v[244:247], a[92:95], v[60:63], v[244:247]
v_fma_mix_f32 v78, v91, v54, v46 op_sel:[0,0,0] op_sel_hi:[1,0,0]
v_fma_mix_f32 v79, v91, v55, v47 op_sel:[1,0,0] op_sel_hi:[1,0,0]
v_mfma_f32_16x16x32_bf16 v[252:255], a[96:99], v[60:63], v[252:255]
v_cvt_pk_bf16_f32 v64, v72, v73
v_cvt_pk_bf16_f32 v65, v74, v75
v_mfma_f32_16x16x32_bf16 v[248:251], a[96:99], v[56:59], v[248:251]
buffer_load_dwordx4 v16, s[12:15], s57 offen lds
v_cvt_pk_bf16_f32 v66, v76, v77
buffer_load_dwordx4 v17, s[12:15], s57 offen offset:1024 lds
v_cvt_pk_bf16_f32 v67, v78, v79
v_fma_mix_f32 v72, v92, v48, v40 op_sel:[0,0,0] op_sel_hi:[1,0,0]
v_fma_mix_f32 v73, v92, v49, v41 op_sel:[1,0,0] op_sel_hi:[1,0,0]
s_add_u32 m0, s5, 40960
s_movk_i32 s57, 16384
v_fma_mix_f32 v74, v93, v50, v42 op_sel:[0,0,0] op_sel_hi:[1,0,0]
v_fma_mix_f32 v75, v93, v51, v43 op_sel:[1,0,0] op_sel_hi:[1,0,0]
v_fma_mix_f32 v76, v94, v52, v44 op_sel:[0,0,0] op_sel_hi:[1,0,0]
s_waitcnt lgkmcnt(6)
v_mfma_f32_16x16x32_bf16 v[128:131], a[100:103], v[64:67], v[128:131]
v_fma_mix_f32 v77, v94, v53, v45 op_sel:[1,0,0] op_sel_hi:[1,0,0]
v_fma_mix_f32 v78, v95, v54, v46 op_sel:[0,0,0] op_sel_hi:[1,0,0]
buffer_load_dwordx4 v16, s[12:15], s58 offen lds
buffer_load_dwordx4 v17, s[12:15], s58 offen offset:1024 lds
v_cvt_pk_bf16_f32 v68, v72, v73
v_fma_mix_f32 v79, v95, v55, v47 op_sel:[1,0,0] op_sel_hi:[1,0,0]
s_add_u32 m0, s4, 49152
s_movk_i32 s58, 8192
v_cvt_pk_bf16_f32 v69, v74, v75
v_cvt_pk_bf16_f32 v70, v76, v77
v_cvt_pk_bf16_f32 v71, v78, v79
ds_read_b64_tr_b16 a[122:123], v5 offset:26624
ds_read_b64_tr_b16 a[124:125], v6 offset:24576
ds_read_b64_tr_b16 a[126:127], v6 offset:26624
ds_read_b64_tr_b16 a[128:129], v7 offset:24576
v_mfma_f32_16x16x32_bf16 v[132:135], a[100:103], v[68:71], v[132:135]
ds_read_b64_tr_b16 a[130:131], v7 offset:26624
ds_read_b64_tr_b16 a[84:85], v4 offset:20480
v_mfma_f32_16x16x32_bf16 v[140:143], a[104:107], v[68:71], v[140:143]
ds_read_b64_tr_b16 a[86:87], v4 offset:22528
ds_read_b64_tr_b16 a[88:89], v5 offset:20480
v_mfma_f32_16x16x32_bf16 v[136:139], a[104:107], v[64:67], v[136:139]
s_waitcnt lgkmcnt(8)
ds_read_b64_tr_b16 a[90:91], v5 offset:22528
ds_read_b64_tr_b16 a[92:93], v6 offset:20480
v_mfma_f32_16x16x32_bf16 v[144:147], a[108:111], v[64:67], v[144:147]
ds_read_b64_tr_b16 a[94:95], v6 offset:22528
ds_read_b64_tr_b16 a[96:97], v7 offset:20480
v_mfma_f32_16x16x32_bf16 v[148:151], a[108:111], v[68:71], v[148:151]
ds_read_b64_tr_b16 a[98:99], v7 offset:22528
ds_read_b64_tr_b16 a[100:101], v4 offset:28672
v_mfma_f32_16x16x32_bf16 v[156:159], a[112:115], v[68:71], v[156:159]
ds_read_b64_tr_b16 a[102:103], v4 offset:30720
ds_read_b64_tr_b16 a[104:105], v5 offset:28672
v_mfma_f32_16x16x32_bf16 v[152:155], a[112:115], v[64:67], v[152:155]
ds_read_b64_tr_b16 a[106:107], v5 offset:30720
ds_read_b64_tr_b16 a[108:109], v6 offset:28672
v_mfma_f32_16x16x32_bf16 v[192:195], a[116:119], v[64:67], v[192:195]
ds_read_b64_tr_b16 a[110:111], v6 offset:30720
ds_read_b64_tr_b16 a[112:113], v7 offset:28672
v_mfma_f32_16x16x32_bf16 v[196:199], a[116:119], v[68:71], v[196:199]
s_waitcnt lgkmcnt(15)
ds_read_b64_tr_b16 a[114:115], v7 offset:30720
ds_read_b128 v[24:27], v23 offset:1792
v_mfma_f32_16x16x32_bf16 v[204:207], a[120:123], v[68:71], v[204:207]
ds_read_b128 v[28:31], v23 offset:1808
ds_read_b128 v[32:35], v23 offset:4096
v_mfma_f32_16x16x32_bf16 v[200:203], a[120:123], v[64:67], v[200:203]
ds_read_b128 v[36:39], v23 offset:4112
ds_read_b128 v[40:43], v23 offset:1920
v_mfma_f32_16x16x32_bf16 v[208:211], a[124:127], v[64:67], v[208:211]
ds_read_b128 v[44:47], v23 offset:1936
ds_read_b128 v[48:51], v23 offset:4224
v_mfma_f32_16x16x32_bf16 v[212:215], a[124:127], v[68:71], v[212:215]
ds_read_b128 v[52:55], v23 offset:4240
v_mfma_f32_16x16x32_bf16 v[220:223], a[128:131], v[68:71], v[220:223]
v_mfma_f32_16x16x32_bf16 v[216:219], a[128:131], v[64:67], v[216:219]
s_waitcnt lgkmcnt(13)
v_mfma_f32_16x16x32_bf16 v[160:163], a[84:87], v[64:67], v[160:163]
s_waitcnt vmcnt(14)
s_barrier
ds_read_b64_tr_b16 a[116:117], v4 offset:32768
ds_read_b64_tr_b16 a[118:119], v4 offset:34816
v_mfma_f32_16x16x32_bf16 v[164:167], a[84:87], v[68:71], v[164:167]
s_waitcnt lgkmcnt(7)
v_fma_mix_f32 v72, v96, v32, v24 op_sel:[0,0,0] op_sel_hi:[1,0,0]
v_fma_mix_f32 v73, v96, v33, v25 op_sel:[1,0,0] op_sel_hi:[1,0,0]
v_mfma_f32_16x16x32_bf16 v[172:175], a[88:91], v[68:71], v[172:175]
ds_read_b64_tr_b16 a[120:121], v5 offset:32768
v_fma_mix_f32 v74, v97, v34, v26 op_sel:[0,0,0] op_sel_hi:[1,0,0]
v_mfma_f32_16x16x32_bf16 v[168:171], a[88:91], v[64:67], v[168:171]
s_waitcnt lgkmcnt(7)
v_fma_mix_f32 v75, v97, v35, v27 op_sel:[1,0,0] op_sel_hi:[1,0,0]
v_fma_mix_f32 v76, v98, v36, v28 op_sel:[0,0,0] op_sel_hi:[1,0,0]
v_mfma_f32_16x16x32_bf16 v[176:179], a[92:95], v[64:67], v[176:179]
ds_read_b64_tr_b16 a[122:123], v5 offset:34816
v_fma_mix_f32 v77, v98, v37, v29 op_sel:[1,0,0] op_sel_hi:[1,0,0]
v_mfma_f32_16x16x32_bf16 v[180:183], a[92:95], v[68:71], v[180:183]
v_fma_mix_f32 v78, v99, v38, v30 op_sel:[0,0,0] op_sel_hi:[1,0,0]
v_fma_mix_f32 v79, v99, v39, v31 op_sel:[1,0,0] op_sel_hi:[1,0,0]
v_mfma_f32_16x16x32_bf16 v[188:191], a[96:99], v[68:71], v[188:191]
ds_read_b64_tr_b16 a[124:125], v6 offset:32768
v_cvt_pk_bf16_f32 v56, v72, v73
v_mfma_f32_16x16x32_bf16 v[184:187], a[96:99], v[64:67], v[184:187]
v_cvt_pk_bf16_f32 v57, v74, v75
v_cvt_pk_bf16_f32 v58, v76, v77
v_mfma_f32_16x16x32_bf16 v[224:227], a[100:103], v[64:67], v[224:227]
ds_read_b64_tr_b16 a[126:127], v6 offset:34816
v_cvt_pk_bf16_f32 v59, v78, v79
v_mfma_f32_16x16x32_bf16 v[228:231], a[100:103], v[68:71], v[228:231]
v_fma_mix_f32 v72, v100, v32, v24 op_sel:[0,0,0] op_sel_hi:[1,0,0]
v_fma_mix_f32 v73, v100, v33, v25 op_sel:[1,0,0] op_sel_hi:[1,0,0]
v_mfma_f32_16x16x32_bf16 v[236:239], a[104:107], v[68:71], v[236:239]
ds_read_b64_tr_b16 a[128:129], v7 offset:32768
v_fma_mix_f32 v74, v101, v34, v26 op_sel:[0,0,0] op_sel_hi:[1,0,0]
v_mfma_f32_16x16x32_bf16 v[232:235], a[104:107], v[64:67], v[232:235]
ds_read_b64_tr_b16 a[130:131], v7 offset:34816
v_fma_mix_f32 v75, v101, v35, v27 op_sel:[1,0,0] op_sel_hi:[1,0,0]
v_mfma_f32_16x16x32_bf16 v[240:243], a[108:111], v[64:67], v[240:243]
v_fma_mix_f32 v76, v102, v36, v28 op_sel:[0,0,0] op_sel_hi:[1,0,0]
v_fma_mix_f32 v77, v102, v37, v29 op_sel:[1,0,0] op_sel_hi:[1,0,0]
v_mfma_f32_16x16x32_bf16 v[244:247], a[108:111], v[68:71], v[244:247]
v_fma_mix_f32 v78, v103, v38, v30 op_sel:[0,0,0] op_sel_hi:[1,0,0]
v_fma_mix_f32 v79, v103, v39, v31 op_sel:[1,0,0] op_sel_hi:[1,0,0]
v_mfma_f32_16x16x32_bf16 v[252:255], a[112:115], v[68:71], v[252:255]
v_cvt_pk_bf16_f32 v60, v72, v73
v_cvt_pk_bf16_f32 v61, v74, v75
v_mfma_f32_16x16x32_bf16 v[248:251], a[112:115], v[64:67], v[248:251]
s_waitcnt lgkmcnt(3)
buffer_load_dwordx4 v18, s[16:19], s59 offen lds
v_cvt_pk_bf16_f32 v62, v76, v77
v_mfma_f32_16x16x32_bf16 v[128:131], a[116:119], v[56:59], v[128:131]
s_add_u32 m0, s4, 53248
s_movk_i32 s59, 8320
v_cvt_pk_bf16_f32 v63, v78, v79
ds_read_b64_tr_b16 a[84:85], v4 offset:40960
ds_read_b64_tr_b16 a[86:87], v4 offset:43008
ds_read_b64_tr_b16 a[88:89], v5 offset:40960
buffer_load_dwordx4 v18, s[16:19], s56 offen lds
v_mfma_f32_16x16x32_bf16 v[132:135], a[116:119], v[60:63], v[132:135]
s_add_u32 m0, s5, 57344
s_movk_i32 s56, 24576
ds_read_b64_tr_b16 a[90:91], v5 offset:43008
v_mfma_f32_16x16x32_bf16 v[140:143], a[120:123], v[60:63], v[140:143]
ds_read_b64_tr_b16 a[92:93], v6 offset:40960
ds_read_b64_tr_b16 a[94:95], v6 offset:43008
v_mfma_f32_16x16x32_bf16 v[136:139], a[120:123], v[56:59], v[136:139]
s_waitcnt lgkmcnt(7)
ds_read_b64_tr_b16 a[96:97], v7 offset:40960
ds_read_b64_tr_b16 a[98:99], v7 offset:43008
v_mfma_f32_16x16x32_bf16 v[144:147], a[124:127], v[56:59], v[144:147]
buffer_load_dwordx4 v16, s[12:15], s57 offen lds
v_fma_mix_f32 v72, v104, v48, v40 op_sel:[0,0,0] op_sel_hi:[1,0,0]
v_mfma_f32_16x16x32_bf16 v[148:151], a[124:127], v[60:63], v[148:151]
s_waitcnt lgkmcnt(8)
ds_read_b64_tr_b16 a[100:101], v4 offset:36864
ds_read_b64_tr_b16 a[102:103], v4 offset:38912
v_mfma_f32_16x16x32_bf16 v[156:159], a[128:131], v[60:63], v[156:159]
v_fma_mix_f32 v73, v104, v49, v41 op_sel:[1,0,0] op_sel_hi:[1,0,0]
v_fma_mix_f32 v74, v105, v50, v42 op_sel:[0,0,0] op_sel_hi:[1,0,0]
v_mfma_f32_16x16x32_bf16 v[152:155], a[128:131], v[56:59], v[152:155]
s_waitcnt lgkmcnt(8)
ds_read_b64_tr_b16 a[104:105], v5 offset:36864
ds_read_b64_tr_b16 a[106:107], v5 offset:38912
v_mfma_f32_16x16x32_bf16 v[192:195], a[84:87], v[56:59], v[192:195]
ds_read_b64_tr_b16 a[108:109], v6 offset:36864
buffer_load_dwordx4 v17, s[12:15], s57 offen offset:1024 lds
v_mfma_f32_16x16x32_bf16 v[196:199], a[84:87], v[60:63], v[196:199]
s_waitcnt lgkmcnt(9)
s_mov_b32 m0, 155968
s_movk_i32 s57, 16384
ds_read_b64_tr_b16 a[110:111], v6 offset:38912
v_mfma_f32_16x16x32_bf16 v[204:207], a[88:91], v[60:63], v[204:207]
ds_read_b64_tr_b16 a[112:113], v7 offset:36864
v_fma_mix_f32 v75, v105, v51, v43 op_sel:[1,0,0] op_sel_hi:[1,0,0]
v_mfma_f32_16x16x32_bf16 v[200:203], a[88:91], v[56:59], v[200:203]
s_waitcnt lgkmcnt(9)
ds_read_b64_tr_b16 a[114:115], v7 offset:38912
v_fma_mix_f32 v76, v106, v52, v44 op_sel:[0,0,0] op_sel_hi:[1,0,0]
v_mfma_f32_16x16x32_bf16 v[208:211], a[92:95], v[56:59], v[208:211]
ds_read_b64_tr_b16 a[116:117], v4 offset:45056
s_bfm_b64 exec, 16, 0
buffer_load_dword v22, s[20:23], s49 offen  lds
s_mov_b64 exec, -1
v_mfma_f32_16x16x32_bf16 v[212:215], a[92:95], v[60:63], v[212:215]
s_waitcnt lgkmcnt(9)
s_add_u32 m0, s4, 65536
ds_read_b64_tr_b16 a[118:119], v4 offset:47104
v_fma_mix_f32 v77, v106, v53, v45 op_sel:[1,0,0] op_sel_hi:[1,0,0]
v_mfma_f32_16x16x32_bf16 v[220:223], a[96:99], v[60:63], v[220:223]
ds_read_b64_tr_b16 a[120:121], v5 offset:45056
v_fma_mix_f32 v78, v107, v54, v46 op_sel:[0,0,0] op_sel_hi:[1,0,0]
v_mfma_f32_16x16x32_bf16 v[216:219], a[96:99], v[56:59], v[216:219]
s_waitcnt lgkmcnt(9)
ds_read_b64_tr_b16 a[122:123], v5 offset:47104
v_fma_mix_f32 v79, v107, v55, v47 op_sel:[1,0,0] op_sel_hi:[1,0,0]
v_mfma_f32_16x16x32_bf16 v[160:163], a[100:103], v[56:59], v[160:163]
ds_read_b64_tr_b16 a[124:125], v6 offset:45056
v_cvt_pk_bf16_f32 v64, v72, v73
v_mfma_f32_16x16x32_bf16 v[164:167], a[100:103], v[60:63], v[164:167]
s_waitcnt lgkmcnt(8)
ds_read_b64_tr_b16 a[126:127], v6 offset:47104
v_cvt_pk_bf16_f32 v65, v74, v75
v_mfma_f32_16x16x32_bf16 v[172:175], a[104:107], v[60:63], v[172:175]
ds_read_b64_tr_b16 a[128:129], v7 offset:45056
v_cvt_pk_bf16_f32 v66, v76, v77
v_mfma_f32_16x16x32_bf16 v[168:171], a[104:107], v[56:59], v[168:171]
s_waitcnt lgkmcnt(8)
ds_read_b64_tr_b16 a[130:131], v7 offset:47104
v_cvt_pk_bf16_f32 v67, v78, v79
v_mfma_f32_16x16x32_bf16 v[176:179], a[108:111], v[56:59], v[176:179]
ds_read_b64_tr_b16 a[84:85], v4 offset:49152
v_fma_mix_f32 v72, v108, v48, v40 op_sel:[0,0,0] op_sel_hi:[1,0,0]
v_mfma_f32_16x16x32_bf16 v[180:183], a[108:111], v[60:63], v[180:183]
s_waitcnt lgkmcnt(8)
ds_read_b64_tr_b16 a[86:87], v4 offset:51200
v_fma_mix_f32 v73, v108, v49, v41 op_sel:[1,0,0] op_sel_hi:[1,0,0]
v_mfma_f32_16x16x32_bf16 v[188:191], a[112:115], v[60:63], v[188:191]
ds_read_b64_tr_b16 a[88:89], v5 offset:49152
v_fma_mix_f32 v74, v109, v50, v42 op_sel:[0,0,0] op_sel_hi:[1,0,0]
v_mfma_f32_16x16x32_bf16 v[184:187], a[112:115], v[56:59], v[184:187]
s_waitcnt lgkmcnt(8)
ds_read_b64_tr_b16 a[90:91], v5 offset:51200
v_fma_mix_f32 v75, v109, v51, v43 op_sel:[1,0,0] op_sel_hi:[1,0,0]
v_mfma_f32_16x16x32_bf16 v[224:227], a[116:119], v[56:59], v[224:227]
ds_read_b64_tr_b16 a[92:93], v6 offset:49152
v_fma_mix_f32 v76, v110, v52, v44 op_sel:[0,0,0] op_sel_hi:[1,0,0]
v_mfma_f32_16x16x32_bf16 v[228:231], a[116:119], v[60:63], v[228:231]
s_waitcnt lgkmcnt(8)
ds_read_b64_tr_b16 a[94:95], v6 offset:51200
v_fma_mix_f32 v77, v110, v53, v45 op_sel:[1,0,0] op_sel_hi:[1,0,0]
v_mfma_f32_16x16x32_bf16 v[236:239], a[120:123], v[60:63], v[236:239]
ds_read_b64_tr_b16 a[96:97], v7 offset:49152
v_fma_mix_f32 v78, v111, v54, v46 op_sel:[0,0,0] op_sel_hi:[1,0,0]
v_mfma_f32_16x16x32_bf16 v[232:235], a[120:123], v[56:59], v[232:235]
s_waitcnt lgkmcnt(8)
ds_read_b64_tr_b16 a[98:99], v7 offset:51200
v_fma_mix_f32 v79, v111, v55, v47 op_sel:[1,0,0] op_sel_hi:[1,0,0]
v_mfma_f32_16x16x32_bf16 v[240:243], a[124:127], v[56:59], v[240:243]
v_cvt_pk_bf16_f32 v68, v72, v73
v_cvt_pk_bf16_f32 v69, v74, v75
v_mfma_f32_16x16x32_bf16 v[244:247], a[124:127], v[60:63], v[244:247]
s_waitcnt lgkmcnt(7)
v_cvt_pk_bf16_f32 v70, v76, v77
v_cvt_pk_bf16_f32 v71, v78, v79
v_mfma_f32_16x16x32_bf16 v[252:255], a[128:131], v[60:63], v[252:255]
ds_read_b64_tr_b16 a[100:101], v4 offset:57344
ds_read_b64_tr_b16 a[102:103], v4 offset:59392
v_mfma_f32_16x16x32_bf16 v[248:251], a[128:131], v[56:59], v[248:251]
s_waitcnt lgkmcnt(7)
ds_read_b64_tr_b16 a[104:105], v5 offset:57344
buffer_load_dwordx4 v18, s[16:19], s58 offen lds
v_mfma_f32_16x16x32_bf16 v[128:131], a[84:87], v[64:67], v[128:131]
s_add_u32 m0, s4, 69632
s_movk_i32 s58, 16512
ds_read_b64_tr_b16 a[106:107], v5 offset:59392
v_mfma_f32_16x16x32_bf16 v[132:135], a[84:87], v[68:71], v[132:135]
s_waitcnt lgkmcnt(7)
ds_read_b64_tr_b16 a[108:109], v6 offset:57344
ds_read_b64_tr_b16 a[110:111], v6 offset:59392
v_mfma_f32_16x16x32_bf16 v[140:143], a[88:91], v[68:71], v[140:143]
ds_read_b64_tr_b16 a[112:113], v7 offset:57344
ds_read_b64_tr_b16 a[114:115], v7 offset:59392
v_mfma_f32_16x16x32_bf16 v[136:139], a[88:91], v[64:67], v[136:139]
s_waitcnt lgkmcnt(9)
ds_read_b64_tr_b16 a[116:117], v4 offset:53248
buffer_load_dwordx4 v18, s[16:19], s59 offen lds
v_mfma_f32_16x16x32_bf16 v[144:147], a[92:95], v[64:67], v[144:147]
s_add_u32 m0, s5, 73728
s_mov_b32 s59, 32768
ds_read_b64_tr_b16 a[118:119], v4 offset:55296
v_mfma_f32_16x16x32_bf16 v[148:151], a[92:95], v[68:71], v[148:151]
s_waitcnt lgkmcnt(10)
ds_read_b64_tr_b16 a[120:121], v5 offset:53248
ds_read_b64_tr_b16 a[122:123], v5 offset:55296
v_mfma_f32_16x16x32_bf16 v[156:159], a[96:99], v[68:71], v[156:159]
ds_read_b64_tr_b16 a[124:125], v6 offset:53248
ds_read_b64_tr_b16 a[126:127], v6 offset:55296
v_mfma_f32_16x16x32_bf16 v[152:155], a[96:99], v[64:67], v[152:155]
s_waitcnt lgkmcnt(12)
ds_read_b64_tr_b16 a[128:129], v7 offset:53248
buffer_load_dwordx4 v16, s[12:15], s56 offen lds
v_mfma_f32_16x16x32_bf16 v[192:195], a[100:103], v[64:67], v[192:195]
ds_read_b64_tr_b16 a[130:131], v7 offset:55296
ds_read_b64_tr_b16 a[84:85], v4 offset:61440
v_mfma_f32_16x16x32_bf16 v[196:199], a[100:103], v[68:71], v[196:199]
s_waitcnt lgkmcnt(13)
ds_read_b64_tr_b16 a[86:87], v4 offset:63488
ds_read_b64_tr_b16 a[88:89], v5 offset:61440
v_mfma_f32_16x16x32_bf16 v[204:207], a[104:107], v[68:71], v[204:207]
ds_read_b64_tr_b16 a[90:91], v5 offset:63488
ds_read_b64_tr_b16 a[92:93], v6 offset:61440
v_mfma_f32_16x16x32_bf16 v[200:203], a[104:107], v[64:67], v[200:203]
s_waitcnt lgkmcnt(13)
ds_read_b64_tr_b16 a[94:95], v6 offset:63488
buffer_load_dwordx4 v17, s[12:15], s56 offen offset:1024 lds
v_mfma_f32_16x16x32_bf16 v[208:211], a[108:111], v[64:67], v[208:211]
s_add_u32 m0, s4, 81920
s_movk_i32 s56, 24576
ds_read_b64_tr_b16 a[96:97], v7 offset:61440
v_mfma_f32_16x16x32_bf16 v[212:215], a[108:111], v[68:71], v[212:215]
ds_read_b64_tr_b16 a[98:99], v7 offset:63488
ds_read_b128 v[24:27], v23 offset:2048
v_mfma_f32_16x16x32_bf16 v[220:223], a[112:115], v[68:71], v[220:223]
ds_read_b128 v[28:31], v23 offset:2064
ds_read_b128 v[32:35], v23 offset:4352
v_mfma_f32_16x16x32_bf16 v[216:219], a[112:115], v[64:67], v[216:219]
s_waitcnt lgkmcnt(13)
ds_read_b128 v[36:39], v23 offset:4368
ds_read_b128 v[40:43], v23 offset:2176
v_mfma_f32_16x16x32_bf16 v[160:163], a[116:119], v[64:67], v[160:163]
s_waitcnt vmcnt(13)
s_barrier
ds_read_b64_tr_b16 a[100:101], v0 offset:0
ds_read_b64_tr_b16 a[102:103], v0 offset:2048
v_mfma_f32_16x16x32_bf16 v[164:167], a[116:119], v[68:71], v[164:167]
ds_read_b64_tr_b16 a[104:105], v1 offset:0
ds_read_b64_tr_b16 a[106:107], v1 offset:2048
v_mfma_f32_16x16x32_bf16 v[172:175], a[120:123], v[68:71], v[172:175]
ds_read_b64_tr_b16 a[108:109], v2 offset:0
ds_read_b64_tr_b16 a[110:111], v2 offset:2048
v_mfma_f32_16x16x32_bf16 v[168:171], a[120:123], v[64:67], v[168:171]
ds_read_b64_tr_b16 a[112:113], v3 offset:0
ds_read_b64_tr_b16 a[114:115], v3 offset:2048
v_mfma_f32_16x16x32_bf16 v[176:179], a[124:127], v[64:67], v[176:179]
ds_read_b64_tr_b16 a[116:117], v0 offset:8192
ds_read_b64_tr_b16 a[118:119], v0 offset:10240
v_mfma_f32_16x16x32_bf16 v[180:183], a[124:127], v[68:71], v[180:183]
s_waitcnt lgkmcnt(12)
v_fma_mix_f32 v72, v112, v32, v24 op_sel:[0,0,0] op_sel_hi:[1,0,0]
v_fma_mix_f32 v73, v112, v33, v25 op_sel:[1,0,0] op_sel_hi:[1,0,0]
v_mfma_f32_16x16x32_bf16 v[188:191], a[128:131], v[68:71], v[188:191]
ds_read_b64_tr_b16 a[120:121], v1 offset:8192
v_fma_mix_f32 v74, v113, v34, v26 op_sel:[0,0,0] op_sel_hi:[1,0,0]
v_mfma_f32_16x16x32_bf16 v[184:187], a[128:131], v[64:67], v[184:187]
s_waitcnt lgkmcnt(12)
v_fma_mix_f32 v75, v113, v35, v27 op_sel:[1,0,0] op_sel_hi:[1,0,0]
v_fma_mix_f32 v76, v114, v36, v28 op_sel:[0,0,0] op_sel_hi:[1,0,0]
v_mfma_f32_16x16x32_bf16 v[224:227], a[84:87], v[64:67], v[224:227]
ds_read_b64_tr_b16 a[122:123], v1 offset:10240
v_fma_mix_f32 v77, v114, v37, v29 op_sel:[1,0,0] op_sel_hi:[1,0,0]
v_mfma_f32_16x16x32_bf16 v[228:231], a[84:87], v[68:71], v[228:231]
v_fma_mix_f32 v78, v115, v38, v30 op_sel:[0,0,0] op_sel_hi:[1,0,0]
v_fma_mix_f32 v79, v115, v39, v31 op_sel:[1,0,0] op_sel_hi:[1,0,0]
v_mfma_f32_16x16x32_bf16 v[236:239], a[88:91], v[68:71], v[236:239]
ds_read_b64_tr_b16 a[124:125], v2 offset:8192
v_cvt_pk_bf16_f32 v56, v72, v73
v_mfma_f32_16x16x32_bf16 v[232:235], a[88:91], v[64:67], v[232:235]
v_cvt_pk_bf16_f32 v57, v74, v75
v_cvt_pk_bf16_f32 v58, v76, v77
v_mfma_f32_16x16x32_bf16 v[240:243], a[92:95], v[64:67], v[240:243]
v_cvt_pk_bf16_f32 v59, v78, v79
v_fma_mix_f32 v72, v116, v32, v24 op_sel:[0,0,0] op_sel_hi:[1,0,0]
v_mfma_f32_16x16x32_bf16 v[244:247], a[92:95], v[68:71], v[244:247]
v_fma_mix_f32 v73, v116, v33, v25 op_sel:[1,0,0] op_sel_hi:[1,0,0]
v_fma_mix_f32 v74, v117, v34, v26 op_sel:[0,0,0] op_sel_hi:[1,0,0]
v_mfma_f32_16x16x32_bf16 v[252:255], a[96:99], v[68:71], v[252:255]
v_fma_mix_f32 v75, v117, v35, v27 op_sel:[1,0,0] op_sel_hi:[1,0,0]
v_fma_mix_f32 v76, v118, v36, v28 op_sel:[0,0,0] op_sel_hi:[1,0,0]
v_mfma_f32_16x16x32_bf16 v[248:251], a[96:99], v[64:67], v[248:251]
s_waitcnt lgkmcnt(2)
buffer_load_dwordx4 v18, s[16:19], s57 offen lds
v_fma_mix_f32 v77, v118, v37, v29 op_sel:[1,0,0] op_sel_hi:[1,0,0]
v_mfma_f32_16x16x32_bf16 v[128:131], a[100:103], v[56:59], v[128:131]
s_add_u32 m0, s4, 86016
s_movk_i32 s57, 24704
v_fma_mix_f32 v78, v119, v38, v30 op_sel:[0,0,0] op_sel_hi:[1,0,0]
buffer_load_dwordx4 v18, s[16:19], s58 offen lds
v_cvt_pk_bf16_f32 v60, v72, v73
v_cvt_pk_bf16_f32 v61, v74, v75
v_fma_mix_f32 v79, v119, v39, v31 op_sel:[1,0,0] op_sel_hi:[1,0,0]
s_add_u32 m0, s5, 90112
s_mov_b32 s58, 40960
ds_read_b64_tr_b16 a[126:127], v2 offset:10240
v_cvt_pk_bf16_f32 v62, v76, v77
v_cvt_pk_bf16_f32 v63, v78, v79
ds_read_b64_tr_b16 a[128:129], v3 offset:8192
ds_read_b64_tr_b16 a[130:131], v3 offset:10240
buffer_load_dwordx4 v16, s[12:15], s59 offen lds
buffer_load_dwordx4 v17, s[12:15], s59 offen offset:1024 lds
v_mfma_f32_16x16x32_bf16 v[132:135], a[100:103], v[60:63], v[132:135]
s_mov_b32 m0, 155968
s_mov_b32 s59, 32768
ds_read_b64_tr_b16 a[84:85], v0 offset:4096
v_mfma_f32_16x16x32_bf16 v[140:143], a[104:107], v[60:63], v[140:143]
ds_read_b64_tr_b16 a[86:87], v0 offset:6144
v_mov_b32 v24, 0xff800000
v_mfma_f32_16x16x32_bf16 v[136:139], a[104:107], v[56:59], v[136:139]
ds_read_b64_tr_b16 a[88:89], v1 offset:4096
v_mov_b32 v28, 0xff800000
v_mfma_f32_16x16x32_bf16 v[144:147], a[108:111], v[56:59], v[144:147]
ds_read_b64_tr_b16 a[90:91], v1 offset:6144
s_bfm_b64 exec, 16, 16
buffer_load_dword v22, s[20:23], s49 offen  lds
s_mov_b64 exec, -1
v_mfma_f32_16x16x32_bf16 v[148:151], a[108:111], v[60:63], v[148:151]
s_add_u32 m0, s4, 98304
ds_read_b64_tr_b16 a[92:93], v2 offset:4096
v_mov_b32 v32, 0xff800000
v_mfma_f32_16x16x32_bf16 v[156:159], a[112:115], v[60:63], v[156:159]
ds_read_b64_tr_b16 a[94:95], v2 offset:6144
v_mov_b32 v36, 0xff800000
v_mfma_f32_16x16x32_bf16 v[152:155], a[112:115], v[56:59], v[152:155]
ds_read_b64_tr_b16 a[96:97], v3 offset:4096
ds_read_b64_tr_b16 a[98:99], v3 offset:6144
v_mfma_f32_16x16x32_bf16 v[192:195], a[116:119], v[56:59], v[192:195]
ds_read_b64_tr_b16 a[100:101], v0 offset:12288
ds_read_b64_tr_b16 a[102:103], v0 offset:14336
v_mfma_f32_16x16x32_bf16 v[196:199], a[116:119], v[60:63], v[196:199]
s_waitcnt lgkmcnt(10)
ds_read_b64_tr_b16 a[104:105], v1 offset:12288
ds_read_b64_tr_b16 a[106:107], v1 offset:14336
v_mfma_f32_16x16x32_bf16 v[204:207], a[120:123], v[60:63], v[204:207]
ds_read_b64_tr_b16 a[108:109], v2 offset:12288
ds_read_b64_tr_b16 a[110:111], v2 offset:14336
v_mfma_f32_16x16x32_bf16 v[200:203], a[120:123], v[56:59], v[200:203]
ds_read_b64_tr_b16 a[112:113], v3 offset:12288
ds_read_b64_tr_b16 a[114:115], v3 offset:14336
v_mfma_f32_16x16x32_bf16 v[208:211], a[124:127], v[56:59], v[208:211]
ds_read_b128 v[44:47], v23 offset:2192
ds_read_b128 v[48:51], v23 offset:4480
v_mfma_f32_16x16x32_bf16 v[212:215], a[124:127], v[60:63], v[212:215]
ds_read_b128 v[52:55], v23 offset:4496
v_mbcnt_lo_u32_b32 v23, -1, 0
v_mfma_f32_16x16x32_bf16 v[220:223], a[128:131], v[60:63], v[220:223]
v_mbcnt_hi_u32_b32 v23, -1, v23
v_lshl_add_u32 v23, v23, 4, s4
v_mfma_f32_16x16x32_bf16 v[216:219], a[128:131], v[56:59], v[216:219]
s_waitcnt lgkmcnt(13)
ds_read_b64_tr_b16 a[116:117], v0 offset:16384
ds_read_b64_tr_b16 a[118:119], v0 offset:18432
v_mfma_f32_16x16x32_bf16 v[160:163], a[84:87], v[56:59], v[160:163]
ds_read_b64_tr_b16 a[120:121], v1 offset:16384
ds_read_b64_tr_b16 a[122:123], v1 offset:18432
v_mfma_f32_16x16x32_bf16 v[164:167], a[84:87], v[60:63], v[164:167]
ds_read_b64_tr_b16 a[124:125], v2 offset:16384
ds_read_b64_tr_b16 a[126:127], v2 offset:18432
v_mfma_f32_16x16x32_bf16 v[172:175], a[88:91], v[60:63], v[172:175]
ds_read_b64_tr_b16 a[128:129], v3 offset:16384
ds_read_b64_tr_b16 a[130:131], v3 offset:18432
v_mfma_f32_16x16x32_bf16 v[168:171], a[88:91], v[56:59], v[168:171]
s_waitcnt lgkmcnt(9)
v_fma_mix_f32 v72, v120, v48, v40 op_sel:[0,0,0] op_sel_hi:[1,0,0]
v_fma_mix_f32 v73, v120, v49, v41 op_sel:[1,0,0] op_sel_hi:[1,0,0]
v_mfma_f32_16x16x32_bf16 v[176:179], a[92:95], v[56:59], v[176:179]
ds_read_b64_tr_b16 a[84:85], v0 offset:24576
v_fma_mix_f32 v74, v121, v50, v42 op_sel:[0,0,0] op_sel_hi:[1,0,0]
v_mfma_f32_16x16x32_bf16 v[180:183], a[92:95], v[60:63], v[180:183]
s_waitcnt lgkmcnt(9)
v_fma_mix_f32 v75, v121, v51, v43 op_sel:[1,0,0] op_sel_hi:[1,0,0]
v_fma_mix_f32 v76, v122, v52, v44 op_sel:[0,0,0] op_sel_hi:[1,0,0]
v_mfma_f32_16x16x32_bf16 v[188:191], a[96:99], v[60:63], v[188:191]
ds_read_b64_tr_b16 a[86:87], v0 offset:26624
v_fma_mix_f32 v77, v122, v53, v45 op_sel:[1,0,0] op_sel_hi:[1,0,0]
v_mfma_f32_16x16x32_bf16 v[184:187], a[96:99], v[56:59], v[184:187]
v_fma_mix_f32 v78, v123, v54, v46 op_sel:[0,0,0] op_sel_hi:[1,0,0]
v_fma_mix_f32 v79, v123, v55, v47 op_sel:[1,0,0] op_sel_hi:[1,0,0]
v_mfma_f32_16x16x32_bf16 v[224:227], a[100:103], v[56:59], v[224:227]
ds_read_b64_tr_b16 a[88:89], v1 offset:24576
v_cvt_pk_bf16_f32 v64, v72, v73
v_mfma_f32_16x16x32_bf16 v[228:231], a[100:103], v[60:63], v[228:231]
v_cvt_pk_bf16_f32 v65, v74, v75
v_cvt_pk_bf16_f32 v66, v76, v77
v_mfma_f32_16x16x32_bf16 v[236:239], a[104:107], v[60:63], v[236:239]
ds_read_b64_tr_b16 a[90:91], v1 offset:26624
v_cvt_pk_bf16_f32 v67, v78, v79
v_mfma_f32_16x16x32_bf16 v[232:235], a[104:107], v[56:59], v[232:235]
v_fma_mix_f32 v72, v124, v48, v40 op_sel:[0,0,0] op_sel_hi:[1,0,0]
v_fma_mix_f32 v73, v124, v49, v41 op_sel:[1,0,0] op_sel_hi:[1,0,0]
v_mfma_f32_16x16x32_bf16 v[240:243], a[108:111], v[56:59], v[240:243]
v_fma_mix_f32 v74, v125, v50, v42 op_sel:[0,0,0] op_sel_hi:[1,0,0]
v_fma_mix_f32 v75, v125, v51, v43 op_sel:[1,0,0] op_sel_hi:[1,0,0]
v_mfma_f32_16x16x32_bf16 v[244:247], a[108:111], v[60:63], v[244:247]
v_fma_mix_f32 v76, v126, v52, v44 op_sel:[0,0,0] op_sel_hi:[1,0,0]
v_fma_mix_f32 v77, v126, v53, v45 op_sel:[1,0,0] op_sel_hi:[1,0,0]
v_mfma_f32_16x16x32_bf16 v[252:255], a[112:115], v[60:63], v[252:255]
v_fma_mix_f32 v78, v127, v54, v46 op_sel:[0,0,0] op_sel_hi:[1,0,0]
v_fma_mix_f32 v79, v127, v55, v47 op_sel:[1,0,0] op_sel_hi:[1,0,0]
v_mfma_f32_16x16x32_bf16 v[248:251], a[112:115], v[56:59], v[248:251]
s_waitcnt lgkmcnt(2)
buffer_load_dwordx4 v18, s[16:19], s56 offen lds
v_cvt_pk_bf16_f32 v68, v72, v73
v_mfma_f32_16x16x32_bf16 v[128:131], a[116:119], v[64:67], v[128:131]
s_add_u32 m0, s4, 102400
s_mov_b32 s56, 32896
v_cvt_pk_bf16_f32 v69, v74, v75
ds_read_b64_tr_b16 a[92:93], v2 offset:24576
buffer_load_dwordx4 v18, s[16:19], s57 offen lds
v_cvt_pk_bf16_f32 v70, v76, v77
v_cvt_pk_bf16_f32 v71, v78, v79
s_add_u32 m0, s5, 106496
s_mov_b32 s57, 49152
ds_read_b64_tr_b16 a[94:95], v2 offset:26624
ds_read_b64_tr_b16 a[96:97], v3 offset:24576
ds_read_b64_tr_b16 a[98:99], v3 offset:26624
v_mfma_f32_16x16x32_bf16 v[132:135], a[116:119], v[68:71], v[132:135]
v_cvt_pk_bf16_f32 v128, v128, v129
v_cvt_pk_bf16_f32 v130, v130, v131
v_mfma_f32_16x16x32_bf16 v[140:143], a[120:123], v[68:71], v[140:143]
ds_read_b64_tr_b16 a[100:101], v0 offset:20480
ds_read_b64_tr_b16 a[102:103], v0 offset:22528
v_mfma_f32_16x16x32_bf16 v[136:139], a[120:123], v[64:67], v[136:139]
ds_read_b64_tr_b16 a[104:105], v1 offset:20480
buffer_load_dwordx4 v16, s[12:15], s58 offen lds
v_mfma_f32_16x16x32_bf16 v[144:147], a[124:127], v[64:67], v[144:147]
ds_read_b64_tr_b16 a[106:107], v1 offset:22528
v_cvt_pk_bf16_f32 v132, v132, v133
v_mfma_f32_16x16x32_bf16 v[148:151], a[124:127], v[68:71], v[148:151]
ds_read_b64_tr_b16 a[108:109], v2 offset:20480
s_nop 0
v_cvt_pk_bf16_f32 v136, v136, v137
v_mfma_f32_16x16x32_bf16 v[156:159], a[128:131], v[68:71], v[156:159]
ds_read_b64_tr_b16 a[110:111], v2 offset:22528
v_cvt_pk_bf16_f32 v138, v138, v139
v_mfma_f32_16x16x32_bf16 v[152:155], a[128:131], v[64:67], v[152:155]
ds_read_b64_tr_b16 a[112:113], v3 offset:20480
buffer_load_dwordx4 v17, s[12:15], s58 offen offset:1024 lds
v_mfma_f32_16x16x32_bf16 v[192:195], a[84:87], v[64:67], v[192:195]
s_add_u32 m0, s4, 114688
s_mov_b32 s58, 40960
ds_read_b64_tr_b16 a[114:115], v3 offset:22528
v_mfma_f32_16x16x32_bf16 v[196:199], a[84:87], v[68:71], v[196:199]
s_waitcnt lgkmcnt(8)
ds_read_b64_tr_b16 a[116:117], v0 offset:28672
v_permlane16_swap_b32 v128, v136
v_mfma_f32_16x16x32_bf16 v[204:207], a[88:91], v[68:71], v[204:207]
ds_read_b64_tr_b16 a[118:119], v0 offset:30720
v_permlane16_swap_b32_e64 v130, v138
v_mfma_f32_16x16x32_bf16 v[200:203], a[88:91], v[64:67], v[200:203]
ds_read_b64_tr_b16 a[120:121], v1 offset:28672
v_cvt_pk_bf16_f32 v134, v134, v135
v_mfma_f32_16x16x32_bf16 v[208:211], a[92:95], v[64:67], v[208:211]
ds_read_b64_tr_b16 a[122:123], v1 offset:30720
v_cvt_pk_bf16_f32 v140, v140, v141
v_mfma_f32_16x16x32_bf16 v[212:215], a[92:95], v[68:71], v[212:215]
ds_read_b64_tr_b16 a[124:125], v2 offset:28672
v_cvt_pk_bf16_f32 v142, v142, v143
v_mfma_f32_16x16x32_bf16 v[220:223], a[96:99], v[68:71], v[220:223]
ds_read_b64_tr_b16 a[126:127], v2 offset:30720
v_accvgpr_write_b32 a0, v128
v_mfma_f32_16x16x32_bf16 v[216:219], a[96:99], v[64:67], v[216:219]
s_waitcnt lgkmcnt(8)
ds_read_b64_tr_b16 a[128:129], v3 offset:28672
v_accvgpr_write_b32 a1, v130
v_mfma_f32_16x16x32_bf16 v[160:163], a[100:103], v[64:67], v[160:163]
ds_read_b64_tr_b16 a[130:131], v3 offset:30720
v_accvgpr_write_b32 a2, v136
v_mfma_f32_16x16x32_bf16 v[164:167], a[100:103], v[68:71], v[164:167]
v_accvgpr_write_b32 a3, v138
v_permlane16_swap_b32 v132, v140
v_mfma_f32_16x16x32_bf16 v[172:175], a[104:107], v[68:71], v[172:175]
v_permlane16_swap_b32 v134, v142
v_mfma_f32_16x16x32_bf16 v[168:171], a[104:107], v[64:67], v[168:171]
v_cvt_pk_bf16_f32 v192, v192, v193
v_cvt_pk_bf16_f32 v194, v194, v195
v_mfma_f32_16x16x32_bf16 v[176:179], a[108:111], v[64:67], v[176:179]
v_cvt_pk_bf16_f32 v200, v200, v201
v_mfma_f32_16x16x32_bf16 v[180:183], a[108:111], v[68:71], v[180:183]
s_waitcnt lgkmcnt(4)
v_accvgpr_write_b32 a16, v132
v_cvt_pk_bf16_f32 v202, v202, v203
v_mfma_f32_16x16x32_bf16 v[188:191], a[112:115], v[68:71], v[188:191]
s_waitcnt vmcnt(9)
s_barrier
ds_read_b128 a[84:87], v8 offset:32768
v_accvgpr_write_b32 a17, v134
v_mfma_f32_16x16x32_bf16 v[184:187], a[112:115], v[64:67], v[184:187]
ds_read_b128 a[88:91], v8 offset:36864
v_accvgpr_write_b32 a18, v140
v_mfma_f32_16x16x32_bf16 v[224:227], a[116:119], v[64:67], v[224:227]
v_accvgpr_write_b32 a19, v142
v_permlane16_swap_b32_e64 v192, v200
v_mfma_f32_16x16x32_bf16 v[228:231], a[116:119], v[68:71], v[228:231]
ds_read_b128 a[92:95], v9 offset:32768
v_permlane16_swap_b32 v194, v202
v_mfma_f32_16x16x32_bf16 v[236:239], a[120:123], v[68:71], v[236:239]
v_cvt_pk_bf16_f32 v196, v196, v197
v_cvt_pk_bf16_f32 v198, v198, v199
v_mfma_f32_16x16x32_bf16 v[232:235], a[120:123], v[64:67], v[232:235]
s_waitcnt lgkmcnt(3)
ds_read_b128 a[96:99], v9 offset:36864
v_cvt_pk_bf16_f32 v204, v204, v205
v_mfma_f32_16x16x32_bf16 v[240:243], a[124:127], v[64:67], v[240:243]
v_accvgpr_write_b32 a32, v192
v_cvt_pk_bf16_f32 v206, v206, v207
v_mfma_f32_16x16x32_bf16 v[244:247], a[124:127], v[68:71], v[244:247]
v_accvgpr_write_b32 a33, v194
v_accvgpr_write_b32 a34, v200
v_mfma_f32_16x16x32_bf16 v[252:255], a[128:131], v[68:71], v[252:255]
v_accvgpr_write_b32 a35, v202
v_permlane16_swap_b32 v196, v204
v_mfma_f32_16x16x32_bf16 v[248:251], a[128:131], v[64:67], v[248:251]
s_waitcnt lgkmcnt(3)
buffer_load_dwordx4 v18, s[16:19], s59 offen lds
v_permlane16_swap_b32_e64 v198, v206
v_mfma_f32_16x16x32_bf16 v[64:67], a[84:87], a[0:3], 0
s_add_u32 m0, s4, 118784
s_mov_b32 s59, 41088
v_accvgpr_write_b32 a48, v196
v_mfma_f32_16x16x32_bf16 v[72:75], a[84:87], a[16:19], 0
v_accvgpr_write_b32 a49, v198
v_accvgpr_write_b32 a50, v204
v_mfma_f32_16x16x32_bf16 v[80:83], a[84:87], a[32:35], 0
v_accvgpr_write_b32 a51, v206
v_cvt_pk_bf16_f32 v144, v144, v145
buffer_load_dwordx4 v18, s[16:19], s56 offen lds
v_cvt_pk_bf16_f32 v146, v146, v147
v_cvt_pk_bf16_f32 v152, v152, v153
v_cvt_pk_bf16_f32 v154, v154, v155
v_mfma_f32_16x16x32_bf16 v[88:91], a[84:87], a[48:51], 0
s_waitcnt lgkmcnt(1)
s_add_u32 m0, s5, 122880
s_mov_b32 s56, 57344
v_permlane16_swap_b32 v144, v152
v_mfma_f32_16x16x32_bf16 v[92:95], a[88:91], a[48:51], 0
v_permlane16_swap_b32_e64 v146, v154
v_cvt_pk_bf16_f32 v148, v148, v149
v_mfma_f32_16x16x32_bf16 v[84:87], a[88:91], a[32:35], 0
v_cvt_pk_bf16_f32 v150, v150, v151
v_cvt_pk_bf16_f32 v156, v156, v157
v_mfma_f32_16x16x32_bf16 v[76:79], a[88:91], a[16:19], 0
v_accvgpr_write_b32 a4, v144
v_cvt_pk_bf16_f32 v158, v158, v159
v_mfma_f32_16x16x32_bf16 v[68:71], a[88:91], a[0:3], 0
buffer_load_dwordx4 v16, s[12:15], s57 offen lds
v_accvgpr_write_b32 a5, v146
buffer_load_dwordx4 v17, s[12:15], s57 offen offset:1024 lds
v_accvgpr_write_b32 a6, v152
v_accvgpr_write_b32 a7, v154
v_permlane16_swap_b32 v148, v156
s_add_u32 m0, s4, 0
s_add_u32 s57, s52, 0
v_permlane16_swap_b32 v150, v158
v_cvt_pk_bf16_f32 v208, v208, v209
v_cvt_pk_bf16_f32 v210, v210, v211
v_mfma_f32_16x16x32_bf16 v[64:67], a[92:95], a[4:7], v[64:67]
v_cvt_pk_bf16_f32 v216, v216, v217
v_cvt_pk_bf16_f32 v218, v218, v219
v_accvgpr_write_b32 a20, v148
v_accvgpr_write_b32 a21, v150
v_accvgpr_write_b32 a22, v156
v_accvgpr_write_b32 a23, v158
v_permlane16_swap_b32 v208, v216
v_permlane16_swap_b32 v210, v218
v_cvt_pk_bf16_f32 v212, v212, v213
v_cvt_pk_bf16_f32 v214, v214, v215
v_mfma_f32_16x16x32_bf16 v[72:75], a[92:95], a[20:23], v[72:75]
v_cvt_pk_bf16_f32 v220, v220, v221
v_cvt_pk_bf16_f32 v222, v222, v223
v_accvgpr_write_b32 a36, v208
v_accvgpr_write_b32 a37, v210
v_accvgpr_write_b32 a38, v216
v_accvgpr_write_b32 a39, v218
ds_read_b128 a[100:103], v10 offset:32768
v_permlane16_swap_b32 v212, v220
v_permlane16_swap_b32 v214, v222
v_accvgpr_write_b32 a52, v212
v_mfma_f32_16x16x32_bf16 v[80:83], a[92:95], a[36:39], v[80:83]
v_accvgpr_write_b32 a53, v214
v_accvgpr_write_b32 a54, v220
ds_read_b128 a[104:107], v10 offset:36864
v_accvgpr_write_b32 a55, v222
v_cvt_pk_bf16_f32 v160, v160, v161
v_cvt_pk_bf16_f32 v162, v162, v163
v_cvt_pk_bf16_f32 v168, v168, v169
v_cvt_pk_bf16_f32 v170, v170, v171
v_cvt_pk_bf16_f32 v164, v164, v165
v_cvt_pk_bf16_f32 v166, v166, v167
v_mfma_f32_16x16x32_bf16 v[88:91], a[92:95], a[52:55], v[88:91]
s_waitcnt lgkmcnt(2)
buffer_load_dwordx4 v18, s[16:19], s58 offen lds
v_permlane16_swap_b32 v160, v168
v_mfma_f32_16x16x32_bf16 v[92:95], a[96:99], a[52:55], v[92:95]
s_add_u32 m0, s4, 4096
s_movk_i32 s58, 4608
v_permlane16_swap_b32 v162, v170
v_mfma_f32_16x16x32_bf16 v[84:87], a[96:99], a[36:39], v[84:87]
v_cvt_pk_bf16_f32 v172, v172, v173
v_cvt_pk_bf16_f32 v174, v174, v175
v_mfma_f32_16x16x32_bf16 v[76:79], a[96:99], a[20:23], v[76:79]
v_accvgpr_write_b32 a8, v160
v_accvgpr_write_b32 a9, v162
v_mfma_f32_16x16x32_bf16 v[68:71], a[96:99], a[4:7], v[68:71]
s_waitcnt lgkmcnt(1)
v_accvgpr_write_b32 a10, v168
v_accvgpr_write_b32 a11, v170
buffer_load_dwordx4 v18, s[16:19], s59 offen lds
v_permlane16_swap_b32 v164, v172
v_permlane16_swap_b32_e64 v166, v174
v_cvt_pk_bf16_f32 v224, v224, v225
v_mfma_f32_16x16x32_bf16 v[64:67], a[100:103], a[8:11], v[64:67]
s_add_u32 m0, s5, 8192
s_mov_b32 s59, 18432
v_cvt_pk_bf16_f32 v226, v226, v227
buffer_load_dwordx4 v16, s[12:15], s56 offen lds
buffer_load_dwordx4 v17, s[12:15], s56 offen offset:1024 lds
v_cvt_pk_bf16_f32 v232, v232, v233
v_cvt_pk_bf16_f32 v234, v234, v235
s_mov_b32 m0, 155968
s_add_u32 s56, s55, 0
v_accvgpr_write_b32 a24, v164
v_accvgpr_write_b32 a25, v166
v_accvgpr_write_b32 a26, v172
s_bfm_b64 exec, 16, 32
buffer_load_dword v22, s[20:23], s49 offen  lds
s_mov_b64 exec, -1
v_accvgpr_write_b32 a27, v174
v_permlane16_swap_b32 v224, v232
v_permlane16_swap_b32_e64 v226, v234
s_mov_b32 m0, 155968
v_cvt_pk_bf16_f32 v228, v228, v229
v_cvt_pk_bf16_f32 v230, v230, v231
v_cvt_pk_bf16_f32 v236, v236, v237
v_cvt_pk_bf16_f32 v238, v238, v239
v_mfma_f32_16x16x32_bf16 v[72:75], a[100:103], a[24:27], v[72:75]
v_accvgpr_write_b32 a40, v224
v_accvgpr_write_b32 a41, v226
ds_read_b128 a[108:111], v11 offset:32768
s_bfm_b64 exec, 16, 48
buffer_load_dword v22, s[20:23], s49 offen  lds
s_mov_b64 exec, -1
v_accvgpr_write_b32 a42, v232
v_accvgpr_write_b32 a43, v234
s_mov_b32 m0, 155968
v_permlane16_swap_b32 v228, v236
v_permlane16_swap_b32 v230, v238
v_accvgpr_write_b32 a56, v228
v_accvgpr_write_b32 a57, v230
v_mfma_f32_16x16x32_bf16 v[80:83], a[100:103], a[40:43], v[80:83]
v_accvgpr_write_b32 a58, v236
v_accvgpr_write_b32 a59, v238
ds_read_b128 a[112:115], v11 offset:36864
s_bfm_b64 exec, 16, 0
buffer_load_dword v21, s[8:11], s73 offen  lds
s_mov_b64 exec, -1
v_cvt_pk_bf16_f32 v176, v176, v177
v_cvt_pk_bf16_f32 v178, v178, v179
v_mfma_f32_16x16x32_bf16 v[88:91], a[100:103], a[56:59], v[88:91]
s_waitcnt lgkmcnt(2)
s_add_u32 m0, s4, 16384
v_cvt_pk_bf16_f32 v184, v184, v185
v_cvt_pk_bf16_f32 v186, v186, v187
v_mfma_f32_16x16x32_bf16 v[92:95], a[104:107], a[56:59], v[92:95]
v_permlane16_swap_b32 v176, v184
v_permlane16_swap_b32_e64 v178, v186
v_mfma_f32_16x16x32_bf16 v[84:87], a[104:107], a[40:43], v[84:87]
v_cvt_pk_bf16_f32 v180, v180, v181
v_cvt_pk_bf16_f32 v182, v182, v183
v_mfma_f32_16x16x32_bf16 v[76:79], a[104:107], a[24:27], v[76:79]
v_cvt_pk_bf16_f32 v188, v188, v189
v_cvt_pk_bf16_f32 v190, v190, v191
v_mfma_f32_16x16x32_bf16 v[68:71], a[104:107], a[8:11], v[68:71]
v_accvgpr_write_b32 a12, v176
v_accvgpr_write_b32 a13, v178
v_accvgpr_write_b32 a14, v184
v_accvgpr_write_b32 a15, v186
v_permlane16_swap_b32_e64 v180, v188
v_permlane16_swap_b32 v182, v190
v_cvt_pk_bf16_f32 v240, v240, v241
v_cvt_pk_bf16_f32 v242, v242, v243
v_cvt_pk_bf16_f32 v248, v248, v249
v_cvt_pk_bf16_f32 v250, v250, v251
s_waitcnt lgkmcnt(1)
v_mfma_f32_16x16x32_bf16 v[64:67], a[108:111], a[12:15], v[64:67]
v_accvgpr_write_b32 a28, v180
v_accvgpr_write_b32 a29, v182
v_accvgpr_write_b32 a30, v188
v_accvgpr_write_b32 a31, v190
v_permlane16_swap_b32 v240, v248
v_permlane16_swap_b32 v242, v250
v_cvt_pk_bf16_f32 v244, v244, v245
v_cvt_pk_bf16_f32 v246, v246, v247
v_cvt_pk_bf16_f32 v252, v252, v253
v_cvt_pk_bf16_f32 v254, v254, v255
v_mfma_f32_16x16x32_bf16 v[72:75], a[108:111], a[28:31], v[72:75]
v_accvgpr_write_b32 a44, v240
v_accvgpr_write_b32 a45, v242
ds_read_b128 a[116:119], v8 offset:40960
v_accvgpr_write_b32 a46, v248
v_accvgpr_write_b32 a47, v250
v_permlane16_swap_b32_e64 v244, v252
v_permlane16_swap_b32 v246, v254
v_accvgpr_write_b32 a60, v244
v_accvgpr_write_b32 a61, v246
v_accvgpr_write_b32 a62, v252
v_mfma_f32_16x16x32_bf16 v[80:83], a[108:111], a[44:47], v[80:83]
ds_read_b128 a[120:123], v8 offset:45056
v_accvgpr_write_b32 a63, v254
ds_read_b128 a[124:127], v9 offset:40960
ds_read_b128 a[128:131], v9 offset:45056
ds_read_b128 a[84:87], v10 offset:40960
ds_read_b128 a[88:91], v10 offset:45056
v_mfma_f32_16x16x32_bf16 v[88:91], a[108:111], a[60:63], v[88:91]
s_cmp_lg_u32 s60, 0
s_cbranch_scc1 k1_fb
k1_fbret:
v_max3_f32 v24, v24, v64, v65
s_waitcnt lgkmcnt(6)
v_mfma_f32_16x16x32_bf16 v[92:95], a[112:115], a[60:63], v[92:95]
v_max3_f32 v24, v24, v66, v67
v_max3_f32 v28, v28, v72, v73
v_mfma_f32_16x16x32_bf16 v[84:87], a[112:115], a[44:47], v[84:87]
ds_read_b128 a[92:95], v11 offset:40960
v_max3_f32 v28, v28, v74, v75
v_mfma_f32_16x16x32_bf16 v[76:79], a[112:115], a[28:31], v[76:79]
v_max3_f32 v32, v32, v80, v81
v_max3_f32 v32, v32, v82, v83
v_mfma_f32_16x16x32_bf16 v[68:71], a[112:115], a[12:15], v[68:71]
s_waitcnt lgkmcnt(6)
ds_read_b128 a[96:99], v11 offset:45056
v_max3_f32 v32, v32, v84, v85
v_mfma_f32_16x16x32_bf16 v[96:99], a[116:119], a[0:3], 0
s_nop 0
v_max3_f32 v28, v28, v76, v77
v_max3_f32 v28, v28, v78, v79
v_mfma_f32_16x16x32_bf16 v[104:107], a[116:119], a[16:19], 0
ds_read_b64_tr_b16 a[100:101], v0 offset:49152
v_max3_f32 v24, v24, v68, v69
v_mfma_f32_16x16x32_bf16 v[112:115], a[116:119], a[32:35], 0
v_max3_f32 v24, v24, v70, v71
v_mov_b32 v25, v24
v_mfma_f32_16x16x32_bf16 v[120:123], a[116:119], a[48:51], 0
s_waitcnt lgkmcnt(3)
ds_read_b64_tr_b16 a[102:103], v0 offset:51200
v_permlane16_swap_b32_e64 v25, v24
v_mfma_f32_16x16x32_bf16 v[124:127], a[120:123], a[48:51], 0
v_max_f32 v24, v24, v25
v_mov_b32 v29, v28
v_mfma_f32_16x16x32_bf16 v[116:119], a[120:123], a[32:35], 0
ds_read_b64_tr_b16 a[104:105], v1 offset:49152
v_mov_b32_e64 v25, v24
v_mfma_f32_16x16x32_bf16 v[108:111], a[120:123], a[16:19], 0
ds_read_b64_tr_b16 a[106:107], v1 offset:51200
v_max3_f32 v32, v32, v86, v87
v_mfma_f32_16x16x32_bf16 v[100:103], a[120:123], a[0:3], 0
v_permlane16_swap_b32 v29, v28
v_mov_b32 v33, v32
v_mfma_f32_16x16x32_bf16 v[96:99], a[124:127], a[4:7], v[96:99]
ds_read_b64_tr_b16 a[108:109], v2 offset:49152
v_max_f32_e64 v28, v28, v29
v_mfma_f32_16x16x32_bf16 v[104:107], a[124:127], a[20:23], v[104:107]
v_permlane32_swap_b32 v25, v24
v_mov_b32 v29, v28
v_mfma_f32_16x16x32_bf16 v[112:115], a[124:127], a[36:39], v[112:115]
ds_read_b64_tr_b16 a[110:111], v2 offset:51200
v_min_f32_e64 v24, -v24, -v25
v_mfma_f32_16x16x32_bf16 v[120:123], a[124:127], a[52:55], v[120:123]
v_add_f32 v64, v64, v24
v_add_f32 v65, v65, v24
v_mfma_f32_16x16x32_bf16 v[124:127], a[128:131], a[52:55], v[124:127]
ds_read_b64_tr_b16 a[112:113], v3 offset:49152
v_add_f32_e64 v66, v66, v24
v_mfma_f32_16x16x32_bf16 v[116:119], a[128:131], a[36:39], v[116:119]
v_add_f32 v67, v67, v24
v_add_f32 v68, v68, v24
v_mfma_f32_16x16x32_bf16 v[108:111], a[128:131], a[20:23], v[108:111]
ds_read_b64_tr_b16 a[114:115], v3 offset:51200
v_add_f32_e64 v69, v69, v24
v_mfma_f32_16x16x32_bf16 v[100:103], a[128:131], a[4:7], v[100:103]
v_add_f32 v70, v70, v24
v_add_f32 v71, v71, v24
v_mfma_f32_16x16x32_bf16 v[96:99], a[84:87], a[8:11], v[96:99]
v_exp_f32_e64 v64, v64
v_mfma_f32_16x16x32_bf16 v[104:107], a[84:87], a[24:27], v[104:107]
v_exp_f32_e64 v65, v65
v_mfma_f32_16x16x32_bf16 v[112:115], a[84:87], a[40:43], v[112:115]
v_exp_f32_e64 v66, v66
v_mfma_f32_16x16x32_bf16 v[120:123], a[84:87], a[56:59], v[120:123]
v_exp_f32_e64 v67, v67
v_mfma_f32_16x16x32_bf16 v[124:127], a[88:91], a[56:59], v[124:127]
v_exp_f32_e64 v68, v68
v_mfma_f32_16x16x32_bf16 v[116:119], a[88:91], a[40:43], v[116:119]
v_exp_f32_e64 v69, v69
v_mfma_f32_16x16x32_bf16 v[108:111], a[88:91], a[24:27], v[108:111]
v_exp_f32_e64 v70, v70
v_mfma_f32_16x16x32_bf16 v[100:103], a[88:91], a[8:11], v[100:103]
s_waitcnt lgkmcnt(0)
v_exp_f32 v71, v71
v_mfma_f32_16x16x32_bf16 v[96:99], a[92:95], a[12:15], v[96:99]
v_max3_f32 v36, v36, v88, v89
v_max3_f32 v36, v36, v90, v91
v_mfma_f32_16x16x32_bf16 v[104:107], a[92:95], a[28:31], v[104:107]
ds_read_b64_tr_b16 a[116:117], v0 offset:53248
v_max3_f32 v36, v36, v92, v93
v_mfma_f32_16x16x32_bf16 v[112:115], a[92:95], a[44:47], v[112:115]
v_permlane16_swap_b32_e64 v33, v32
v_max3_f32 v36, v36, v94, v95
v_mfma_f32_16x16x32_bf16 v[120:123], a[92:95], a[60:63], v[120:123]
v_max_f32 v32, v32, v33
v_mov_b32 v37, v36
v_mfma_f32_16x16x32_bf16 v[124:127], a[96:99], a[60:63], v[124:127]
v_permlane32_swap_b32 v29, v28
v_mov_b32 v33, v32
v_mfma_f32_16x16x32_bf16 v[116:119], a[96:99], a[44:47], v[116:119]
v_min_f32_e64 v28, -v28, -v29
v_add_f32_e64 v72, v72, v28
v_mfma_f32_16x16x32_bf16 v[108:111], a[96:99], a[28:31], v[108:111]
v_add_f32 v73, v73, v28
v_add_f32 v74, v74, v28
v_mfma_f32_16x16x32_bf16 v[100:103], a[96:99], a[12:15], v[100:103]
v_add_f32 v75, v75, v28
v_add_f32 v76, v76, v28
v_cvt_pk_bf16_f32 v40, v64, v65
v_add_f32 v77, v77, v28
v_add_f32 v78, v78, v28
v_add_f32 v79, v79, v28
v_permlane16_swap_b32 v37, v36
v_cvt_pk_bf16_f32 v41, v66, v67
v_cvt_pk_bf16_f32 v42, v68, v69
v_cvt_pk_bf16_f32 v43, v70, v71
v_exp_f32 v72, v72
v_exp_f32 v73, v73
v_mfma_f32_16x16x32_bf16 v[128:131], a[100:103], v[40:43], 0
v_exp_f32 v74, v74
v_exp_f32 v75, v75
v_exp_f32 v76, v76
v_exp_f32 v77, v77
v_exp_f32 v78, v78
v_permlane32_swap_b32 v33, v32
v_max_f32 v36, v36, v37
v_exp_f32 v79, v79
v_min_f32_e64 v32, -v32, -v33
v_mov_b32 v37, v36
v_add_f32 v80, v80, v32
v_add_f32 v81, v81, v32
v_add_f32 v82, v82, v32
v_add_f32 v83, v83, v32
v_add_f32 v84, v84, v32
v_add_f32_e64 v85, v85, v32
v_cvt_pk_bf16_f32 v44, v72, v73
v_cvt_pk_bf16_f32 v45, v74, v75
v_add_f32 v86, v86, v32
v_add_f32 v87, v87, v32
v_cvt_pk_bf16_f32 v46, v76, v77
v_cvt_pk_bf16_f32 v47, v78, v79
v_exp_f32 v80, v80
v_exp_f32 v81, v81
v_exp_f32_e64 v82, v82
v_mfma_f32_16x16x32_bf16 v[160:163], a[100:103], v[44:47], 0
v_exp_f32 v83, v83
v_exp_f32 v84, v84
v_exp_f32 v85, v85
v_exp_f32 v86, v86
v_exp_f32 v87, v87
v_permlane32_swap_b32 v37, v36
v_min_f32_e64 v36, -v36, -v37
v_add_f32 v88, v88, v36
v_add_f32 v89, v89, v36
v_add_f32 v90, v90, v36
v_add_f32 v91, v91, v36
v_add_f32 v92, v92, v36
v_add_f32 v93, v93, v36
v_cvt_pk_bf16_f32 v48, v80, v81
v_cvt_pk_bf16_f32 v49, v82, v83
v_add_f32 v94, v94, v36
v_add_f32 v95, v95, v36
v_cvt_pk_bf16_f32 v50, v84, v85
v_cvt_pk_bf16_f32 v51, v86, v87
v_exp_f32 v88, v88
v_exp_f32 v89, v89
v_exp_f32_e64 v90, v90
v_mfma_f32_16x16x32_bf16 v[192:195], a[100:103], v[48:51], 0
v_exp_f32 v91, v91
v_exp_f32 v92, v92
v_exp_f32 v93, v93
v_exp_f32 v94, v94
v_exp_f32_e64 v95, v95
v_cvt_pk_bf16_f32 v52, v88, v89
v_cvt_pk_bf16_f32 v53, v90, v91
v_cvt_pk_bf16_f32 v54, v92, v93
v_cvt_pk_bf16_f32 v55, v94, v95
ds_read_b64_tr_b16 a[118:119], v0 offset:55296
ds_read_b64_tr_b16 a[120:121], v1 offset:53248
ds_read_b64_tr_b16 a[122:123], v1 offset:55296
ds_read_b64_tr_b16 a[124:125], v2 offset:53248
v_mfma_f32_16x16x32_bf16 v[224:227], a[100:103], v[52:55], 0
v_mov_b32 v37, v36
v_mov_b32 v38, v36
v_mfma_f32_16x16x32_bf16 v[228:231], a[104:107], v[52:55], 0
ds_read_b64_tr_b16 a[126:127], v2 offset:55296
v_mov_b32_e64 v39, v36
v_mfma_f32_16x16x32_bf16 v[196:199], a[104:107], v[48:51], 0
ds_read_b64_tr_b16 a[128:129], v3 offset:53248
v_mov_b32_e64 v33, v32
v_mfma_f32_16x16x32_bf16 v[164:167], a[104:107], v[44:47], 0
ds_read_b64_tr_b16 a[130:131], v3 offset:55296
v_mov_b32_e64 v34, v32
v_mfma_f32_16x16x32_bf16 v[132:135], a[104:107], v[40:43], 0
ds_read_b128 a[84:87], v8 offset:57344
v_mov_b32_e64 v35, v32
v_mfma_f32_16x16x32_bf16 v[136:139], a[108:111], v[40:43], 0
ds_read_b128 a[88:91], v8 offset:61440
v_mov_b32_e64 v29, v28
v_mfma_f32_16x16x32_bf16 v[168:171], a[108:111], v[44:47], 0
v_mov_b32 v30, v28
v_mov_b32 v31, v28
v_mfma_f32_16x16x32_bf16 v[200:203], a[108:111], v[48:51], 0
ds_read_b128 a[92:95], v9 offset:57344
v_mov_b32_e64 v25, v24
v_mfma_f32_16x16x32_bf16 v[232:235], a[108:111], v[52:55], 0
v_mov_b32 v26, v24
v_mov_b32 v27, v24
v_mfma_f32_16x16x32_bf16 v[236:239], a[112:115], v[52:55], 0
ds_read_b128 a[96:99], v9 offset:61440
v_add_f32_e64 v120, v120, v36
v_mfma_f32_16x16x32_bf16 v[204:207], a[112:115], v[48:51], 0
ds_read_b128 a[100:103], v10 offset:57344
v_add_f32_e64 v121, v121, v36
v_mfma_f32_16x16x32_bf16 v[172:175], a[112:115], v[44:47], 0
v_add_f32 v122, v122, v36
v_add_f32 v123, v123, v36
v_mfma_f32_16x16x32_bf16 v[140:143], a[112:115], v[40:43], 0
s_waitcnt lgkmcnt(5)
ds_read_b128 a[104:107], v10 offset:61440
v_add_f32 v124, v124, v36
v_mfma_f32_16x16x32_bf16 v[144:147], a[116:119], v[40:43], 0
ds_read_b128 a[108:111], v11 offset:57344
v_add_f32_e64 v125, v125, v36
v_mfma_f32_16x16x32_bf16 v[176:179], a[116:119], v[44:47], 0
v_add_f32 v126, v126, v36
v_add_f32 v127, v127, v36
v_mfma_f32_16x16x32_bf16 v[208:211], a[116:119], v[48:51], 0
ds_read_b128 a[112:115], v11 offset:61440
v_add_f32_e64 v112, v112, v32
v_mfma_f32_16x16x32_bf16 v[240:243], a[116:119], v[52:55], 0
ds_read_b64_tr_b16 a[116:117], v4 offset:0
v_add_f32_e64 v113, v113, v32
v_mfma_f32_16x16x32_bf16 v[244:247], a[120:123], v[52:55], 0
ds_read_b64_tr_b16 a[118:119], v4 offset:2048
v_add_f32_e64 v114, v114, v32
v_mfma_f32_16x16x32_bf16 v[212:215], a[120:123], v[48:51], 0
v_exp_f32_e64 v120, v120
v_mfma_f32_16x16x32_bf16 v[180:183], a[120:123], v[44:47], 0
v_exp_f32_e64 v121, v121
v_mfma_f32_16x16x32_bf16 v[148:151], a[120:123], v[40:43], 0
ds_read_b64_tr_b16 a[120:121], v5 offset:0
buffer_store_dwordx4 a[132:135], v20, s[28:31], s57 offen offset:0 sc1
v_mfma_f32_16x16x32_bf16 v[152:155], a[124:127], v[40:43], 0
s_mov_b32 s57, 49152
ds_read_b64_tr_b16 a[122:123], v5 offset:2048
v_add_f32_e64 v115, v115, v32
v_mfma_f32_16x16x32_bf16 v[184:187], a[124:127], v[44:47], 0
v_exp_f32_e64 v122, v122
v_mfma_f32_16x16x32_bf16 v[216:219], a[124:127], v[48:51], 0
v_exp_f32_e64 v123, v123
v_mfma_f32_16x16x32_bf16 v[248:251], a[124:127], v[52:55], 0
v_exp_f32_e64 v124, v124
v_mfma_f32_16x16x32_bf16 v[252:255], a[128:131], v[52:55], 0
v_exp_f32_e64 v125, v125
v_mfma_f32_16x16x32_bf16 v[220:223], a[128:131], v[48:51], 0
v_exp_f32_e64 v126, v126
v_mfma_f32_16x16x32_bf16 v[188:191], a[128:131], v[44:47], 0
v_exp_f32_e64 v127, v127
v_mfma_f32_16x16x32_bf16 v[156:159], a[128:131], v[40:43], 0
v_add_f32 v116, v116, v32
v_add_f32 v117, v117, v32
v_mfma_f32_16x16x32_bf16 a[64:67], a[80:83], v[40:43], 0
ds_read_b64_tr_b16 a[124:125], v6 offset:0
v_add_f32_e64 v118, v118, v32
v_mfma_f32_16x16x32_bf16 a[68:71], a[80:83], v[44:47], 0
v_add_f32_e64 v119, v119, v32
v_cvt_pk_bf16_f32 v44, v120, v121
v_mfma_f32_16x16x32_bf16 a[72:75], a[80:83], v[48:51], 0
v_exp_f32_e64 v112, v112
v_mfma_f32_16x16x32_bf16 a[76:79], a[80:83], v[52:55], 0
s_waitcnt lgkmcnt(1)
v_exp_f32 v113, v113
v_mfma_f32_16x16x32_bf16 v[88:91], a[84:87], a[48:51], v[36:39]
v_exp_f32_e64 v114, v114
v_mfma_f32_16x16x32_bf16 v[80:83], a[84:87], a[32:35], v[32:35]
v_exp_f32_e64 v115, v115
v_mfma_f32_16x16x32_bf16 v[72:75], a[84:87], a[16:19], v[28:31]
v_exp_f32_e64 v116, v116
v_mfma_f32_16x16x32_bf16 v[64:67], a[84:87], a[0:3], v[24:27]
v_exp_f32_e64 v117, v117
v_mfma_f32_16x16x32_bf16 v[68:71], a[88:91], a[0:3], v[24:27]
v_exp_f32_e64 v118, v118
v_mfma_f32_16x16x32_bf16 v[76:79], a[88:91], a[16:19], v[28:31]
v_exp_f32_e64 v119, v119
v_mfma_f32_16x16x32_bf16 v[84:87], a[88:91], a[32:35], v[32:35]
v_cvt_pk_bf16_f32 v45, v122, v123
v_cvt_pk_bf16_f32 v46, v124, v125
v_mfma_f32_16x16x32_bf16 v[92:95], a[88:91], a[48:51], v[36:39]
ds_read_b64_tr_b16 a[126:127], v6 offset:2048
v_cvt_pk_bf16_f32 v47, v126, v127
v_mfma_f32_16x16x32_bf16 v[88:91], a[92:95], a[52:55], v[88:91]
v_add_f32 v104, v104, v28
v_add_f32 v105, v105, v28
v_mfma_f32_16x16x32_bf16 v[80:83], a[92:95], a[36:39], v[80:83]
ds_read_b64_tr_b16 a[128:129], v7 offset:0
v_add_f32_e64 v106, v106, v28
v_mfma_f32_16x16x32_bf16 v[72:75], a[92:95], a[20:23], v[72:75]
v_add_f32 v107, v107, v28
v_add_f32 v108, v108, v28
v_mfma_f32_16x16x32_bf16 v[64:67], a[92:95], a[4:7], v[64:67]
ds_read_b64_tr_b16 a[130:131], v7 offset:2048
v_add_f32_e64 v109, v109, v28
v_mfma_f32_16x16x32_bf16 v[68:71], a[96:99], a[4:7], v[68:71]
v_add_f32 v110, v110, v28
v_add_f32 v111, v111, v28
v_mfma_f32_16x16x32_bf16 v[76:79], a[96:99], a[20:23], v[76:79]
v_exp_f32_e64 v104, v104
v_mfma_f32_16x16x32_bf16 v[84:87], a[96:99], a[36:39], v[84:87]
v_exp_f32_e64 v105, v105
v_mfma_f32_16x16x32_bf16 v[92:95], a[96:99], a[52:55], v[92:95]
v_exp_f32_e64 v106, v106
v_mfma_f32_16x16x32_bf16 v[88:91], a[100:103], a[56:59], v[88:91]
v_exp_f32_e64 v107, v107
v_mfma_f32_16x16x32_bf16 v[80:83], a[100:103], a[40:43], v[80:83]
v_exp_f32_e64 v108, v108
v_mfma_f32_16x16x32_bf16 v[72:75], a[100:103], a[24:27], v[72:75]
v_exp_f32_e64 v109, v109
v_mfma_f32_16x16x32_bf16 v[64:67], a[100:103], a[8:11], v[64:67]
v_exp_f32_e64 v110, v110
v_mfma_f32_16x16x32_bf16 v[68:71], a[104:107], a[8:11], v[68:71]
v_exp_f32_e64 v111, v111
v_mfma_f32_16x16x32_bf16 v[76:79], a[104:107], a[24:27], v[76:79]
v_cvt_pk_bf16_f32 v40, v112, v113
v_cvt_pk_bf16_f32 v41, v114, v115
v_mfma_f32_16x16x32_bf16 v[84:87], a[104:107], a[40:43], v[84:87]
ds_read_b64_tr_b16 a[84:85], v4 offset:4096
v_cvt_pk_bf16_f32 v42, v116, v117
v_mfma_f32_16x16x32_bf16 v[92:95], a[104:107], a[56:59], v[92:95]
v_add_f32_e64 v96, v96, v24
v_cvt_pk_bf16_f32 v43, v118, v119
v_mfma_f32_16x16x32_bf16 v[88:91], a[108:111], a[60:63], v[88:91]
ds_read_b64_tr_b16 a[86:87], v4 offset:6144
v_add_f32_e64 v97, v97, v24
v_mfma_f32_16x16x32_bf16 v[80:83], a[108:111], a[44:47], v[80:83]
v_add_f32 v98, v98, v24
v_add_f32 v99, v99, v24
v_mfma_f32_16x16x32_bf16 v[72:75], a[108:111], a[28:31], v[72:75]
ds_read_b64_tr_b16 a[88:89], v5 offset:4096
v_add_f32_e64 v100, v100, v24
v_mfma_f32_16x16x32_bf16 v[64:67], a[108:111], a[12:15], v[64:67]
v_add_f32 v101, v101, v24
v_add_f32 v102, v102, v24
v_mfma_f32_16x16x32_bf16 v[68:71], a[112:115], a[12:15], v[68:71]
ds_read_b64_tr_b16 a[90:91], v5 offset:6144
v_add_f32_e64 v103, v103, v24
v_mfma_f32_16x16x32_bf16 v[76:79], a[112:115], a[28:31], v[76:79]
v_exp_f32_e64 v96, v96
v_mfma_f32_16x16x32_bf16 v[84:87], a[112:115], a[44:47], v[84:87]
v_exp_f32_e64 v97, v97
v_mfma_f32_16x16x32_bf16 v[92:95], a[112:115], a[60:63], v[92:95]
v_exp_f32_e64 v98, v98
v_mfma_f32_16x16x32_bf16 v[224:227], a[116:119], v[44:47], v[224:227]
v_exp_f32_e64 v99, v99
v_mfma_f32_16x16x32_bf16 v[192:195], a[116:119], v[40:43], v[192:195]
v_exp_f32 v100, v100
v_exp_f32 v101, v101
v_exp_f32 v102, v102
v_exp_f32 v103, v103
v_cvt_pk_bf16_f32 v60, v104, v105
v_cvt_pk_bf16_f32 v61, v106, v107
v_cvt_pk_bf16_f32 v56, v96, v97
v_cvt_pk_bf16_f32 v57, v98, v99
v_cvt_pk_bf16_f32 v62, v108, v109
v_cvt_pk_bf16_f32 v63, v110, v111
ds_read_b64_tr_b16 a[92:93], v6 offset:4096
ds_read_b64_tr_b16 a[94:95], v6 offset:6144
v_cvt_pk_bf16_f32 v58, v100, v101
v_cvt_pk_bf16_f32 v59, v102, v103
v_mfma_f32_16x16x32_bf16 v[160:163], a[116:119], v[60:63], v[160:163]
ds_read_b64_tr_b16 a[96:97], v7 offset:4096
ds_read_b64_tr_b16 a[98:99], v7 offset:6144
v_mfma_f32_16x16x32_bf16 v[128:131], a[116:119], v[56:59], v[128:131]
v_exp_f32_e64 v64, v64
v_mfma_f32_16x16x32_bf16 v[132:135], a[120:123], v[56:59], v[132:135]
ds_read_b128 a[100:103], v12 offset:8192
ds_read_b128 a[104:107], v12 offset:12288
v_mfma_f32_16x16x32_bf16 v[164:167], a[120:123], v[60:63], v[164:167]
v_exp_f32_e64 v65, v65
v_mfma_f32_16x16x32_bf16 v[196:199], a[120:123], v[40:43], v[196:199]
v_exp_f32 v66, v66
v_mfma_f32_16x16x32_bf16 v[228:231], a[120:123], v[44:47], v[228:231]
s_waitcnt lgkmcnt(6)
ds_read_b128 a[108:111], v13 offset:8192
v_cvt_pk_bf16_f32 v48, v64, v65
v_mfma_f32_16x16x32_bf16 v[232:235], a[124:127], v[44:47], v[232:235]
ds_read_b128 a[112:115], v13 offset:12288
ds_read_b128 a[116:119], v14 offset:8192
v_mfma_f32_16x16x32_bf16 v[200:203], a[124:127], v[40:43], v[200:203]
v_exp_f32_e64 v67, v67
v_mfma_f32_16x16x32_bf16 v[168:171], a[124:127], v[60:63], v[168:171]
v_exp_f32_e64 v68, v68
v_mfma_f32_16x16x32_bf16 v[136:139], a[124:127], v[56:59], v[136:139]
ds_read_b128 a[120:123], v14 offset:12288
v_cvt_pk_bf16_f32 v49, v66, v67
v_mfma_f32_16x16x32_bf16 v[140:143], a[128:131], v[56:59], v[140:143]
ds_read_b128 a[124:127], v15 offset:8192
v_mfma_f32_16x16x32_bf16 v[172:175], a[128:131], v[60:63], v[172:175]
v_exp_f32_e64 v69, v69
v_mfma_f32_16x16x32_bf16 v[204:207], a[128:131], v[40:43], v[204:207]
v_exp_f32_e64 v70, v70
v_mfma_f32_16x16x32_bf16 v[236:239], a[128:131], v[44:47], v[236:239]
ds_read_b128 a[128:131], v15 offset:12288
v_cvt_pk_bf16_f32 v50, v68, v69
v_mfma_f32_16x16x32_bf16 v[240:243], a[84:87], v[44:47], v[240:243]
v_exp_f32_e64 v71, v71
v_mfma_f32_16x16x32_bf16 v[208:211], a[84:87], v[40:43], v[208:211]
v_cvt_pk_bf16_f32 v51, v70, v71
v_mfma_f32_16x16x32_bf16 v[176:179], a[84:87], v[60:63], v[176:179]
v_exp_f32_e64 v72, v72
v_mfma_f32_16x16x32_bf16 v[144:147], a[84:87], v[56:59], v[144:147]
v_exp_f32_e64 v73, v73
v_mfma_f32_16x16x32_bf16 v[148:151], a[88:91], v[56:59], v[148:151]
v_exp_f32_e64 v74, v74
v_mfma_f32_16x16x32_bf16 v[180:183], a[88:91], v[60:63], v[180:183]
v_exp_f32_e64 v75, v75
v_mfma_f32_16x16x32_bf16 v[212:215], a[88:91], v[40:43], v[212:215]
v_exp_f32 v76, v76
v_mfma_f32_16x16x32_bf16 v[244:247], a[88:91], v[44:47], v[244:247]
s_waitcnt lgkmcnt(1)
buffer_store_dwordx4 a[132:135], v20, s[28:31], s56 offen offset:0 sc1
v_cvt_pk_bf16_f32 v52, v72, v73
v_mfma_f32_16x16x32_bf16 v[248:251], a[92:95], v[44:47], v[248:251]
s_mov_b32 s56, 57344
v_exp_f32_e64 v77, v77
v_mfma_f32_16x16x32_bf16 v[216:219], a[92:95], v[40:43], v[216:219]
v_exp_f32_e64 v78, v78
v_mfma_f32_16x16x32_bf16 v[184:187], a[92:95], v[60:63], v[184:187]
v_exp_f32_e64 v79, v79
v_mfma_f32_16x16x32_bf16 v[152:155], a[92:95], v[56:59], v[152:155]
v_cvt_pk_bf16_f32 v53, v74, v75
v_cvt_pk_bf16_f32 v54, v76, v77
v_mfma_f32_16x16x32_bf16 v[156:159], a[96:99], v[56:59], v[156:159]
v_cvt_pk_bf16_f32 v55, v78, v79
v_mfma_f32_16x16x32_bf16 v[188:191], a[96:99], v[60:63], v[188:191]
buffer_load_dwordx4 a[200:203], v23, s[32:35], s58 offen
v_mfma_f32_16x16x32_bf16 v[220:223], a[96:99], v[40:43], v[220:223]
s_mov_b32 s58, 49280
v_exp_f32_e64 v80, v80
v_mfma_f32_16x16x32_bf16 v[252:255], a[96:99], v[44:47], v[252:255]
v_exp_f32_e64 v81, v81
v_mfma_f32_16x16x32_bf16 a[76:79], a[80:83], v[44:47], a[76:79]
v_exp_f32_e64 v82, v82
v_mfma_f32_16x16x32_bf16 a[72:75], a[80:83], v[40:43], a[72:75]
v_exp_f32_e64 v83, v83
v_mfma_f32_16x16x32_bf16 a[68:71], a[80:83], v[60:63], a[68:71]
v_exp_f32_e64 v84, v84
v_mfma_f32_16x16x32_bf16 a[64:67], a[80:83], v[56:59], a[64:67]
v_exp_f32_e64 v85, v85
v_mfma_f32_16x16x32_bf16 v[96:99], a[100:103], a[0:3], v[24:27]
v_exp_f32_e64 v86, v86
v_mfma_f32_16x16x32_bf16 v[104:107], a[100:103], a[16:19], v[28:31]
v_exp_f32_e64 v87, v87
v_mfma_f32_16x16x32_bf16 v[112:115], a[100:103], a[32:35], v[32:35]
v_cvt_pk_bf16_f32 v56, v80, v81
v_cvt_pk_bf16_f32 v57, v82, v83
v_mfma_f32_16x16x32_bf16 v[120:123], a[100:103], a[48:51], v[36:39]
v_cvt_pk_bf16_f32 v58, v84, v85
v_mfma_f32_16x16x32_bf16 v[124:127], a[104:107], a[48:51], v[36:39]
v_cvt_pk_bf16_f32 v59, v86, v87
v_mfma_f32_16x16x32_bf16 v[116:119], a[104:107], a[32:35], v[32:35]
v_exp_f32_e64 v88, v88
v_mfma_f32_16x16x32_bf16 v[108:111], a[104:107], a[16:19], v[28:31]
v_exp_f32_e64 v89, v89
v_mfma_f32_16x16x32_bf16 v[100:103], a[104:107], a[0:3], v[24:27]
v_exp_f32_e64 v90, v90
v_mfma_f32_16x16x32_bf16 v[96:99], a[108:111], a[4:7], v[96:99]
v_exp_f32_e64 v91, v91
v_mfma_f32_16x16x32_bf16 v[104:107], a[108:111], a[20:23], v[104:107]
buffer_load_dwordx4 a[204:207], v23, s[32:35], s59 offen
v_cvt_pk_bf16_f32 v60, v88, v89
v_mfma_f32_16x16x32_bf16 v[112:115], a[108:111], a[36:39], v[112:115]
s_mov_b32 s59, 65536
v_exp_f32_e64 v92, v92
v_mfma_f32_16x16x32_bf16 v[120:123], a[108:111], a[52:55], v[120:123]
v_exp_f32_e64 v93, v93
v_mfma_f32_16x16x32_bf16 v[124:127], a[112:115], a[52:55], v[124:127]
v_exp_f32_e64 v94, v94
v_mfma_f32_16x16x32_bf16 v[116:119], a[112:115], a[36:39], v[116:119]
v_exp_f32_e64 v95, v95
v_mfma_f32_16x16x32_bf16 v[108:111], a[112:115], a[20:23], v[108:111]
v_cvt_pk_bf16_f32 v61, v90, v91
v_cvt_pk_bf16_f32 v62, v92, v93
v_mfma_f32_16x16x32_bf16 v[100:103], a[112:115], a[4:7], v[100:103]
v_cvt_pk_bf16_f32 v63, v94, v95
v_mfma_f32_16x16x32_bf16 v[96:99], a[116:119], a[8:11], v[96:99]
s_waitcnt vmcnt(11)
s_barrier
ds_read_b64_tr_b16 a[84:85], v4 offset:16384
ds_read_b64_tr_b16 a[86:87], v4 offset:18432
v_mfma_f32_16x16x32_bf16 v[104:107], a[116:119], a[24:27], v[104:107]
ds_read_b64_tr_b16 a[88:89], v5 offset:16384
ds_read_b64_tr_b16 a[90:91], v5 offset:18432
v_mfma_f32_16x16x32_bf16 v[112:115], a[116:119], a[40:43], v[112:115]
ds_read_b64_tr_b16 a[92:93], v6 offset:16384
ds_read_b64_tr_b16 a[94:95], v6 offset:18432
v_mfma_f32_16x16x32_bf16 v[120:123], a[116:119], a[56:59], v[120:123]
ds_read_b64_tr_b16 a[96:97], v7 offset:16384
ds_read_b64_tr_b16 a[98:99], v7 offset:18432
v_mfma_f32_16x16x32_bf16 v[124:127], a[120:123], a[56:59], v[124:127]
ds_read_b64_tr_b16 a[100:101], v4 offset:20480
ds_read_b64_tr_b16 a[102:103], v4 offset:22528
v_mfma_f32_16x16x32_bf16 v[116:119], a[120:123], a[40:43], v[116:119]
ds_read_b64_tr_b16 a[104:105], v5 offset:20480
ds_read_b64_tr_b16 a[106:107], v5 offset:22528
v_mfma_f32_16x16x32_bf16 v[108:111], a[120:123], a[24:27], v[108:111]
ds_read_b64_tr_b16 a[108:109], v6 offset:20480
ds_read_b64_tr_b16 a[110:111], v6 offset:22528
v_mfma_f32_16x16x32_bf16 v[100:103], a[120:123], a[8:11], v[100:103]
ds_read_b64_tr_b16 a[112:113], v7 offset:20480
ds_read_b64_tr_b16 a[114:115], v7 offset:22528
v_mfma_f32_16x16x32_bf16 v[96:99], a[124:127], a[12:15], v[96:99]
ds_read_b128 a[116:119], v12 offset:24576
ds_read_b128 a[120:123], v12 offset:28672
v_mfma_f32_16x16x32_bf16 v[104:107], a[124:127], a[28:31], v[104:107]
v_mfma_f32_16x16x32_bf16 v[112:115], a[124:127], a[44:47], v[112:115]
s_nop 3
v_exp_f32 v96, v96
v_mfma_f32_16x16x32_bf16 v[120:123], a[124:127], a[60:63], v[120:123]
s_waitcnt lgkmcnt(12)
v_exp_f32 v104, v104
v_mfma_f32_16x16x32_bf16 v[124:127], a[128:131], a[60:63], v[124:127]
v_exp_f32_e64 v112, v112
v_mfma_f32_16x16x32_bf16 v[116:119], a[128:131], a[44:47], v[116:119]
ds_read_b128 a[124:127], v13 offset:24576
v_mfma_f32_16x16x32_bf16 v[108:111], a[128:131], a[28:31], v[108:111]
s_nop 0
v_exp_f32 v120, v120
v_mfma_f32_16x16x32_bf16 v[100:103], a[128:131], a[12:15], v[100:103]
ds_read_b128 a[128:131], v13 offset:28672
buffer_load_dwordx4 v18, s[16:19], s57 offen lds
v_mfma_f32_16x16x32_bf16 v[128:131], a[84:87], v[48:51], v[128:131]
s_add_u32 m0, s4, 20480
s_mov_b32 s57, 57472
v_mfma_f32_16x16x32_bf16 v[160:163], a[84:87], v[52:55], v[160:163]
v_exp_f32_e64 v121, v121
v_mfma_f32_16x16x32_bf16 v[192:195], a[84:87], v[56:59], v[192:195]
v_exp_f32_e64 v122, v122
v_mfma_f32_16x16x32_bf16 v[224:227], a[84:87], v[60:63], v[224:227]
ds_read_b128 a[84:87], v14 offset:24576
v_mfma_f32_16x16x32_bf16 v[228:231], a[88:91], v[60:63], v[228:231]
buffer_load_dwordx4 v18, s[16:19], s58 offen lds
v_mfma_f32_16x16x32_bf16 v[196:199], a[88:91], v[56:59], v[196:199]
s_add_u32 m0, s5, 24576
s_mov_b32 s58, 73728
v_mfma_f32_16x16x32_bf16 v[164:167], a[88:91], v[52:55], v[164:167]
v_exp_f32_e64 v123, v123
v_mfma_f32_16x16x32_bf16 v[132:135], a[88:91], v[48:51], v[132:135]
ds_read_b128 a[88:91], v14 offset:28672
v_mfma_f32_16x16x32_bf16 v[136:139], a[92:95], v[48:51], v[136:139]
v_exp_f32_e64 v124, v124
v_mfma_f32_16x16x32_bf16 v[168:171], a[92:95], v[52:55], v[168:171]
buffer_load_dwordx4 v16, s[12:15], s59 offen lds
v_mfma_f32_16x16x32_bf16 v[200:203], a[92:95], v[56:59], v[200:203]
v_exp_f32 v125, v125
v_mfma_f32_16x16x32_bf16 v[232:235], a[92:95], v[60:63], v[232:235]
s_waitcnt lgkmcnt(2)
ds_read_b128 a[92:95], v15 offset:24576
v_mfma_f32_16x16x32_bf16 v[236:239], a[96:99], v[60:63], v[236:239]
v_exp_f32_e64 v126, v126
v_mfma_f32_16x16x32_bf16 v[204:207], a[96:99], v[56:59], v[204:207]
v_exp_f32_e64 v127, v127
v_mfma_f32_16x16x32_bf16 v[172:175], a[96:99], v[52:55], v[172:175]
buffer_load_dwordx4 v17, s[12:15], s59 offen offset:1024 lds
v_mfma_f32_16x16x32_bf16 v[140:143], a[96:99], v[48:51], v[140:143]
s_add_u32 m0, s4, 32768
s_mov_b32 s59, 32256
ds_read_b128 a[96:99], v15 offset:28672
v_mfma_f32_16x16x32_bf16 v[144:147], a[100:103], v[48:51], v[144:147]
v_exp_f32_e64 v113, v113
v_mfma_f32_16x16x32_bf16 v[176:179], a[100:103], v[52:55], v[176:179]
v_exp_f32_e64 v114, v114
v_mfma_f32_16x16x32_bf16 v[208:211], a[100:103], v[56:59], v[208:211]
v_exp_f32_e64 v115, v115
v_mfma_f32_16x16x32_bf16 v[240:243], a[100:103], v[60:63], v[240:243]
ds_read_b64_tr_b16 a[100:101], v4 offset:32768
buffer_load_dwordx4 v18, s[16:19], s56 offen lds
v_mfma_f32_16x16x32_bf16 v[244:247], a[104:107], v[60:63], v[244:247]
s_add_u32 m0, s4, 36864
s_mov_b32 s56, 46080
ds_read_b64_tr_b16 a[102:103], v4 offset:34816
v_mfma_f32_16x16x32_bf16 v[212:215], a[104:107], v[56:59], v[212:215]
v_exp_f32_e64 v116, v116
v_mfma_f32_16x16x32_bf16 v[180:183], a[104:107], v[52:55], v[180:183]
v_exp_f32_e64 v117, v117
v_mfma_f32_16x16x32_bf16 v[148:151], a[104:107], v[48:51], v[148:151]
ds_read_b64_tr_b16 a[104:105], v5 offset:32768
ds_read_b64_tr_b16 a[106:107], v5 offset:34816
v_mfma_f32_16x16x32_bf16 v[152:155], a[108:111], v[48:51], v[152:155]
buffer_load_dwordx4 v18, s[16:19], s57 offen lds
v_mfma_f32_16x16x32_bf16 v[184:187], a[108:111], v[52:55], v[184:187]
s_add_u32 m0, s5, 40960
s_mov_b32 s57, 65536
v_mfma_f32_16x16x32_bf16 v[216:219], a[108:111], v[56:59], v[216:219]
v_exp_f32_e64 v118, v118
v_mfma_f32_16x16x32_bf16 v[248:251], a[108:111], v[60:63], v[248:251]
v_exp_f32_e64 v119, v119
v_mfma_f32_16x16x32_bf16 v[252:255], a[112:115], v[60:63], v[252:255]
v_exp_f32_e64 v105, v105
v_mfma_f32_16x16x32_bf16 v[220:223], a[112:115], v[56:59], v[220:223]
buffer_load_dwordx4 v16, s[12:15], s58 offen lds
v_cvt_pk_bf16_f32 v44, v104, v105
v_mfma_f32_16x16x32_bf16 v[188:191], a[112:115], v[52:55], v[188:191]
v_exp_f32_e64 v106, v106
v_mfma_f32_16x16x32_bf16 v[156:159], a[112:115], v[48:51], v[156:159]
v_exp_f32_e64 v107, v107
v_mfma_f32_16x16x32_bf16 a[64:67], a[80:83], v[48:51], a[64:67]
v_exp_f32_e64 v108, v108
v_mfma_f32_16x16x32_bf16 a[68:71], a[80:83], v[52:55], a[68:71]
v_cvt_pk_bf16_f32 v52, v120, v121
v_cvt_pk_bf16_f32 v53, v122, v123
v_mfma_f32_16x16x32_bf16 a[72:75], a[80:83], v[56:59], a[72:75]
buffer_load_dwordx4 v17, s[12:15], s58 offen offset:1024 lds
v_cvt_pk_bf16_f32 v54, v124, v125
v_mfma_f32_16x16x32_bf16 a[76:79], a[80:83], v[60:63], a[76:79]
s_mov_b32 m0, 155968
s_mov_b32 s58, 65664
v_cvt_pk_bf16_f32 v55, v126, v127
v_mfma_f32_16x16x32_bf16 v[88:91], a[116:119], a[48:51], v[36:39]
v_exp_f32_e64 v109, v109
v_mfma_f32_16x16x32_bf16 v[80:83], a[116:119], a[32:35], v[32:35]
v_exp_f32_e64 v110, v110
v_mfma_f32_16x16x32_bf16 v[72:75], a[116:119], a[16:19], v[28:31]
v_exp_f32_e64 v111, v111
v_mfma_f32_16x16x32_bf16 v[64:67], a[116:119], a[0:3], v[24:27]
s_bfm_b64 exec, 16, 16
buffer_load_dword v21, s[8:11], s73 offen  lds
s_mov_b64 exec, -1
v_cvt_pk_bf16_f32 v48, v112, v113
v_mfma_f32_16x16x32_bf16 v[68:71], a[120:123], a[0:3], v[24:27]
s_add_u32 m0, s4, 49152
v_cvt_pk_bf16_f32 v49, v114, v115
v_cvt_pk_bf16_f32 v50, v116, v117
v_mfma_f32_16x16x32_bf16 v[76:79], a[120:123], a[16:19], v[28:31]
ds_read_b64_tr_b16 a[108:109], v6 offset:32768
v_cvt_pk_bf16_f32 v51, v118, v119
v_mfma_f32_16x16x32_bf16 v[84:87], a[120:123], a[32:35], v[32:35]
v_exp_f32_e64 v97, v97
v_mfma_f32_16x16x32_bf16 v[92:95], a[120:123], a[48:51], v[36:39]
v_exp_f32_e64 v98, v98
v_mfma_f32_16x16x32_bf16 v[88:91], a[124:127], a[52:55], v[88:91]
buffer_load_dwordx4 a[208:211], v23, s[32:35], s59 offen
v_cvt_pk_bf16_f32 v45, v106, v107
v_mfma_f32_16x16x32_bf16 v[80:83], a[124:127], a[36:39], v[80:83]
s_mov_b32 s59, 81920
v_exp_f32_e64 v99, v99
v_mfma_f32_16x16x32_bf16 v[72:75], a[124:127], a[20:23], v[72:75]
v_exp_f32_e64 v100, v100
v_mfma_f32_16x16x32_bf16 v[64:67], a[124:127], a[4:7], v[64:67]
v_exp_f32_e64 v101, v101
v_mfma_f32_16x16x32_bf16 v[68:71], a[128:131], a[4:7], v[68:71]
v_exp_f32_e64 v102, v102
v_mfma_f32_16x16x32_bf16 v[76:79], a[128:131], a[20:23], v[76:79]
buffer_load_dwordx4 a[212:215], v23, s[32:35], s56 offen
v_cvt_pk_bf16_f32 v46, v108, v109
v_mfma_f32_16x16x32_bf16 v[84:87], a[128:131], a[36:39], v[84:87]
s_mov_b32 s56, 8704
v_exp_f32 v103, v103
v_mfma_f32_16x16x32_bf16 v[92:95], a[128:131], a[52:55], v[92:95]
s_waitcnt lgkmcnt(0)
ds_read_b64_tr_b16 a[110:111], v6 offset:34816
v_cvt_pk_bf16_f32 v47, v110, v111
v_mfma_f32_16x16x32_bf16 v[88:91], a[84:87], a[56:59], v[88:91]
v_cvt_pk_bf16_f32 v40, v96, v97
v_cvt_pk_bf16_f32 v41, v98, v99
v_mfma_f32_16x16x32_bf16 v[80:83], a[84:87], a[40:43], v[80:83]
ds_read_b64_tr_b16 a[112:113], v7 offset:32768
v_cvt_pk_bf16_f32 v42, v100, v101
v_mfma_f32_16x16x32_bf16 v[72:75], a[84:87], a[24:27], v[72:75]
ds_read_b64_tr_b16 a[114:115], v7 offset:34816
v_cvt_pk_bf16_f32 v43, v102, v103
v_mfma_f32_16x16x32_bf16 v[64:67], a[84:87], a[8:11], v[64:67]
ds_read_b64_tr_b16 a[116:117], v4 offset:36864
ds_read_b64_tr_b16 a[118:119], v4 offset:38912
v_mfma_f32_16x16x32_bf16 v[68:71], a[88:91], a[8:11], v[68:71]
ds_read_b64_tr_b16 a[120:121], v5 offset:36864
ds_read_b64_tr_b16 a[122:123], v5 offset:38912
v_mfma_f32_16x16x32_bf16 v[76:79], a[88:91], a[24:27], v[76:79]
ds_read_b64_tr_b16 a[124:125], v6 offset:36864
ds_read_b64_tr_b16 a[126:127], v6 offset:38912
v_mfma_f32_16x16x32_bf16 v[84:87], a[88:91], a[40:43], v[84:87]
ds_read_b64_tr_b16 a[128:129], v7 offset:36864
ds_read_b64_tr_b16 a[130:131], v7 offset:38912
v_mfma_f32_16x16x32_bf16 v[92:95], a[88:91], a[56:59], v[92:95]
ds_read_b128 a[84:87], v12 offset:40960
ds_read_b128 a[88:91], v12 offset:45056
v_mfma_f32_16x16x32_bf16 v[88:91], a[92:95], a[60:63], v[88:91]
v_mfma_f32_16x16x32_bf16 v[80:83], a[92:95], a[44:47], v[80:83]
v_mfma_f32_16x16x32_bf16 v[72:75], a[92:95], a[28:31], v[72:75]
s_nop 5
v_exp_f32 v88, v88
v_mfma_f32_16x16x32_bf16 v[64:67], a[92:95], a[12:15], v[64:67]
ds_read_b128 a[92:95], v13 offset:40960
v_mfma_f32_16x16x32_bf16 v[68:71], a[96:99], a[12:15], v[68:71]
v_exp_f32_e64 v72, v72
v_mfma_f32_16x16x32_bf16 v[76:79], a[96:99], a[28:31], v[76:79]
s_nop 3
v_exp_f32 v64, v64
v_mfma_f32_16x16x32_bf16 v[84:87], a[96:99], a[44:47], v[84:87]
v_exp_f32_e64 v65, v65
v_mfma_f32_16x16x32_bf16 v[92:95], a[96:99], a[60:63], v[92:95]
ds_read_b128 a[96:99], v13 offset:45056
buffer_load_dwordx4 v18, s[16:19], s57 offen lds
v_mfma_f32_16x16x32_bf16 v[224:227], a[100:103], v[52:55], v[224:227]
s_add_u32 m0, s4, 53248
s_mov_b32 s57, 22528
v_cvt_pk_bf16_f32 v56, v64, v65
v_mfma_f32_16x16x32_bf16 v[192:195], a[100:103], v[48:51], v[192:195]
v_exp_f32_e64 v66, v66
v_mfma_f32_16x16x32_bf16 v[160:163], a[100:103], v[44:47], v[160:163]
v_exp_f32_e64 v67, v67
v_mfma_f32_16x16x32_bf16 v[128:131], a[100:103], v[40:43], v[128:131]
ds_read_b128 a[100:103], v14 offset:40960
v_cvt_pk_bf16_f32 v57, v66, v67
v_mfma_f32_16x16x32_bf16 v[132:135], a[104:107], v[40:43], v[132:135]
buffer_load_dwordx4 v18, s[16:19], s58 offen lds
v_mfma_f32_16x16x32_bf16 v[164:167], a[104:107], v[44:47], v[164:167]
s_add_u32 m0, s5, 57344
s_add_u32 s58, s52, 0
v_mfma_f32_16x16x32_bf16 v[196:199], a[104:107], v[48:51], v[196:199]
v_exp_f32 v68, v68
v_mfma_f32_16x16x32_bf16 v[228:231], a[104:107], v[52:55], v[228:231]
s_waitcnt lgkmcnt(2)
ds_read_b128 a[104:107], v14 offset:45056
v_mfma_f32_16x16x32_bf16 v[232:235], a[108:111], v[52:55], v[232:235]
v_exp_f32 v69, v69
v_mfma_f32_16x16x32_bf16 v[200:203], a[108:111], v[48:51], v[200:203]
buffer_load_dwordx4 v16, s[12:15], s59 offen lds
v_cvt_pk_bf16_f32 v58, v68, v69
v_mfma_f32_16x16x32_bf16 v[168:171], a[108:111], v[44:47], v[168:171]
v_exp_f32_e64 v70, v70
v_mfma_f32_16x16x32_bf16 v[136:139], a[108:111], v[40:43], v[136:139]
ds_read_b128 a[108:111], v15 offset:40960
v_mfma_f32_16x16x32_bf16 v[140:143], a[112:115], v[40:43], v[140:143]
v_exp_f32_e64 v71, v71
v_mfma_f32_16x16x32_bf16 v[172:175], a[112:115], v[44:47], v[172:175]
v_cvt_pk_bf16_f32 v59, v70, v71
v_mfma_f32_16x16x32_bf16 v[204:207], a[112:115], v[48:51], v[204:207]
buffer_load_dwordx4 v17, s[12:15], s59 offen offset:1024 lds
v_mfma_f32_16x16x32_bf16 v[236:239], a[112:115], v[52:55], v[236:239]
s_mov_b32 m0, 155968
s_mov_b32 s59, 36352
ds_read_b128 a[112:115], v15 offset:45056
v_mfma_f32_16x16x32_bf16 v[240:243], a[116:119], v[52:55], v[240:243]
v_exp_f32_e64 v73, v73
v_mfma_f32_16x16x32_bf16 v[208:211], a[116:119], v[48:51], v[208:211]
v_exp_f32_e64 v74, v74
v_mfma_f32_16x16x32_bf16 v[176:179], a[116:119], v[44:47], v[176:179]
v_exp_f32_e64 v75, v75
v_mfma_f32_16x16x32_bf16 v[144:147], a[116:119], v[40:43], v[144:147]
ds_read_b64_tr_b16 a[116:117], v4 offset:49152
s_bfm_b64 exec, 16, 32
buffer_load_dword v21, s[8:11], s73 offen  lds
s_mov_b64 exec, -1
v_mfma_f32_16x16x32_bf16 v[148:151], a[120:123], v[40:43], v[148:151]
s_mov_b32 m0, 155968
ds_read_b64_tr_b16 a[118:119], v4 offset:51200
v_cvt_pk_bf16_f32 v60, v72, v73
v_mfma_f32_16x16x32_bf16 v[180:183], a[120:123], v[44:47], v[180:183]
v_exp_f32_e64 v76, v76
v_mfma_f32_16x16x32_bf16 v[212:215], a[120:123], v[48:51], v[212:215]
v_exp_f32_e64 v77, v77
v_mfma_f32_16x16x32_bf16 v[244:247], a[120:123], v[52:55], v[244:247]
ds_read_b64_tr_b16 a[120:121], v5 offset:49152
v_cvt_pk_bf16_f32 v61, v74, v75
v_mfma_f32_16x16x32_bf16 v[248:251], a[124:127], v[52:55], v[248:251]
ds_read_b64_tr_b16 a[122:123], v5 offset:51200
s_bfm_b64 exec, 16, 48
buffer_load_dword v21, s[8:11], s73 offen  lds
s_mov_b64 exec, -1
v_mfma_f32_16x16x32_bf16 v[216:219], a[124:127], v[48:51], v[216:219]
s_add_u32 m0, s4, 65536
v_exp_f32_e64 v78, v78
v_mfma_f32_16x16x32_bf16 v[184:187], a[124:127], v[44:47], v[184:187]
v_exp_f32_e64 v79, v79
v_mfma_f32_16x16x32_bf16 v[152:155], a[124:127], v[40:43], v[152:155]
v_cvt_pk_bf16_f32 v62, v76, v77
v_cvt_pk_bf16_f32 v63, v78, v79
v_mfma_f32_16x16x32_bf16 v[156:159], a[128:131], v[40:43], v[156:159]
v_exp_f32_e64 v80, v80
v_mfma_f32_16x16x32_bf16 v[188:191], a[128:131], v[44:47], v[188:191]
ds_read_b64_tr_b16 a[124:125], v6 offset:49152
buffer_store_dwordx4 a[132:135], v20, s[28:31], s58 offen offset:512 sc1
v_mfma_f32_16x16x32_bf16 v[220:223], a[128:131], v[48:51], v[220:223]
s_mov_b32 s58, 73856
v_exp_f32_e64 v81, v81
v_mfma_f32_16x16x32_bf16 v[252:255], a[128:131], v[52:55], v[252:255]
v_exp_f32_e64 v82, v82
v_mfma_f32_16x16x32_bf16 a[76:79], a[80:83], v[52:55], a[76:79]
v_exp_f32_e64 v83, v83
v_mfma_f32_16x16x32_bf16 a[72:75], a[80:83], v[48:51], a[72:75]
v_exp_f32_e64 v84, v84
v_mfma_f32_16x16x32_bf16 a[68:71], a[80:83], v[44:47], a[68:71]
ds_read_b64_tr_b16 a[126:127], v6 offset:51200
buffer_load_dwordx4 a[232:235], v23, s[32:35], s56 offen
v_mfma_f32_16x16x32_bf16 a[64:67], a[80:83], v[40:43], a[64:67]
s_mov_b32 s56, 50176
v_exp_f32_e64 v85, v85
v_mfma_f32_16x16x32_bf16 v[96:99], a[84:87], a[0:3], v[24:27]
v_exp_f32_e64 v86, v86
v_mfma_f32_16x16x32_bf16 v[104:107], a[84:87], a[16:19], v[28:31]
v_exp_f32_e64 v87, v87
v_mfma_f32_16x16x32_bf16 v[112:115], a[84:87], a[32:35], v[32:35]
v_cvt_pk_bf16_f32 v40, v80, v81
v_cvt_pk_bf16_f32 v41, v82, v83
v_mfma_f32_16x16x32_bf16 v[120:123], a[84:87], a[48:51], v[36:39]
ds_read_b64_tr_b16 a[128:129], v7 offset:49152
v_cvt_pk_bf16_f32 v42, v84, v85
v_mfma_f32_16x16x32_bf16 v[124:127], a[88:91], a[48:51], v[36:39]
ds_read_b64_tr_b16 a[130:131], v7 offset:51200
v_cvt_pk_bf16_f32 v43, v86, v87
v_mfma_f32_16x16x32_bf16 v[116:119], a[88:91], a[32:35], v[32:35]
v_exp_f32_e64 v89, v89
v_mfma_f32_16x16x32_bf16 v[108:111], a[88:91], a[16:19], v[28:31]
v_exp_f32_e64 v90, v90
v_mfma_f32_16x16x32_bf16 v[100:103], a[88:91], a[0:3], v[24:27]
v_exp_f32_e64 v91, v91
v_mfma_f32_16x16x32_bf16 v[96:99], a[92:95], a[4:7], v[96:99]
v_exp_f32_e64 v92, v92
v_mfma_f32_16x16x32_bf16 v[104:107], a[92:95], a[20:23], v[104:107]
buffer_load_dwordx4 a[236:239], v23, s[32:35], s57 offen
v_cvt_pk_bf16_f32 v44, v88, v89
v_mfma_f32_16x16x32_bf16 v[112:115], a[92:95], a[36:39], v[112:115]
s_mov_b32 s57, 73728
v_exp_f32_e64 v93, v93
v_mfma_f32_16x16x32_bf16 v[120:123], a[92:95], a[52:55], v[120:123]
s_waitcnt lgkmcnt(2)
v_exp_f32 v94, v94
v_mfma_f32_16x16x32_bf16 v[124:127], a[96:99], a[52:55], v[124:127]
v_exp_f32_e64 v95, v95
v_mfma_f32_16x16x32_bf16 v[116:119], a[96:99], a[36:39], v[116:119]
v_cvt_pk_bf16_f32 v45, v90, v91
v_cvt_pk_bf16_f32 v46, v92, v93
v_mfma_f32_16x16x32_bf16 v[108:111], a[96:99], a[20:23], v[108:111]
ds_read_b64_tr_b16 a[84:85], v4 offset:53248
v_cvt_pk_bf16_f32 v47, v94, v95
v_mfma_f32_16x16x32_bf16 v[100:103], a[96:99], a[4:7], v[100:103]
ds_read_b64_tr_b16 a[86:87], v4 offset:55296
ds_read_b64_tr_b16 a[88:89], v5 offset:53248
v_mfma_f32_16x16x32_bf16 v[96:99], a[100:103], a[8:11], v[96:99]
ds_read_b64_tr_b16 a[90:91], v5 offset:55296
ds_read_b64_tr_b16 a[92:93], v6 offset:53248
v_mfma_f32_16x16x32_bf16 v[104:107], a[100:103], a[24:27], v[104:107]
ds_read_b64_tr_b16 a[94:95], v6 offset:55296
ds_read_b64_tr_b16 a[96:97], v7 offset:53248
v_mfma_f32_16x16x32_bf16 v[112:115], a[100:103], a[40:43], v[112:115]
ds_read_b64_tr_b16 a[98:99], v7 offset:55296
v_mfma_f32_16x16x32_bf16 v[120:123], a[100:103], a[56:59], v[120:123]
ds_read_b128 a[100:103], v12 offset:57344
v_mfma_f32_16x16x32_bf16 v[124:127], a[104:107], a[56:59], v[124:127]
v_mfma_f32_16x16x32_bf16 v[116:119], a[104:107], a[40:43], v[116:119]
v_mfma_f32_16x16x32_bf16 v[108:111], a[104:107], a[24:27], v[108:111]
v_mfma_f32_16x16x32_bf16 v[100:103], a[104:107], a[8:11], v[100:103]
ds_read_b128 a[104:107], v12 offset:61440
v_mfma_f32_16x16x32_bf16 v[96:99], a[108:111], a[12:15], v[96:99]
v_mfma_f32_16x16x32_bf16 v[104:107], a[108:111], a[28:31], v[104:107]
v_mfma_f32_16x16x32_bf16 v[112:115], a[108:111], a[44:47], v[112:115]
s_nop 5
v_exp_f32 v96, v96
v_mfma_f32_16x16x32_bf16 v[120:123], a[108:111], a[60:63], v[120:123]
ds_read_b128 a[108:111], v13 offset:57344
v_mfma_f32_16x16x32_bf16 v[124:127], a[112:115], a[60:63], v[124:127]
v_exp_f32_e64 v112, v112
v_mfma_f32_16x16x32_bf16 v[116:119], a[112:115], a[44:47], v[116:119]
s_nop 3
v_exp_f32 v120, v120
v_mfma_f32_16x16x32_bf16 v[108:111], a[112:115], a[28:31], v[108:111]
v_exp_f32_e64 v121, v121
v_mfma_f32_16x16x32_bf16 v[100:103], a[112:115], a[12:15], v[100:103]
ds_read_b128 a[112:115], v13 offset:61440
v_mfma_f32_16x16x32_bf16 v[128:131], a[116:119], v[56:59], v[128:131]
v_exp_f32_e64 v122, v122
v_mfma_f32_16x16x32_bf16 v[160:163], a[116:119], v[60:63], v[160:163]
v_exp_f32_e64 v123, v123
v_mfma_f32_16x16x32_bf16 v[192:195], a[116:119], v[40:43], v[192:195]
v_exp_f32_e64 v124, v124
v_mfma_f32_16x16x32_bf16 v[224:227], a[116:119], v[44:47], v[224:227]
ds_read_b128 a[116:119], v14 offset:57344
v_mfma_f32_16x16x32_bf16 v[228:231], a[120:123], v[44:47], v[228:231]
v_exp_f32_e64 v125, v125
v_mfma_f32_16x16x32_bf16 v[196:199], a[120:123], v[40:43], v[196:199]
v_exp_f32_e64 v126, v126
v_mfma_f32_16x16x32_bf16 v[164:167], a[120:123], v[60:63], v[164:167]
v_exp_f32_e64 v127, v127
v_mfma_f32_16x16x32_bf16 v[132:135], a[120:123], v[56:59], v[132:135]
ds_read_b128 a[120:123], v14 offset:61440
v_mfma_f32_16x16x32_bf16 v[136:139], a[124:127], v[56:59], v[136:139]
v_exp_f32_e64 v113, v113
v_mfma_f32_16x16x32_bf16 v[168:171], a[124:127], v[60:63], v[168:171]
v_exp_f32_e64 v114, v114
v_mfma_f32_16x16x32_bf16 v[200:203], a[124:127], v[40:43], v[200:203]
v_exp_f32 v115, v115
v_mfma_f32_16x16x32_bf16 v[232:235], a[124:127], v[44:47], v[232:235]
s_waitcnt lgkmcnt(2)
ds_read_b128 a[124:127], v15 offset:57344
v_mfma_f32_16x16x32_bf16 v[236:239], a[128:131], v[44:47], v[236:239]
v_exp_f32_e64 v116, v116
v_mfma_f32_16x16x32_bf16 v[204:207], a[128:131], v[40:43], v[204:207]
v_exp_f32_e64 v117, v117
v_mfma_f32_16x16x32_bf16 v[172:175], a[128:131], v[60:63], v[172:175]
v_exp_f32_e64 v118, v118
v_mfma_f32_16x16x32_bf16 v[140:143], a[128:131], v[56:59], v[140:143]
ds_read_b128 a[128:131], v15 offset:61440
v_mfma_f32_16x16x32_bf16 v[144:147], a[84:87], v[56:59], v[144:147]
v_exp_f32_e64 v119, v119
v_mfma_f32_16x16x32_bf16 v[176:179], a[84:87], v[60:63], v[176:179]
v_exp_f32_e64 v104, v104
v_mfma_f32_16x16x32_bf16 v[208:211], a[84:87], v[40:43], v[208:211]
v_exp_f32_e64 v105, v105
v_mfma_f32_16x16x32_bf16 v[240:243], a[84:87], v[44:47], v[240:243]
v_exp_f32_e64 v106, v106
v_mfma_f32_16x16x32_bf16 v[244:247], a[88:91], v[44:47], v[244:247]
v_exp_f32_e64 v107, v107
v_mfma_f32_16x16x32_bf16 v[212:215], a[88:91], v[40:43], v[212:215]
v_exp_f32_e64 v108, v108
v_mfma_f32_16x16x32_bf16 v[180:183], a[88:91], v[60:63], v[180:183]
v_exp_f32_e64 v109, v109
v_mfma_f32_16x16x32_bf16 v[148:151], a[88:91], v[56:59], v[148:151]
v_exp_f32_e64 v110, v110
v_mfma_f32_16x16x32_bf16 v[152:155], a[92:95], v[56:59], v[152:155]
v_exp_f32_e64 v111, v111
v_mfma_f32_16x16x32_bf16 v[184:187], a[92:95], v[60:63], v[184:187]
v_exp_f32_e64 v97, v97
v_mfma_f32_16x16x32_bf16 v[216:219], a[92:95], v[40:43], v[216:219]
v_exp_f32_e64 v98, v98
v_mfma_f32_16x16x32_bf16 v[248:251], a[92:95], v[44:47], v[248:251]
v_exp_f32_e64 v99, v99
v_mfma_f32_16x16x32_bf16 v[252:255], a[96:99], v[44:47], v[252:255]
v_exp_f32_e64 v100, v100
v_mfma_f32_16x16x32_bf16 v[220:223], a[96:99], v[40:43], v[220:223]
buffer_load_dwordx4 a[240:243], v23, s[32:35], s59 offen
v_cvt_pk_bf16_f32 v52, v104, v105
v_mfma_f32_16x16x32_bf16 v[188:191], a[96:99], v[60:63], v[188:191]
s_mov_b32 s59, 90112
v_exp_f32_e64 v101, v101
v_mfma_f32_16x16x32_bf16 v[156:159], a[96:99], v[56:59], v[156:159]
v_exp_f32_e64 v102, v102
v_mfma_f32_16x16x32_bf16 a[64:67], a[80:83], v[56:59], a[64:67]
v_cvt_pk_bf16_f32 v56, v112, v113
v_cvt_pk_bf16_f32 v57, v114, v115
v_mfma_f32_16x16x32_bf16 a[68:71], a[80:83], v[60:63], a[68:71]
v_cvt_pk_bf16_f32 v60, v120, v121
v_mfma_f32_16x16x32_bf16 a[72:75], a[80:83], v[40:43], a[72:75]
v_cvt_pk_bf16_f32 v61, v122, v123
v_cvt_pk_bf16_f32 v62, v124, v125
v_mfma_f32_16x16x32_bf16 a[76:79], a[80:83], v[44:47], a[76:79]
v_cvt_pk_bf16_f32 v63, v126, v127
v_mfma_f32_16x16x32_bf16 v[88:91], a[100:103], a[48:51], v[36:39]
v_cvt_pk_bf16_f32 v58, v116, v117
v_cvt_pk_bf16_f32 v59, v118, v119
v_mfma_f32_16x16x32_bf16 v[80:83], a[100:103], a[32:35], v[32:35]
v_exp_f32_e64 v103, v103
v_mfma_f32_16x16x32_bf16 v[72:75], a[100:103], a[16:19], v[28:31]
v_cvt_pk_bf16_f32 v53, v106, v107
v_cvt_pk_bf16_f32 v54, v108, v109
v_mfma_f32_16x16x32_bf16 v[64:67], a[100:103], a[0:3], v[24:27]
v_cvt_pk_bf16_f32 v55, v110, v111
v_mfma_f32_16x16x32_bf16 v[68:71], a[104:107], a[0:3], v[24:27]
v_cvt_pk_bf16_f32 v48, v96, v97
v_cvt_pk_bf16_f32 v49, v98, v99
v_mfma_f32_16x16x32_bf16 v[76:79], a[104:107], a[16:19], v[28:31]
v_cvt_pk_bf16_f32 v50, v100, v101
v_mfma_f32_16x16x32_bf16 v[84:87], a[104:107], a[32:35], v[32:35]
v_cvt_pk_bf16_f32 v51, v102, v103
v_mfma_f32_16x16x32_bf16 v[92:95], a[104:107], a[48:51], v[36:39]
v_mfma_f32_16x16x32_bf16 v[88:91], a[108:111], a[52:55], v[88:91]
v_mfma_f32_16x16x32_bf16 v[80:83], a[108:111], a[36:39], v[80:83]
buffer_load_dwordx4 a[244:247], v23, s[32:35], s56 offen
v_lshrrev_b32 v23, 2, v23
v_mfma_f32_16x16x32_bf16 v[72:75], a[108:111], a[20:23], v[72:75]
s_mov_b32 s56, 81920
v_mfma_f32_16x16x32_bf16 v[64:67], a[108:111], a[4:7], v[64:67]
v_mfma_f32_16x16x32_bf16 v[68:71], a[112:115], a[4:7], v[68:71]
v_mfma_f32_16x16x32_bf16 v[76:79], a[112:115], a[20:23], v[76:79]
v_mfma_f32_16x16x32_bf16 v[84:87], a[112:115], a[36:39], v[84:87]
v_mfma_f32_16x16x32_bf16 v[92:95], a[112:115], a[52:55], v[92:95]
s_waitcnt lgkmcnt(0)
v_mfma_f32_16x16x32_bf16 v[88:91], a[116:119], a[56:59], v[88:91]
s_waitcnt vmcnt(14)
s_barrier
ds_read_b64_tr_b16 a[84:85], v0 offset:0
ds_read_b64_tr_b16 a[86:87], v0 offset:2048
v_mfma_f32_16x16x32_bf16 v[80:83], a[116:119], a[40:43], v[80:83]
ds_read_b64_tr_b16 a[88:89], v1 offset:0
ds_read_b64_tr_b16 a[90:91], v1 offset:2048
v_mfma_f32_16x16x32_bf16 v[72:75], a[116:119], a[24:27], v[72:75]
ds_read_b64_tr_b16 a[92:93], v2 offset:0
ds_read_b64_tr_b16 a[94:95], v2 offset:2048
v_mfma_f32_16x16x32_bf16 v[64:67], a[116:119], a[8:11], v[64:67]
ds_read_b64_tr_b16 a[96:97], v3 offset:0
ds_read_b64_tr_b16 a[98:99], v3 offset:2048
v_mfma_f32_16x16x32_bf16 v[68:71], a[120:123], a[8:11], v[68:71]
ds_read_b64_tr_b16 a[100:101], v0 offset:4096
ds_read_b64_tr_b16 a[102:103], v0 offset:6144
v_mfma_f32_16x16x32_bf16 v[76:79], a[120:123], a[24:27], v[76:79]
ds_read_b64_tr_b16 a[104:105], v1 offset:4096
ds_read_b64_tr_b16 a[106:107], v1 offset:6144
v_mfma_f32_16x16x32_bf16 v[84:87], a[120:123], a[40:43], v[84:87]
ds_read_b64_tr_b16 a[108:109], v2 offset:4096
ds_read_b64_tr_b16 a[110:111], v2 offset:6144
v_mfma_f32_16x16x32_bf16 v[92:95], a[120:123], a[56:59], v[92:95]
ds_read_b64_tr_b16 a[112:113], v3 offset:4096
ds_read_b64_tr_b16 a[114:115], v3 offset:6144
v_mfma_f32_16x16x32_bf16 v[88:91], a[124:127], a[60:63], v[88:91]
ds_read_b128 a[116:119], v8 offset:8192
ds_read_b128 a[120:123], v8 offset:12288
v_mfma_f32_16x16x32_bf16 v[80:83], a[124:127], a[44:47], v[80:83]
v_mfma_f32_16x16x32_bf16 v[72:75], a[124:127], a[28:31], v[72:75]
s_nop 3
v_exp_f32 v88, v88
v_mfma_f32_16x16x32_bf16 v[64:67], a[124:127], a[12:15], v[64:67]
s_nop 0
v_exp_f32 v80, v80
v_mfma_f32_16x16x32_bf16 v[68:71], a[128:131], a[12:15], v[68:71]
v_exp_f32_e64 v72, v72
v_mfma_f32_16x16x32_bf16 v[76:79], a[128:131], a[28:31], v[76:79]
ds_read_b128 a[124:127], v9 offset:8192
v_mfma_f32_16x16x32_bf16 v[84:87], a[128:131], a[44:47], v[84:87]
s_nop 0
v_exp_f32_e64 v64, v64
v_mfma_f32_16x16x32_bf16 v[92:95], a[128:131], a[60:63], v[92:95]
s_waitcnt lgkmcnt(5)
ds_read_b128 a[128:131], v9 offset:12288
buffer_load_dwordx4 v18, s[16:19], s57 offen lds
v_mfma_f32_16x16x32_bf16 v[224:227], a[84:87], v[60:63], v[224:227]
s_add_u32 m0, s4, 69632
s_mov_b32 s57, 82048
v_mfma_f32_16x16x32_bf16 v[192:195], a[84:87], v[56:59], v[192:195]
v_exp_f32_e64 v65, v65
v_mfma_f32_16x16x32_bf16 v[160:163], a[84:87], v[52:55], v[160:163]
v_exp_f32_e64 v66, v66
v_mfma_f32_16x16x32_bf16 v[128:131], a[84:87], v[48:51], v[128:131]
ds_read_b128 a[84:87], v10 offset:8192
v_cvt_pk_bf16_f32 v40, v64, v65
v_mfma_f32_16x16x32_bf16 v[132:135], a[88:91], v[48:51], v[132:135]
buffer_load_dwordx4 v18, s[16:19], s58 offen lds
v_mfma_f32_16x16x32_bf16 v[164:167], a[88:91], v[52:55], v[164:167]
s_add_u32 m0, s5, 73728
s_mov_b32 s58, 98304
v_mfma_f32_16x16x32_bf16 v[196:199], a[88:91], v[56:59], v[196:199]
v_exp_f32_e64 v67, v67
v_mfma_f32_16x16x32_bf16 v[228:231], a[88:91], v[60:63], v[228:231]
ds_read_b128 a[88:91], v10 offset:12288
v_cvt_pk_bf16_f32 v41, v66, v67
v_mfma_f32_16x16x32_bf16 v[232:235], a[92:95], v[60:63], v[232:235]
v_exp_f32_e64 v68, v68
v_mfma_f32_16x16x32_bf16 v[200:203], a[92:95], v[56:59], v[200:203]
buffer_load_dwordx4 v16, s[12:15], s59 offen lds
v_mfma_f32_16x16x32_bf16 v[168:171], a[92:95], v[52:55], v[168:171]
v_exp_f32_e64 v69, v69
v_mfma_f32_16x16x32_bf16 v[136:139], a[92:95], v[48:51], v[136:139]
ds_read_b128 a[92:95], v11 offset:8192
v_cvt_pk_bf16_f32 v42, v68, v69
v_mfma_f32_16x16x32_bf16 v[140:143], a[96:99], v[48:51], v[140:143]
v_exp_f32_e64 v70, v70
v_mfma_f32_16x16x32_bf16 v[172:175], a[96:99], v[52:55], v[172:175]
v_exp_f32_e64 v71, v71
v_mfma_f32_16x16x32_bf16 v[204:207], a[96:99], v[56:59], v[204:207]
buffer_load_dwordx4 v17, s[12:15], s59 offen offset:1024 lds
v_cvt_pk_bf16_f32 v43, v70, v71
v_mfma_f32_16x16x32_bf16 v[236:239], a[96:99], v[60:63], v[236:239]
s_add_u32 m0, s4, 81920
s_mov_b32 s59, 12800
ds_read_b128 a[96:99], v11 offset:12288
v_mfma_f32_16x16x32_bf16 v[240:243], a[100:103], v[60:63], v[240:243]
v_exp_f32_e64 v73, v73
v_mfma_f32_16x16x32_bf16 v[208:211], a[100:103], v[56:59], v[208:211]
v_exp_f32_e64 v74, v74
v_mfma_f32_16x16x32_bf16 v[176:179], a[100:103], v[52:55], v[176:179]
v_exp_f32_e64 v75, v75
v_mfma_f32_16x16x32_bf16 v[144:147], a[100:103], v[48:51], v[144:147]
ds_read_b64_tr_b16 a[100:101], v0 offset:16384
buffer_load_dwordx4 v18, s[16:19], s56 offen lds
v_mfma_f32_16x16x32_bf16 v[148:151], a[104:107], v[48:51], v[148:151]
s_add_u32 m0, s4, 86016
s_mov_b32 s56, 26624
ds_read_b64_tr_b16 a[102:103], v0 offset:18432
v_mfma_f32_16x16x32_bf16 v[180:183], a[104:107], v[52:55], v[180:183]
v_exp_f32_e64 v76, v76
v_mfma_f32_16x16x32_bf16 v[212:215], a[104:107], v[56:59], v[212:215]
v_exp_f32_e64 v77, v77
v_mfma_f32_16x16x32_bf16 v[244:247], a[104:107], v[60:63], v[244:247]
ds_read_b64_tr_b16 a[104:105], v1 offset:16384
v_cvt_pk_bf16_f32 v44, v72, v73
v_mfma_f32_16x16x32_bf16 v[248:251], a[108:111], v[60:63], v[248:251]
ds_read_b64_tr_b16 a[106:107], v1 offset:18432
buffer_load_dwordx4 v18, s[16:19], s57 offen lds
v_mfma_f32_16x16x32_bf16 v[216:219], a[108:111], v[56:59], v[216:219]
s_add_u32 m0, s5, 90112
s_add_u32 s57, s55, 0
v_cvt_pk_bf16_f32 v45, v74, v75
v_mfma_f32_16x16x32_bf16 v[184:187], a[108:111], v[52:55], v[184:187]
v_exp_f32 v78, v78
v_mfma_f32_16x16x32_bf16 v[152:155], a[108:111], v[48:51], v[152:155]
s_waitcnt lgkmcnt(4)
v_exp_f32 v79, v79
v_mfma_f32_16x16x32_bf16 v[156:159], a[112:115], v[48:51], v[156:159]
v_cvt_pk_bf16_f32 v46, v76, v77
v_cvt_pk_bf16_f32 v47, v78, v79
v_mfma_f32_16x16x32_bf16 v[188:191], a[112:115], v[52:55], v[188:191]
ds_read_b64_tr_b16 a[108:109], v2 offset:16384
buffer_load_dwordx4 v16, s[12:15], s58 offen lds
v_mfma_f32_16x16x32_bf16 v[220:223], a[112:115], v[56:59], v[220:223]
v_exp_f32_e64 v81, v81
v_mfma_f32_16x16x32_bf16 v[252:255], a[112:115], v[60:63], v[252:255]
v_exp_f32_e64 v82, v82
v_mfma_f32_16x16x32_bf16 a[76:79], a[80:83], v[60:63], a[76:79]
v_exp_f32_e64 v83, v83
v_mfma_f32_16x16x32_bf16 a[72:75], a[80:83], v[56:59], a[72:75]
v_exp_f32_e64 v84, v84
v_mfma_f32_16x16x32_bf16 a[68:71], a[80:83], v[52:55], a[68:71]
ds_read_b64_tr_b16 a[110:111], v2 offset:18432
buffer_load_dwordx4 v17, s[12:15], s58 offen offset:1024 lds
v_mfma_f32_16x16x32_bf16 a[64:67], a[80:83], v[48:51], a[64:67]
s_mov_b32 m0, 155968
s_mov_b32 s58, 90112
v_cvt_pk_bf16_f32 v48, v80, v81
v_mfma_f32_16x16x32_bf16 v[96:99], a[116:119], a[0:3], v[24:27]
v_exp_f32_e64 v85, v85
v_mfma_f32_16x16x32_bf16 v[104:107], a[116:119], a[16:19], v[28:31]
v_exp_f32_e64 v86, v86
v_mfma_f32_16x16x32_bf16 v[112:115], a[116:119], a[32:35], v[32:35]
v_exp_f32_e64 v87, v87
v_mfma_f32_16x16x32_bf16 v[120:123], a[116:119], a[48:51], v[36:39]
s_bfm_b64 exec, 16, 0
buffer_load_dword v21, s[24:27], s73 offen  lds
s_mov_b64 exec, -1
v_cvt_pk_bf16_f32 v49, v82, v83
v_mfma_f32_16x16x32_bf16 v[124:127], a[120:123], a[48:51], v[36:39]
s_add_u32 m0, s4, 98304
v_cvt_pk_bf16_f32 v50, v84, v85
v_cvt_pk_bf16_f32 v51, v86, v87
v_mfma_f32_16x16x32_bf16 v[116:119], a[120:123], a[32:35], v[32:35]
v_exp_f32_e64 v89, v89
v_mfma_f32_16x16x32_bf16 v[108:111], a[120:123], a[16:19], v[28:31]
v_exp_f32_e64 v90, v90
v_mfma_f32_16x16x32_bf16 v[100:103], a[120:123], a[0:3], v[24:27]
v_exp_f32_e64 v91, v91
v_mfma_f32_16x16x32_bf16 v[96:99], a[124:127], a[4:7], v[96:99]
buffer_load_dword a248, v23, s[32:35], s59 offen
v_cvt_pk_bf16_f32 v52, v88, v89
v_mfma_f32_16x16x32_bf16 v[104:107], a[124:127], a[20:23], v[104:107]
s_mov_b32 s59, 90240
v_exp_f32_e64 v92, v92
v_mfma_f32_16x16x32_bf16 v[112:115], a[124:127], a[36:39], v[112:115]
v_exp_f32_e64 v93, v93
v_mfma_f32_16x16x32_bf16 v[120:123], a[124:127], a[52:55], v[120:123]
v_exp_f32_e64 v94, v94
v_mfma_f32_16x16x32_bf16 v[124:127], a[128:131], a[52:55], v[124:127]
v_exp_f32_e64 v95, v95
v_mfma_f32_16x16x32_bf16 v[116:119], a[128:131], a[36:39], v[116:119]
buffer_load_dword a249, v23, s[32:35], s56 offen
v_cvt_pk_bf16_f32 v53, v90, v91
v_mfma_f32_16x16x32_bf16 v[108:111], a[128:131], a[20:23], v[108:111]
s_mov_b32 s56, 106496
v_cvt_pk_bf16_f32 v54, v92, v93
v_cvt_pk_bf16_f32 v55, v94, v95
v_mfma_f32_16x16x32_bf16 v[100:103], a[128:131], a[4:7], v[100:103]
ds_read_b64_tr_b16 a[112:113], v3 offset:16384
ds_read_b64_tr_b16 a[114:115], v3 offset:18432
v_mfma_f32_16x16x32_bf16 v[96:99], a[84:87], a[8:11], v[96:99]
ds_read_b64_tr_b16 a[116:117], v0 offset:20480
ds_read_b64_tr_b16 a[118:119], v0 offset:22528
v_mfma_f32_16x16x32_bf16 v[104:107], a[84:87], a[24:27], v[104:107]
ds_read_b64_tr_b16 a[120:121], v1 offset:20480
ds_read_b64_tr_b16 a[122:123], v1 offset:22528
v_mfma_f32_16x16x32_bf16 v[112:115], a[84:87], a[40:43], v[112:115]
ds_read_b64_tr_b16 a[124:125], v2 offset:20480
buffer_store_dwordx4 a[132:135], v20, s[28:31], s57 offen offset:512 sc1
v_mfma_f32_16x16x32_bf16 v[120:123], a[84:87], a[56:59], v[120:123]
s_mov_b32 s57, 40448
ds_read_b64_tr_b16 a[126:127], v2 offset:22528
ds_read_b64_tr_b16 a[128:129], v3 offset:20480
v_mfma_f32_16x16x32_bf16 v[124:127], a[88:91], a[56:59], v[124:127]
ds_read_b64_tr_b16 a[130:131], v3 offset:22528
ds_read_b128 a[84:87], v8 offset:24576
v_mfma_f32_16x16x32_bf16 v[116:119], a[88:91], a[40:43], v[116:119]
v_mfma_f32_16x16x32_bf16 v[108:111], a[88:91], a[24:27], v[108:111]
v_mfma_f32_16x16x32_bf16 v[100:103], a[88:91], a[8:11], v[100:103]
ds_read_b128 a[88:91], v8 offset:28672
v_mfma_f32_16x16x32_bf16 v[96:99], a[92:95], a[12:15], v[96:99]
v_mfma_f32_16x16x32_bf16 v[104:107], a[92:95], a[28:31], v[104:107]
v_mfma_f32_16x16x32_bf16 v[112:115], a[92:95], a[44:47], v[112:115]
s_nop 5
v_exp_f32 v96, v96
v_mfma_f32_16x16x32_bf16 v[120:123], a[92:95], a[60:63], v[120:123]
ds_read_b128 a[92:95], v9 offset:24576
v_mfma_f32_16x16x32_bf16 v[124:127], a[96:99], a[60:63], v[124:127]
v_exp_f32_e64 v112, v112
v_mfma_f32_16x16x32_bf16 v[116:119], a[96:99], a[44:47], v[116:119]
s_nop 3
v_exp_f32 v120, v120
v_mfma_f32_16x16x32_bf16 v[108:111], a[96:99], a[28:31], v[108:111]
v_exp_f32 v121, v121
v_mfma_f32_16x16x32_bf16 v[100:103], a[96:99], a[12:15], v[100:103]
s_waitcnt lgkmcnt(2)
ds_read_b128 a[96:99], v9 offset:28672
buffer_load_dwordx4 v18, s[16:19], s58 offen lds
v_mfma_f32_16x16x32_bf16 v[128:131], a[100:103], v[40:43], v[128:131]
s_add_u32 m0, s4, 102400
s_mov_b32 s58, 54272
v_mfma_f32_16x16x32_bf16 v[160:163], a[100:103], v[44:47], v[160:163]
v_exp_f32_e64 v122, v122
v_mfma_f32_16x16x32_bf16 v[192:195], a[100:103], v[48:51], v[192:195]
v_exp_f32_e64 v123, v123
v_mfma_f32_16x16x32_bf16 v[224:227], a[100:103], v[52:55], v[224:227]
ds_read_b128 a[100:103], v10 offset:24576
v_mfma_f32_16x16x32_bf16 v[228:231], a[104:107], v[52:55], v[228:231]
buffer_load_dwordx4 v18, s[16:19], s59 offen lds
v_mfma_f32_16x16x32_bf16 v[196:199], a[104:107], v[48:51], v[196:199]
s_add_u32 m0, s5, 106496
s_add_u32 s59, s52, 37748736
v_mfma_f32_16x16x32_bf16 v[164:167], a[104:107], v[44:47], v[164:167]
v_exp_f32_e64 v124, v124
v_mfma_f32_16x16x32_bf16 v[132:135], a[104:107], v[40:43], v[132:135]
ds_read_b128 a[104:107], v10 offset:28672
v_mfma_f32_16x16x32_bf16 v[136:139], a[108:111], v[40:43], v[136:139]
v_exp_f32_e64 v125, v125
v_mfma_f32_16x16x32_bf16 v[168:171], a[108:111], v[44:47], v[168:171]
buffer_load_dwordx4 v16, s[12:15], s56 offen lds
v_mfma_f32_16x16x32_bf16 v[200:203], a[108:111], v[48:51], v[200:203]
v_exp_f32_e64 v126, v126
v_mfma_f32_16x16x32_bf16 v[232:235], a[108:111], v[52:55], v[232:235]
ds_read_b128 a[108:111], v11 offset:24576
v_mfma_f32_16x16x32_bf16 v[236:239], a[112:115], v[52:55], v[236:239]
v_exp_f32_e64 v127, v127
v_mfma_f32_16x16x32_bf16 v[204:207], a[112:115], v[48:51], v[204:207]
v_exp_f32_e64 v113, v113
v_mfma_f32_16x16x32_bf16 v[172:175], a[112:115], v[44:47], v[172:175]
buffer_load_dwordx4 v17, s[12:15], s56 offen offset:1024 lds
v_mfma_f32_16x16x32_bf16 v[140:143], a[112:115], v[40:43], v[140:143]
s_mov_b32 m0, 155968
s_mov_b32 s56, 98304
ds_read_b128 a[112:115], v11 offset:28672
v_mfma_f32_16x16x32_bf16 v[144:147], a[116:119], v[40:43], v[144:147]
v_exp_f32_e64 v114, v114
v_mfma_f32_16x16x32_bf16 v[176:179], a[116:119], v[44:47], v[176:179]
v_exp_f32_e64 v115, v115
v_mfma_f32_16x16x32_bf16 v[208:211], a[116:119], v[48:51], v[208:211]
v_exp_f32_e64 v116, v116
v_mfma_f32_16x16x32_bf16 v[240:243], a[116:119], v[52:55], v[240:243]
ds_read_b64_tr_b16 a[116:117], v0 offset:32768
s_bfm_b64 exec, 16, 16
buffer_load_dword v21, s[24:27], s73 offen  lds
s_mov_b64 exec, -1
v_mfma_f32_16x16x32_bf16 v[244:247], a[120:123], v[52:55], v[244:247]
s_mov_b32 m0, 155968
ds_read_b64_tr_b16 a[118:119], v0 offset:34816
v_mfma_f32_16x16x32_bf16 v[212:215], a[120:123], v[48:51], v[212:215]
v_exp_f32_e64 v117, v117
v_mfma_f32_16x16x32_bf16 v[180:183], a[120:123], v[44:47], v[180:183]
v_exp_f32_e64 v118, v118
v_mfma_f32_16x16x32_bf16 v[148:151], a[120:123], v[40:43], v[148:151]
ds_read_b64_tr_b16 a[120:121], v1 offset:32768
ds_read_b64_tr_b16 a[122:123], v1 offset:34816
v_mfma_f32_16x16x32_bf16 v[152:155], a[124:127], v[40:43], v[152:155]
s_bfm_b64 exec, 16, 32
buffer_load_dword v21, s[24:27], s73 offen  lds
s_mov_b64 exec, -1
v_mfma_f32_16x16x32_bf16 v[184:187], a[124:127], v[44:47], v[184:187]
s_add_u32 m0, s4, 114688
v_exp_f32_e64 v119, v119
v_mfma_f32_16x16x32_bf16 v[216:219], a[124:127], v[48:51], v[216:219]
v_exp_f32_e64 v104, v104
v_mfma_f32_16x16x32_bf16 v[248:251], a[124:127], v[52:55], v[248:251]
v_exp_f32_e64 v105, v105
v_mfma_f32_16x16x32_bf16 v[252:255], a[128:131], v[52:55], v[252:255]
v_exp_f32_e64 v106, v106
v_mfma_f32_16x16x32_bf16 v[220:223], a[128:131], v[48:51], v[220:223]
buffer_load_dword a250, v23, s[32:35], s57 offen
v_cvt_pk_bf16_f32 v60, v104, v105
v_mfma_f32_16x16x32_bf16 v[188:191], a[128:131], v[44:47], v[188:191]
s_mov_b32 s57, 98432
v_exp_f32_e64 v107, v107
v_mfma_f32_16x16x32_bf16 v[156:159], a[128:131], v[40:43], v[156:159]
v_exp_f32_e64 v108, v108
v_mfma_f32_16x16x32_bf16 a[64:67], a[80:83], v[40:43], a[64:67]
v_exp_f32_e64 v109, v109
v_mfma_f32_16x16x32_bf16 a[68:71], a[80:83], v[44:47], a[68:71]
v_cvt_pk_bf16_f32 v44, v120, v121
v_cvt_pk_bf16_f32 v45, v122, v123
v_mfma_f32_16x16x32_bf16 a[72:75], a[80:83], v[48:51], a[72:75]
ds_read_b64_tr_b16 a[124:125], v2 offset:32768
v_cvt_pk_bf16_f32 v46, v124, v125
v_mfma_f32_16x16x32_bf16 a[76:79], a[80:83], v[52:55], a[76:79]
v_cvt_pk_bf16_f32 v40, v112, v113
v_cvt_pk_bf16_f32 v47, v126, v127
v_mfma_f32_16x16x32_bf16 v[88:91], a[84:87], a[48:51], v[36:39]
v_exp_f32_e64 v110, v110
v_mfma_f32_16x16x32_bf16 v[80:83], a[84:87], a[32:35], v[32:35]
v_exp_f32_e64 v111, v111
v_mfma_f32_16x16x32_bf16 v[72:75], a[84:87], a[16:19], v[28:31]
v_cvt_pk_bf16_f32 v41, v114, v115
v_cvt_pk_bf16_f32 v42, v116, v117
v_mfma_f32_16x16x32_bf16 v[64:67], a[84:87], a[0:3], v[24:27]
s_waitcnt lgkmcnt(1)
ds_read_b64_tr_b16 a[126:127], v2 offset:34816
v_cvt_pk_bf16_f32 v43, v118, v119
v_mfma_f32_16x16x32_bf16 v[68:71], a[88:91], a[0:3], v[24:27]
v_exp_f32 v97, v97
v_mfma_f32_16x16x32_bf16 v[76:79], a[88:91], a[16:19], v[28:31]
v_exp_f32_e64 v98, v98
v_mfma_f32_16x16x32_bf16 v[84:87], a[88:91], a[32:35], v[32:35]
v_exp_f32_e64 v99, v99
v_mfma_f32_16x16x32_bf16 v[92:95], a[88:91], a[48:51], v[36:39]
v_exp_f32_e64 v100, v100
v_mfma_f32_16x16x32_bf16 v[88:91], a[92:95], a[52:55], v[88:91]
v_exp_f32_e64 v101, v101
v_mfma_f32_16x16x32_bf16 v[80:83], a[92:95], a[36:39], v[80:83]
buffer_load_dword a251, v23, s[32:35], s58 offen
v_cvt_pk_bf16_f32 v61, v106, v107
v_mfma_f32_16x16x32_bf16 v[72:75], a[92:95], a[20:23], v[72:75]
s_mov_b32 s58, 114688
v_exp_f32_e64 v102, v102
v_mfma_f32_16x16x32_bf16 v[64:67], a[92:95], a[4:7], v[64:67]
s_mov_b64 s[32:33], s[90:91]
v_exp_f32 v103, v103
v_mfma_f32_16x16x32_bf16 v[68:71], a[96:99], a[4:7], v[68:71]
s_mov_b32 s34, 5308416
v_cvt_pk_bf16_f32 v62, v108, v109
v_cvt_pk_bf16_f32 v63, v110, v111
v_mfma_f32_16x16x32_bf16 v[76:79], a[96:99], a[20:23], v[76:79]
ds_read_b64_tr_b16 a[128:129], v3 offset:32768
v_cvt_pk_bf16_f32 v56, v96, v97
v_mfma_f32_16x16x32_bf16 v[84:87], a[96:99], a[36:39], v[84:87]
v_cvt_pk_bf16_f32 v57, v98, v99
v_cvt_pk_bf16_f32 v58, v100, v101
v_mfma_f32_16x16x32_bf16 v[92:95], a[96:99], a[52:55], v[92:95]
ds_read_b64_tr_b16 a[130:131], v3 offset:34816
v_cvt_pk_bf16_f32 v59, v102, v103
v_mfma_f32_16x16x32_bf16 v[88:91], a[100:103], a[56:59], v[88:91]
ds_read_b64_tr_b16 a[84:85], v0 offset:36864
ds_read_b64_tr_b16 a[86:87], v0 offset:38912
v_mfma_f32_16x16x32_bf16 v[80:83], a[100:103], a[40:43], v[80:83]
ds_read_b64_tr_b16 a[88:89], v1 offset:36864
ds_read_b64_tr_b16 a[90:91], v1 offset:38912
v_mfma_f32_16x16x32_bf16 v[72:75], a[100:103], a[24:27], v[72:75]
ds_read_b64_tr_b16 a[92:93], v2 offset:36864
ds_read_b64_tr_b16 a[94:95], v2 offset:38912
v_mfma_f32_16x16x32_bf16 v[64:67], a[100:103], a[8:11], v[64:67]
ds_read_b64_tr_b16 a[96:97], v3 offset:36864
ds_read_b64_tr_b16 a[98:99], v3 offset:38912
v_mfma_f32_16x16x32_bf16 v[68:71], a[104:107], a[8:11], v[68:71]
ds_read_b128 a[100:103], v8 offset:40960
v_mfma_f32_16x16x32_bf16 v[76:79], a[104:107], a[24:27], v[76:79]
v_mfma_f32_16x16x32_bf16 v[84:87], a[104:107], a[40:43], v[84:87]
v_mfma_f32_16x16x32_bf16 v[92:95], a[104:107], a[56:59], v[92:95]
ds_read_b128 a[104:107], v8 offset:45056
v_mfma_f32_16x16x32_bf16 v[88:91], a[108:111], a[60:63], v[88:91]
v_mfma_f32_16x16x32_bf16 v[80:83], a[108:111], a[44:47], v[80:83]
v_mfma_f32_16x16x32_bf16 v[72:75], a[108:111], a[28:31], v[72:75]
s_nop 5
v_exp_f32 v88, v88
v_mfma_f32_16x16x32_bf16 v[64:67], a[108:111], a[12:15], v[64:67]
ds_read_b128 a[108:111], v9 offset:40960
v_mfma_f32_16x16x32_bf16 v[68:71], a[112:115], a[12:15], v[68:71]
v_exp_f32_e64 v72, v72
v_mfma_f32_16x16x32_bf16 v[76:79], a[112:115], a[28:31], v[76:79]
s_nop 3
v_exp_f32 v64, v64
v_mfma_f32_16x16x32_bf16 v[84:87], a[112:115], a[44:47], v[84:87]
v_exp_f32_e64 v65, v65
v_mfma_f32_16x16x32_bf16 v[92:95], a[112:115], a[60:63], v[92:95]
ds_read_b128 a[112:115], v9 offset:45056
v_cvt_pk_bf16_f32 v48, v64, v65
v_mfma_f32_16x16x32_bf16 v[224:227], a[116:119], v[44:47], v[224:227]
v_exp_f32_e64 v66, v66
v_mfma_f32_16x16x32_bf16 v[192:195], a[116:119], v[40:43], v[192:195]
v_exp_f32_e64 v67, v67
v_mfma_f32_16x16x32_bf16 v[160:163], a[116:119], v[60:63], v[160:163]
v_exp_f32_e64 v68, v68
v_mfma_f32_16x16x32_bf16 v[128:131], a[116:119], v[56:59], v[128:131]
ds_read_b128 a[116:119], v10 offset:40960
v_cvt_pk_bf16_f32 v49, v66, v67
v_mfma_f32_16x16x32_bf16 v[132:135], a[120:123], v[56:59], v[132:135]
v_exp_f32_e64 v69, v69
v_mfma_f32_16x16x32_bf16 v[164:167], a[120:123], v[60:63], v[164:167]
v_exp_f32_e64 v70, v70
v_mfma_f32_16x16x32_bf16 v[196:199], a[120:123], v[40:43], v[196:199]
v_exp_f32 v71, v71
v_mfma_f32_16x16x32_bf16 v[228:231], a[120:123], v[44:47], v[228:231]
s_waitcnt lgkmcnt(2)
ds_read_b128 a[120:123], v10 offset:45056
v_cvt_pk_bf16_f32 v50, v68, v69
v_mfma_f32_16x16x32_bf16 v[232:235], a[124:127], v[44:47], v[232:235]
v_cvt_pk_bf16_f32 v51, v70, v71
v_mfma_f32_16x16x32_bf16 v[200:203], a[124:127], v[40:43], v[200:203]
v_exp_f32_e64 v73, v73
v_mfma_f32_16x16x32_bf16 v[168:171], a[124:127], v[60:63], v[168:171]
v_exp_f32_e64 v74, v74
v_mfma_f32_16x16x32_bf16 v[136:139], a[124:127], v[56:59], v[136:139]
ds_read_b128 a[124:127], v11 offset:40960
v_cvt_pk_bf16_f32 v52, v72, v73
v_mfma_f32_16x16x32_bf16 v[140:143], a[128:131], v[56:59], v[140:143]
v_exp_f32_e64 v75, v75
v_mfma_f32_16x16x32_bf16 v[172:175], a[128:131], v[60:63], v[172:175]
v_exp_f32_e64 v76, v76
v_mfma_f32_16x16x32_bf16 v[204:207], a[128:131], v[40:43], v[204:207]
v_exp_f32_e64 v77, v77
v_mfma_f32_16x16x32_bf16 v[236:239], a[128:131], v[44:47], v[236:239]
ds_read_b128 a[128:131], v11 offset:45056
v_cvt_pk_bf16_f32 v53, v74, v75
v_mfma_f32_16x16x32_bf16 v[240:243], a[84:87], v[44:47], v[240:243]
v_exp_f32_e64 v78, v78
v_mfma_f32_16x16x32_bf16 v[208:211], a[84:87], v[40:43], v[208:211]
v_exp_f32_e64 v79, v79
v_mfma_f32_16x16x32_bf16 v[176:179], a[84:87], v[60:63], v[176:179]
v_cvt_pk_bf16_f32 v54, v76, v77
v_cvt_pk_bf16_f32 v55, v78, v79
v_mfma_f32_16x16x32_bf16 v[144:147], a[84:87], v[56:59], v[144:147]
v_exp_f32_e64 v80, v80
v_mfma_f32_16x16x32_bf16 v[148:151], a[88:91], v[56:59], v[148:151]
v_exp_f32_e64 v81, v81
v_mfma_f32_16x16x32_bf16 v[180:183], a[88:91], v[60:63], v[180:183]
v_exp_f32_e64 v82, v82
v_mfma_f32_16x16x32_bf16 v[212:215], a[88:91], v[40:43], v[212:215]
v_exp_f32_e64 v83, v83
v_mfma_f32_16x16x32_bf16 v[244:247], a[88:91], v[44:47], v[244:247]
buffer_store_dwordx4 a[132:135], v20, s[28:31], s59 offen offset:0 sc1
v_mfma_f32_16x16x32_bf16 v[248:251], a[92:95], v[44:47], v[248:251]
s_mov_b32 s59, 106496
v_exp_f32_e64 v84, v84
v_mfma_f32_16x16x32_bf16 v[216:219], a[92:95], v[40:43], v[216:219]
v_exp_f32_e64 v85, v85
v_mfma_f32_16x16x32_bf16 v[184:187], a[92:95], v[60:63], v[184:187]
v_exp_f32_e64 v86, v86
v_mfma_f32_16x16x32_bf16 v[152:155], a[92:95], v[56:59], v[152:155]
v_exp_f32_e64 v87, v87
v_mfma_f32_16x16x32_bf16 v[156:159], a[96:99], v[56:59], v[156:159]
v_exp_f32_e64 v89, v89
v_mfma_f32_16x16x32_bf16 v[188:191], a[96:99], v[60:63], v[188:191]
v_exp_f32_e64 v90, v90
v_mfma_f32_16x16x32_bf16 v[220:223], a[96:99], v[40:43], v[220:223]
v_exp_f32_e64 v91, v91
v_mfma_f32_16x16x32_bf16 v[252:255], a[96:99], v[44:47], v[252:255]
v_exp_f32_e64 v92, v92
v_mfma_f32_16x16x32_bf16 a[76:79], a[80:83], v[44:47], a[76:79]
v_exp_f32_e64 v93, v93
v_mfma_f32_16x16x32_bf16 a[72:75], a[80:83], v[40:43], a[72:75]
v_exp_f32_e64 v94, v94
v_mfma_f32_16x16x32_bf16 a[68:71], a[80:83], v[60:63], a[68:71]
v_exp_f32 v95, v95
v_mfma_f32_16x16x32_bf16 a[64:67], a[80:83], v[56:59], a[64:67]
v_cvt_pk_bf16_f32 v56, v80, v81
v_cvt_pk_bf16_f32 v57, v82, v83
v_mfma_f32_16x16x32_bf16 v[96:99], a[100:103], a[0:3], v[24:27]
v_cvt_pk_bf16_f32 v58, v84, v85
v_mfma_f32_16x16x32_bf16 v[104:107], a[100:103], a[16:19], v[28:31]
v_cvt_pk_bf16_f32 v59, v86, v87
v_cvt_pk_bf16_f32 v60, v88, v89
v_mfma_f32_16x16x32_bf16 v[112:115], a[100:103], a[32:35], v[32:35]
v_cvt_pk_bf16_f32 v61, v90, v91
v_mfma_f32_16x16x32_bf16 v[120:123], a[100:103], a[48:51], v[36:39]
v_cvt_pk_bf16_f32 v62, v92, v93
v_cvt_pk_bf16_f32 v63, v94, v95
v_mfma_f32_16x16x32_bf16 v[124:127], a[104:107], a[48:51], v[36:39]
v_mfma_f32_16x16x32_bf16 v[116:119], a[104:107], a[32:35], v[32:35]
v_mfma_f32_16x16x32_bf16 v[108:111], a[104:107], a[16:19], v[28:31]
v_mfma_f32_16x16x32_bf16 v[100:103], a[104:107], a[0:3], v[24:27]
v_mfma_f32_16x16x32_bf16 v[96:99], a[108:111], a[4:7], v[96:99]
v_mfma_f32_16x16x32_bf16 v[104:107], a[108:111], a[20:23], v[104:107]
v_mfma_f32_16x16x32_bf16 v[112:115], a[108:111], a[36:39], v[112:115]
v_mfma_f32_16x16x32_bf16 v[120:123], a[108:111], a[52:55], v[120:123]
s_waitcnt lgkmcnt(0)
v_mfma_f32_16x16x32_bf16 v[124:127], a[112:115], a[52:55], v[124:127]
v_mfma_f32_16x16x32_bf16 v[116:119], a[112:115], a[36:39], v[116:119]
v_mfma_f32_16x16x32_bf16 v[108:111], a[112:115], a[20:23], v[108:111]
v_mfma_f32_16x16x32_bf16 v[100:103], a[112:115], a[4:7], v[100:103]
v_mfma_f32_16x16x32_bf16 v[96:99], a[116:119], a[8:11], v[96:99]
s_waitcnt vmcnt(13)
s_barrier
ds_read_b64_tr_b16 a[84:85], v0 offset:49152
ds_read_b64_tr_b16 a[86:87], v0 offset:51200
v_mfma_f32_16x16x32_bf16 v[104:107], a[116:119], a[24:27], v[104:107]
ds_read_b64_tr_b16 a[88:89], v1 offset:49152
ds_read_b64_tr_b16 a[90:91], v1 offset:51200
v_mfma_f32_16x16x32_bf16 v[112:115], a[116:119], a[40:43], v[112:115]
ds_read_b64_tr_b16 a[92:93], v2 offset:49152
ds_read_b64_tr_b16 a[94:95], v2 offset:51200
v_mfma_f32_16x16x32_bf16 v[120:123], a[116:119], a[56:59], v[120:123]
ds_read_b64_tr_b16 a[96:97], v3 offset:49152
ds_read_b64_tr_b16 a[98:99], v3 offset:51200
v_mfma_f32_16x16x32_bf16 v[124:127], a[120:123], a[56:59], v[124:127]
ds_read_b64_tr_b16 a[100:101], v0 offset:53248
ds_read_b64_tr_b16 a[102:103], v0 offset:55296
v_mfma_f32_16x16x32_bf16 v[116:119], a[120:123], a[40:43], v[116:119]
ds_read_b64_tr_b16 a[104:105], v1 offset:53248
ds_read_b64_tr_b16 a[106:107], v1 offset:55296
v_mfma_f32_16x16x32_bf16 v[108:111], a[120:123], a[24:27], v[108:111]
ds_read_b64_tr_b16 a[108:109], v2 offset:53248
ds_read_b64_tr_b16 a[110:111], v2 offset:55296
v_mfma_f32_16x16x32_bf16 v[100:103], a[120:123], a[8:11], v[100:103]
ds_read_b64_tr_b16 a[112:113], v3 offset:53248
ds_read_b64_tr_b16 a[114:115], v3 offset:55296
v_mfma_f32_16x16x32_bf16 v[96:99], a[124:127], a[12:15], v[96:99]
ds_read_b128 a[116:119], v8 offset:57344
ds_read_b128 a[120:123], v8 offset:61440
v_mfma_f32_16x16x32_bf16 v[104:107], a[124:127], a[28:31], v[104:107]
v_mfma_f32_16x16x32_bf16 v[112:115], a[124:127], a[44:47], v[112:115]
s_nop 3
v_exp_f32 v96, v96
v_mfma_f32_16x16x32_bf16 v[120:123], a[124:127], a[60:63], v[120:123]
s_nop 0
v_exp_f32 v104, v104
v_mfma_f32_16x16x32_bf16 v[124:127], a[128:131], a[60:63], v[124:127]
v_exp_f32_e64 v112, v112
v_mfma_f32_16x16x32_bf16 v[116:119], a[128:131], a[44:47], v[116:119]
ds_read_b128 a[124:127], v9 offset:57344
v_mfma_f32_16x16x32_bf16 v[108:111], a[128:131], a[28:31], v[108:111]
s_nop 0
v_exp_f32_e64 v120, v120
v_mfma_f32_16x16x32_bf16 v[100:103], a[128:131], a[12:15], v[100:103]
s_waitcnt lgkmcnt(5)
ds_read_b128 a[128:131], v9 offset:61440
buffer_load_dwordx4 v18, s[16:19], s56 offen lds
v_mfma_f32_16x16x32_bf16 v[128:131], a[84:87], v[48:51], v[128:131]
s_add_u32 m0, s4, 118784
s_mov_b32 s56, 106624
v_mfma_f32_16x16x32_bf16 v[160:163], a[84:87], v[52:55], v[160:163]
v_exp_f32_e64 v121, v121
v_mfma_f32_16x16x32_bf16 v[192:195], a[84:87], v[56:59], v[192:195]
v_exp_f32_e64 v122, v122
v_mfma_f32_16x16x32_bf16 v[224:227], a[84:87], v[60:63], v[224:227]
ds_read_b128 a[84:87], v10 offset:57344
v_mfma_f32_16x16x32_bf16 v[228:231], a[88:91], v[60:63], v[228:231]
buffer_load_dwordx4 v18, s[16:19], s57 offen lds
v_mfma_f32_16x16x32_bf16 v[196:199], a[88:91], v[56:59], v[196:199]
s_add_u32 m0, s5, 122880
s_mov_b32 s57, 122880
v_mfma_f32_16x16x32_bf16 v[164:167], a[88:91], v[52:55], v[164:167]
v_exp_f32_e64 v123, v123
v_mfma_f32_16x16x32_bf16 v[132:135], a[88:91], v[48:51], v[132:135]
ds_read_b128 a[88:91], v10 offset:61440
v_mfma_f32_16x16x32_bf16 v[136:139], a[92:95], v[48:51], v[136:139]
v_exp_f32_e64 v124, v124
v_mfma_f32_16x16x32_bf16 v[168:171], a[92:95], v[52:55], v[168:171]
buffer_load_dwordx4 v16, s[12:15], s58 offen lds
v_mfma_f32_16x16x32_bf16 v[200:203], a[92:95], v[56:59], v[200:203]
v_exp_f32_e64 v125, v125
v_mfma_f32_16x16x32_bf16 v[232:235], a[92:95], v[60:63], v[232:235]
ds_read_b128 a[92:95], v11 offset:57344
v_mfma_f32_16x16x32_bf16 v[236:239], a[96:99], v[60:63], v[236:239]
v_exp_f32_e64 v126, v126
v_mfma_f32_16x16x32_bf16 v[204:207], a[96:99], v[56:59], v[204:207]
v_exp_f32 v127, v127
v_mfma_f32_16x16x32_bf16 v[172:175], a[96:99], v[52:55], v[172:175]
buffer_load_dwordx4 v17, s[12:15], s58 offen offset:1024 lds
v_mfma_f32_16x16x32_bf16 v[140:143], a[96:99], v[48:51], v[140:143]
s_add_u32 m0, s4, 0
s_add_u32 s58, s55, 37748736
ds_read_b128 a[96:99], v11 offset:61440
v_mfma_f32_16x16x32_bf16 v[144:147], a[100:103], v[48:51], v[144:147]
v_exp_f32_e64 v113, v113
v_mfma_f32_16x16x32_bf16 v[176:179], a[100:103], v[52:55], v[176:179]
v_exp_f32_e64 v114, v114
v_mfma_f32_16x16x32_bf16 v[208:211], a[100:103], v[56:59], v[208:211]
v_exp_f32_e64 v115, v115
v_mfma_f32_16x16x32_bf16 v[240:243], a[100:103], v[60:63], v[240:243]
ds_read_b64_tr_b16 a[100:101], v4 offset:0
buffer_load_dwordx4 v18, s[16:19], s59 offen lds
v_mfma_f32_16x16x32_bf16 v[244:247], a[104:107], v[60:63], v[244:247]
s_add_u32 m0, s4, 4096
s_mov_b32 s59, 114688
ds_read_b64_tr_b16 a[102:103], v4 offset:2048
v_mfma_f32_16x16x32_bf16 v[212:215], a[104:107], v[56:59], v[212:215]
v_exp_f32_e64 v116, v116
v_mfma_f32_16x16x32_bf16 v[180:183], a[104:107], v[52:55], v[180:183]
v_exp_f32_e64 v117, v117
v_mfma_f32_16x16x32_bf16 v[148:151], a[104:107], v[48:51], v[148:151]
ds_read_b64_tr_b16 a[104:105], v5 offset:0
ds_read_b64_tr_b16 a[106:107], v5 offset:2048
v_mfma_f32_16x16x32_bf16 v[152:155], a[108:111], v[48:51], v[152:155]
buffer_load_dwordx4 v18, s[16:19], s56 offen lds
v_mfma_f32_16x16x32_bf16 v[184:187], a[108:111], v[52:55], v[184:187]
s_add_u32 m0, s5, 8192
s_mov_b32 s56, 114816
v_mfma_f32_16x16x32_bf16 v[216:219], a[108:111], v[56:59], v[216:219]
v_exp_f32_e64 v118, v118
v_mfma_f32_16x16x32_bf16 v[248:251], a[108:111], v[60:63], v[248:251]
s_waitcnt lgkmcnt(4)
v_exp_f32 v119, v119
v_mfma_f32_16x16x32_bf16 v[252:255], a[112:115], v[60:63], v[252:255]
v_exp_f32_e64 v105, v105
v_mfma_f32_16x16x32_bf16 v[220:223], a[112:115], v[56:59], v[220:223]
buffer_load_dwordx4 v16, s[12:15], s57 offen lds
v_cvt_pk_bf16_f32 v44, v104, v105
v_mfma_f32_16x16x32_bf16 v[188:191], a[112:115], v[52:55], v[188:191]
v_exp_f32_e64 v106, v106
v_mfma_f32_16x16x32_bf16 v[156:159], a[112:115], v[48:51], v[156:159]
v_exp_f32_e64 v107, v107
v_mfma_f32_16x16x32_bf16 a[64:67], a[80:83], v[48:51], a[64:67]
v_exp_f32_e64 v108, v108
v_mfma_f32_16x16x32_bf16 a[68:71], a[80:83], v[52:55], a[68:71]
v_cvt_pk_bf16_f32 v52, v120, v121
v_cvt_pk_bf16_f32 v53, v122, v123
v_mfma_f32_16x16x32_bf16 a[72:75], a[80:83], v[56:59], a[72:75]
buffer_load_dwordx4 v17, s[12:15], s57 offen offset:1024 lds
v_cvt_pk_bf16_f32 v54, v124, v125
v_mfma_f32_16x16x32_bf16 a[76:79], a[80:83], v[60:63], a[76:79]
s_mov_b32 m0, 155968
s_mov_b32 s57, 122880
v_cvt_pk_bf16_f32 v55, v126, v127
v_mfma_f32_16x16x32_bf16 v[88:91], a[116:119], a[48:51], v[36:39]
v_exp_f32_e64 v109, v109
v_mfma_f32_16x16x32_bf16 v[80:83], a[116:119], a[32:35], v[32:35]
v_exp_f32_e64 v110, v110
v_mfma_f32_16x16x32_bf16 v[72:75], a[116:119], a[16:19], v[28:31]
v_exp_f32_e64 v111, v111
v_mfma_f32_16x16x32_bf16 v[64:67], a[116:119], a[0:3], v[24:27]
s_bfm_b64 exec, 16, 48
buffer_load_dword v21, s[24:27], s73 offen  lds
s_mov_b64 exec, -1
v_cvt_pk_bf16_f32 v48, v112, v113
v_mfma_f32_16x16x32_bf16 v[68:71], a[120:123], a[0:3], v[24:27]
s_add_u32 m0, s4, 16384
v_cvt_pk_bf16_f32 v49, v114, v115
v_cvt_pk_bf16_f32 v50, v116, v117
v_mfma_f32_16x16x32_bf16 v[76:79], a[120:123], a[16:19], v[28:31]
s_mul_i32 s73, s6, 331776
ds_read_b64_tr_b16 a[108:109], v6 offset:0
v_cvt_pk_bf16_f32 v51, v118, v119
v_mfma_f32_16x16x32_bf16 v[84:87], a[120:123], a[32:35], v[32:35]
s_add_u32 s73, s73, s72
v_exp_f32 v97, v97
v_mfma_f32_16x16x32_bf16 v[92:95], a[120:123], a[48:51], v[36:39]
s_lshr_b32 s72, s2, 3
v_exp_f32_e64 v98, v98
v_mfma_f32_16x16x32_bf16 v[88:91], a[124:127], a[52:55], v[88:91]
s_lshl_b32 s72, s72, 11
buffer_store_dwordx4 a[132:135], v20, s[28:31], s58 offen offset:0 sc1
v_cvt_pk_bf16_f32 v45, v106, v107
v_mfma_f32_16x16x32_bf16 v[80:83], a[124:127], a[36:39], v[80:83]
s_mov_b32 s58, 123008
v_exp_f32_e64 v99, v99
v_mfma_f32_16x16x32_bf16 v[72:75], a[124:127], a[20:23], v[72:75]
s_add_u32 s72, s72, k3_start-k1_kernel-1024
v_exp_f32_e64 v100, v100
v_mfma_f32_16x16x32_bf16 v[64:67], a[124:127], a[4:7], v[64:67]
v_exp_f32_e64 v101, v101
v_mfma_f32_16x16x32_bf16 v[68:71], a[128:131], a[4:7], v[68:71]
v_exp_f32_e64 v102, v102
v_mfma_f32_16x16x32_bf16 v[76:79], a[128:131], a[20:23], v[76:79]
v_exp_f32_e64 v103, v103
v_mfma_f32_16x16x32_bf16 v[84:87], a[128:131], a[36:39], v[84:87]
v_cvt_pk_bf16_f32 v46, v108, v109
v_cvt_pk_bf16_f32 v47, v110, v111
v_mfma_f32_16x16x32_bf16 v[92:95], a[128:131], a[52:55], v[92:95]
ds_read_b64_tr_b16 a[110:111], v6 offset:2048
v_cvt_pk_bf16_f32 v40, v96, v97
v_mfma_f32_16x16x32_bf16 v[88:91], a[84:87], a[56:59], v[88:91]
v_cvt_pk_bf16_f32 v41, v98, v99
v_cvt_pk_bf16_f32 v42, v100, v101
v_mfma_f32_16x16x32_bf16 v[80:83], a[84:87], a[40:43], v[80:83]
ds_read_b64_tr_b16 a[112:113], v7 offset:0
v_cvt_pk_bf16_f32 v43, v102, v103
v_mfma_f32_16x16x32_bf16 v[72:75], a[84:87], a[24:27], v[72:75]
ds_read_b64_tr_b16 a[114:115], v7 offset:2048
v_lshrrev_b32_e64 v21, 3, v22
v_mfma_f32_16x16x32_bf16 v[64:67], a[84:87], a[8:11], v[64:67]
ds_read_b64_tr_b16 a[116:117], v4 offset:4096
ds_read_b64_tr_b16 a[118:119], v4 offset:6144
v_mfma_f32_16x16x32_bf16 v[68:71], a[88:91], a[8:11], v[68:71]
ds_read_b64_tr_b16 a[120:121], v5 offset:4096
ds_read_b64_tr_b16 a[122:123], v5 offset:6144
v_mfma_f32_16x16x32_bf16 v[76:79], a[88:91], a[24:27], v[76:79]
ds_read_b64_tr_b16 a[124:125], v6 offset:4096
ds_read_b64_tr_b16 a[126:127], v6 offset:6144
v_mfma_f32_16x16x32_bf16 v[84:87], a[88:91], a[40:43], v[84:87]
ds_read_b64_tr_b16 a[128:129], v7 offset:4096
ds_read_b64_tr_b16 a[130:131], v7 offset:6144
v_mfma_f32_16x16x32_bf16 v[92:95], a[88:91], a[56:59], v[92:95]
ds_read_b128 a[84:87], v12 offset:8192
ds_read_b128 a[88:91], v12 offset:12288
v_mfma_f32_16x16x32_bf16 v[88:91], a[92:95], a[60:63], v[88:91]
v_mfma_f32_16x16x32_bf16 v[80:83], a[92:95], a[44:47], v[80:83]
v_mfma_f32_16x16x32_bf16 v[72:75], a[92:95], a[28:31], v[72:75]
s_nop 5
v_exp_f32 v88, v88
v_mfma_f32_16x16x32_bf16 v[64:67], a[92:95], a[12:15], v[64:67]
ds_read_b128 a[92:95], v13 offset:8192
v_mfma_f32_16x16x32_bf16 v[68:71], a[96:99], a[12:15], v[68:71]
v_exp_f32_e64 v72, v72
v_mfma_f32_16x16x32_bf16 v[76:79], a[96:99], a[28:31], v[76:79]
s_nop 3
v_exp_f32 v64, v64
v_mfma_f32_16x16x32_bf16 v[84:87], a[96:99], a[44:47], v[84:87]
v_exp_f32 v65, v65
v_mfma_f32_16x16x32_bf16 v[92:95], a[96:99], a[60:63], v[92:95]
s_waitcnt lgkmcnt(3)
ds_read_b128 a[96:99], v13 offset:12288
buffer_load_dwordx4 v18, s[16:19], s59 offen lds
v_mfma_f32_16x16x32_bf16 v[224:227], a[100:103], v[52:55], v[224:227]
s_add_u32 m0, s4, 20480
s_add_u32 s59, s52, 37748736
v_cvt_pk_bf16_f32 v56, v64, v65
v_mfma_f32_16x16x32_bf16 v[192:195], a[100:103], v[48:51], v[192:195]
v_exp_f32_e64 v66, v66
v_mfma_f32_16x16x32_bf16 v[160:163], a[100:103], v[44:47], v[160:163]
v_exp_f32_e64 v67, v67
v_mfma_f32_16x16x32_bf16 v[128:131], a[100:103], v[40:43], v[128:131]
ds_read_b128 a[100:103], v14 offset:8192
v_cvt_pk_bf16_f32 v57, v66, v67
v_mfma_f32_16x16x32_bf16 v[132:135], a[104:107], v[40:43], v[132:135]
buffer_load_dwordx4 v18, s[16:19], s56 offen lds
v_mfma_f32_16x16x32_bf16 v[164:167], a[104:107], v[44:47], v[164:167]
s_add_u32 m0, s4, 24576
s_mov_b32 s56, 0
v_mfma_f32_16x16x32_bf16 v[196:199], a[104:107], v[48:51], v[196:199]
v_exp_f32 v68, v68
v_mfma_f32_16x16x32_bf16 v[228:231], a[104:107], v[52:55], v[228:231]
ds_read_b128 a[104:107], v14 offset:12288
v_mfma_f32_16x16x32_bf16 v[232:235], a[108:111], v[52:55], v[232:235]
v_exp_f32_e64 v69, v69
v_mfma_f32_16x16x32_bf16 v[200:203], a[108:111], v[48:51], v[200:203]
buffer_load_dwordx4 v18, s[16:19], s57 offen lds
v_cvt_pk_bf16_f32 v58, v68, v69
v_mfma_f32_16x16x32_bf16 v[168:171], a[108:111], v[44:47], v[168:171]
s_add_u32 m0, s4, 28672
s_mov_b32 s57, 147456
v_mfma_f32_16x16x32_bf16 v[136:139], a[108:111], v[40:43], v[136:139]
ds_read_b128 a[108:111], v15 offset:8192
v_mfma_f32_16x16x32_bf16 v[140:143], a[112:115], v[40:43], v[140:143]
v_exp_f32_e64 v70, v70
v_mfma_f32_16x16x32_bf16 v[172:175], a[112:115], v[44:47], v[172:175]
v_exp_f32_e64 v71, v71
v_mfma_f32_16x16x32_bf16 v[204:207], a[112:115], v[48:51], v[204:207]
buffer_load_dwordx4 v18, s[16:19], s58 offen lds
v_cvt_pk_bf16_f32 v59, v70, v71
v_mfma_f32_16x16x32_bf16 v[236:239], a[112:115], v[52:55], v[236:239]
s_mov_b32 m0, 155968
s_mov_b32 s58, 36864
ds_read_b128 a[112:115], v15 offset:12288
v_mfma_f32_16x16x32_bf16 v[240:243], a[116:119], v[52:55], v[240:243]
v_exp_f32_e64 v73, v73
v_mfma_f32_16x16x32_bf16 v[208:211], a[116:119], v[48:51], v[208:211]
v_exp_f32_e64 v74, v74
v_mfma_f32_16x16x32_bf16 v[176:179], a[116:119], v[44:47], v[176:179]
v_exp_f32_e64 v75, v75
v_mfma_f32_16x16x32_bf16 v[144:147], a[116:119], v[40:43], v[144:147]
ds_read_b64_tr_b16 a[116:117], v4 offset:16384
s_bfm_b64 exec, 16, 0
buffer_load_dword v22, s[32:35], s73 offen  lds
s_mov_b64 exec, -1
v_mfma_f32_16x16x32_bf16 v[148:151], a[120:123], v[40:43], v[148:151]
s_mov_b32 m0, 155968
ds_read_b64_tr_b16 a[118:119], v4 offset:18432
v_cvt_pk_bf16_f32 v60, v72, v73
v_mfma_f32_16x16x32_bf16 v[180:183], a[120:123], v[44:47], v[180:183]
v_exp_f32_e64 v76, v76
v_mfma_f32_16x16x32_bf16 v[212:215], a[120:123], v[48:51], v[212:215]
v_exp_f32_e64 v77, v77
v_mfma_f32_16x16x32_bf16 v[244:247], a[120:123], v[52:55], v[244:247]
ds_read_b64_tr_b16 a[120:121], v5 offset:16384
v_cvt_pk_bf16_f32 v61, v74, v75
v_mfma_f32_16x16x32_bf16 v[248:251], a[124:127], v[52:55], v[248:251]
ds_read_b64_tr_b16 a[122:123], v5 offset:18432
s_bfm_b64 exec, 16, 16
buffer_load_dword v22, s[32:35], s73 offen  lds
s_mov_b64 exec, -1
v_mfma_f32_16x16x32_bf16 v[216:219], a[124:127], v[48:51], v[216:219]
s_add_u32 m0, s4, 32768
v_exp_f32_e64 v78, v78
v_mfma_f32_16x16x32_bf16 v[184:187], a[124:127], v[44:47], v[184:187]
v_exp_f32_e64 v79, v79
v_mfma_f32_16x16x32_bf16 v[152:155], a[124:127], v[40:43], v[152:155]
v_cvt_pk_bf16_f32 v62, v76, v77
v_cvt_pk_bf16_f32 v63, v78, v79
v_mfma_f32_16x16x32_bf16 v[156:159], a[128:131], v[40:43], v[156:159]
v_exp_f32_e64 v80, v80
v_mfma_f32_16x16x32_bf16 v[188:191], a[128:131], v[44:47], v[188:191]
v_exp_f32_e64 v81, v81
v_mfma_f32_16x16x32_bf16 v[220:223], a[128:131], v[48:51], v[220:223]
v_exp_f32_e64 v82, v82
v_mfma_f32_16x16x32_bf16 v[252:255], a[128:131], v[52:55], v[252:255]
v_exp_f32_e64 v83, v83
v_mfma_f32_16x16x32_bf16 a[76:79], a[80:83], v[52:55], a[76:79]
v_exp_f32_e64 v84, v84
v_mfma_f32_16x16x32_bf16 a[72:75], a[80:83], v[48:51], a[72:75]
v_exp_f32_e64 v85, v85
v_mfma_f32_16x16x32_bf16 a[68:71], a[80:83], v[44:47], a[68:71]
v_exp_f32_e64 v86, v86
v_mfma_f32_16x16x32_bf16 a[64:67], a[80:83], v[40:43], a[64:67]
s_waitcnt lgkmcnt(0)
v_exp_f32 v87, v87
v_mfma_f32_16x16x32_bf16 v[96:99], a[84:87], a[0:3], v[24:27]
v_cvt_pk_bf16_f32 v40, v80, v81
v_cvt_pk_bf16_f32 v41, v82, v83
v_mfma_f32_16x16x32_bf16 v[104:107], a[84:87], a[16:19], v[28:31]
ds_read_b64_tr_b16 a[124:125], v6 offset:16384
v_cvt_pk_bf16_f32 v42, v84, v85
v_mfma_f32_16x16x32_bf16 v[112:115], a[84:87], a[32:35], v[32:35]
ds_read_b64_tr_b16 a[126:127], v6 offset:18432
v_cvt_pk_bf16_f32 v43, v86, v87
v_mfma_f32_16x16x32_bf16 v[120:123], a[84:87], a[48:51], v[36:39]
v_exp_f32_e64 v89, v89
v_mfma_f32_16x16x32_bf16 v[124:127], a[88:91], a[48:51], v[36:39]
v_exp_f32_e64 v90, v90
v_mfma_f32_16x16x32_bf16 v[116:119], a[88:91], a[32:35], v[32:35]
v_exp_f32_e64 v91, v91
v_mfma_f32_16x16x32_bf16 v[108:111], a[88:91], a[16:19], v[28:31]
v_exp_f32_e64 v92, v92
v_mfma_f32_16x16x32_bf16 v[100:103], a[88:91], a[0:3], v[24:27]
v_exp_f32_e64 v93, v93
v_mfma_f32_16x16x32_bf16 v[96:99], a[92:95], a[4:7], v[96:99]
v_exp_f32_e64 v94, v94
v_mfma_f32_16x16x32_bf16 v[104:107], a[92:95], a[20:23], v[104:107]
v_exp_f32_e64 v95, v95
v_mfma_f32_16x16x32_bf16 v[112:115], a[92:95], a[36:39], v[112:115]
v_cvt_pk_bf16_f32 v44, v88, v89
v_cvt_pk_bf16_f32 v45, v90, v91
v_mfma_f32_16x16x32_bf16 v[120:123], a[92:95], a[52:55], v[120:123]
ds_read_b64_tr_b16 a[128:129], v7 offset:16384
v_cvt_pk_bf16_f32 v46, v92, v93
v_mfma_f32_16x16x32_bf16 v[124:127], a[96:99], a[52:55], v[124:127]
ds_read_b64_tr_b16 a[130:131], v7 offset:18432
v_cvt_pk_bf16_f32 v47, v94, v95
v_mfma_f32_16x16x32_bf16 v[116:119], a[96:99], a[36:39], v[116:119]
ds_read_b64_tr_b16 a[84:85], v4 offset:20480
ds_read_b64_tr_b16 a[86:87], v4 offset:22528
v_mfma_f32_16x16x32_bf16 v[108:111], a[96:99], a[20:23], v[108:111]
ds_read_b64_tr_b16 a[88:89], v5 offset:20480
ds_read_b64_tr_b16 a[90:91], v5 offset:22528
v_mfma_f32_16x16x32_bf16 v[100:103], a[96:99], a[4:7], v[100:103]
ds_read_b64_tr_b16 a[92:93], v6 offset:20480
ds_read_b64_tr_b16 a[94:95], v6 offset:22528
v_mfma_f32_16x16x32_bf16 v[96:99], a[100:103], a[8:11], v[96:99]
ds_read_b64_tr_b16 a[96:97], v7 offset:20480
ds_read_b64_tr_b16 a[98:99], v7 offset:22528
v_mfma_f32_16x16x32_bf16 v[104:107], a[100:103], a[24:27], v[104:107]
v_mfma_f32_16x16x32_bf16 v[112:115], a[100:103], a[40:43], v[112:115]
v_mfma_f32_16x16x32_bf16 v[120:123], a[100:103], a[56:59], v[120:123]
ds_read_b128 a[100:103], v12 offset:24576
v_mfma_f32_16x16x32_bf16 v[124:127], a[104:107], a[56:59], v[124:127]
v_mfma_f32_16x16x32_bf16 v[116:119], a[104:107], a[40:43], v[116:119]
v_mfma_f32_16x16x32_bf16 v[108:111], a[104:107], a[24:27], v[108:111]
v_mfma_f32_16x16x32_bf16 v[100:103], a[104:107], a[8:11], v[100:103]
ds_read_b128 a[104:107], v12 offset:28672
v_mfma_f32_16x16x32_bf16 v[96:99], a[108:111], a[12:15], v[96:99]
v_mfma_f32_16x16x32_bf16 v[104:107], a[108:111], a[28:31], v[104:107]
v_mfma_f32_16x16x32_bf16 v[112:115], a[108:111], a[44:47], v[112:115]
s_nop 5
v_exp_f32 v96, v96
v_mfma_f32_16x16x32_bf16 v[120:123], a[108:111], a[60:63], v[120:123]
ds_read_b128 a[108:111], v13 offset:24576
v_mfma_f32_16x16x32_bf16 v[124:127], a[112:115], a[60:63], v[124:127]
v_exp_f32_e64 v112, v112
v_mfma_f32_16x16x32_bf16 v[116:119], a[112:115], a[44:47], v[116:119]
s_nop 3
v_exp_f32 v120, v120
v_mfma_f32_16x16x32_bf16 v[108:111], a[112:115], a[28:31], v[108:111]
v_exp_f32_e64 v121, v121
v_mfma_f32_16x16x32_bf16 v[100:103], a[112:115], a[12:15], v[100:103]
ds_read_b128 a[112:115], v13 offset:28672
v_mfma_f32_16x16x32_bf16 v[128:131], a[116:119], v[56:59], v[128:131]
v_exp_f32_e64 v122, v122
v_mfma_f32_16x16x32_bf16 v[160:163], a[116:119], v[60:63], v[160:163]
v_exp_f32_e64 v123, v123
v_mfma_f32_16x16x32_bf16 v[192:195], a[116:119], v[40:43], v[192:195]
v_exp_f32_e64 v124, v124
v_mfma_f32_16x16x32_bf16 v[224:227], a[116:119], v[44:47], v[224:227]
ds_read_b128 a[116:119], v14 offset:24576
v_mfma_f32_16x16x32_bf16 v[228:231], a[120:123], v[44:47], v[228:231]
v_exp_f32_e64 v125, v125
v_mfma_f32_16x16x32_bf16 v[196:199], a[120:123], v[40:43], v[196:199]
v_exp_f32_e64 v126, v126
v_mfma_f32_16x16x32_bf16 v[164:167], a[120:123], v[60:63], v[164:167]
v_exp_f32 v127, v127
v_mfma_f32_16x16x32_bf16 v[132:135], a[120:123], v[56:59], v[132:135]
s_waitcnt lgkmcnt(2)
ds_read_b128 a[120:123], v14 offset:28672
v_mfma_f32_16x16x32_bf16 v[136:139], a[124:127], v[56:59], v[136:139]
v_exp_f32_e64 v113, v113
v_mfma_f32_16x16x32_bf16 v[168:171], a[124:127], v[60:63], v[168:171]
v_exp_f32_e64 v114, v114
v_mfma_f32_16x16x32_bf16 v[200:203], a[124:127], v[40:43], v[200:203]
v_exp_f32_e64 v115, v115
v_mfma_f32_16x16x32_bf16 v[232:235], a[124:127], v[44:47], v[232:235]
ds_read_b128 a[124:127], v15 offset:24576
v_mfma_f32_16x16x32_bf16 v[236:239], a[128:131], v[44:47], v[236:239]
v_exp_f32_e64 v116, v116
v_mfma_f32_16x16x32_bf16 v[204:207], a[128:131], v[40:43], v[204:207]
v_exp_f32_e64 v117, v117
v_mfma_f32_16x16x32_bf16 v[172:175], a[128:131], v[60:63], v[172:175]
v_exp_f32_e64 v118, v118
v_mfma_f32_16x16x32_bf16 v[140:143], a[128:131], v[56:59], v[140:143]
ds_read_b128 a[128:131], v15 offset:28672
v_mfma_f32_16x16x32_bf16 v[144:147], a[84:87], v[56:59], v[144:147]
v_exp_f32_e64 v119, v119
v_mfma_f32_16x16x32_bf16 v[176:179], a[84:87], v[60:63], v[176:179]
v_exp_f32_e64 v104, v104
v_mfma_f32_16x16x32_bf16 v[208:211], a[84:87], v[40:43], v[208:211]
v_exp_f32_e64 v105, v105
v_mfma_f32_16x16x32_bf16 v[240:243], a[84:87], v[44:47], v[240:243]
v_exp_f32_e64 v106, v106
v_mfma_f32_16x16x32_bf16 v[244:247], a[88:91], v[44:47], v[244:247]
v_exp_f32_e64 v107, v107
v_mfma_f32_16x16x32_bf16 v[212:215], a[88:91], v[40:43], v[212:215]
v_exp_f32_e64 v108, v108
v_mfma_f32_16x16x32_bf16 v[180:183], a[88:91], v[60:63], v[180:183]
v_exp_f32_e64 v109, v109
v_mfma_f32_16x16x32_bf16 v[148:151], a[88:91], v[56:59], v[148:151]
buffer_store_dwordx4 a[132:135], v20, s[28:31], s59 offen offset:512 sc1
v_cvt_pk_bf16_f32 v52, v104, v105
v_mfma_f32_16x16x32_bf16 v[152:155], a[92:95], v[56:59], v[152:155]
s_mov_b32 s59, 184320
v_exp_f32_e64 v110, v110
v_mfma_f32_16x16x32_bf16 v[184:187], a[92:95], v[60:63], v[184:187]
v_exp_f32_e64 v111, v111
v_mfma_f32_16x16x32_bf16 v[216:219], a[92:95], v[40:43], v[216:219]
v_exp_f32_e64 v97, v97
v_mfma_f32_16x16x32_bf16 v[248:251], a[92:95], v[44:47], v[248:251]
v_exp_f32_e64 v98, v98
v_mfma_f32_16x16x32_bf16 v[252:255], a[96:99], v[44:47], v[252:255]
v_exp_f32_e64 v99, v99
v_mfma_f32_16x16x32_bf16 v[220:223], a[96:99], v[40:43], v[220:223]
v_exp_f32_e64 v100, v100
v_mfma_f32_16x16x32_bf16 v[188:191], a[96:99], v[60:63], v[188:191]
v_exp_f32_e64 v101, v101
v_mfma_f32_16x16x32_bf16 v[156:159], a[96:99], v[56:59], v[156:159]
v_exp_f32_e64 v102, v102
v_mfma_f32_16x16x32_bf16 a[64:67], a[80:83], v[56:59], a[64:67]
v_cvt_pk_bf16_f32 v56, v112, v113
v_cvt_pk_bf16_f32 v57, v114, v115
v_mfma_f32_16x16x32_bf16 a[68:71], a[80:83], v[60:63], a[68:71]
v_cvt_pk_bf16_f32 v60, v120, v121
v_mfma_f32_16x16x32_bf16 a[72:75], a[80:83], v[40:43], a[72:75]
v_cvt_pk_bf16_f32 v61, v122, v123
v_cvt_pk_bf16_f32 v62, v124, v125
v_mfma_f32_16x16x32_bf16 a[76:79], a[80:83], v[44:47], a[76:79]
v_cvt_pk_bf16_f32 v63, v126, v127
v_mfma_f32_16x16x32_bf16 v[88:91], a[100:103], a[48:51], v[36:39]
v_cvt_pk_bf16_f32 v58, v116, v117
v_cvt_pk_bf16_f32 v59, v118, v119
v_mfma_f32_16x16x32_bf16 v[80:83], a[100:103], a[32:35], v[32:35]
v_exp_f32 v103, v103
v_mfma_f32_16x16x32_bf16 v[72:75], a[100:103], a[16:19], v[28:31]
v_cvt_pk_bf16_f32 v53, v106, v107
v_cvt_pk_bf16_f32 v54, v108, v109
v_mfma_f32_16x16x32_bf16 v[64:67], a[100:103], a[0:3], v[24:27]
v_cvt_pk_bf16_f32 v55, v110, v111
v_mfma_f32_16x16x32_bf16 v[68:71], a[104:107], a[0:3], v[24:27]
v_cvt_pk_bf16_f32 v48, v96, v97
v_cvt_pk_bf16_f32 v49, v98, v99
v_mfma_f32_16x16x32_bf16 v[76:79], a[104:107], a[16:19], v[28:31]
v_cvt_pk_bf16_f32 v50, v100, v101
v_mfma_f32_16x16x32_bf16 v[84:87], a[104:107], a[32:35], v[32:35]
v_cvt_pk_bf16_f32 v51, v102, v103
v_mfma_f32_16x16x32_bf16 v[92:95], a[104:107], a[48:51], v[36:39]
v_mfma_f32_16x16x32_bf16 v[88:91], a[108:111], a[52:55], v[88:91]
v_mfma_f32_16x16x32_bf16 v[80:83], a[108:111], a[36:39], v[80:83]
v_mfma_f32_16x16x32_bf16 v[72:75], a[108:111], a[20:23], v[72:75]
v_mfma_f32_16x16x32_bf16 v[64:67], a[108:111], a[4:7], v[64:67]
s_waitcnt lgkmcnt(0)
v_mfma_f32_16x16x32_bf16 v[68:71], a[112:115], a[4:7], v[68:71]
v_mfma_f32_16x16x32_bf16 v[76:79], a[112:115], a[20:23], v[76:79]
v_mfma_f32_16x16x32_bf16 v[84:87], a[112:115], a[36:39], v[84:87]
v_mfma_f32_16x16x32_bf16 v[92:95], a[112:115], a[52:55], v[92:95]
v_mfma_f32_16x16x32_bf16 v[88:91], a[116:119], a[56:59], v[88:91]
s_waitcnt vmcnt(9)
s_barrier
ds_read_b64_tr_b16 a[84:85], v4 offset:32768
ds_read_b64_tr_b16 a[86:87], v4 offset:34816
v_mfma_f32_16x16x32_bf16 v[80:83], a[116:119], a[40:43], v[80:83]
ds_read_b64_tr_b16 a[88:89], v5 offset:32768
ds_read_b64_tr_b16 a[90:91], v5 offset:34816
v_mfma_f32_16x16x32_bf16 v[72:75], a[116:119], a[24:27], v[72:75]
ds_read_b64_tr_b16 a[92:93], v6 offset:32768
ds_read_b64_tr_b16 a[94:95], v6 offset:34816
v_mfma_f32_16x16x32_bf16 v[64:67], a[116:119], a[8:11], v[64:67]
ds_read_b64_tr_b16 a[96:97], v7 offset:32768
ds_read_b64_tr_b16 a[98:99], v7 offset:34816
v_mfma_f32_16x16x32_bf16 v[68:71], a[120:123], a[8:11], v[68:71]
ds_read_b64_tr_b16 a[100:101], v4 offset:36864
ds_read_b64_tr_b16 a[102:103], v4 offset:38912
v_mfma_f32_16x16x32_bf16 v[76:79], a[120:123], a[24:27], v[76:79]
ds_read_b64_tr_b16 a[104:105], v5 offset:36864
ds_read_b64_tr_b16 a[106:107], v5 offset:38912
v_mfma_f32_16x16x32_bf16 v[84:87], a[120:123], a[40:43], v[84:87]
ds_read_b64_tr_b16 a[108:109], v6 offset:36864
ds_read_b64_tr_b16 a[110:111], v6 offset:38912
v_mfma_f32_16x16x32_bf16 v[92:95], a[120:123], a[56:59], v[92:95]
ds_read_b64_tr_b16 a[112:113], v7 offset:36864
ds_read_b64_tr_b16 a[114:115], v7 offset:38912
v_mfma_f32_16x16x32_bf16 v[88:91], a[124:127], a[60:63], v[88:91]
ds_read_b128 a[116:119], v12 offset:40960
ds_read_b128 a[120:123], v12 offset:45056
v_mfma_f32_16x16x32_bf16 v[80:83], a[124:127], a[44:47], v[80:83]
v_mfma_f32_16x16x32_bf16 v[72:75], a[124:127], a[28:31], v[72:75]
s_nop 3
v_exp_f32 v88, v88
v_mfma_f32_16x16x32_bf16 v[64:67], a[124:127], a[12:15], v[64:67]
s_nop 0
v_exp_f32 v80, v80
v_mfma_f32_16x16x32_bf16 v[68:71], a[128:131], a[12:15], v[68:71]
v_exp_f32_e64 v72, v72
v_mfma_f32_16x16x32_bf16 v[76:79], a[128:131], a[28:31], v[76:79]
ds_read_b128 a[124:127], v13 offset:40960
v_mfma_f32_16x16x32_bf16 v[84:87], a[128:131], a[44:47], v[84:87]
s_nop 0
v_exp_f32_e64 v64, v64
v_mfma_f32_16x16x32_bf16 v[92:95], a[128:131], a[60:63], v[92:95]
s_waitcnt lgkmcnt(5)
ds_read_b128 a[128:131], v13 offset:45056
buffer_load_dwordx4 v19, s[20:23], s56 offen lds
v_mfma_f32_16x16x32_bf16 v[224:227], a[84:87], v[60:63], v[224:227]
s_add_u32 m0, s4, 36864
s_mov_b32 s56, 73728
v_mfma_f32_16x16x32_bf16 v[192:195], a[84:87], v[56:59], v[192:195]
v_exp_f32_e64 v65, v65
v_mfma_f32_16x16x32_bf16 v[160:163], a[84:87], v[52:55], v[160:163]
v_exp_f32_e64 v66, v66
v_mfma_f32_16x16x32_bf16 v[128:131], a[84:87], v[48:51], v[128:131]
ds_read_b128 a[84:87], v14 offset:40960
v_cvt_pk_bf16_f32 v40, v64, v65
v_mfma_f32_16x16x32_bf16 v[132:135], a[88:91], v[48:51], v[132:135]
buffer_load_dwordx4 v19, s[20:23], s57 offen lds
v_mfma_f32_16x16x32_bf16 v[164:167], a[88:91], v[52:55], v[164:167]
s_add_u32 m0, s4, 40960
s_mov_b32 s57, 221184
v_mfma_f32_16x16x32_bf16 v[196:199], a[88:91], v[56:59], v[196:199]
v_exp_f32_e64 v67, v67
v_mfma_f32_16x16x32_bf16 v[228:231], a[88:91], v[60:63], v[228:231]
ds_read_b128 a[88:91], v14 offset:45056
v_cvt_pk_bf16_f32 v41, v66, v67
v_mfma_f32_16x16x32_bf16 v[232:235], a[92:95], v[60:63], v[232:235]
v_exp_f32_e64 v68, v68
v_mfma_f32_16x16x32_bf16 v[200:203], a[92:95], v[56:59], v[200:203]
buffer_load_dwordx4 v19, s[20:23], s58 offen lds
v_mfma_f32_16x16x32_bf16 v[168:171], a[92:95], v[52:55], v[168:171]
s_add_u32 m0, s4, 45056
s_mov_b32 s58, 110592
v_mfma_f32_16x16x32_bf16 v[136:139], a[92:95], v[48:51], v[136:139]
ds_read_b128 a[92:95], v15 offset:40960
v_mfma_f32_16x16x32_bf16 v[140:143], a[96:99], v[48:51], v[140:143]
v_exp_f32_e64 v69, v69
v_mfma_f32_16x16x32_bf16 v[172:175], a[96:99], v[52:55], v[172:175]
v_exp_f32_e64 v70, v70
v_mfma_f32_16x16x32_bf16 v[204:207], a[96:99], v[56:59], v[204:207]
buffer_load_dwordx4 v19, s[20:23], s59 offen lds
v_cvt_pk_bf16_f32 v42, v68, v69
v_mfma_f32_16x16x32_bf16 v[236:239], a[96:99], v[60:63], v[236:239]
s_add_u32 m0, s4, 49152
s_mov_b32 s59, 258048
ds_read_b128 a[96:99], v15 offset:45056
v_mfma_f32_16x16x32_bf16 v[240:243], a[100:103], v[60:63], v[240:243]
v_exp_f32_e64 v71, v71
v_mfma_f32_16x16x32_bf16 v[208:211], a[100:103], v[56:59], v[208:211]
v_cvt_pk_bf16_f32 v43, v70, v71
v_mfma_f32_16x16x32_bf16 v[176:179], a[100:103], v[52:55], v[176:179]
v_exp_f32_e64 v73, v73
v_mfma_f32_16x16x32_bf16 v[144:147], a[100:103], v[48:51], v[144:147]
ds_read_b64_tr_b16 a[100:101], v4 offset:49152
buffer_load_dwordx4 v19, s[20:23], s56 offen lds
v_mfma_f32_16x16x32_bf16 v[148:151], a[104:107], v[48:51], v[148:151]
s_add_u32 m0, s4, 53248
s_mov_b32 s56, 128
ds_read_b64_tr_b16 a[102:103], v4 offset:51200
v_mfma_f32_16x16x32_bf16 v[180:183], a[104:107], v[52:55], v[180:183]
v_exp_f32_e64 v74, v74
v_mfma_f32_16x16x32_bf16 v[212:215], a[104:107], v[56:59], v[212:215]
v_exp_f32_e64 v75, v75
v_mfma_f32_16x16x32_bf16 v[244:247], a[104:107], v[60:63], v[244:247]
ds_read_b64_tr_b16 a[104:105], v5 offset:49152
v_cvt_pk_bf16_f32 v44, v72, v73
v_mfma_f32_16x16x32_bf16 v[248:251], a[108:111], v[60:63], v[248:251]
ds_read_b64_tr_b16 a[106:107], v5 offset:51200
buffer_load_dwordx4 v19, s[20:23], s57 offen lds
v_mfma_f32_16x16x32_bf16 v[216:219], a[108:111], v[56:59], v[216:219]
s_add_u32 m0, s4, 57344
s_mov_b32 s57, 147584
v_cvt_pk_bf16_f32 v45, v74, v75
v_mfma_f32_16x16x32_bf16 v[184:187], a[108:111], v[52:55], v[184:187]
v_exp_f32_e64 v76, v76
v_mfma_f32_16x16x32_bf16 v[152:155], a[108:111], v[48:51], v[152:155]
s_waitcnt lgkmcnt(4)
v_exp_f32 v77, v77
v_mfma_f32_16x16x32_bf16 v[156:159], a[112:115], v[48:51], v[156:159]
v_exp_f32_e64 v78, v78
v_mfma_f32_16x16x32_bf16 v[188:191], a[112:115], v[52:55], v[188:191]
buffer_load_dwordx4 v19, s[20:23], s58 offen lds
v_cvt_pk_bf16_f32 v46, v76, v77
v_mfma_f32_16x16x32_bf16 v[220:223], a[112:115], v[56:59], v[220:223]
s_add_u32 m0, s4, 61440
s_mov_b32 s58, 36992
ds_read_b64_tr_b16 a[108:109], v6 offset:49152
v_mfma_f32_16x16x32_bf16 v[252:255], a[112:115], v[60:63], v[252:255]
v_exp_f32_e64 v79, v79
v_mfma_f32_16x16x32_bf16 a[76:79], a[80:83], v[60:63], a[76:79]
ds_read_b64_tr_b16 a[110:111], v6 offset:51200
v_cvt_pk_bf16_f32 v47, v78, v79
v_mfma_f32_16x16x32_bf16 a[72:75], a[80:83], v[56:59], a[72:75]
v_exp_f32_e64 v81, v81
v_mfma_f32_16x16x32_bf16 a[68:71], a[80:83], v[52:55], a[68:71]
ds_read_b64_tr_b16 a[112:113], v7 offset:49152
buffer_load_dwordx4 v19, s[20:23], s59 offen lds
v_mfma_f32_16x16x32_bf16 a[64:67], a[80:83], v[48:51], a[64:67]
s_mov_b32 m0, 155968
s_mov_b32 s59, 184448
v_cvt_pk_bf16_f32 v48, v80, v81
v_mfma_f32_16x16x32_bf16 v[96:99], a[116:119], a[0:3], v[24:27]
v_exp_f32_e64 v82, v82
v_mfma_f32_16x16x32_bf16 v[104:107], a[116:119], a[16:19], v[28:31]
v_exp_f32_e64 v83, v83
v_mfma_f32_16x16x32_bf16 v[112:115], a[116:119], a[32:35], v[32:35]
v_exp_f32_e64 v84, v84
v_mfma_f32_16x16x32_bf16 v[120:123], a[116:119], a[48:51], v[36:39]
s_bfm_b64 exec, 16, 32
buffer_load_dword v22, s[32:35], s73 offen  lds
s_mov_b64 exec, -1
v_cvt_pk_bf16_f32 v49, v82, v83
v_mfma_f32_16x16x32_bf16 v[124:127], a[120:123], a[48:51], v[36:39]
s_add_u32 m0, s4, 65536
v_exp_f32_e64 v85, v85
v_mfma_f32_16x16x32_bf16 v[116:119], a[120:123], a[32:35], v[32:35]
v_exp_f32_e64 v86, v86
v_mfma_f32_16x16x32_bf16 v[108:111], a[120:123], a[16:19], v[28:31]
v_exp_f32_e64 v87, v87
v_mfma_f32_16x16x32_bf16 v[100:103], a[120:123], a[0:3], v[24:27]
v_cvt_pk_bf16_f32 v50, v84, v85
v_cvt_pk_bf16_f32 v51, v86, v87
v_mfma_f32_16x16x32_bf16 v[96:99], a[124:127], a[4:7], v[96:99]
v_exp_f32_e64 v89, v89
v_mfma_f32_16x16x32_bf16 v[104:107], a[124:127], a[20:23], v[104:107]
v_exp_f32_e64 v90, v90
v_mfma_f32_16x16x32_bf16 v[112:115], a[124:127], a[36:39], v[112:115]
v_exp_f32_e64 v91, v91
v_mfma_f32_16x16x32_bf16 v[120:123], a[124:127], a[52:55], v[120:123]
v_exp_f32_e64 v92, v92
v_mfma_f32_16x16x32_bf16 v[124:127], a[128:131], a[52:55], v[124:127]
v_exp_f32_e64 v93, v93
v_mfma_f32_16x16x32_bf16 v[116:119], a[128:131], a[36:39], v[116:119]
v_exp_f32_e64 v94, v94
v_mfma_f32_16x16x32_bf16 v[108:111], a[128:131], a[20:23], v[108:111]
v_exp_f32_e64 v95, v95
v_mfma_f32_16x16x32_bf16 v[100:103], a[128:131], a[4:7], v[100:103]
v_cvt_pk_bf16_f32 v52, v88, v89
v_cvt_pk_bf16_f32 v53, v90, v91
v_mfma_f32_16x16x32_bf16 v[96:99], a[84:87], a[8:11], v[96:99]
ds_read_b64_tr_b16 a[114:115], v7 offset:51200
v_cvt_pk_bf16_f32 v54, v92, v93
v_mfma_f32_16x16x32_bf16 v[104:107], a[84:87], a[24:27], v[104:107]
ds_read_b64_tr_b16 a[116:117], v4 offset:53248
v_cvt_pk_bf16_f32 v55, v94, v95
v_mfma_f32_16x16x32_bf16 v[112:115], a[84:87], a[40:43], v[112:115]
ds_read_b64_tr_b16 a[118:119], v4 offset:55296
ds_read_b64_tr_b16 a[120:121], v5 offset:53248
v_mfma_f32_16x16x32_bf16 v[120:123], a[84:87], a[56:59], v[120:123]
ds_read_b64_tr_b16 a[122:123], v5 offset:55296
ds_read_b64_tr_b16 a[124:125], v6 offset:53248
v_mfma_f32_16x16x32_bf16 v[124:127], a[88:91], a[56:59], v[124:127]
ds_read_b64_tr_b16 a[126:127], v6 offset:55296
ds_read_b64_tr_b16 a[128:129], v7 offset:53248
v_mfma_f32_16x16x32_bf16 v[116:119], a[88:91], a[40:43], v[116:119]
ds_read_b64_tr_b16 a[130:131], v7 offset:55296
ds_read_b128 a[84:87], v12 offset:57344
v_mfma_f32_16x16x32_bf16 v[108:111], a[88:91], a[24:27], v[108:111]
v_mfma_f32_16x16x32_bf16 v[100:103], a[88:91], a[8:11], v[100:103]
ds_read_b128 a[88:91], v12 offset:61440
v_mfma_f32_16x16x32_bf16 v[96:99], a[92:95], a[12:15], v[96:99]
v_mfma_f32_16x16x32_bf16 v[104:107], a[92:95], a[28:31], v[104:107]
v_mfma_f32_16x16x32_bf16 v[112:115], a[92:95], a[44:47], v[112:115]
s_nop 5
v_exp_f32 v96, v96
v_mfma_f32_16x16x32_bf16 v[120:123], a[92:95], a[60:63], v[120:123]
ds_read_b128 a[92:95], v13 offset:57344
v_mfma_f32_16x16x32_bf16 v[124:127], a[96:99], a[60:63], v[124:127]
v_exp_f32_e64 v112, v112
v_mfma_f32_16x16x32_bf16 v[116:119], a[96:99], a[44:47], v[116:119]
s_nop 3
v_exp_f32 v120, v120
v_mfma_f32_16x16x32_bf16 v[108:111], a[96:99], a[28:31], v[108:111]
v_exp_f32 v121, v121
v_mfma_f32_16x16x32_bf16 v[100:103], a[96:99], a[12:15], v[100:103]
s_waitcnt lgkmcnt(2)
ds_read_b128 a[96:99], v13 offset:61440
buffer_load_dwordx4 v19, s[20:23], s56 offen lds
v_mfma_f32_16x16x32_bf16 v[128:131], a[100:103], v[40:43], v[128:131]
s_add_u32 m0, s4, 69632
s_add_u32 s56, s55, 37748736
v_mfma_f32_16x16x32_bf16 v[160:163], a[100:103], v[44:47], v[160:163]
v_exp_f32_e64 v122, v122
v_mfma_f32_16x16x32_bf16 v[192:195], a[100:103], v[48:51], v[192:195]
v_exp_f32_e64 v123, v123
v_mfma_f32_16x16x32_bf16 v[224:227], a[100:103], v[52:55], v[224:227]
ds_read_b128 a[100:103], v14 offset:57344
v_mfma_f32_16x16x32_bf16 v[228:231], a[104:107], v[52:55], v[228:231]
buffer_load_dwordx4 v19, s[20:23], s57 offen lds
v_mfma_f32_16x16x32_bf16 v[196:199], a[104:107], v[48:51], v[196:199]
s_add_u32 m0, s4, 73728
s_mov_b32 s57, 73856
v_mfma_f32_16x16x32_bf16 v[164:167], a[104:107], v[44:47], v[164:167]
v_exp_f32_e64 v124, v124
v_mfma_f32_16x16x32_bf16 v[132:135], a[104:107], v[40:43], v[132:135]
ds_read_b128 a[104:107], v14 offset:61440
v_mfma_f32_16x16x32_bf16 v[136:139], a[108:111], v[40:43], v[136:139]
v_exp_f32_e64 v125, v125
v_mfma_f32_16x16x32_bf16 v[168:171], a[108:111], v[44:47], v[168:171]
buffer_load_dwordx4 v19, s[20:23], s58 offen lds
v_mfma_f32_16x16x32_bf16 v[200:203], a[108:111], v[48:51], v[200:203]
s_add_u32 m0, s4, 77824
s_mov_b32 s58, 221312
v_mfma_f32_16x16x32_bf16 v[232:235], a[108:111], v[52:55], v[232:235]
ds_read_b128 a[108:111], v15 offset:57344
v_mfma_f32_16x16x32_bf16 v[236:239], a[112:115], v[52:55], v[236:239]
v_exp_f32_e64 v126, v126
v_mfma_f32_16x16x32_bf16 v[204:207], a[112:115], v[48:51], v[204:207]
v_exp_f32_e64 v127, v127
v_mfma_f32_16x16x32_bf16 v[172:175], a[112:115], v[44:47], v[172:175]
buffer_load_dwordx4 v19, s[20:23], s59 offen lds
v_mfma_f32_16x16x32_bf16 v[140:143], a[112:115], v[40:43], v[140:143]
s_mov_b32 m0, 155968
s_mov_b32 s59, 110720
ds_read_b128 a[112:115], v15 offset:61440
v_mfma_f32_16x16x32_bf16 v[144:147], a[116:119], v[40:43], v[144:147]
v_exp_f32_e64 v113, v113
v_mfma_f32_16x16x32_bf16 v[176:179], a[116:119], v[44:47], v[176:179]
v_exp_f32_e64 v114, v114
v_mfma_f32_16x16x32_bf16 v[208:211], a[116:119], v[48:51], v[208:211]
v_exp_f32_e64 v115, v115
v_mfma_f32_16x16x32_bf16 v[240:243], a[116:119], v[52:55], v[240:243]
ds_read_b64_tr_b16 a[116:117], v0 offset:0
s_bfm_b64 exec, 16, 48
buffer_load_dword v22, s[32:35], s73 offen  lds
s_mov_b64 exec, -1
v_mfma_f32_16x16x32_bf16 v[244:247], a[120:123], v[52:55], v[244:247]
s_mov_b32 m0, 155968
ds_read_b64_tr_b16 a[118:119], v0 offset:2048
v_mfma_f32_16x16x32_bf16 v[212:215], a[120:123], v[48:51], v[212:215]
v_exp_f32_e64 v116, v116
v_mfma_f32_16x16x32_bf16 v[180:183], a[120:123], v[44:47], v[180:183]
v_exp_f32_e64 v117, v117
v_mfma_f32_16x16x32_bf16 v[148:151], a[120:123], v[40:43], v[148:151]
ds_read_b64_tr_b16 a[120:121], v1 offset:0
ds_read_b64_tr_b16 a[122:123], v1 offset:2048
v_mfma_f32_16x16x32_bf16 v[152:155], a[124:127], v[40:43], v[152:155]
buffer_load_dword v21, s[36:39], s72 offen  lds
v_mfma_f32_16x16x32_bf16 v[184:187], a[124:127], v[44:47], v[184:187]
s_add_u32 m0, s4, 81920
v_exp_f32_e64 v118, v118
v_mfma_f32_16x16x32_bf16 v[216:219], a[124:127], v[48:51], v[216:219]
v_exp_f32_e64 v119, v119
v_mfma_f32_16x16x32_bf16 v[248:251], a[124:127], v[52:55], v[248:251]
v_exp_f32_e64 v104, v104
v_mfma_f32_16x16x32_bf16 v[252:255], a[128:131], v[52:55], v[252:255]
v_exp_f32_e64 v105, v105
v_mfma_f32_16x16x32_bf16 v[220:223], a[128:131], v[48:51], v[220:223]
buffer_store_dwordx4 a[132:135], v20, s[28:31], s56 offen offset:512 sc1
v_cvt_pk_bf16_f32 v60, v104, v105
v_mfma_f32_16x16x32_bf16 v[188:191], a[128:131], v[44:47], v[188:191]
s_mov_b32 s56, 258176
v_exp_f32_e64 v106, v106
v_mfma_f32_16x16x32_bf16 v[156:159], a[128:131], v[40:43], v[156:159]
v_exp_f32_e64 v107, v107
v_mfma_f32_16x16x32_bf16 a[64:67], a[80:83], v[40:43], a[64:67]
v_exp_f32_e64 v108, v108
v_mfma_f32_16x16x32_bf16 a[68:71], a[80:83], v[44:47], a[68:71]
v_cvt_pk_bf16_f32 v44, v120, v121
v_cvt_pk_bf16_f32 v45, v122, v123
v_mfma_f32_16x16x32_bf16 a[72:75], a[80:83], v[48:51], a[72:75]
ds_read_b64_tr_b16 a[124:125], v2 offset:0
v_cvt_pk_bf16_f32 v46, v124, v125
v_mfma_f32_16x16x32_bf16 a[76:79], a[80:83], v[52:55], a[76:79]
v_cvt_pk_bf16_f32 v40, v112, v113
v_cvt_pk_bf16_f32 v47, v126, v127
v_mfma_f32_16x16x32_bf16 v[88:91], a[84:87], a[48:51], v[36:39]
v_exp_f32_e64 v109, v109
v_mfma_f32_16x16x32_bf16 v[80:83], a[84:87], a[32:35], v[32:35]
v_exp_f32_e64 v110, v110
v_mfma_f32_16x16x32_bf16 v[72:75], a[84:87], a[16:19], v[28:31]
v_exp_f32 v111, v111
v_mfma_f32_16x16x32_bf16 v[64:67], a[84:87], a[0:3], v[24:27]
s_waitcnt lgkmcnt(1)
v_cvt_pk_bf16_f32 v41, v114, v115
v_cvt_pk_bf16_f32 v42, v116, v117
v_mfma_f32_16x16x32_bf16 v[68:71], a[88:91], a[0:3], v[24:27]
ds_read_b64_tr_b16 a[126:127], v2 offset:2048
v_cvt_pk_bf16_f32 v43, v118, v119
v_mfma_f32_16x16x32_bf16 v[76:79], a[88:91], a[16:19], v[28:31]
v_exp_f32_e64 v97, v97
v_mfma_f32_16x16x32_bf16 v[84:87], a[88:91], a[32:35], v[32:35]
v_exp_f32_e64 v98, v98
v_mfma_f32_16x16x32_bf16 v[92:95], a[88:91], a[48:51], v[36:39]
v_exp_f32_e64 v99, v99
v_mfma_f32_16x16x32_bf16 v[88:91], a[92:95], a[52:55], v[88:91]
v_exp_f32_e64 v100, v100
v_mfma_f32_16x16x32_bf16 v[80:83], a[92:95], a[36:39], v[80:83]
v_exp_f32_e64 v101, v101
v_mfma_f32_16x16x32_bf16 v[72:75], a[92:95], a[20:23], v[72:75]
v_exp_f32_e64 v102, v102
v_mfma_f32_16x16x32_bf16 v[64:67], a[92:95], a[4:7], v[64:67]
v_exp_f32_e64 v103, v103
v_mfma_f32_16x16x32_bf16 v[68:71], a[96:99], a[4:7], v[68:71]
v_cvt_pk_bf16_f32 v61, v106, v107
v_cvt_pk_bf16_f32 v62, v108, v109
v_mfma_f32_16x16x32_bf16 v[76:79], a[96:99], a[20:23], v[76:79]
ds_read_b64_tr_b16 a[128:129], v3 offset:0
v_cvt_pk_bf16_f32 v63, v110, v111
v_mfma_f32_16x16x32_bf16 v[84:87], a[96:99], a[36:39], v[84:87]
v_cvt_pk_bf16_f32 v56, v96, v97
v_cvt_pk_bf16_f32 v57, v98, v99
v_mfma_f32_16x16x32_bf16 v[92:95], a[96:99], a[52:55], v[92:95]
ds_read_b64_tr_b16 a[130:131], v3 offset:2048
v_cvt_pk_bf16_f32 v58, v100, v101
v_mfma_f32_16x16x32_bf16 v[88:91], a[100:103], a[56:59], v[88:91]
ds_read_b64_tr_b16 a[84:85], v0 offset:4096
v_cvt_pk_bf16_f32 v59, v102, v103
v_mfma_f32_16x16x32_bf16 v[80:83], a[100:103], a[40:43], v[80:83]
ds_read_b64_tr_b16 a[86:87], v0 offset:6144
ds_read_b64_tr_b16 a[88:89], v1 offset:4096
v_mfma_f32_16x16x32_bf16 v[72:75], a[100:103], a[24:27], v[72:75]
ds_read_b64_tr_b16 a[90:91], v1 offset:6144
ds_read_b64_tr_b16 a[92:93], v2 offset:4096
v_mfma_f32_16x16x32_bf16 v[64:67], a[100:103], a[8:11], v[64:67]
ds_read_b64_tr_b16 a[94:95], v2 offset:6144
ds_read_b64_tr_b16 a[96:97], v3 offset:4096
v_mfma_f32_16x16x32_bf16 v[68:71], a[104:107], a[8:11], v[68:71]
ds_read_b64_tr_b16 a[98:99], v3 offset:6144
ds_read_b128 a[100:103], v8 offset:8192
v_mfma_f32_16x16x32_bf16 v[76:79], a[104:107], a[24:27], v[76:79]
v_mfma_f32_16x16x32_bf16 v[84:87], a[104:107], a[40:43], v[84:87]
v_mfma_f32_16x16x32_bf16 v[92:95], a[104:107], a[56:59], v[92:95]
ds_read_b128 a[104:107], v8 offset:12288
v_mfma_f32_16x16x32_bf16 v[88:91], a[108:111], a[60:63], v[88:91]
v_mfma_f32_16x16x32_bf16 v[80:83], a[108:111], a[44:47], v[80:83]
v_mfma_f32_16x16x32_bf16 v[72:75], a[108:111], a[28:31], v[72:75]
s_nop 5
v_exp_f32 v88, v88
v_mfma_f32_16x16x32_bf16 v[64:67], a[108:111], a[12:15], v[64:67]
ds_read_b128 a[108:111], v9 offset:8192
v_mfma_f32_16x16x32_bf16 v[68:71], a[112:115], a[12:15], v[68:71]
v_exp_f32_e64 v72, v72
v_mfma_f32_16x16x32_bf16 v[76:79], a[112:115], a[28:31], v[76:79]
s_nop 3
v_exp_f32 v64, v64
v_mfma_f32_16x16x32_bf16 v[84:87], a[112:115], a[44:47], v[84:87]
v_exp_f32_e64 v65, v65
v_mfma_f32_16x16x32_bf16 v[92:95], a[112:115], a[60:63], v[92:95]
ds_read_b128 a[112:115], v9 offset:12288
v_cvt_pk_bf16_f32 v48, v64, v65
v_mfma_f32_16x16x32_bf16 v[224:227], a[116:119], v[44:47], v[224:227]
v_exp_f32_e64 v66, v66
v_mfma_f32_16x16x32_bf16 v[192:195], a[116:119], v[40:43], v[192:195]
v_exp_f32_e64 v67, v67
v_mfma_f32_16x16x32_bf16 v[160:163], a[116:119], v[60:63], v[160:163]
v_exp_f32_e64 v68, v68
v_mfma_f32_16x16x32_bf16 v[128:131], a[116:119], v[56:59], v[128:131]
ds_read_b128 a[116:119], v10 offset:8192
v_cvt_pk_bf16_f32 v49, v66, v67
v_mfma_f32_16x16x32_bf16 v[132:135], a[120:123], v[56:59], v[132:135]
v_exp_f32_e64 v69, v69
v_mfma_f32_16x16x32_bf16 v[164:167], a[120:123], v[60:63], v[164:167]
v_exp_f32_e64 v70, v70
v_mfma_f32_16x16x32_bf16 v[196:199], a[120:123], v[40:43], v[196:199]
v_exp_f32 v71, v71
v_mfma_f32_16x16x32_bf16 v[228:231], a[120:123], v[44:47], v[228:231]
s_waitcnt lgkmcnt(2)
ds_read_b128 a[120:123], v10 offset:12288
v_cvt_pk_bf16_f32 v50, v68, v69
v_mfma_f32_16x16x32_bf16 v[232:235], a[124:127], v[44:47], v[232:235]
v_cvt_pk_bf16_f32 v51, v70, v71
v_mfma_f32_16x16x32_bf16 v[200:203], a[124:127], v[40:43], v[200:203]
v_exp_f32_e64 v73, v73
v_mfma_f32_16x16x32_bf16 v[168:171], a[124:127], v[60:63], v[168:171]
v_exp_f32_e64 v74, v74
v_mfma_f32_16x16x32_bf16 v[136:139], a[124:127], v[56:59], v[136:139]
ds_read_b128 a[124:127], v11 offset:8192
v_cvt_pk_bf16_f32 v52, v72, v73
v_mfma_f32_16x16x32_bf16 v[140:143], a[128:131], v[56:59], v[140:143]
v_exp_f32_e64 v75, v75
v_mfma_f32_16x16x32_bf16 v[172:175], a[128:131], v[60:63], v[172:175]
v_exp_f32_e64 v76, v76
v_mfma_f32_16x16x32_bf16 v[204:207], a[128:131], v[40:43], v[204:207]
v_exp_f32_e64 v77, v77
v_mfma_f32_16x16x32_bf16 v[236:239], a[128:131], v[44:47], v[236:239]
ds_read_b128 a[128:131], v11 offset:12288
v_cvt_pk_bf16_f32 v53, v74, v75
v_mfma_f32_16x16x32_bf16 v[240:243], a[84:87], v[44:47], v[240:243]
v_exp_f32_e64 v78, v78
v_mfma_f32_16x16x32_bf16 v[208:211], a[84:87], v[40:43], v[208:211]
v_exp_f32_e64 v79, v79
v_mfma_f32_16x16x32_bf16 v[176:179], a[84:87], v[60:63], v[176:179]
v_cvt_pk_bf16_f32 v54, v76, v77
v_cvt_pk_bf16_f32 v55, v78, v79
v_mfma_f32_16x16x32_bf16 v[144:147], a[84:87], v[56:59], v[144:147]
v_exp_f32_e64 v80, v80
v_mfma_f32_16x16x32_bf16 v[148:151], a[88:91], v[56:59], v[148:151]
v_exp_f32_e64 v81, v81
v_mfma_f32_16x16x32_bf16 v[180:183], a[88:91], v[60:63], v[180:183]
v_exp_f32_e64 v82, v82
v_mfma_f32_16x16x32_bf16 v[212:215], a[88:91], v[40:43], v[212:215]
v_exp_f32_e64 v83, v83
v_mfma_f32_16x16x32_bf16 v[244:247], a[88:91], v[44:47], v[244:247]
v_exp_f32_e64 v84, v84
v_mfma_f32_16x16x32_bf16 v[248:251], a[92:95], v[44:47], v[248:251]
v_exp_f32_e64 v85, v85
v_mfma_f32_16x16x32_bf16 v[216:219], a[92:95], v[40:43], v[216:219]
v_exp_f32_e64 v86, v86
v_mfma_f32_16x16x32_bf16 v[184:187], a[92:95], v[60:63], v[184:187]
v_exp_f32_e64 v87, v87
v_mfma_f32_16x16x32_bf16 v[152:155], a[92:95], v[56:59], v[152:155]
v_exp_f32_e64 v89, v89
v_mfma_f32_16x16x32_bf16 v[156:159], a[96:99], v[56:59], v[156:159]
v_exp_f32_e64 v90, v90
v_mfma_f32_16x16x32_bf16 v[188:191], a[96:99], v[60:63], v[188:191]
v_exp_f32_e64 v91, v91
v_mfma_f32_16x16x32_bf16 v[220:223], a[96:99], v[40:43], v[220:223]
v_exp_f32_e64 v92, v92
v_mfma_f32_16x16x32_bf16 v[252:255], a[96:99], v[44:47], v[252:255]
v_exp_f32_e64 v93, v93
v_mfma_f32_16x16x32_bf16 a[76:79], a[80:83], v[44:47], a[76:79]
v_exp_f32_e64 v94, v94
v_mfma_f32_16x16x32_bf16 a[72:75], a[80:83], v[40:43], a[72:75]
v_exp_f32 v95, v95
v_mfma_f32_16x16x32_bf16 a[68:71], a[80:83], v[60:63], a[68:71]
v_cvt_pk_bf16_f32 v60, v88, v89
v_cvt_pk_bf16_f32 v61, v90, v91
v_mfma_f32_16x16x32_bf16 a[64:67], a[80:83], v[56:59], a[64:67]
v_cvt_pk_bf16_f32 v56, v80, v81
v_mfma_f32_16x16x32_bf16 v[96:99], a[100:103], a[0:3], v[24:27]
v_cvt_pk_bf16_f32 v57, v82, v83
v_cvt_pk_bf16_f32 v58, v84, v85
v_mfma_f32_16x16x32_bf16 v[104:107], a[100:103], a[16:19], v[28:31]
v_cvt_pk_bf16_f32 v59, v86, v87
v_mfma_f32_16x16x32_bf16 v[112:115], a[100:103], a[32:35], v[32:35]
v_cvt_pk_bf16_f32 v62, v92, v93
v_cvt_pk_bf16_f32 v63, v94, v95
v_mfma_f32_16x16x32_bf16 v[120:123], a[100:103], a[48:51], v[36:39]
v_mfma_f32_16x16x32_bf16 v[124:127], a[104:107], a[48:51], v[36:39]
v_mfma_f32_16x16x32_bf16 v[116:119], a[104:107], a[32:35], v[32:35]
v_mfma_f32_16x16x32_bf16 v[108:111], a[104:107], a[16:19], v[28:31]
v_mfma_f32_16x16x32_bf16 v[100:103], a[104:107], a[0:3], v[24:27]
v_mfma_f32_16x16x32_bf16 v[96:99], a[108:111], a[4:7], v[96:99]
v_mfma_f32_16x16x32_bf16 v[104:107], a[108:111], a[20:23], v[104:107]
v_mfma_f32_16x16x32_bf16 v[112:115], a[108:111], a[36:39], v[112:115]
v_mfma_f32_16x16x32_bf16 v[120:123], a[108:111], a[52:55], v[120:123]
s_waitcnt lgkmcnt(0)
v_mfma_f32_16x16x32_bf16 v[124:127], a[112:115], a[52:55], v[124:127]
v_mfma_f32_16x16x32_bf16 v[116:119], a[112:115], a[36:39], v[116:119]
v_mfma_f32_16x16x32_bf16 v[108:111], a[112:115], a[20:23], v[108:111]
v_mfma_f32_16x16x32_bf16 v[100:103], a[112:115], a[4:7], v[100:103]
v_mfma_f32_16x16x32_bf16 v[96:99], a[116:119], a[8:11], v[96:99]
s_waitcnt vmcnt(19)
s_barrier
ds_read_b64_tr_b16 a[84:85], v0 offset:16384
ds_read_b64_tr_b16 a[86:87], v0 offset:18432
v_mfma_f32_16x16x32_bf16 v[104:107], a[116:119], a[24:27], v[104:107]
ds_read_b64_tr_b16 a[88:89], v1 offset:16384
ds_read_b64_tr_b16 a[90:91], v1 offset:18432
v_mfma_f32_16x16x32_bf16 v[112:115], a[116:119], a[40:43], v[112:115]
ds_read_b64_tr_b16 a[92:93], v2 offset:16384
ds_read_b64_tr_b16 a[94:95], v2 offset:18432
v_mfma_f32_16x16x32_bf16 v[120:123], a[116:119], a[56:59], v[120:123]
ds_read_b64_tr_b16 a[96:97], v3 offset:16384
ds_read_b64_tr_b16 a[98:99], v3 offset:18432
v_mfma_f32_16x16x32_bf16 v[124:127], a[120:123], a[56:59], v[124:127]
ds_read_b64_tr_b16 a[100:101], v0 offset:20480
ds_read_b64_tr_b16 a[102:103], v0 offset:22528
v_mfma_f32_16x16x32_bf16 v[116:119], a[120:123], a[40:43], v[116:119]
ds_read_b64_tr_b16 a[104:105], v1 offset:20480
ds_read_b64_tr_b16 a[106:107], v1 offset:22528
v_mfma_f32_16x16x32_bf16 v[108:111], a[120:123], a[24:27], v[108:111]
ds_read_b64_tr_b16 a[108:109], v2 offset:20480
ds_read_b64_tr_b16 a[110:111], v2 offset:22528
v_mfma_f32_16x16x32_bf16 v[100:103], a[120:123], a[8:11], v[100:103]
ds_read_b64_tr_b16 a[112:113], v3 offset:20480
ds_read_b64_tr_b16 a[114:115], v3 offset:22528
v_mfma_f32_16x16x32_bf16 v[96:99], a[124:127], a[12:15], v[96:99]
ds_read_b64_tr_b16 a[116:117], v0 offset:24576
ds_read_b64_tr_b16 a[118:119], v0 offset:26624
v_mfma_f32_16x16x32_bf16 v[104:107], a[124:127], a[28:31], v[104:107]
ds_read_b64_tr_b16 a[120:121], v1 offset:24576
ds_read_b64_tr_b16 a[122:123], v1 offset:26624
v_mfma_f32_16x16x32_bf16 v[112:115], a[124:127], a[44:47], v[112:115]
s_nop 1
v_exp_f32 v96, v96
v_mfma_f32_16x16x32_bf16 v[120:123], a[124:127], a[60:63], v[120:123]
s_nop 0
v_exp_f32 v104, v104
v_mfma_f32_16x16x32_bf16 v[124:127], a[128:131], a[60:63], v[124:127]
s_nop 0
v_exp_f32 v112, v112
v_mfma_f32_16x16x32_bf16 v[116:119], a[128:131], a[44:47], v[116:119]
s_nop 1
v_exp_f32 v120, v120
v_mfma_f32_16x16x32_bf16 v[108:111], a[128:131], a[28:31], v[108:111]
v_exp_f32 v121, v121
v_mfma_f32_16x16x32_bf16 v[100:103], a[128:131], a[12:15], v[100:103]
s_waitcnt lgkmcnt(6)
ds_read_b64_tr_b16 a[124:125], v2 offset:24576
buffer_load_dwordx4 v19, s[20:23], s57 offen lds
v_mfma_f32_16x16x32_bf16 v[128:131], a[84:87], v[48:51], v[128:131]
s_add_u32 m0, s4, 86016
s_mov_b32 s57, 256
ds_read_b64_tr_b16 a[126:127], v2 offset:26624
v_mfma_f32_16x16x32_bf16 v[160:163], a[84:87], v[52:55], v[160:163]
v_exp_f32_e64 v122, v122
v_mfma_f32_16x16x32_bf16 v[192:195], a[84:87], v[56:59], v[192:195]
v_exp_f32_e64 v123, v123
v_mfma_f32_16x16x32_bf16 v[224:227], a[84:87], v[60:63], v[224:227]
v_exp_f32_e64 v124, v124
v_mfma_f32_16x16x32_bf16 v[228:231], a[88:91], v[60:63], v[228:231]
ds_read_b64_tr_b16 a[128:129], v3 offset:24576
buffer_load_dwordx4 v19, s[20:23], s58 offen lds
v_mfma_f32_16x16x32_bf16 v[196:199], a[88:91], v[56:59], v[196:199]
s_add_u32 m0, s4, 90112
s_mov_b32 s58, 147712
ds_read_b64_tr_b16 a[130:131], v3 offset:26624
v_mfma_f32_16x16x32_bf16 v[164:167], a[88:91], v[52:55], v[164:167]
v_exp_f32_e64 v125, v125
v_mfma_f32_16x16x32_bf16 v[132:135], a[88:91], v[48:51], v[132:135]
v_exp_f32_e64 v126, v126
v_mfma_f32_16x16x32_bf16 v[136:139], a[92:95], v[48:51], v[136:139]
v_exp_f32_e64 v127, v127
v_mfma_f32_16x16x32_bf16 v[168:171], a[92:95], v[52:55], v[168:171]
ds_read_b64_tr_b16 a[84:85], v0 offset:28672
buffer_load_dwordx4 v19, s[20:23], s59 offen lds
v_mfma_f32_16x16x32_bf16 v[200:203], a[92:95], v[56:59], v[200:203]
s_add_u32 m0, s4, 94208
s_mov_b32 s59, 37120
ds_read_b64_tr_b16 a[86:87], v0 offset:30720
v_mfma_f32_16x16x32_bf16 v[232:235], a[92:95], v[60:63], v[232:235]
v_exp_f32_e64 v113, v113
v_mfma_f32_16x16x32_bf16 v[236:239], a[96:99], v[60:63], v[236:239]
v_exp_f32_e64 v114, v114
v_mfma_f32_16x16x32_bf16 v[204:207], a[96:99], v[56:59], v[204:207]
v_exp_f32_e64 v115, v115
v_mfma_f32_16x16x32_bf16 v[172:175], a[96:99], v[52:55], v[172:175]
ds_read_b64_tr_b16 a[88:89], v1 offset:28672
buffer_load_dwordx4 v19, s[20:23], s56 offen lds
v_mfma_f32_16x16x32_bf16 v[140:143], a[96:99], v[48:51], v[140:143]
s_add_u32 m0, s4, 98304
s_mov_b32 s56, 184576
ds_read_b64_tr_b16 a[90:91], v1 offset:30720
v_mfma_f32_16x16x32_bf16 v[144:147], a[100:103], v[48:51], v[144:147]
v_exp_f32_e64 v116, v116
v_mfma_f32_16x16x32_bf16 v[176:179], a[100:103], v[52:55], v[176:179]
v_exp_f32_e64 v117, v117
v_mfma_f32_16x16x32_bf16 v[208:211], a[100:103], v[56:59], v[208:211]
v_exp_f32_e64 v118, v118
v_mfma_f32_16x16x32_bf16 v[240:243], a[100:103], v[60:63], v[240:243]
ds_read_b64_tr_b16 a[92:93], v2 offset:28672
buffer_load_dwordx4 v19, s[20:23], s57 offen lds
v_mfma_f32_16x16x32_bf16 v[244:247], a[104:107], v[60:63], v[244:247]
s_add_u32 m0, s4, 102400
s_mov_b32 s57, 73984
ds_read_b64_tr_b16 a[94:95], v2 offset:30720
v_mfma_f32_16x16x32_bf16 v[212:215], a[104:107], v[56:59], v[212:215]
v_exp_f32_e64 v119, v119
v_mfma_f32_16x16x32_bf16 v[180:183], a[104:107], v[52:55], v[180:183]
v_exp_f32_e64 v105, v105
v_mfma_f32_16x16x32_bf16 v[148:151], a[104:107], v[48:51], v[148:151]
v_exp_f32_e64 v106, v106
v_mfma_f32_16x16x32_bf16 v[152:155], a[108:111], v[48:51], v[152:155]
buffer_load_dwordx4 v19, s[20:23], s58 offen lds
v_cvt_pk_bf16_f32 v44, v104, v105
v_mfma_f32_16x16x32_bf16 v[184:187], a[108:111], v[52:55], v[184:187]
s_add_u32 m0, s4, 106496
s_mov_b32 s58, 221440
ds_read_b64_tr_b16 a[96:97], v3 offset:28672
v_mfma_f32_16x16x32_bf16 v[216:219], a[108:111], v[56:59], v[216:219]
v_exp_f32_e64 v107, v107
v_mfma_f32_16x16x32_bf16 v[248:251], a[108:111], v[60:63], v[248:251]
s_waitcnt lgkmcnt(3)
v_exp_f32 v108, v108
v_mfma_f32_16x16x32_bf16 v[252:255], a[112:115], v[60:63], v[252:255]
v_exp_f32_e64 v109, v109
v_mfma_f32_16x16x32_bf16 v[220:223], a[112:115], v[56:59], v[220:223]
buffer_load_dwordx4 v19, s[20:23], s59 offen lds
v_cvt_pk_bf16_f32 v45, v106, v107
v_mfma_f32_16x16x32_bf16 v[188:191], a[112:115], v[52:55], v[188:191]
s_add_u32 m0, s4, 110592
s_mov_b32 s59, 110848
v_cvt_pk_bf16_f32 v46, v108, v109
v_mfma_f32_16x16x32_bf16 v[156:159], a[112:115], v[48:51], v[156:159]
v_exp_f32_e64 v110, v110
v_mfma_f32_16x16x32_bf16 a[64:67], a[80:83], v[48:51], a[64:67]
v_exp_f32_e64 v111, v111
v_mfma_f32_16x16x32_bf16 a[68:71], a[80:83], v[52:55], a[68:71]
v_cvt_pk_bf16_f32 v52, v120, v121
v_cvt_pk_bf16_f32 v53, v122, v123
v_mfma_f32_16x16x32_bf16 a[72:75], a[80:83], v[56:59], a[72:75]
buffer_load_dwordx4 v19, s[20:23], s56 offen lds
v_cvt_pk_bf16_f32 v54, v124, v125
v_mfma_f32_16x16x32_bf16 a[76:79], a[80:83], v[60:63], a[76:79]
s_add_u32 m0, s4, 114688
s_mov_b32 s56, 258304
v_cvt_pk_bf16_f32 v55, v126, v127
v_cvt_pk_bf16_f32 v48, v112, v113
v_cvt_pk_bf16_f32 v49, v114, v115
v_cvt_pk_bf16_f32 v50, v116, v117
v_cvt_pk_bf16_f32 v51, v118, v119
v_mfma_f32_16x16x32_bf16 a[76:79], a[80:83], v[52:55], a[76:79]
v_exp_f32_e64 v97, v97
v_mfma_f32_16x16x32_bf16 a[72:75], a[80:83], v[48:51], a[72:75]
v_exp_f32 v98, v98
v_exp_f32 v99, v99
v_exp_f32 v100, v100
v_exp_f32 v101, v101
v_exp_f32 v102, v102
v_exp_f32 v103, v103
v_cvt_pk_bf16_f32 v40, v96, v97
v_cvt_pk_bf16_f32 v47, v110, v111
ds_read_b64_tr_b16 a[98:99], v3 offset:30720
v_cvt_pk_bf16_f32 v41, v98, v99
v_cvt_pk_bf16_f32 v42, v100, v101
v_cvt_pk_bf16_f32 v43, v102, v103
v_mfma_f32_16x16x32_bf16 a[68:71], a[80:83], v[44:47], a[68:71]
v_accvgpr_read_b32 v58, a72
v_mfma_f32_16x16x32_bf16 a[64:67], a[80:83], v[40:43], a[64:67]
v_accvgpr_read_b32 v59, a76
v_mfma_f32_16x16x32_bf16 v[128:131], a[116:119], v[40:43], v[128:131]
s_nop 3
v_accvgpr_read_b32 v57, a68
v_mfma_f32_16x16x32_bf16 v[160:163], a[116:119], v[44:47], v[160:163]
v_accvgpr_read_b32 v56, a64
v_cmp_nlt_f32_e64 s[64:65], v56, s67
v_mfma_f32_16x16x32_bf16 v[192:195], a[116:119], v[48:51], v[192:195]
s_or_b64 s[62:63], s[62:63], s[64:65]
v_rcp_f32_e64 v56, v56
v_mfma_f32_16x16x32_bf16 v[224:227], a[116:119], v[52:55], v[224:227]
v_cmp_nlt_f32_e64 s[64:65], v57, s67
v_mul_f32_e64 v128, v128, v56
v_mfma_f32_16x16x32_bf16 v[228:231], a[120:123], v[52:55], v[228:231]
s_or_b64 s[62:63], s[62:63], s[64:65]
v_rcp_f32 v57, v57
v_mfma_f32_16x16x32_bf16 v[196:199], a[120:123], v[48:51], v[196:199]
v_mul_f32 v129, v129, v56
v_mul_f32 v130, v130, v56
v_mfma_f32_16x16x32_bf16 v[164:167], a[120:123], v[44:47], v[164:167]
v_mul_f32_e64 v131, v131, v56
v_mfma_f32_16x16x32_bf16 v[132:135], a[120:123], v[40:43], v[132:135]
v_cvt_pk_bf16_f32 v64, v128, v129
v_cvt_pk_bf16_f32 v65, v130, v131
v_mfma_f32_16x16x32_bf16 v[136:139], a[124:127], v[40:43], v[136:139]
v_mul_f32_e64 v160, v160, v57
v_mfma_f32_16x16x32_bf16 v[168:171], a[124:127], v[44:47], v[168:171]
s_nop 2
v_mul_f32 v132, v132, v56
v_mul_f32_e64 v133, v133, v56
v_mfma_f32_16x16x32_bf16 v[200:203], a[124:127], v[48:51], v[200:203]
v_mul_f32_e64 v134, v134, v56
v_mfma_f32_16x16x32_bf16 v[232:235], a[124:127], v[52:55], v[232:235]
v_mul_f32_e64 v135, v135, v56
v_cvt_pk_bf16_f32 v66, v132, v133
v_mfma_f32_16x16x32_bf16 v[236:239], a[128:131], v[52:55], v[236:239]
v_cvt_pk_bf16_f32 v67, v134, v135
v_mfma_f32_16x16x32_bf16 v[204:207], a[128:131], v[48:51], v[204:207]
v_mul_f32 v161, v161, v57
v_mul_f32 v162, v162, v57
v_mfma_f32_16x16x32_bf16 v[172:175], a[128:131], v[44:47], v[172:175]
v_mul_f32_e64 v163, v163, v57
v_mfma_f32_16x16x32_bf16 v[140:143], a[128:131], v[40:43], v[140:143]
v_mul_f32 v164, v164, v57
v_mul_f32 v165, v165, v57
v_mfma_f32_16x16x32_bf16 v[144:147], a[84:87], v[40:43], v[144:147]
s_waitcnt vmcnt(20)
s_barrier
ds_read_b64_tr_b16 a[100:101], v0 offset:32768
v_mul_f32_e64 v166, v166, v57
v_mfma_f32_16x16x32_bf16 v[176:179], a[84:87], v[44:47], v[176:179]
ds_read_b64_tr_b16 a[102:103], v0 offset:34816
ds_read_b64_tr_b16 a[104:105], v1 offset:32768
v_mfma_f32_16x16x32_bf16 v[208:211], a[84:87], v[48:51], v[208:211]
ds_read_b64_tr_b16 a[106:107], v1 offset:34816
ds_read_b64_tr_b16 a[108:109], v2 offset:32768
v_mfma_f32_16x16x32_bf16 v[240:243], a[84:87], v[52:55], v[240:243]
ds_read_b64_tr_b16 a[110:111], v2 offset:34816
ds_read_b64_tr_b16 a[112:113], v3 offset:32768
v_mfma_f32_16x16x32_bf16 v[244:247], a[88:91], v[52:55], v[244:247]
ds_read_b64_tr_b16 a[114:115], v3 offset:34816
v_mul_f32 v167, v167, v57
v_mfma_f32_16x16x32_bf16 v[212:215], a[88:91], v[48:51], v[212:215]
v_cvt_pk_bf16_f32 v96, v160, v161
v_cvt_pk_bf16_f32 v97, v162, v163
v_mfma_f32_16x16x32_bf16 v[180:183], a[88:91], v[44:47], v[180:183]
ds_read_b64_tr_b16 a[116:117], v0 offset:36864
v_cvt_pk_bf16_f32 v98, v164, v165
v_mfma_f32_16x16x32_bf16 v[148:151], a[88:91], v[40:43], v[148:151]
s_waitcnt lgkmcnt(9)
ds_read_b64_tr_b16 a[118:119], v0 offset:38912
v_cvt_pk_bf16_f32 v99, v166, v167
v_mfma_f32_16x16x32_bf16 v[152:155], a[92:95], v[40:43], v[152:155]
ds_read_b64_tr_b16 a[120:121], v1 offset:36864
ds_read_b64_tr_b16 a[122:123], v1 offset:38912
v_mfma_f32_16x16x32_bf16 v[184:187], a[92:95], v[44:47], v[184:187]
ds_read_b64_tr_b16 a[124:125], v2 offset:36864
ds_read_b64_tr_b16 a[126:127], v2 offset:38912
v_mfma_f32_16x16x32_bf16 v[216:219], a[92:95], v[48:51], v[216:219]
ds_read_b64_tr_b16 a[128:129], v3 offset:36864
v_cmp_nlt_f32_e64 s[64:65], v58, s67
v_mfma_f32_16x16x32_bf16 v[248:251], a[92:95], v[52:55], v[248:251]
s_or_b64 s[62:63], s[62:63], s[64:65]
v_rcp_f32 v58, v58
v_mfma_f32_16x16x32_bf16 v[252:255], a[96:99], v[52:55], v[252:255]
v_cmp_nlt_f32_e64 s[64:65], v59, s67
v_mul_f32_e64 v192, v192, v58
v_mfma_f32_16x16x32_bf16 v[220:223], a[96:99], v[48:51], v[220:223]
s_or_b64 s[62:63], s[62:63], s[64:65]
v_rcp_f32 v59, v59
v_mfma_f32_16x16x32_bf16 v[188:191], a[96:99], v[44:47], v[188:191]
v_mul_f32 v193, v193, v58
v_mul_f32 v194, v194, v58
v_mfma_f32_16x16x32_bf16 v[156:159], a[96:99], v[40:43], v[156:159]
s_waitcnt lgkmcnt(6)
buffer_load_dwordx4 v19, s[20:23], s57 offen lds
v_mul_f32 v195, v195, v58
v_mfma_f32_16x16x32_bf16 v[24:27], a[100:103], v[64:67], 0
s_add_u32 m0, s4, 118784
s_movk_i32 s57, 384
v_mul_f32 v196, v196, v58
v_mfma_f32_16x16x32_bf16 v[28:31], a[100:103], v[96:99], 0
buffer_load_dwordx4 v19, s[20:23], s58 offen lds
v_mul_f32_e64 v197, v197, v58
v_mfma_f32_16x16x32_bf16 v[36:39], a[104:107], v[96:99], 0
s_add_u32 m0, s4, 122880
s_mov_b32 s58, 147840
v_mul_f32_e64 v198, v198, v58
v_mfma_f32_16x16x32_bf16 v[32:35], a[104:107], v[64:67], 0
buffer_load_dwordx4 v19, s[20:23], s59 offen lds
v_mul_f32_e64 v199, v199, v58
v_mfma_f32_16x16x32_bf16 v[40:43], a[108:111], v[64:67], 0
s_add_u32 m0, s4, 126976
s_mov_b32 s59, 37248
v_cvt_pk_bf16_f32 v80, v192, v193
v_mfma_f32_16x16x32_bf16 v[44:47], a[108:111], v[96:99], 0
buffer_load_dwordx4 v19, s[20:23], s56 offen lds
v_cvt_pk_bf16_f32 v81, v194, v195
v_mfma_f32_16x16x32_bf16 v[52:55], a[112:115], v[96:99], 0
s_add_u32 m0, s4, 0
s_mov_b32 s56, 184704
v_cvt_pk_bf16_f32 v82, v196, v197
v_mfma_f32_16x16x32_bf16 v[48:51], a[112:115], v[64:67], 0
s_waitcnt lgkmcnt(0)
ds_read_b64_tr_b16 a[130:131], v3 offset:38912
v_cvt_pk_bf16_f32 v83, v198, v199
v_mul_f32 v224, v224, v59
v_mul_f32 v225, v225, v59
v_mul_f32 v226, v226, v59
v_mul_f32 v227, v227, v59
v_mfma_f32_16x16x32_bf16 v[24:27], a[116:119], v[80:83], v[24:27]
v_mul_f32 v228, v228, v59
v_mul_f32 v229, v229, v59
v_mul_f32 v230, v230, v59
v_mul_f32 v231, v231, v59
v_cvt_pk_bf16_f32 v112, v224, v225
v_cvt_pk_bf16_f32 v113, v226, v227
ds_read_b64_tr_b16 a[84:85], v0 offset:40960
ds_read_b64_tr_b16 a[86:87], v0 offset:43008
v_cvt_pk_bf16_f32 v114, v228, v229
v_cvt_pk_bf16_f32 v115, v230, v231
ds_read_b64_tr_b16 a[88:89], v1 offset:40960
ds_read_b64_tr_b16 a[90:91], v1 offset:43008
ds_read_b64_tr_b16 a[92:93], v2 offset:40960
ds_read_b64_tr_b16 a[94:95], v2 offset:43008
v_mfma_f32_16x16x32_bf16 v[28:31], a[116:119], v[112:115], v[28:31]
v_mul_f32 v136, v136, v56
v_mul_f32 v137, v137, v56
v_mfma_f32_16x16x32_bf16 v[36:39], a[120:123], v[112:115], v[36:39]
ds_read_b64_tr_b16 a[96:97], v3 offset:40960
v_mul_f32_e64 v138, v138, v56
v_mfma_f32_16x16x32_bf16 v[32:35], a[120:123], v[80:83], v[32:35]
buffer_load_dwordx4 v19, s[20:23], s57 offen lds
v_mul_f32_e64 v139, v139, v56
v_mfma_f32_16x16x32_bf16 v[40:43], a[124:127], v[80:83], v[40:43]
s_add_u32 m0, s4, 4096
s_mov_b32 s57, 74112
v_mul_f32 v140, v140, v56
v_mfma_f32_16x16x32_bf16 v[44:47], a[124:127], v[112:115], v[44:47]
s_waitcnt lgkmcnt(7)
buffer_load_dwordx4 v19, s[20:23], s58 offen lds
v_mul_f32_e64 v141, v141, v56
v_mfma_f32_16x16x32_bf16 v[52:55], a[128:131], v[112:115], v[52:55]
s_add_u32 m0, s4, 8192
s_mov_b32 s58, 221568
v_mul_f32_e64 v142, v142, v56
v_mfma_f32_16x16x32_bf16 v[48:51], a[128:131], v[80:83], v[48:51]
buffer_load_dwordx4 v19, s[20:23], s59 offen lds
v_mul_f32_e64 v143, v143, v56
s_add_u32 m0, s4, 12288
s_mov_b32 s59, 110976
v_cvt_pk_bf16_f32 v68, v136, v137
v_cvt_pk_bf16_f32 v69, v138, v139
v_cvt_pk_bf16_f32 v70, v140, v141
ds_read_b64_tr_b16 a[98:99], v3 offset:43008
buffer_load_dwordx4 v19, s[20:23], s56 offen lds
v_cvt_pk_bf16_f32 v71, v142, v143
v_mul_f32_e64 v168, v168, v57
s_add_u32 m0, s4, 16384
s_mov_b32 s56, 258432
v_mul_f32 v169, v169, v57
v_mul_f32 v170, v170, v57
v_mul_f32 v171, v171, v57
s_waitcnt lgkmcnt(6)
v_mfma_f32_16x16x32_bf16 v[24:27], a[84:87], v[68:71], v[24:27]
s_waitcnt vmcnt(24)
s_barrier
v_mul_f32 v172, v172, v57
v_mul_f32 v173, v173, v57
v_mul_f32 v174, v174, v57
v_mul_f32 v175, v175, v57
v_cvt_pk_bf16_f32 v100, v168, v169
v_cvt_pk_bf16_f32 v101, v170, v171
ds_read_b64_tr_b16 a[100:101], v0 offset:45056
ds_read_b64_tr_b16 a[102:103], v0 offset:47104
v_cvt_pk_bf16_f32 v102, v172, v173
v_cvt_pk_bf16_f32 v103, v174, v175
ds_read_b64_tr_b16 a[104:105], v1 offset:45056
ds_read_b64_tr_b16 a[106:107], v1 offset:47104
ds_read_b64_tr_b16 a[108:109], v2 offset:45056
ds_read_b64_tr_b16 a[110:111], v2 offset:47104
v_mfma_f32_16x16x32_bf16 v[28:31], a[84:87], v[100:103], v[28:31]
s_waitcnt lgkmcnt(8)
v_mul_f32 v200, v200, v58
v_mul_f32_e64 v201, v201, v58
v_mfma_f32_16x16x32_bf16 v[36:39], a[88:91], v[100:103], v[36:39]
ds_read_b64_tr_b16 a[112:113], v3 offset:45056
v_mul_f32_e64 v202, v202, v58
v_mfma_f32_16x16x32_bf16 v[32:35], a[88:91], v[68:71], v[32:35]
v_mul_f32 v203, v203, v58
v_mul_f32 v204, v204, v58
v_mfma_f32_16x16x32_bf16 v[40:43], a[92:95], v[68:71], v[40:43]
v_mul_f32 v205, v205, v58
v_mul_f32 v206, v206, v58
v_mfma_f32_16x16x32_bf16 v[44:47], a[92:95], v[100:103], v[44:47]
s_waitcnt lgkmcnt(7)
v_mul_f32 v207, v207, v58
v_cvt_pk_bf16_f32 v84, v200, v201
v_mfma_f32_16x16x32_bf16 v[52:55], a[96:99], v[100:103], v[52:55]
v_cvt_pk_bf16_f32 v85, v202, v203
v_cvt_pk_bf16_f32 v86, v204, v205
v_mfma_f32_16x16x32_bf16 v[48:51], a[96:99], v[68:71], v[48:51]
s_waitcnt lgkmcnt(5)
ds_read_b64_tr_b16 a[114:115], v3 offset:47104
v_cvt_pk_bf16_f32 v87, v206, v207
v_mul_f32 v232, v232, v59
v_mul_f32 v233, v233, v59
v_mul_f32 v234, v234, v59
v_mul_f32_e64 v235, v235, v59
v_mfma_f32_16x16x32_bf16 v[24:27], a[100:103], v[84:87], v[24:27]
v_mul_f32 v236, v236, v59
v_mul_f32 v237, v237, v59
v_mul_f32 v238, v238, v59
v_mul_f32 v239, v239, v59
v_cvt_pk_bf16_f32 v116, v232, v233
v_cvt_pk_bf16_f32 v117, v234, v235
ds_read_b64_tr_b16 a[116:117], v0 offset:49152
ds_read_b64_tr_b16 a[118:119], v0 offset:51200
v_cvt_pk_bf16_f32 v118, v236, v237
v_cvt_pk_bf16_f32 v119, v238, v239
ds_read_b64_tr_b16 a[120:121], v1 offset:49152
ds_read_b64_tr_b16 a[122:123], v1 offset:51200
ds_read_b64_tr_b16 a[124:125], v2 offset:49152
ds_read_b64_tr_b16 a[126:127], v2 offset:51200
v_mfma_f32_16x16x32_bf16 v[28:31], a[100:103], v[116:119], v[28:31]
s_waitcnt lgkmcnt(8)
v_mul_f32 v144, v144, v56
v_mul_f32_e64 v145, v145, v56
v_mfma_f32_16x16x32_bf16 v[36:39], a[104:107], v[116:119], v[36:39]
ds_read_b64_tr_b16 a[128:129], v3 offset:49152
v_mul_f32_e64 v146, v146, v56
v_mfma_f32_16x16x32_bf16 v[32:35], a[104:107], v[84:87], v[32:35]
v_mul_f32 v147, v147, v56
v_mul_f32 v148, v148, v56
v_mfma_f32_16x16x32_bf16 v[40:43], a[108:111], v[84:87], v[40:43]
v_mul_f32 v149, v149, v56
v_mul_f32 v150, v150, v56
v_mfma_f32_16x16x32_bf16 v[44:47], a[108:111], v[116:119], v[44:47]
s_waitcnt lgkmcnt(7)
v_mul_f32 v151, v151, v56
v_cvt_pk_bf16_f32 v72, v144, v145
v_mfma_f32_16x16x32_bf16 v[52:55], a[112:115], v[116:119], v[52:55]
v_cvt_pk_bf16_f32 v73, v146, v147
v_cvt_pk_bf16_f32 v74, v148, v149
v_mfma_f32_16x16x32_bf16 v[48:51], a[112:115], v[84:87], v[48:51]
buffer_load_dwordx4 v19, s[20:23], s57 offen lds
v_cvt_pk_bf16_f32 v75, v150, v151
s_add_u32 m0, s4, 20480
s_mov_b32 s57, 512
ds_read_b64_tr_b16 a[130:131], v3 offset:51200
v_mul_f32_e64 v176, v176, v57
v_mul_f32 v177, v177, v57
s_waitcnt lgkmcnt(6)
v_mfma_f32_16x16x32_bf16 v[24:27], a[116:119], v[72:75], v[24:27]
buffer_load_dwordx4 v19, s[20:23], s58 offen lds
v_mul_f32_e64 v178, v178, v57
s_add_u32 m0, s4, 24576
s_mov_b32 s58, 147968
v_mul_f32 v179, v179, v57
v_mul_f32 v180, v180, v57
v_mul_f32_e64 v181, v181, v57
buffer_load_dwordx4 v19, s[20:23], s59 offen lds
v_mul_f32 v182, v182, v57
v_mul_f32 v183, v183, v57
v_cvt_pk_bf16_f32 v104, v176, v177
s_add_u32 m0, s4, 28672
s_mov_b32 s59, 37376
v_cvt_pk_bf16_f32 v105, v178, v179
v_cvt_pk_bf16_f32 v106, v180, v181
v_cvt_pk_bf16_f32 v107, v182, v183
ds_read_b64_tr_b16 a[84:85], v0 offset:53248
ds_read_b64_tr_b16 a[86:87], v0 offset:55296
ds_read_b64_tr_b16 a[88:89], v1 offset:53248
buffer_load_dwordx4 v19, s[20:23], s56 offen lds
v_mfma_f32_16x16x32_bf16 v[28:31], a[116:119], v[104:107], v[28:31]
s_waitcnt lgkmcnt(5)
s_add_u32 m0, s4, 32768
s_mov_b32 s56, 184832
ds_read_b64_tr_b16 a[90:91], v1 offset:55296
v_mfma_f32_16x16x32_bf16 v[36:39], a[120:123], v[104:107], v[36:39]
ds_read_b64_tr_b16 a[92:93], v2 offset:53248
ds_read_b64_tr_b16 a[94:95], v2 offset:55296
v_mfma_f32_16x16x32_bf16 v[32:35], a[120:123], v[72:75], v[32:35]
v_mul_f32 v208, v208, v58
v_mul_f32_e64 v209, v209, v58
v_mfma_f32_16x16x32_bf16 v[40:43], a[124:127], v[72:75], v[40:43]
v_mul_f32 v210, v210, v58
v_mul_f32 v211, v211, v58
v_mfma_f32_16x16x32_bf16 v[44:47], a[124:127], v[104:107], v[44:47]
s_waitcnt lgkmcnt(6)
v_mul_f32 v212, v212, v58
v_mul_f32_e64 v213, v213, v58
v_mfma_f32_16x16x32_bf16 v[52:55], a[128:131], v[104:107], v[52:55]
v_mul_f32 v214, v214, v58
v_mul_f32 v215, v215, v58
v_mfma_f32_16x16x32_bf16 v[48:51], a[128:131], v[72:75], v[48:51]
v_cvt_pk_bf16_f32 v88, v208, v209
v_cvt_pk_bf16_f32 v89, v210, v211
ds_read_b64_tr_b16 a[96:97], v3 offset:53248
ds_read_b64_tr_b16 a[98:99], v3 offset:55296
v_cvt_pk_bf16_f32 v90, v212, v213
v_cvt_pk_bf16_f32 v91, v214, v215
v_mul_f32 v240, v240, v59
v_mul_f32 v241, v241, v59
v_mul_f32_e64 v242, v242, v59
v_mul_f32 v243, v243, v59
s_waitcnt lgkmcnt(6)
v_mfma_f32_16x16x32_bf16 v[24:27], a[84:87], v[88:91], v[24:27]
v_mul_f32 v244, v244, v59
v_mul_f32 v245, v245, v59
v_mul_f32 v246, v246, v59
v_mul_f32 v247, v247, v59
v_cvt_pk_bf16_f32 v120, v240, v241
v_cvt_pk_bf16_f32 v121, v242, v243
ds_read_b64_tr_b16 a[100:101], v0 offset:57344
ds_read_b64_tr_b16 a[102:103], v0 offset:59392
v_cvt_pk_bf16_f32 v122, v244, v245
v_cvt_pk_bf16_f32 v123, v246, v247
ds_read_b64_tr_b16 a[104:105], v1 offset:57344
ds_read_b64_tr_b16 a[106:107], v1 offset:59392
ds_read_b64_tr_b16 a[108:109], v2 offset:57344
ds_read_b64_tr_b16 a[110:111], v2 offset:59392
v_mfma_f32_16x16x32_bf16 v[28:31], a[84:87], v[120:123], v[28:31]
s_waitcnt lgkmcnt(10)
v_mul_f32 v152, v152, v56
v_mul_f32_e64 v153, v153, v56
v_mfma_f32_16x16x32_bf16 v[36:39], a[88:91], v[120:123], v[36:39]
ds_read_b64_tr_b16 a[112:113], v3 offset:57344
v_mul_f32_e64 v154, v154, v56
v_mfma_f32_16x16x32_bf16 v[32:35], a[88:91], v[88:91], v[32:35]
s_waitcnt lgkmcnt(9)
v_mul_f32 v155, v155, v56
v_mul_f32_e64 v156, v156, v56
v_mfma_f32_16x16x32_bf16 v[40:43], a[92:95], v[88:91], v[40:43]
v_mul_f32 v157, v157, v56
v_mul_f32 v158, v158, v56
v_mfma_f32_16x16x32_bf16 v[44:47], a[92:95], v[120:123], v[44:47]
s_waitcnt lgkmcnt(7)
v_mul_f32 v159, v159, v56
v_cvt_pk_bf16_f32 v76, v152, v153
v_mfma_f32_16x16x32_bf16 v[52:55], a[96:99], v[120:123], v[52:55]
v_cvt_pk_bf16_f32 v77, v154, v155
v_cvt_pk_bf16_f32 v78, v156, v157
v_mfma_f32_16x16x32_bf16 v[48:51], a[96:99], v[88:91], v[48:51]
s_waitcnt lgkmcnt(5)
ds_read_b64_tr_b16 a[114:115], v3 offset:59392
v_cvt_pk_bf16_f32 v79, v158, v159
v_mul_f32 v184, v184, v57
v_mul_f32 v185, v185, v57
v_mul_f32 v186, v186, v57
v_mul_f32_e64 v187, v187, v57
v_mfma_f32_16x16x32_bf16 v[24:27], a[100:103], v[76:79], v[24:27]
s_waitcnt vmcnt(23)
s_barrier
v_mul_f32 v188, v188, v57
v_mul_f32 v189, v189, v57
v_mul_f32 v190, v190, v57
v_mul_f32 v191, v191, v57
v_cvt_pk_bf16_f32 v108, v184, v185
v_cvt_pk_bf16_f32 v109, v186, v187
ds_read_b64_tr_b16 a[116:117], v0 offset:61440
ds_read_b64_tr_b16 a[118:119], v0 offset:63488
v_cvt_pk_bf16_f32 v110, v188, v189
v_cvt_pk_bf16_f32 v111, v190, v191
ds_read_b64_tr_b16 a[120:121], v1 offset:61440
ds_read_b64_tr_b16 a[122:123], v1 offset:63488
ds_read_b64_tr_b16 a[124:125], v2 offset:61440
ds_read_b64_tr_b16 a[126:127], v2 offset:63488
v_mfma_f32_16x16x32_bf16 v[28:31], a[100:103], v[108:111], v[28:31]
s_waitcnt lgkmcnt(8)
v_mul_f32 v216, v216, v58
v_mul_f32_e64 v217, v217, v58
v_mfma_f32_16x16x32_bf16 v[36:39], a[104:107], v[108:111], v[36:39]
ds_read_b64_tr_b16 a[128:129], v3 offset:61440
v_mul_f32_e64 v218, v218, v58
v_mfma_f32_16x16x32_bf16 v[32:35], a[104:107], v[76:79], v[32:35]
v_mul_f32 v219, v219, v58
v_mul_f32 v220, v220, v58
v_mfma_f32_16x16x32_bf16 v[40:43], a[108:111], v[76:79], v[40:43]
v_mul_f32 v221, v221, v58
v_mul_f32 v222, v222, v58
v_mfma_f32_16x16x32_bf16 v[44:47], a[108:111], v[108:111], v[44:47]
s_waitcnt lgkmcnt(7)
v_mul_f32 v223, v223, v58
v_cvt_pk_bf16_f32 v92, v216, v217
v_mfma_f32_16x16x32_bf16 v[52:55], a[112:115], v[108:111], v[52:55]
v_cvt_pk_bf16_f32 v93, v218, v219
v_cvt_pk_bf16_f32 v94, v220, v221
v_mfma_f32_16x16x32_bf16 v[48:51], a[112:115], v[76:79], v[48:51]
s_waitcnt lgkmcnt(5)
ds_read_b64_tr_b16 a[130:131], v3 offset:63488
v_cvt_pk_bf16_f32 v95, v222, v223
v_mul_f32 v248, v248, v59
v_mul_f32 v249, v249, v59
v_mul_f32 v250, v250, v59
v_mul_f32_e64 v251, v251, v59
v_mfma_f32_16x16x32_bf16 v[24:27], a[116:119], v[92:95], v[24:27]
v_mul_f32 v252, v252, v59
v_mul_f32 v253, v253, v59
v_mul_f32_e64 v254, v254, v59
v_mul_f32 v255, v255, v59
v_cvt_pk_bf16_f32 v124, v248, v249
v_cvt_pk_bf16_f32 v125, v250, v251
ds_read_b64_tr_b16 a[84:85], v4 offset:0
ds_read_b64_tr_b16 a[86:87], v4 offset:2048
v_cvt_pk_bf16_f32 v126, v252, v253
v_cvt_pk_bf16_f32 v127, v254, v255
ds_read_b64_tr_b16 a[88:89], v5 offset:0
ds_read_b64_tr_b16 a[90:91], v5 offset:2048
ds_read_b64_tr_b16 a[92:93], v6 offset:0
ds_read_b64_tr_b16 a[94:95], v6 offset:2048
v_mfma_f32_16x16x32_bf16 v[28:31], a[116:119], v[124:127], v[28:31]
s_waitcnt lgkmcnt(8)
ds_read_b64_tr_b16 a[96:97], v7 offset:0
ds_read_b64_tr_b16 a[98:99], v7 offset:2048
v_mfma_f32_16x16x32_bf16 v[36:39], a[120:123], v[124:127], v[36:39]
ds_read_b64_tr_b16 a[100:101], v4 offset:4096
ds_read_b64_tr_b16 a[102:103], v4 offset:6144
v_mfma_f32_16x16x32_bf16 v[32:35], a[120:123], v[92:95], v[32:35]
ds_read_b64_tr_b16 a[104:105], v5 offset:4096
ds_read_b64_tr_b16 a[106:107], v5 offset:6144
v_mfma_f32_16x16x32_bf16 v[40:43], a[124:127], v[92:95], v[40:43]
ds_read_b64_tr_b16 a[108:109], v6 offset:4096
ds_read_b64_tr_b16 a[110:111], v6 offset:6144
v_mfma_f32_16x16x32_bf16 v[44:47], a[124:127], v[124:127], v[44:47]
s_waitcnt lgkmcnt(14)
ds_read_b64_tr_b16 a[112:113], v7 offset:4096
ds_read_b64_tr_b16 a[114:115], v7 offset:6144
v_mfma_f32_16x16x32_bf16 v[52:55], a[128:131], v[124:127], v[52:55]
ds_read_b64_tr_b16 a[116:117], v4 offset:8192
ds_read_b64_tr_b16 a[118:119], v4 offset:10240
v_mfma_f32_16x16x32_bf16 v[48:51], a[128:131], v[92:95], v[48:51]
s_waitcnt lgkmcnt(15)
ds_read_b64_tr_b16 a[120:121], v5 offset:8192
buffer_load_dwordx4 v19, s[20:23], s57 offen lds
v_mfma_f32_16x16x32_bf16 v[128:131], a[84:87], v[64:67], 0
s_add_u32 m0, s4, 36864
s_mov_b32 s57, 74240
ds_read_b64_tr_b16 a[122:123], v5 offset:10240
v_mfma_f32_16x16x32_bf16 v[132:135], a[84:87], v[96:99], 0
s_waitcnt lgkmcnt(14)
ds_read_b64_tr_b16 a[124:125], v6 offset:8192
buffer_load_dwordx4 v19, s[20:23], s58 offen lds
v_mfma_f32_16x16x32_bf16 v[140:143], a[88:91], v[96:99], 0
s_add_u32 m0, s4, 40960
s_mov_b32 s58, 221696
ds_read_b64_tr_b16 a[126:127], v6 offset:10240
v_mfma_f32_16x16x32_bf16 v[136:139], a[88:91], v[64:67], 0
ds_read_b64_tr_b16 a[128:129], v7 offset:8192
buffer_load_dwordx4 v19, s[20:23], s59 offen lds
v_mfma_f32_16x16x32_bf16 v[144:147], a[92:95], v[64:67], 0
s_add_u32 m0, s4, 45056
s_mov_b32 s59, 111104
ds_read_b64_tr_b16 a[130:131], v7 offset:10240
v_mfma_f32_16x16x32_bf16 v[148:151], a[92:95], v[96:99], 0
s_waitcnt lgkmcnt(10)
ds_read_b64_tr_b16 a[84:85], v4 offset:12288
buffer_load_dwordx4 v19, s[20:23], s56 offen lds
v_mfma_f32_16x16x32_bf16 v[156:159], a[96:99], v[96:99], 0
s_add_u32 m0, s4, 49152
s_mov_b32 s56, 258560
ds_read_b64_tr_b16 a[86:87], v4 offset:14336
v_mfma_f32_16x16x32_bf16 v[152:155], a[96:99], v[64:67], 0
ds_read_b64_tr_b16 a[88:89], v5 offset:12288
ds_read_b64_tr_b16 a[90:91], v5 offset:14336
v_mfma_f32_16x16x32_bf16 v[128:131], a[100:103], v[80:83], v[128:131]
ds_read_b64_tr_b16 a[92:93], v6 offset:12288
ds_read_b64_tr_b16 a[94:95], v6 offset:14336
v_mfma_f32_16x16x32_bf16 v[132:135], a[100:103], v[112:115], v[132:135]
ds_read_b64_tr_b16 a[96:97], v7 offset:12288
ds_read_b64_tr_b16 a[98:99], v7 offset:14336
v_mfma_f32_16x16x32_bf16 v[140:143], a[104:107], v[112:115], v[140:143]
v_cmp_nlt_f32_e64 s[64:65], |v24|, s66
v_mov_b32 v230, s68
v_mfma_f32_16x16x32_bf16 v[136:139], a[104:107], v[80:83], v[136:139]
s_or_b64 s[62:63], s[62:63], s[64:65]
v_cmp_nlt_f32_e64 s[64:65], |v28|, s66
v_mfma_f32_16x16x32_bf16 v[144:147], a[108:111], v[80:83], v[144:147]
s_or_b64 s[62:63], s[62:63], s[64:65]
s_or_b32 s62, s62, s63
v_mov_b32_e64 v229, s62
v_mfma_f32_16x16x32_bf16 v[148:151], a[108:111], v[112:115], v[148:151]
s_waitcnt lgkmcnt(8)
ds_write_b32 v230, v229
v_mfma_f32_16x16x32_bf16 v[156:159], a[112:115], v[112:115], v[156:159]
v_cvt_pk_bf16_f32 v192, v24, v25
v_cvt_pk_bf16_f32 v193, v26, v27
v_mfma_f32_16x16x32_bf16 v[152:155], a[112:115], v[80:83], v[152:155]
s_lshr_b32 s70, s6, 2
s_lshl_b32 s49, s7, 13
v_cvt_pk_bf16_f32 v196, v28, v29
v_mfma_f32_16x16x32_bf16 v[128:131], a[116:119], v[68:71], v[128:131]
s_waitcnt vmcnt(20)
s_barrier
ds_read_b64_tr_b16 a[100:101], v4 offset:16384
ds_read_b64_tr_b16 a[102:103], v4 offset:18432
v_mfma_f32_16x16x32_bf16 v[132:135], a[116:119], v[100:103], v[132:135]
s_sub_u32 s12, s28, 16777216
s_subb_u32 s13, s29, 0
ds_read_b64_tr_b16 a[104:105], v5 offset:16384
ds_read_b64_tr_b16 a[106:107], v5 offset:18432
v_mfma_f32_16x16x32_bf16 v[140:143], a[120:123], v[100:103], v[140:143]
s_mov_b32 s14, 16777216
ds_read_b64_tr_b16 a[108:109], v6 offset:16384
ds_read_b64_tr_b16 a[110:111], v6 offset:18432
v_mfma_f32_16x16x32_bf16 v[136:139], a[120:123], v[68:71], v[136:139]
s_add_u32 s49, s49, 3145728
ds_read_b64_tr_b16 a[112:113], v7 offset:16384
ds_read_b64_tr_b16 a[114:115], v7 offset:18432
v_mfma_f32_16x16x32_bf16 v[144:147], a[124:127], v[68:71], v[144:147]
s_mov_b32 s69, 0x8000
ds_read_b64_tr_b16 a[116:117], v4 offset:20480
ds_read_b64_tr_b16 a[118:119], v4 offset:22528
v_mfma_f32_16x16x32_bf16 v[148:151], a[124:127], v[100:103], v[148:151]
s_mov_b64 s[16:17], s[100:101]
ds_read_b64_tr_b16 a[120:121], v5 offset:20480
ds_read_b64_tr_b16 a[122:123], v5 offset:22528
v_mfma_f32_16x16x32_bf16 v[156:159], a[128:131], v[100:103], v[156:159]
s_mov_b32 s18, 2359296
ds_read_b64_tr_b16 a[124:125], v6 offset:20480
ds_read_b64_tr_b16 a[126:127], v6 offset:22528
v_mfma_f32_16x16x32_bf16 v[152:155], a[128:131], v[68:71], v[152:155]
s_waitcnt lgkmcnt(14)
ds_read_b64_tr_b16 a[128:129], v7 offset:20480
ds_read_b64_tr_b16 a[130:131], v7 offset:22528
v_mfma_f32_16x16x32_bf16 v[128:131], a[84:87], v[84:87], v[128:131]
v_cvt_pk_bf16_f32 v197, v30, v31
v_cvt_pk_bf16_f32 v198, v36, v37
v_mfma_f32_16x16x32_bf16 v[132:135], a[84:87], v[116:119], v[132:135]
s_mul_i32 s72, s2, 147456
ds_read_b64_tr_b16 a[84:85], v4 offset:24576
ds_read_b64_tr_b16 a[86:87], v4 offset:26624
v_mfma_f32_16x16x32_bf16 v[140:143], a[88:91], v[116:119], v[140:143]
s_lshl_b32 s73, s3, 9
v_cvt_pk_bf16_f32 v194, v32, v33
v_cvt_pk_bf16_f32 v199, v38, v39
v_mfma_f32_16x16x32_bf16 v[136:139], a[88:91], v[84:87], v[136:139]
s_add_u32 s72, s72, s73
ds_read_b64_tr_b16 a[88:89], v5 offset:24576
buffer_store_dwordx4 v[196:199], v20, s[28:31], s53 offen offset:0 sc1
v_mfma_f32_16x16x32_bf16 v[144:147], a[92:95], v[84:87], v[144:147]
ds_read_b64_tr_b16 a[90:91], v5 offset:26624
v_cvt_pk_bf16_f32 v195, v34, v35
v_mfma_f32_16x16x32_bf16 v[148:151], a[92:95], v[116:119], v[148:151]
ds_read_b64_tr_b16 a[92:93], v6 offset:24576
buffer_store_dwordx4 v[192:195], v20, s[28:31], s50 offen offset:0 sc1
v_mfma_f32_16x16x32_bf16 v[156:159], a[96:99], v[116:119], v[156:159]
ds_read_b64_tr_b16 a[94:95], v6 offset:26624
v_cvt_pk_bf16_f32 v200, v40, v41
v_mfma_f32_16x16x32_bf16 v[152:155], a[96:99], v[84:87], v[152:155]
s_waitcnt lgkmcnt(8)
ds_read_b64_tr_b16 a[96:97], v7 offset:24576
buffer_load_dwordx4 v19, s[20:23], s57 offen lds
v_mfma_f32_16x16x32_bf16 v[128:131], a[100:103], v[72:75], v[128:131]
s_add_u32 m0, s4, 53248
s_movk_i32 s57, 640
ds_read_b64_tr_b16 a[98:99], v7 offset:26624
v_mfma_f32_16x16x32_bf16 v[132:135], a[100:103], v[104:107], v[132:135]
ds_read_b64_tr_b16 a[100:101], v4 offset:28672
buffer_load_dwordx4 v19, s[20:23], s58 offen lds
v_mfma_f32_16x16x32_bf16 v[140:143], a[104:107], v[104:107], v[140:143]
s_add_u32 m0, s4, 57344
s_mov_b32 s58, 148096
ds_read_b64_tr_b16 a[102:103], v4 offset:30720
v_mfma_f32_16x16x32_bf16 v[136:139], a[104:107], v[72:75], v[136:139]
ds_read_b64_tr_b16 a[104:105], v5 offset:28672
buffer_load_dwordx4 v19, s[20:23], s59 offen lds
v_mfma_f32_16x16x32_bf16 v[144:147], a[108:111], v[72:75], v[144:147]
s_add_u32 m0, s4, 61440
s_mov_b32 s59, 37504
ds_read_b64_tr_b16 a[106:107], v5 offset:30720
v_mfma_f32_16x16x32_bf16 v[148:151], a[108:111], v[104:107], v[148:151]
ds_read_b64_tr_b16 a[108:109], v6 offset:28672
buffer_load_dwordx4 v19, s[20:23], s56 offen lds
v_mfma_f32_16x16x32_bf16 v[156:159], a[112:115], v[104:107], v[156:159]
s_add_u32 m0, s4, 65536
s_mov_b32 s56, 184960
ds_read_b64_tr_b16 a[110:111], v6 offset:30720
v_mfma_f32_16x16x32_bf16 v[152:155], a[112:115], v[72:75], v[152:155]
ds_read_b64_tr_b16 a[112:113], v7 offset:28672
ds_read_b64_tr_b16 a[114:115], v7 offset:30720
v_mfma_f32_16x16x32_bf16 v[128:131], a[116:119], v[88:91], v[128:131]
v_cvt_pk_bf16_f32 v201, v42, v43
v_cvt_pk_bf16_f32 v204, v44, v45
v_mfma_f32_16x16x32_bf16 v[132:135], a[116:119], v[120:123], v[132:135]
v_cvt_pk_bf16_f32 v205, v46, v47
v_mfma_f32_16x16x32_bf16 v[140:143], a[120:123], v[120:123], v[140:143]
v_cvt_pk_bf16_f32 v206, v52, v53
v_cvt_pk_bf16_f32 v207, v54, v55
v_mfma_f32_16x16x32_bf16 v[136:139], a[120:123], v[88:91], v[136:139]
buffer_store_dwordx4 v[204:207], v20, s[28:31], s53 offen offset:512 sc1
v_cvt_pk_bf16_f32 v202, v48, v49
v_mfma_f32_16x16x32_bf16 v[144:147], a[124:127], v[88:91], v[144:147]
v_cvt_pk_bf16_f32 v203, v50, v51
v_mov_b32 v231, 155904
v_mfma_f32_16x16x32_bf16 v[148:151], a[124:127], v[120:123], v[148:151]
s_waitcnt lgkmcnt(4)
buffer_store_dwordx4 v[200:203], v20, s[28:31], s50 offen offset:512 sc1
v_mbcnt_lo_u32_b32 v60, -1, 0
v_mfma_f32_16x16x32_bf16 v[156:159], a[128:131], v[120:123], v[156:159]
v_mbcnt_hi_u32_b32 v60, -1, v60
v_lshrrev_b32 v61, 4, v60
v_mfma_f32_16x16x32_bf16 v[152:155], a[128:131], v[88:91], v[152:155]
v_min_u32_e64 v61, 1, v61
v_mfma_f32_16x16x32_bf16 v[128:131], a[84:87], v[76:79], v[128:131]
s_waitcnt vmcnt(24)
s_barrier
ds_read_b64_tr_b16 a[116:117], v4 offset:32768
ds_read_b64_tr_b16 a[118:119], v4 offset:34816
v_mfma_f32_16x16x32_bf16 v[132:135], a[84:87], v[108:111], v[132:135]
ds_read_b64_tr_b16 a[120:121], v5 offset:32768
ds_read_b64_tr_b16 a[122:123], v5 offset:34816
v_mfma_f32_16x16x32_bf16 v[140:143], a[88:91], v[108:111], v[140:143]
ds_read_b64_tr_b16 a[124:125], v6 offset:32768
ds_read_b64_tr_b16 a[126:127], v6 offset:34816
v_mfma_f32_16x16x32_bf16 v[136:139], a[88:91], v[76:79], v[136:139]
ds_read_b64_tr_b16 a[128:129], v7 offset:32768
ds_read_b64_tr_b16 a[130:131], v7 offset:34816
v_mfma_f32_16x16x32_bf16 v[144:147], a[92:95], v[76:79], v[144:147]
ds_read_b64_tr_b16 a[84:85], v4 offset:36864
ds_read_b64_tr_b16 a[86:87], v4 offset:38912
v_mfma_f32_16x16x32_bf16 v[148:151], a[92:95], v[108:111], v[148:151]
ds_read_b64_tr_b16 a[88:89], v5 offset:36864
ds_read_b64_tr_b16 a[90:91], v5 offset:38912
v_mfma_f32_16x16x32_bf16 v[156:159], a[96:99], v[108:111], v[156:159]
ds_read_b64_tr_b16 a[92:93], v6 offset:36864
ds_read_b64_tr_b16 a[94:95], v6 offset:38912
v_mfma_f32_16x16x32_bf16 v[152:155], a[96:99], v[76:79], v[152:155]
s_lshl_b32 s73, s3, 6
ds_read_b64_tr_b16 a[96:97], v7 offset:36864
ds_read_b64_tr_b16 a[98:99], v7 offset:38912
v_mfma_f32_16x16x32_bf16 v[128:131], a[100:103], v[92:95], v[128:131]
ds_read_b128 v[232:235], v231
v_lshlrev_b32 v61, 30, v61
v_mfma_f32_16x16x32_bf16 v[132:135], a[100:103], v[124:127], v[132:135]
ds_read_b64_tr_b16 a[100:101], v4 offset:40960
ds_read_b64_tr_b16 a[102:103], v4 offset:43008
v_mfma_f32_16x16x32_bf16 v[140:143], a[104:107], v[124:127], v[140:143]
s_nop 1
v_cvt_pk_bf16_f32 v208, v128, v129
v_cvt_pk_bf16_f32 v209, v130, v131
v_mfma_f32_16x16x32_bf16 v[136:139], a[104:107], v[92:95], v[136:139]
s_waitcnt lgkmcnt(13)
ds_read_b64_tr_b16 a[104:105], v5 offset:40960
ds_read_b64_tr_b16 a[106:107], v5 offset:43008
v_mfma_f32_16x16x32_bf16 v[144:147], a[108:111], v[92:95], v[144:147]
v_cvt_pk_bf16_f32 v212, v132, v133
v_cvt_pk_bf16_f32 v213, v134, v135
v_mfma_f32_16x16x32_bf16 v[148:151], a[108:111], v[124:127], v[148:151]
ds_read_b64_tr_b16 a[108:109], v6 offset:40960
ds_read_b64_tr_b16 a[110:111], v6 offset:43008
v_mfma_f32_16x16x32_bf16 v[156:159], a[112:115], v[124:127], v[156:159]
v_cvt_pk_bf16_f32 v214, v140, v141
v_cvt_pk_bf16_f32 v215, v142, v143
v_mfma_f32_16x16x32_bf16 v[152:155], a[112:115], v[92:95], v[152:155]
ds_read_b64_tr_b16 a[112:113], v7 offset:40960
buffer_load_dwordx4 v19, s[20:23], s57 offen lds
v_mfma_f32_16x16x32_bf16 v[24:27], a[116:119], v[64:67], 0
s_add_u32 m0, s4, 69632
s_mov_b32 s57, 74368
ds_read_b64_tr_b16 a[114:115], v7 offset:43008
v_mfma_f32_16x16x32_bf16 v[28:31], a[116:119], v[96:99], 0
ds_read_b64_tr_b16 a[116:117], v4 offset:45056
buffer_load_dwordx4 v19, s[20:23], s58 offen lds
v_mfma_f32_16x16x32_bf16 v[36:39], a[120:123], v[96:99], 0
s_add_u32 m0, s4, 73728
s_mov_b32 s58, 221824
ds_read_b64_tr_b16 a[118:119], v4 offset:47104
v_mfma_f32_16x16x32_bf16 v[32:35], a[120:123], v[64:67], 0
ds_read_b64_tr_b16 a[120:121], v5 offset:45056
buffer_load_dwordx4 v19, s[20:23], s59 offen lds
v_mfma_f32_16x16x32_bf16 v[40:43], a[124:127], v[64:67], 0
s_add_u32 m0, s4, 77824
s_mov_b32 s59, 111232
ds_read_b64_tr_b16 a[122:123], v5 offset:47104
v_mfma_f32_16x16x32_bf16 v[44:47], a[124:127], v[96:99], 0
s_waitcnt lgkmcnt(8)
ds_read_b64_tr_b16 a[124:125], v6 offset:45056
buffer_load_dwordx4 v19, s[20:23], s56 offen lds
v_mfma_f32_16x16x32_bf16 v[52:55], a[128:131], v[96:99], 0
s_add_u32 m0, s4, 81920
s_mov_b32 s56, 258688
buffer_store_dwordx4 v[212:215], v20, s[28:31], s53 offen offset:1024 sc1
v_mfma_f32_16x16x32_bf16 v[48:51], a[128:131], v[64:67], 0
ds_read_b64_tr_b16 a[126:127], v6 offset:47104
ds_read_b64_tr_b16 a[128:129], v7 offset:45056
v_mfma_f32_16x16x32_bf16 v[24:27], a[84:87], v[80:83], v[24:27]
ds_read_b64_tr_b16 a[130:131], v7 offset:47104
v_cvt_pk_bf16_f32 v210, v136, v137
v_mfma_f32_16x16x32_bf16 v[28:31], a[84:87], v[112:115], v[28:31]
v_cvt_pk_bf16_f32 v211, v138, v139
v_cvt_pk_bf16_f32 v216, v144, v145
v_mfma_f32_16x16x32_bf16 v[36:39], a[88:91], v[112:115], v[36:39]
buffer_store_dwordx4 v[208:211], v20, s[28:31], s50 offen offset:1024 sc1
v_cvt_pk_bf16_f32 v217, v146, v147
v_mfma_f32_16x16x32_bf16 v[32:35], a[88:91], v[80:83], v[32:35]
v_cvt_pk_bf16_f32 v220, v148, v149
v_cvt_pk_bf16_f32 v221, v150, v151
v_mfma_f32_16x16x32_bf16 v[40:43], a[92:95], v[80:83], v[40:43]
v_cvt_pk_bf16_f32 v222, v156, v157
v_mfma_f32_16x16x32_bf16 v[44:47], a[92:95], v[112:115], v[44:47]
v_cvt_pk_bf16_f32 v218, v152, v153
v_cvt_pk_bf16_f32 v223, v158, v159
v_mfma_f32_16x16x32_bf16 v[52:55], a[96:99], v[112:115], v[52:55]
buffer_store_dwordx4 v[220:223], v20, s[28:31], s53 offen offset:1536 sc1
v_cvt_pk_bf16_f32 v219, v154, v155
v_mfma_f32_16x16x32_bf16 v[48:51], a[96:99], v[80:83], v[48:51]
buffer_store_dwordx4 v[216:219], v20, s[28:31], s50 offen offset:1536 sc1
v_or_b32_e64 v232, v232, v233
v_mfma_f32_16x16x32_bf16 v[24:27], a[100:103], v[68:71], v[24:27]
s_waitcnt vmcnt(28)
s_barrier
ds_read_b64_tr_b16 a[84:85], v4 offset:49152
ds_read_b64_tr_b16 a[86:87], v4 offset:51200
v_mfma_f32_16x16x32_bf16 v[28:31], a[100:103], v[100:103], v[28:31]
ds_read_b64_tr_b16 a[88:89], v5 offset:49152
ds_read_b64_tr_b16 a[90:91], v5 offset:51200
v_mfma_f32_16x16x32_bf16 v[36:39], a[104:107], v[100:103], v[36:39]
ds_read_b64_tr_b16 a[92:93], v6 offset:49152
ds_read_b64_tr_b16 a[94:95], v6 offset:51200
v_mfma_f32_16x16x32_bf16 v[32:35], a[104:107], v[68:71], v[32:35]
s_waitcnt lgkmcnt(6)
ds_read_b64_tr_b16 a[96:97], v7 offset:49152
ds_read_b64_tr_b16 a[98:99], v7 offset:51200
v_mfma_f32_16x16x32_bf16 v[40:43], a[108:111], v[68:71], v[40:43]
ds_read_b64_tr_b16 a[100:101], v4 offset:53248
ds_read_b64_tr_b16 a[102:103], v4 offset:55296
v_mfma_f32_16x16x32_bf16 v[44:47], a[108:111], v[100:103], v[44:47]
ds_read_b64_tr_b16 a[104:105], v5 offset:53248
ds_read_b64_tr_b16 a[106:107], v5 offset:55296
v_mfma_f32_16x16x32_bf16 v[52:55], a[112:115], v[100:103], v[52:55]
ds_read_b64_tr_b16 a[108:109], v6 offset:53248
ds_read_b64_tr_b16 a[110:111], v6 offset:55296
v_mfma_f32_16x16x32_bf16 v[48:51], a[112:115], v[68:71], v[48:51]
ds_read_b64_tr_b16 a[112:113], v7 offset:53248
ds_read_b64_tr_b16 a[114:115], v7 offset:55296
v_mfma_f32_16x16x32_bf16 v[24:27], a[116:119], v[84:87], v[24:27]
v_or3_b32 v232, v232, v234, v235
s_nop 0
v_readfirstlane_b32 s71, v232
v_mfma_f32_16x16x32_bf16 v[28:31], a[116:119], v[116:119], v[28:31]
s_cmp_lg_u32 s71, 0
s_cbranch_scc1 k1_redo
k1_redor:
ds_read_b64_tr_b16 a[116:117], v4 offset:57344
v_mfma_f32_16x16x32_bf16 v[36:39], a[120:123], v[116:119], v[36:39]
ds_read_b64_tr_b16 a[118:119], v4 offset:59392
v_lshl_add_u32 v10, v60, 9, v61
v_mfma_f32_16x16x32_bf16 v[32:35], a[120:123], v[84:87], v[32:35]
ds_read_b64_tr_b16 a[120:121], v5 offset:57344
ds_read_b64_tr_b16 a[122:123], v5 offset:59392
v_mfma_f32_16x16x32_bf16 v[40:43], a[124:127], v[84:87], v[40:43]
v_min_u32 v60, 1, v60
v_lshlrev_b32 v60, 30, v60
v_mfma_f32_16x16x32_bf16 v[44:47], a[124:127], v[116:119], v[44:47]
ds_read_b64_tr_b16 a[124:125], v6 offset:57344
ds_read_b64_tr_b16 a[126:127], v6 offset:59392
v_mfma_f32_16x16x32_bf16 v[52:55], a[128:131], v[116:119], v[52:55]
v_lshl_add_u32 v60, s6, 9, v60
v_lshl_add_u32 v11, s3, 7, v60
v_mfma_f32_16x16x32_bf16 v[48:51], a[128:131], v[84:87], v[48:51]
s_waitcnt lgkmcnt(8)
ds_read_b64_tr_b16 a[128:129], v7 offset:57344
buffer_load_dwordx4 v19, s[20:23], s57 offen lds
v_mfma_f32_16x16x32_bf16 v[24:27], a[84:87], v[72:75], v[24:27]
s_add_u32 m0, s4, 86016
s_movk_i32 s57, 768
ds_read_b64_tr_b16 a[130:131], v7 offset:59392
v_mfma_f32_16x16x32_bf16 v[28:31], a[84:87], v[104:107], v[28:31]
ds_read_b64_tr_b16 a[84:85], v4 offset:61440
buffer_load_dwordx4 v19, s[20:23], s58 offen lds
v_mfma_f32_16x16x32_bf16 v[36:39], a[88:91], v[104:107], v[36:39]
s_add_u32 m0, s4, 90112
s_mov_b32 s58, 148224
ds_read_b64_tr_b16 a[86:87], v4 offset:63488
v_mfma_f32_16x16x32_bf16 v[32:35], a[88:91], v[72:75], v[32:35]
ds_read_b64_tr_b16 a[88:89], v5 offset:61440
buffer_load_dwordx4 v19, s[20:23], s59 offen lds
v_mfma_f32_16x16x32_bf16 v[40:43], a[92:95], v[72:75], v[40:43]
s_add_u32 m0, s4, 94208
s_mov_b32 s59, 37632
ds_read_b64_tr_b16 a[90:91], v5 offset:63488
v_mfma_f32_16x16x32_bf16 v[44:47], a[92:95], v[104:107], v[44:47]
ds_read_b64_tr_b16 a[92:93], v6 offset:61440
buffer_load_dwordx4 v19, s[20:23], s56 offen lds
v_mfma_f32_16x16x32_bf16 v[52:55], a[96:99], v[104:107], v[52:55]
s_add_u32 m0, s4, 98304
s_mov_b32 s56, 185088
ds_read_b64_tr_b16 a[94:95], v6 offset:63488
v_mfma_f32_16x16x32_bf16 v[48:51], a[96:99], v[72:75], v[48:51]
ds_read_b64_tr_b16 a[96:97], v7 offset:61440
ds_read_b64_tr_b16 a[98:99], v7 offset:63488
v_mfma_f32_16x16x32_bf16 v[24:27], a[100:103], v[88:91], v[24:27]
v_lshl_add_u32 v10, s70, 7, v10
v_mbcnt_lo_u32_b32 v252, -1, 0
v_mfma_f32_16x16x32_bf16 v[28:31], a[100:103], v[120:123], v[28:31]
s_lshr_b32 s70, s3, 1
v_mbcnt_hi_u32_b32 v252, -1, v252
v_mfma_f32_16x16x32_bf16 v[36:39], a[104:107], v[120:123], v[36:39]
v_lshl_add_u32 v252, v252, 4, s4
v_mov_b32 v224, 0x3fb8aa3b
v_mfma_f32_16x16x32_bf16 v[32:35], a[104:107], v[88:91], v[32:35]
v_cmp_gt_u32 vcc, 2304, v252
v_mfma_f32_16x16x32_bf16 v[40:43], a[108:111], v[88:91], v[40:43]
v_mbcnt_lo_u32_b32 v60, -1, 0
v_cndmask_b32_e64 v226, v224, 1.0, vcc
v_mfma_f32_16x16x32_bf16 v[44:47], a[108:111], v[120:123], v[44:47]
s_waitcnt lgkmcnt(4)
v_mbcnt_hi_u32_b32 v60, -1, v60
v_mfma_f32_16x16x32_bf16 v[52:55], a[112:115], v[120:123], v[52:55]
v_cmp_gt_u32 vcc, 2816, v252
v_mov_b32 v254, 154112
v_mfma_f32_16x16x32_bf16 v[48:51], a[112:115], v[88:91], v[48:51]
v_mov_b32 v17, 1
v_mfma_f32_16x16x32_bf16 v[24:27], a[116:119], v[76:79], v[24:27]
s_waitcnt vmcnt(28)
s_barrier
ds_read_b64_tr_b16 a[100:101], v0 offset:0
ds_read_b64_tr_b16 a[102:103], v0 offset:2048
v_mfma_f32_16x16x32_bf16 v[28:31], a[116:119], v[108:111], v[28:31]
ds_read_b64_tr_b16 a[104:105], v1 offset:0
ds_read_b64_tr_b16 a[106:107], v1 offset:2048
v_mfma_f32_16x16x32_bf16 v[36:39], a[120:123], v[108:111], v[36:39]
ds_read_b64_tr_b16 a[108:109], v2 offset:0
ds_read_b64_tr_b16 a[110:111], v2 offset:2048
v_mfma_f32_16x16x32_bf16 v[32:35], a[120:123], v[76:79], v[32:35]
s_waitcnt vmcnt(4)
ds_read_b64_tr_b16 a[112:113], v3 offset:0
buffer_store_dword v17, v11, s[12:15], s49 offen sc1
v_mfma_f32_16x16x32_bf16 v[40:43], a[124:127], v[76:79], v[40:43]
ds_read_b64_tr_b16 a[114:115], v3 offset:2048
ds_read_b64_tr_b16 a[116:117], v0 offset:4096
v_mfma_f32_16x16x32_bf16 v[44:47], a[124:127], v[108:111], v[44:47]
ds_read_b64_tr_b16 a[118:119], v0 offset:6144
ds_read_b64_tr_b16 a[120:121], v1 offset:4096
v_mfma_f32_16x16x32_bf16 v[52:55], a[128:131], v[108:111], v[52:55]
ds_read_b64_tr_b16 a[122:123], v1 offset:6144
ds_read_b64_tr_b16 a[124:125], v2 offset:4096
v_mfma_f32_16x16x32_bf16 v[48:51], a[128:131], v[76:79], v[48:51]
ds_read_b64_tr_b16 a[126:127], v2 offset:6144
ds_read_b64_tr_b16 a[128:129], v3 offset:4096
v_mfma_f32_16x16x32_bf16 v[24:27], a[84:87], v[92:95], v[24:27]
ds_read_b64_tr_b16 a[130:131], v3 offset:6144
v_mov_b32 v255, 139776
v_mfma_f32_16x16x32_bf16 v[28:31], a[84:87], v[124:127], v[28:31]
ds_read_b64_tr_b16 a[84:85], v0 offset:8192
ds_read_b64_tr_b16 a[86:87], v0 offset:10240
v_mfma_f32_16x16x32_bf16 v[36:39], a[88:91], v[124:127], v[36:39]
s_nop 1
v_cvt_pk_bf16_f32 v192, v24, v25
v_cvt_pk_bf16_f32 v193, v26, v27
v_mfma_f32_16x16x32_bf16 v[32:35], a[88:91], v[92:95], v[32:35]
s_waitcnt lgkmcnt(12)
ds_read_b64_tr_b16 a[88:89], v1 offset:8192
ds_read_b64_tr_b16 a[90:91], v1 offset:10240
v_mfma_f32_16x16x32_bf16 v[40:43], a[92:95], v[92:95], v[40:43]
v_cvt_pk_bf16_f32 v196, v28, v29
v_cvt_pk_bf16_f32 v197, v30, v31
v_mfma_f32_16x16x32_bf16 v[44:47], a[92:95], v[124:127], v[44:47]
ds_read_b64_tr_b16 a[92:93], v2 offset:8192
ds_read_b64_tr_b16 a[94:95], v2 offset:10240
v_mfma_f32_16x16x32_bf16 v[52:55], a[96:99], v[124:127], v[52:55]
v_cvt_pk_bf16_f32 v198, v36, v37
v_cvt_pk_bf16_f32 v199, v38, v39
v_mfma_f32_16x16x32_bf16 v[48:51], a[96:99], v[92:95], v[48:51]
ds_read_b64_tr_b16 a[96:97], v3 offset:8192
buffer_load_dwordx4 v19, s[20:23], s57 offen lds
v_mfma_f32_16x16x32_bf16 v[128:131], a[100:103], v[64:67], 0
s_add_u32 m0, s4, 102400
s_mov_b32 s57, 74496
ds_read_b64_tr_b16 a[98:99], v3 offset:10240
v_mfma_f32_16x16x32_bf16 v[132:135], a[100:103], v[96:99], 0
ds_read_b64_tr_b16 a[100:101], v0 offset:12288
buffer_load_dwordx4 v19, s[20:23], s58 offen lds
v_mfma_f32_16x16x32_bf16 v[140:143], a[104:107], v[96:99], 0
s_add_u32 m0, s4, 106496
s_mov_b32 s58, 221952
ds_read_b64_tr_b16 a[102:103], v0 offset:14336
v_mfma_f32_16x16x32_bf16 v[136:139], a[104:107], v[64:67], 0
ds_read_b64_tr_b16 a[104:105], v1 offset:12288
buffer_load_dwordx4 v19, s[20:23], s59 offen lds
v_mfma_f32_16x16x32_bf16 v[144:147], a[108:111], v[64:67], 0
s_add_u32 m0, s4, 110592
s_mov_b32 s59, 111360
ds_read_b64_tr_b16 a[106:107], v1 offset:14336
v_mfma_f32_16x16x32_bf16 v[148:151], a[108:111], v[96:99], 0
s_waitcnt lgkmcnt(8)
ds_read_b64_tr_b16 a[108:109], v2 offset:12288
buffer_load_dwordx4 v19, s[20:23], s56 offen lds
v_mfma_f32_16x16x32_bf16 v[156:159], a[112:115], v[96:99], 0
s_add_u32 m0, s4, 114688
s_mov_b32 s56, 258816
buffer_store_dwordx4 v[196:199], v20, s[28:31], s53 offen offset:2048 sc1
v_mfma_f32_16x16x32_bf16 v[152:155], a[112:115], v[64:67], 0
ds_read_b64_tr_b16 a[110:111], v2 offset:14336
ds_read_b64_tr_b16 a[112:113], v3 offset:12288
v_mfma_f32_16x16x32_bf16 v[128:131], a[116:119], v[80:83], v[128:131]
ds_read_b64_tr_b16 a[114:115], v3 offset:14336
v_cvt_pk_bf16_f32 v194, v32, v33
v_mfma_f32_16x16x32_bf16 v[132:135], a[116:119], v[112:115], v[132:135]
v_cvt_pk_bf16_f32 v195, v34, v35
v_cvt_pk_bf16_f32 v200, v40, v41
v_mfma_f32_16x16x32_bf16 v[140:143], a[120:123], v[112:115], v[140:143]
buffer_store_dwordx4 v[192:195], v20, s[28:31], s50 offen offset:2048 sc1
v_cvt_pk_bf16_f32 v201, v42, v43
v_mfma_f32_16x16x32_bf16 v[136:139], a[120:123], v[80:83], v[136:139]
v_cvt_pk_bf16_f32 v204, v44, v45
v_cvt_pk_bf16_f32 v205, v46, v47
v_mfma_f32_16x16x32_bf16 v[144:147], a[124:127], v[80:83], v[144:147]
v_cvt_pk_bf16_f32 v206, v52, v53
v_mfma_f32_16x16x32_bf16 v[148:151], a[124:127], v[112:115], v[148:151]
v_cvt_pk_bf16_f32 v202, v48, v49
v_cvt_pk_bf16_f32 v207, v54, v55
v_mfma_f32_16x16x32_bf16 v[156:159], a[128:131], v[112:115], v[156:159]
buffer_store_dwordx4 v[204:207], v20, s[28:31], s53 offen offset:2560 sc1
v_cvt_pk_bf16_f32 v203, v50, v51
v_mfma_f32_16x16x32_bf16 v[152:155], a[128:131], v[80:83], v[152:155]
buffer_store_dwordx4 v[200:203], v20, s[28:31], s50 offen offset:2560 sc1
v_lshrrev_b32 v62, 4, v60
v_mfma_f32_16x16x32_bf16 v[128:131], a[84:87], v[68:71], v[128:131]
s_barrier
ds_read_b64_tr_b16 a[116:117], v0 offset:16384
ds_read_b64_tr_b16 a[118:119], v0 offset:18432
v_mfma_f32_16x16x32_bf16 v[132:135], a[84:87], v[100:103], v[132:135]
ds_read_b64_tr_b16 a[120:121], v1 offset:16384
ds_read_b64_tr_b16 a[122:123], v1 offset:18432
v_mfma_f32_16x16x32_bf16 v[140:143], a[88:91], v[100:103], v[140:143]
ds_read_b64_tr_b16 a[124:125], v2 offset:16384
ds_read_b64_tr_b16 a[126:127], v2 offset:18432
v_mfma_f32_16x16x32_bf16 v[136:139], a[88:91], v[68:71], v[136:139]
s_waitcnt lgkmcnt(6)
ds_read_b64_tr_b16 a[128:129], v3 offset:16384
ds_read_b64_tr_b16 a[130:131], v3 offset:18432
v_mfma_f32_16x16x32_bf16 v[144:147], a[92:95], v[68:71], v[144:147]
ds_read_b64_tr_b16 a[84:85], v0 offset:20480
ds_read_b64_tr_b16 a[86:87], v0 offset:22528
v_mfma_f32_16x16x32_bf16 v[148:151], a[92:95], v[100:103], v[148:151]
ds_read_b64_tr_b16 a[88:89], v1 offset:20480
ds_read_b64_tr_b16 a[90:91], v1 offset:22528
v_mfma_f32_16x16x32_bf16 v[156:159], a[96:99], v[100:103], v[156:159]
ds_read_b64_tr_b16 a[92:93], v2 offset:20480
ds_read_b64_tr_b16 a[94:95], v2 offset:22528
v_mfma_f32_16x16x32_bf16 v[152:155], a[96:99], v[68:71], v[152:155]
ds_read_b64_tr_b16 a[96:97], v3 offset:20480
ds_read_b64_tr_b16 a[98:99], v3 offset:22528
v_mfma_f32_16x16x32_bf16 v[128:131], a[100:103], v[84:87], v[128:131]
v_mov_b32 v225, 0x3f317218
v_cndmask_b32_e64 v254, v254, v255, vcc
v_mfma_f32_16x16x32_bf16 v[132:135], a[100:103], v[116:119], v[132:135]
ds_read_b64_tr_b16 a[100:101], v0 offset:24576
ds_read_b64_tr_b16 a[102:103], v0 offset:26624
v_mfma_f32_16x16x32_bf16 v[140:143], a[104:107], v[116:119], v[140:143]
v_and_b32 v63, 1, v62
v_cndmask_b32 v225, v225, v224, vcc
v_mfma_f32_16x16x32_bf16 v[136:139], a[104:107], v[84:87], v[136:139]
ds_read_b64_tr_b16 a[104:105], v1 offset:24576
ds_read_b64_tr_b16 a[106:107], v1 offset:26624
v_mfma_f32_16x16x32_bf16 v[144:147], a[108:111], v[84:87], v[144:147]
v_and_b32_e64 v61, 15, v60
v_subrev_u32 v255, 512, v252
v_mfma_f32_16x16x32_bf16 v[148:151], a[108:111], v[116:119], v[148:151]
ds_read_b64_tr_b16 a[108:109], v2 offset:24576
ds_read_b64_tr_b16 a[110:111], v2 offset:26624
v_mfma_f32_16x16x32_bf16 v[156:159], a[112:115], v[116:119], v[156:159]
v_mul_u32_u24 v63, 9216, v63
v_cmp_gt_u32 vcc, 2304, v255
v_mfma_f32_16x16x32_bf16 v[152:155], a[112:115], v[84:87], v[152:155]
s_waitcnt lgkmcnt(8)
ds_read_b64_tr_b16 a[112:113], v3 offset:24576
buffer_load_dwordx4 v19, s[20:23], s57 offen lds
v_mfma_f32_16x16x32_bf16 v[128:131], a[116:119], v[72:75], v[128:131]
s_add_u32 m0, s4, 118784
s_movk_i32 s57, 896
ds_read_b64_tr_b16 a[114:115], v3 offset:26624
v_mfma_f32_16x16x32_bf16 v[132:135], a[116:119], v[104:107], v[132:135]
ds_read_b64_tr_b16 a[116:117], v0 offset:28672
buffer_load_dwordx4 v19, s[20:23], s58 offen lds
v_mfma_f32_16x16x32_bf16 v[140:143], a[120:123], v[104:107], v[140:143]
s_add_u32 m0, s4, 122880
s_mov_b32 s58, 148352
ds_read_b64_tr_b16 a[118:119], v0 offset:30720
v_mfma_f32_16x16x32_bf16 v[136:139], a[120:123], v[72:75], v[136:139]
ds_read_b64_tr_b16 a[120:121], v1 offset:28672
buffer_load_dwordx4 v19, s[20:23], s59 offen lds
v_mfma_f32_16x16x32_bf16 v[144:147], a[124:127], v[72:75], v[144:147]
s_add_u32 m0, s4, 126976
s_mov_b32 s59, 37760
ds_read_b64_tr_b16 a[122:123], v1 offset:30720
v_mfma_f32_16x16x32_bf16 v[148:151], a[124:127], v[104:107], v[148:151]
ds_read_b64_tr_b16 a[124:125], v2 offset:28672
buffer_load_dwordx4 v19, s[20:23], s56 offen lds
v_mfma_f32_16x16x32_bf16 v[156:159], a[128:131], v[104:107], v[156:159]
s_add_u32 m0, s4, 0
s_mov_b32 s56, 185216
ds_read_b64_tr_b16 a[126:127], v2 offset:30720
v_mfma_f32_16x16x32_bf16 v[152:155], a[128:131], v[72:75], v[152:155]
ds_read_b64_tr_b16 a[128:129], v3 offset:28672
ds_read_b64_tr_b16 a[130:131], v3 offset:30720
v_mfma_f32_16x16x32_bf16 v[128:131], a[84:87], v[88:91], v[128:131]
v_lshl_add_u32 v63, v61, 4, v63
v_lshrrev_b32 v8, 5, v60
v_mfma_f32_16x16x32_bf16 v[132:135], a[84:87], v[120:123], v[132:135]
v_cndmask_b32_e64 v224, 0, 1.0, vcc
v_mfma_f32_16x16x32_bf16 v[140:143], a[88:91], v[120:123], v[140:143]
v_lshl_add_u32 v8, v8, 8, v63
v_add_u32_e64 v8, s72, v8
v_mfma_f32_16x16x32_bf16 v[136:139], a[88:91], v[88:91], v[136:139]
s_lshr_b32 s72, s3, 1
s_lshl_b32 s72, s72, 30
v_add_u32_e64 v9, s72, v8
v_mfma_f32_16x16x32_bf16 v[144:147], a[92:95], v[88:91], v[144:147]
s_movk_i32 s72, 0x3f80
v_and_b32 v15, 1, v60
v_lshlrev_b32 v15, 4, v15
v_mfma_f32_16x16x32_bf16 v[148:151], a[92:95], v[120:123], v[148:151]
s_waitcnt lgkmcnt(4)
v_lshlrev_b32_e64 v15, v15, s72
v_mfma_f32_16x16x32_bf16 v[156:159], a[96:99], v[120:123], v[156:159]
s_mul_i32 s72, s2, 9216
v_lshrrev_b32_e64 v63, 2, v60
v_xor_b32 v63, v63, v60
v_mfma_f32_16x16x32_bf16 v[152:155], a[96:99], v[88:91], v[152:155]
s_add_u32 s72, s72, s73
buffer_load_dword v16, v10, s[12:15], s49 offen sc1
v_and_b32 v63, 8, v63
v_mfma_f32_16x16x32_bf16 v[128:131], a[100:103], v[76:79], v[128:131]
s_barrier
ds_read_b64_tr_b16 a[84:85], v0 offset:32768
ds_read_b64_tr_b16 a[86:87], v0 offset:34816
v_mfma_f32_16x16x32_bf16 v[132:135], a[100:103], v[108:111], v[132:135]
s_and_b32 s73, s6, 14
ds_read_b64_tr_b16 a[88:89], v1 offset:32768
ds_read_b64_tr_b16 a[90:91], v1 offset:34816
v_mfma_f32_16x16x32_bf16 v[140:143], a[104:107], v[108:111], v[140:143]
s_lshl_b32 s73, s73, 9
ds_read_b64_tr_b16 a[92:93], v2 offset:32768
ds_read_b64_tr_b16 a[94:95], v2 offset:34816
v_mfma_f32_16x16x32_bf16 v[136:139], a[104:107], v[76:79], v[136:139]
ds_read_b64_tr_b16 a[96:97], v3 offset:32768
ds_read_b64_tr_b16 a[98:99], v3 offset:34816
v_mfma_f32_16x16x32_bf16 v[144:147], a[108:111], v[76:79], v[144:147]
ds_read_b64_tr_b16 a[100:101], v0 offset:36864
ds_read_b64_tr_b16 a[102:103], v0 offset:38912
v_mfma_f32_16x16x32_bf16 v[148:151], a[108:111], v[108:111], v[148:151]
ds_read_b64_tr_b16 a[104:105], v1 offset:36864
ds_read_b64_tr_b16 a[106:107], v1 offset:38912
v_mfma_f32_16x16x32_bf16 v[156:159], a[112:115], v[108:111], v[156:159]
ds_read_b64_tr_b16 a[108:109], v2 offset:36864
ds_read_b64_tr_b16 a[110:111], v2 offset:38912
v_mfma_f32_16x16x32_bf16 v[152:155], a[112:115], v[76:79], v[152:155]
ds_read_b64_tr_b16 a[112:113], v3 offset:36864
ds_read_b64_tr_b16 a[114:115], v3 offset:38912
v_mfma_f32_16x16x32_bf16 v[128:131], a[116:119], v[92:95], v[128:131]
v_and_or_b32 v63, v60, 6, v63
v_cmp_eq_u32_e64 s[64:65], 0, v63
v_mfma_f32_16x16x32_bf16 v[132:135], a[116:119], v[124:127], v[132:135]
ds_read_b64_tr_b16 a[116:117], v0 offset:40960
ds_read_b64_tr_b16 a[118:119], v0 offset:43008
v_mfma_f32_16x16x32_bf16 v[140:143], a[120:123], v[124:127], v[140:143]
s_nop 1
v_cvt_pk_bf16_f32 v208, v128, v129
v_cvt_pk_bf16_f32 v209, v130, v131
v_mfma_f32_16x16x32_bf16 v[136:139], a[120:123], v[92:95], v[136:139]
s_waitcnt lgkmcnt(12)
ds_read_b64_tr_b16 a[120:121], v1 offset:40960
ds_read_b64_tr_b16 a[122:123], v1 offset:43008
v_mfma_f32_16x16x32_bf16 v[144:147], a[124:127], v[92:95], v[144:147]
v_cvt_pk_bf16_f32 v212, v132, v133
v_cvt_pk_bf16_f32 v213, v134, v135
v_mfma_f32_16x16x32_bf16 v[148:151], a[124:127], v[124:127], v[148:151]
ds_read_b64_tr_b16 a[124:125], v2 offset:40960
ds_read_b64_tr_b16 a[126:127], v2 offset:43008
v_mfma_f32_16x16x32_bf16 v[156:159], a[128:131], v[124:127], v[156:159]
v_cvt_pk_bf16_f32 v214, v140, v141
v_cvt_pk_bf16_f32 v215, v142, v143
v_mfma_f32_16x16x32_bf16 v[152:155], a[128:131], v[92:95], v[152:155]
ds_read_b64_tr_b16 a[128:129], v3 offset:40960
buffer_load_dwordx4 v19, s[20:23], s57 offen lds
v_mfma_f32_16x16x32_bf16 v[24:27], a[84:87], v[64:67], 0
s_add_u32 m0, s4, 4096
s_mov_b32 s57, 74624
ds_read_b64_tr_b16 a[130:131], v3 offset:43008
v_mfma_f32_16x16x32_bf16 v[28:31], a[84:87], v[96:99], 0
ds_read_b64_tr_b16 a[84:85], v0 offset:45056
buffer_load_dwordx4 v19, s[20:23], s58 offen lds
v_mfma_f32_16x16x32_bf16 v[36:39], a[88:91], v[96:99], 0
s_add_u32 m0, s4, 8192
s_mov_b32 s58, 222080
ds_read_b64_tr_b16 a[86:87], v0 offset:47104
v_mfma_f32_16x16x32_bf16 v[32:35], a[88:91], v[64:67], 0
ds_read_b64_tr_b16 a[88:89], v1 offset:45056
buffer_load_dwordx4 v19, s[20:23], s59 offen lds
v_mfma_f32_16x16x32_bf16 v[40:43], a[92:95], v[64:67], 0
s_add_u32 m0, s4, 12288
s_mov_b32 s59, 111488
ds_read_b64_tr_b16 a[90:91], v1 offset:47104
v_mfma_f32_16x16x32_bf16 v[44:47], a[92:95], v[96:99], 0
s_waitcnt lgkmcnt(8)
ds_read_b64_tr_b16 a[92:93], v2 offset:45056
buffer_load_dwordx4 v19, s[20:23], s56 offen lds
v_mfma_f32_16x16x32_bf16 v[52:55], a[96:99], v[96:99], 0
s_add_u32 m0, s4, 16384
s_mov_b32 s56, 258944
buffer_store_dwordx4 v[212:215], v20, s[28:31], s53 offen offset:3072 sc1
v_mfma_f32_16x16x32_bf16 v[48:51], a[96:99], v[64:67], 0
ds_read_b64_tr_b16 a[94:95], v2 offset:47104
ds_read_b64_tr_b16 a[96:97], v3 offset:45056
v_mfma_f32_16x16x32_bf16 v[24:27], a[100:103], v[80:83], v[24:27]
ds_read_b64_tr_b16 a[98:99], v3 offset:47104
v_cvt_pk_bf16_f32 v210, v136, v137
v_mfma_f32_16x16x32_bf16 v[28:31], a[100:103], v[112:115], v[28:31]
v_cvt_pk_bf16_f32 v211, v138, v139
v_cvt_pk_bf16_f32 v216, v144, v145
v_mfma_f32_16x16x32_bf16 v[36:39], a[104:107], v[112:115], v[36:39]
buffer_store_dwordx4 v[208:211], v20, s[28:31], s50 offen offset:3072 sc1
v_cvt_pk_bf16_f32 v217, v146, v147
v_mfma_f32_16x16x32_bf16 v[32:35], a[104:107], v[80:83], v[32:35]
v_cvt_pk_bf16_f32 v220, v148, v149
v_cvt_pk_bf16_f32 v221, v150, v151
v_mfma_f32_16x16x32_bf16 v[40:43], a[108:111], v[80:83], v[40:43]
v_cvt_pk_bf16_f32 v222, v156, v157
v_mfma_f32_16x16x32_bf16 v[44:47], a[108:111], v[112:115], v[44:47]
v_cvt_pk_bf16_f32 v218, v152, v153
v_cvt_pk_bf16_f32 v223, v158, v159
v_mfma_f32_16x16x32_bf16 v[52:55], a[112:115], v[112:115], v[52:55]
buffer_store_dwordx4 v[220:223], v20, s[28:31], s53 offen offset:3584 sc1
v_cvt_pk_bf16_f32 v219, v154, v155
v_mfma_f32_16x16x32_bf16 v[48:51], a[112:115], v[80:83], v[48:51]
buffer_store_dwordx4 v[216:219], v20, s[28:31], s50 offen offset:3584 sc1
v_cndmask_b32_e64 v12, 0, v15, s[64:65]
v_mfma_f32_16x16x32_bf16 v[24:27], a[116:119], v[68:71], v[24:27]
s_barrier
ds_read_b64_tr_b16 a[100:101], v0 offset:49152
ds_read_b64_tr_b16 a[102:103], v0 offset:51200
v_mfma_f32_16x16x32_bf16 v[28:31], a[116:119], v[100:103], v[28:31]
ds_read_b64_tr_b16 a[104:105], v1 offset:49152
ds_read_b64_tr_b16 a[106:107], v1 offset:51200
v_mfma_f32_16x16x32_bf16 v[36:39], a[120:123], v[100:103], v[36:39]
ds_read_b64_tr_b16 a[108:109], v2 offset:49152
ds_read_b64_tr_b16 a[110:111], v2 offset:51200
v_mfma_f32_16x16x32_bf16 v[32:35], a[120:123], v[68:71], v[32:35]
s_waitcnt lgkmcnt(6)
ds_read_b64_tr_b16 a[112:113], v3 offset:49152
ds_read_b64_tr_b16 a[114:115], v3 offset:51200
v_mfma_f32_16x16x32_bf16 v[40:43], a[124:127], v[68:71], v[40:43]
ds_read_b64_tr_b16 a[116:117], v0 offset:53248
ds_read_b64_tr_b16 a[118:119], v0 offset:55296
v_mfma_f32_16x16x32_bf16 v[44:47], a[124:127], v[100:103], v[44:47]
ds_read_b64_tr_b16 a[120:121], v1 offset:53248
ds_read_b64_tr_b16 a[122:123], v1 offset:55296
v_mfma_f32_16x16x32_bf16 v[52:55], a[128:131], v[100:103], v[52:55]
ds_read_b64_tr_b16 a[124:125], v2 offset:53248
ds_read_b64_tr_b16 a[126:127], v2 offset:55296
v_mfma_f32_16x16x32_bf16 v[48:51], a[128:131], v[68:71], v[48:51]
ds_read_b64_tr_b16 a[128:129], v3 offset:53248
ds_read_b64_tr_b16 a[130:131], v3 offset:55296
v_mfma_f32_16x16x32_bf16 v[24:27], a[84:87], v[84:87], v[24:27]
v_cmp_eq_u32_e64 s[64:65], 2, v63
s_nop 1
v_cndmask_b32_e64 v13, 0, v15, s[64:65]
v_mfma_f32_16x16x32_bf16 v[28:31], a[84:87], v[116:119], v[28:31]
ds_read_b64_tr_b16 a[84:85], v0 offset:57344
ds_read_b64_tr_b16 a[86:87], v0 offset:59392
v_mfma_f32_16x16x32_bf16 v[36:39], a[88:91], v[116:119], v[36:39]
v_cmp_eq_u32_e64 s[64:65], 4, v63
s_nop 1
v_cndmask_b32_e64 v14, 0, v15, s[64:65]
v_mfma_f32_16x16x32_bf16 v[32:35], a[88:91], v[84:87], v[32:35]
ds_read_b64_tr_b16 a[88:89], v1 offset:57344
ds_read_b64_tr_b16 a[90:91], v1 offset:59392
v_mfma_f32_16x16x32_bf16 v[40:43], a[92:95], v[84:87], v[40:43]
v_cmp_eq_u32_e64 s[64:65], 6, v63
v_lshrrev_b32 v63, 5, v60
v_mfma_f32_16x16x32_bf16 v[44:47], a[92:95], v[116:119], v[44:47]
ds_read_b64_tr_b16 a[92:93], v2 offset:57344
ds_read_b64_tr_b16 a[94:95], v2 offset:59392
v_mfma_f32_16x16x32_bf16 v[52:55], a[96:99], v[116:119], v[52:55]
v_bfe_u32 v59, v60, 3, 1
v_and_b32_e64 v61, 7, v61
v_mfma_f32_16x16x32_bf16 v[48:51], a[96:99], v[84:87], v[48:51]
s_waitcnt lgkmcnt(8)
ds_read_b64_tr_b16 a[96:97], v3 offset:57344
buffer_load_dwordx4 v19, s[20:23], s57 offen lds
v_mfma_f32_16x16x32_bf16 v[24:27], a[100:103], v[72:75], v[24:27]
s_add_u32 m0, s4, 20480
s_mov_b32 s57, 0
ds_read_b64_tr_b16 a[98:99], v3 offset:59392
v_mfma_f32_16x16x32_bf16 v[28:31], a[100:103], v[104:107], v[28:31]
ds_read_b64_tr_b16 a[100:101], v0 offset:61440
buffer_load_dwordx4 v19, s[20:23], s58 offen lds
v_mfma_f32_16x16x32_bf16 v[36:39], a[104:107], v[104:107], v[36:39]
s_add_u32 m0, s4, 24576
s_mov_b32 s58, 18432
ds_read_b64_tr_b16 a[102:103], v0 offset:63488
v_mfma_f32_16x16x32_bf16 v[32:35], a[104:107], v[72:75], v[32:35]
ds_read_b64_tr_b16 a[104:105], v1 offset:61440
buffer_load_dwordx4 v19, s[20:23], s59 offen lds
v_mfma_f32_16x16x32_bf16 v[40:43], a[108:111], v[72:75], v[40:43]
s_add_u32 m0, s4, 28672
s_mov_b32 s59, 36864
ds_read_b64_tr_b16 a[106:107], v1 offset:63488
v_mfma_f32_16x16x32_bf16 v[44:47], a[108:111], v[104:107], v[44:47]
ds_read_b64_tr_b16 a[108:109], v2 offset:61440
buffer_load_dwordx4 v19, s[20:23], s56 offen lds
v_mfma_f32_16x16x32_bf16 v[52:55], a[112:115], v[104:107], v[52:55]
s_mov_b32 s56, 55296
s_add_u32 m0, s4, 32768
ds_read_b64_tr_b16 a[110:111], v2 offset:63488
v_mfma_f32_16x16x32_bf16 v[48:51], a[112:115], v[72:75], v[48:51]
ds_read_b64_tr_b16 a[112:113], v3 offset:61440
ds_read_b64_tr_b16 a[114:115], v3 offset:63488
v_mfma_f32_16x16x32_bf16 v[24:27], a[116:119], v[88:91], v[24:27]
v_lshl_add_u32 v58, v63, 3, v61
v_mov_b32_e64 v17, 2
v_mfma_f32_16x16x32_bf16 v[28:31], a[116:119], v[120:123], v[28:31]
v_lshl_add_u32 v63, v63, 1, v59
v_mfma_f32_16x16x32_bf16 v[36:39], a[120:123], v[120:123], v[36:39]
v_and_b32 v62, 1, v62
v_mul_u32_u24 v18, 1152, v61
v_mfma_f32_16x16x32_bf16 v[32:35], a[120:123], v[88:91], v[32:35]
s_waitcnt vmcnt(4)
buffer_store_dword v17, v11, s[12:15], s49 offen sc1
v_lshl_add_u32 v18, v63, 3, v18
v_mfma_f32_16x16x32_bf16 v[40:43], a[124:127], v[88:91], v[40:43]
v_lshl_add_u32 v18, v62, 5, v18
v_add_u32_e64 v18, s72, v18
v_mfma_f32_16x16x32_bf16 v[44:47], a[124:127], v[120:123], v[44:47]
s_waitcnt lgkmcnt(4)
s_lshl_b32 s72, s70, 30
buffer_load_dwordx2 v[180:181], v18, s[16:19], 0 offen offset:0
buffer_load_dwordx2 v[182:183], v18, s[16:19], 0 offen offset:256
v_mfma_f32_16x16x32_bf16 v[52:55], a[128:131], v[120:123], v[52:55]
buffer_load_dwordx2 v[184:185], v18, s[16:19], 0 offen offset:512
buffer_load_dwordx2 v[186:187], v18, s[16:19], 0 offen offset:768
v_mfma_f32_16x16x32_bf16 v[48:51], a[128:131], v[88:91], v[48:51]
v_add_u32 v21, s72, v18
v_lshlrev_b32 v22, 5, v63
v_mfma_f32_16x16x32_bf16 v[24:27], a[84:87], v[76:79], v[24:27]
s_barrier
ds_read_b64_tr_b16 a[116:117], v4 offset:0
buffer_load_dwordx2 v[188:189], v21, s[16:19], 0 offen offset:1024
v_mfma_f32_16x16x32_bf16 v[28:31], a[84:87], v[108:111], v[28:31]
s_lshl_b32 s72, s3, 7
ds_read_b64_tr_b16 a[118:119], v4 offset:2048
ds_read_b64_tr_b16 a[120:121], v5 offset:0
v_mfma_f32_16x16x32_bf16 v[36:39], a[88:91], v[108:111], v[36:39]
s_add_u32 s72, s72, 135680
ds_read_b64_tr_b16 a[122:123], v5 offset:2048
ds_read_b64_tr_b16 a[124:125], v6 offset:0
v_mfma_f32_16x16x32_bf16 v[32:35], a[88:91], v[76:79], v[32:35]
ds_read_b64_tr_b16 a[126:127], v6 offset:2048
ds_read_b64_tr_b16 a[128:129], v7 offset:0
v_mfma_f32_16x16x32_bf16 v[40:43], a[92:95], v[76:79], v[40:43]
ds_read_b64_tr_b16 a[130:131], v7 offset:2048
ds_read_b64_tr_b16 a[84:85], v4 offset:4096
v_mfma_f32_16x16x32_bf16 v[44:47], a[92:95], v[108:111], v[44:47]
ds_read_b64_tr_b16 a[86:87], v4 offset:6144
ds_read_b64_tr_b16 a[88:89], v5 offset:4096
v_mfma_f32_16x16x32_bf16 v[52:55], a[96:99], v[108:111], v[52:55]
ds_read_b64_tr_b16 a[90:91], v5 offset:6144
ds_read_b64_tr_b16 a[92:93], v6 offset:4096
v_mfma_f32_16x16x32_bf16 v[48:51], a[96:99], v[76:79], v[48:51]
ds_read_b64_tr_b16 a[94:95], v6 offset:6144
ds_read_b64_tr_b16 a[96:97], v7 offset:4096
v_mfma_f32_16x16x32_bf16 v[24:27], a[100:103], v[92:95], v[24:27]
ds_read_b64_tr_b16 a[98:99], v7 offset:6144
v_lshl_add_u32 v22, v62, 4, v22
v_mfma_f32_16x16x32_bf16 v[28:31], a[100:103], v[124:127], v[28:31]
ds_read_b64_tr_b16 a[100:101], v4 offset:8192
ds_read_b64_tr_b16 a[102:103], v4 offset:10240
v_mfma_f32_16x16x32_bf16 v[36:39], a[104:107], v[124:127], v[36:39]
s_nop 1
v_cvt_pk_bf16_f32 v192, v24, v25
v_cvt_pk_bf16_f32 v193, v26, v27
v_mfma_f32_16x16x32_bf16 v[32:35], a[104:107], v[92:95], v[32:35]
s_waitcnt lgkmcnt(13)
ds_read_b64_tr_b16 a[104:105], v5 offset:8192
ds_read_b64_tr_b16 a[106:107], v5 offset:10240
v_mfma_f32_16x16x32_bf16 v[40:43], a[108:111], v[92:95], v[40:43]
v_cvt_pk_bf16_f32 v196, v28, v29
v_cvt_pk_bf16_f32 v197, v30, v31
v_mfma_f32_16x16x32_bf16 v[44:47], a[108:111], v[124:127], v[44:47]
ds_read_b64_tr_b16 a[108:109], v6 offset:8192
ds_read_b64_tr_b16 a[110:111], v6 offset:10240
v_mfma_f32_16x16x32_bf16 v[52:55], a[112:115], v[124:127], v[52:55]
v_cvt_pk_bf16_f32 v198, v36, v37
v_cvt_pk_bf16_f32 v199, v38, v39
v_mfma_f32_16x16x32_bf16 v[48:51], a[112:115], v[92:95], v[48:51]
ds_read_b64_tr_b16 a[112:113], v7 offset:8192
v_cmp_gt_u32 vcc, 1, v16
v_mfma_f32_16x16x32_bf16 v[128:131], a[116:119], v[64:67], 0
s_and_b32 vcc_lo, vcc_lo, 0xffff
s_cbranch_scc1 k1_p1
k1_p1r:
buffer_load_dwordx4 a[0:3], v8, s[28:31], s57 offen sc1
v_mfma_f32_16x16x32_bf16 v[132:135], a[116:119], v[96:99], 0
s_mov_b32 s57, 73728
buffer_load_dwordx4 a[4:7], v8, s[28:31], s58 offen sc1
buffer_load_dwordx4 a[8:11], v8, s[28:31], s59 offen sc1
v_mfma_f32_16x16x32_bf16 v[140:143], a[120:123], v[96:99], 0
s_mov_b32 s58, 92160
s_mov_b32 s59, 110592
buffer_load_dwordx4 a[12:15], v8, s[28:31], s56 offen sc1
v_mfma_f32_16x16x32_bf16 v[136:139], a[120:123], v[64:67], 0
s_waitcnt lgkmcnt(5)
s_mov_b32 s56, 129024
ds_read_b64_tr_b16 a[114:115], v7 offset:10240
buffer_load_dwordx4 a[16:19], v8, s[28:31], s57 offen sc1
v_mfma_f32_16x16x32_bf16 v[144:147], a[124:127], v[64:67], 0
s_movk_i32 s57, 1024
ds_read_b64_tr_b16 a[116:117], v4 offset:12288
ds_read_b64_tr_b16 a[118:119], v4 offset:14336
v_mfma_f32_16x16x32_bf16 v[148:151], a[124:127], v[96:99], 0
ds_read_b64_tr_b16 a[120:121], v5 offset:12288
buffer_load_dwordx4 v19, s[20:23], s57 offen lds
v_mfma_f32_16x16x32_bf16 v[156:159], a[128:131], v[96:99], 0
s_add_u32 m0, s4, 36864
s_mov_b32 s57, 74752
buffer_store_dwordx4 v[196:199], v20, s[28:31], s54 offen offset:0 sc1
v_mfma_f32_16x16x32_bf16 v[152:155], a[128:131], v[64:67], 0
ds_read_b64_tr_b16 a[122:123], v5 offset:14336
ds_read_b64_tr_b16 a[124:125], v6 offset:12288
v_mfma_f32_16x16x32_bf16 v[128:131], a[84:87], v[80:83], v[128:131]
ds_read_b64_tr_b16 a[126:127], v6 offset:14336
ds_read_b64_tr_b16 a[128:129], v7 offset:12288
v_mfma_f32_16x16x32_bf16 v[132:135], a[84:87], v[112:115], v[132:135]
ds_read_b64_tr_b16 a[130:131], v7 offset:14336
buffer_load_dwordx4 a[20:23], v8, s[28:31], s58 offen sc1
v_mfma_f32_16x16x32_bf16 v[140:143], a[88:91], v[112:115], v[140:143]
s_mov_b32 s58, 148480
v_cvt_pk_bf16_f32 v194, v32, v33
v_cvt_pk_bf16_f32 v195, v34, v35
v_mfma_f32_16x16x32_bf16 v[136:139], a[88:91], v[80:83], v[136:139]
buffer_store_dwordx4 v[192:195], v20, s[28:31], s51 offen offset:0 sc1
buffer_load_dwordx4 v19, s[20:23], s58 offen lds
v_mfma_f32_16x16x32_bf16 v[144:147], a[92:95], v[80:83], v[144:147]
s_add_u32 m0, s4, 40960
s_mov_b32 s58, 222208
v_cvt_pk_bf16_f32 v200, v40, v41
v_mfma_f32_16x16x32_bf16 v[148:151], a[92:95], v[112:115], v[148:151]
v_cvt_pk_bf16_f32 v201, v42, v43
v_cvt_pk_bf16_f32 v204, v44, v45
v_mfma_f32_16x16x32_bf16 v[156:159], a[96:99], v[112:115], v[156:159]
v_cvt_pk_bf16_f32 v205, v46, v47
v_mfma_f32_16x16x32_bf16 v[152:155], a[96:99], v[80:83], v[152:155]
buffer_load_dwordx4 a[24:27], v8, s[28:31], s59 offen sc1
v_cvt_pk_bf16_f32 v206, v52, v53
v_mfma_f32_16x16x32_bf16 v[128:131], a[100:103], v[68:71], v[128:131]
s_mov_b32 s59, 37888
s_barrier
ds_read_b64_tr_b16 a[84:85], v4 offset:16384
v_mfma_f32_16x16x32_bf16 v[132:135], a[100:103], v[100:103], v[132:135]
s_waitcnt lgkmcnt(2)
ds_read_b64_tr_b16 a[86:87], v4 offset:18432
buffer_load_dwordx4 v19, s[20:23], s59 offen lds
v_mfma_f32_16x16x32_bf16 v[140:143], a[104:107], v[100:103], v[140:143]
s_add_u32 m0, s4, 45056
s_mov_b32 s59, 111616
ds_read_b64_tr_b16 a[88:89], v5 offset:16384
v_mfma_f32_16x16x32_bf16 v[136:139], a[104:107], v[68:71], v[136:139]
ds_read_b64_tr_b16 a[90:91], v5 offset:18432
ds_read_b64_tr_b16 a[92:93], v6 offset:16384
v_mfma_f32_16x16x32_bf16 v[144:147], a[108:111], v[68:71], v[144:147]
ds_read_b64_tr_b16 a[94:95], v6 offset:18432
ds_read_b64_tr_b16 a[96:97], v7 offset:16384
v_mfma_f32_16x16x32_bf16 v[148:151], a[108:111], v[100:103], v[148:151]
ds_read_b64_tr_b16 a[98:99], v7 offset:18432
buffer_load_dwordx4 a[28:31], v8, s[28:31], s56 offen sc1
v_mfma_f32_16x16x32_bf16 v[156:159], a[112:115], v[100:103], v[156:159]
s_mov_b32 s56, 185344
ds_read_b64_tr_b16 a[100:101], v4 offset:20480
ds_read_b64_tr_b16 a[102:103], v4 offset:22528
v_mfma_f32_16x16x32_bf16 v[152:155], a[112:115], v[68:71], v[152:155]
ds_read_b64_tr_b16 a[104:105], v5 offset:20480
buffer_load_dwordx4 v19, s[20:23], s56 offen lds
v_mfma_f32_16x16x32_bf16 v[128:131], a[116:119], v[84:87], v[128:131]
s_add_u32 m0, s4, 49152
s_mov_b32 s56, 259072
ds_read_b64_tr_b16 a[106:107], v5 offset:22528
v_mfma_f32_16x16x32_bf16 v[132:135], a[116:119], v[116:119], v[132:135]
ds_read_b64_tr_b16 a[108:109], v6 offset:20480
ds_read_b64_tr_b16 a[110:111], v6 offset:22528
v_mfma_f32_16x16x32_bf16 v[140:143], a[120:123], v[116:119], v[140:143]
ds_read_b64_tr_b16 a[112:113], v7 offset:20480
ds_read_b64_tr_b16 a[114:115], v7 offset:22528
v_mfma_f32_16x16x32_bf16 v[136:139], a[120:123], v[84:87], v[136:139]
ds_read_b64_tr_b16 a[116:117], v4 offset:24576
ds_read_b64_tr_b16 a[118:119], v4 offset:26624
v_mfma_f32_16x16x32_bf16 v[144:147], a[124:127], v[84:87], v[144:147]
ds_read_b64_tr_b16 a[120:121], v5 offset:24576
ds_read_b64_tr_b16 a[122:123], v5 offset:26624
v_mfma_f32_16x16x32_bf16 v[148:151], a[124:127], v[116:119], v[148:151]
s_waitcnt lgkmcnt(13)
ds_read_b64_tr_b16 a[124:125], v6 offset:24576
ds_read_b64_tr_b16 a[126:127], v6 offset:26624
v_mfma_f32_16x16x32_bf16 v[156:159], a[128:131], v[116:119], v[156:159]
v_cvt_pk_bf16_f32 v202, v48, v49
v_cvt_pk_bf16_f32 v207, v54, v55
v_mfma_f32_16x16x32_bf16 v[152:155], a[128:131], v[84:87], v[152:155]
buffer_store_dwordx4 v[204:207], v20, s[28:31], s54 offen offset:512 sc1
buffer_load_dwordx4 v19, s[20:23], s57 offen lds
v_mfma_f32_16x16x32_bf16 v[128:131], a[84:87], v[72:75], v[128:131]
s_add_u32 m0, s4, 53248
s_movk_i32 s57, 2048
ds_read_b64_tr_b16 a[128:129], v7 offset:24576
v_mfma_f32_16x16x32_bf16 v[132:135], a[84:87], v[104:107], v[132:135]
ds_read_b64_tr_b16 a[130:131], v7 offset:26624
buffer_load_dwordx4 v19, s[20:23], s58 offen lds
v_mfma_f32_16x16x32_bf16 v[140:143], a[88:91], v[104:107], v[140:143]
s_add_u32 m0, s4, 57344
s_movk_i32 s58, 20480
ds_read_b64_tr_b16 a[84:85], v4 offset:28672
v_mfma_f32_16x16x32_bf16 v[136:139], a[88:91], v[72:75], v[136:139]
ds_read_b64_tr_b16 a[86:87], v4 offset:30720
buffer_load_dwordx4 v19, s[20:23], s59 offen lds
v_mfma_f32_16x16x32_bf16 v[144:147], a[92:95], v[72:75], v[144:147]
s_add_u32 m0, s4, 61440
s_mov_b32 s59, 38912
ds_read_b64_tr_b16 a[88:89], v5 offset:28672
v_mfma_f32_16x16x32_bf16 v[148:151], a[92:95], v[104:107], v[148:151]
s_waitcnt lgkmcnt(7)
ds_read_b64_tr_b16 a[90:91], v5 offset:30720
buffer_load_dwordx4 v19, s[20:23], s56 offen lds
v_mfma_f32_16x16x32_bf16 v[156:159], a[96:99], v[104:107], v[156:159]
s_mov_b32 s56, 57344
ds_read_b64_tr_b16 a[92:93], v6 offset:28672
ds_read_b64_tr_b16 a[94:95], v6 offset:30720
v_mfma_f32_16x16x32_bf16 v[152:155], a[96:99], v[72:75], v[152:155]
ds_read_b64_tr_b16 a[96:97], v7 offset:28672
buffer_load_dword v16, v10, s[12:15], s49 offen sc1
v_mfma_f32_16x16x32_bf16 v[128:131], a[100:103], v[88:91], v[128:131]
ds_read_b64_tr_b16 a[98:99], v7 offset:30720
v_cvt_pk_bf16_f32 v203, v50, v51
v_mfma_f32_16x16x32_bf16 v[132:135], a[100:103], v[120:123], v[132:135]
buffer_store_dwordx4 v[200:203], v20, s[28:31], s51 offen offset:512 sc1
v_add_u32_e64 v22, s72, v22
v_mfma_f32_16x16x32_bf16 v[140:143], a[104:107], v[120:123], v[140:143]
s_mul_i32 s72, s7, 147456
s_add_u32 s72, s72, s73
s_and_b32 s73, s6, 1
v_mfma_f32_16x16x32_bf16 v[136:139], a[104:107], v[88:91], v[136:139]
s_lshl_b32 s73, s73, 7
s_add_u32 s72, s72, s73
v_lshlrev_b32_e64 v23, 15, v62
v_mfma_f32_16x16x32_bf16 v[144:147], a[108:111], v[88:91], v[144:147]
s_lshl_b32 s73, s3, 13
s_add_u32 s72, s72, s73
v_lshl_add_u32 v23, v63, 8, v23
v_mfma_f32_16x16x32_bf16 v[148:151], a[108:111], v[120:123], v[148:151]
v_lshl_add_u32 v23, v61, 4, v23
v_add_u32_e64 v23, s72, v23
v_mfma_f32_16x16x32_bf16 v[156:159], a[112:115], v[120:123], v[156:159]
s_mul_i32 s72, s2, 12288
s_add_u32 s72, s72, s4
v_lshl_add_u32 v57, v60, 4, s72
v_mfma_f32_16x16x32_bf16 v[152:155], a[112:115], v[88:91], v[152:155]
s_lshl_b32 s72, s3, 2
s_add_u32 s72, s72, 156416
v_or_b32_e64 v56, s70, v62
v_mfma_f32_16x16x32_bf16 v[128:131], a[116:119], v[76:79], v[128:131]
s_barrier
ds_read_b64_tr_b16 a[100:101], v4 offset:32768
ds_read_b64_tr_b16 a[102:103], v4 offset:34816
v_mfma_f32_16x16x32_bf16 v[132:135], a[116:119], v[108:111], v[132:135]
s_xor_b32 s70, s70, 1
ds_read_b64_tr_b16 a[104:105], v5 offset:32768
ds_read_b64_tr_b16 a[106:107], v5 offset:34816
v_mfma_f32_16x16x32_bf16 v[140:143], a[120:123], v[108:111], v[140:143]
s_mul_i32 s70, s70, 0x3f800000
ds_read_b64_tr_b16 a[108:109], v6 offset:32768
ds_read_b64_tr_b16 a[110:111], v6 offset:34816
v_mfma_f32_16x16x32_bf16 v[136:139], a[120:123], v[76:79], v[136:139]
s_waitcnt lgkmcnt(6)
ds_read_b64_tr_b16 a[112:113], v7 offset:32768
ds_read_b64_tr_b16 a[114:115], v7 offset:34816
v_mfma_f32_16x16x32_bf16 v[144:147], a[124:127], v[76:79], v[144:147]
ds_read_b64_tr_b16 a[116:117], v4 offset:36864
ds_read_b64_tr_b16 a[118:119], v4 offset:38912
v_mfma_f32_16x16x32_bf16 v[148:151], a[124:127], v[108:111], v[148:151]
ds_read_b64_tr_b16 a[120:121], v5 offset:36864
ds_read_b64_tr_b16 a[122:123], v5 offset:38912
v_mfma_f32_16x16x32_bf16 v[156:159], a[128:131], v[108:111], v[156:159]
ds_read_b64_tr_b16 a[124:125], v6 offset:36864
ds_read_b64_tr_b16 a[126:127], v6 offset:38912
v_mfma_f32_16x16x32_bf16 v[152:155], a[128:131], v[76:79], v[152:155]
ds_read_b64_tr_b16 a[128:129], v7 offset:36864
ds_read_b64_tr_b16 a[130:131], v7 offset:38912
v_mfma_f32_16x16x32_bf16 v[128:131], a[84:87], v[92:95], v[128:131]
v_lshlrev_b32 v59, 4, v61
v_lshrrev_b32 v253, 2, v252
v_mfma_f32_16x16x32_bf16 v[132:135], a[84:87], v[124:127], v[132:135]
ds_read_b64_tr_b16 a[84:85], v4 offset:40960
ds_read_b64_tr_b16 a[86:87], v4 offset:43008
v_mfma_f32_16x16x32_bf16 v[140:143], a[88:91], v[124:127], v[140:143]
s_nop 1
v_cvt_pk_bf16_f32 v208, v128, v129
v_cvt_pk_bf16_f32 v209, v130, v131
v_mfma_f32_16x16x32_bf16 v[136:139], a[88:91], v[92:95], v[136:139]
ds_read_b64_tr_b16 a[88:89], v5 offset:40960
ds_read_b64_tr_b16 a[90:91], v5 offset:43008
v_mfma_f32_16x16x32_bf16 v[144:147], a[92:95], v[92:95], v[144:147]
v_cvt_pk_bf16_f32 v212, v132, v133
v_cvt_pk_bf16_f32 v213, v134, v135
v_mfma_f32_16x16x32_bf16 v[148:151], a[92:95], v[124:127], v[148:151]
ds_read_b64_tr_b16 a[92:93], v6 offset:40960
ds_read_b64_tr_b16 a[94:95], v6 offset:43008
v_mfma_f32_16x16x32_bf16 v[156:159], a[96:99], v[124:127], v[156:159]
v_cvt_pk_bf16_f32 v214, v140, v141
v_cvt_pk_bf16_f32 v215, v142, v143
v_mfma_f32_16x16x32_bf16 v[152:155], a[96:99], v[92:95], v[152:155]
s_waitcnt lgkmcnt(8)
ds_read_b64_tr_b16 a[96:97], v7 offset:40960
ds_read_b64_tr_b16 a[98:99], v7 offset:43008
v_mfma_f32_16x16x32_bf16 v[24:27], a[100:103], v[64:67], 0
v_cvt_pk_bf16_f32 v210, v136, v137
v_cvt_pk_bf16_f32 v211, v138, v139
v_mfma_f32_16x16x32_bf16 v[28:31], a[100:103], v[96:99], 0
ds_read_b64_tr_b16 a[100:101], v4 offset:45056
ds_read_b64_tr_b16 a[102:103], v4 offset:47104
v_mfma_f32_16x16x32_bf16 v[36:39], a[104:107], v[96:99], 0
v_cvt_pk_bf16_f32 v216, v144, v145
v_cvt_pk_bf16_f32 v217, v146, v147
v_mfma_f32_16x16x32_bf16 v[32:35], a[104:107], v[64:67], 0
ds_read_b64_tr_b16 a[104:105], v5 offset:45056
buffer_store_dwordx4 v[208:211], v20, s[28:31], s51 offen offset:1024 sc1
v_mfma_f32_16x16x32_bf16 v[40:43], a[108:111], v[64:67], 0
ds_read_b64_tr_b16 a[106:107], v5 offset:47104
v_cvt_pk_bf16_f32 v220, v148, v149
v_mfma_f32_16x16x32_bf16 v[44:47], a[108:111], v[96:99], 0
ds_read_b64_tr_b16 a[108:109], v6 offset:45056
ds_read_b64_tr_b16 a[110:111], v6 offset:47104
v_mfma_f32_16x16x32_bf16 v[52:55], a[112:115], v[96:99], 0
buffer_store_dwordx4 v[212:215], v20, s[28:31], s54 offen offset:1024 sc1
v_cvt_pk_bf16_f32 v221, v150, v151
v_mfma_f32_16x16x32_bf16 v[48:51], a[112:115], v[64:67], 0
ds_read_b64_tr_b16 a[112:113], v7 offset:45056
ds_read_b64_tr_b16 a[114:115], v7 offset:47104
v_mfma_f32_16x16x32_bf16 v[24:27], a[116:119], v[80:83], v[24:27]
v_cvt_pk_bf16_f32 v222, v156, v157
v_cvt_pk_bf16_f32 v223, v158, v159
v_mfma_f32_16x16x32_bf16 v[28:31], a[116:119], v[112:115], v[28:31]
v_cvt_pk_bf16_f32 v218, v152, v153
v_mfma_f32_16x16x32_bf16 v[36:39], a[120:123], v[112:115], v[36:39]
v_cndmask_b32_e64 v15, 0, v15, s[64:65]
v_cvt_pk_bf16_f32 v219, v154, v155
v_mfma_f32_16x16x32_bf16 v[32:35], a[120:123], v[80:83], v[32:35]
buffer_store_dwordx4 v[216:219], v20, s[28:31], s51 offen offset:1536 sc1
v_lshl_add_u32 v56, v56, 30, v23
v_mfma_f32_16x16x32_bf16 v[40:43], a[124:127], v[80:83], v[40:43]
buffer_store_dwordx4 v[220:223], v20, s[28:31], s54 offen offset:1536 sc1
v_lshl_add_u32 v58, v58, 4, s72
v_mfma_f32_16x16x32_bf16 v[44:47], a[124:127], v[112:115], v[44:47]
s_waitcnt lgkmcnt(4)
v_add_u32 v59, 156416, v59
v_add_u32_e64 v254, v254, v252
v_mfma_f32_16x16x32_bf16 v[52:55], a[128:131], v[112:115], v[52:55]
v_add_u32 v255, 135680, v252
v_mfma_f32_16x16x32_bf16 v[48:51], a[128:131], v[80:83], v[48:51]
v_add_u32 v227, 158208, v253
v_mfma_f32_16x16x32_bf16 v[24:27], a[84:87], v[68:71], v[24:27]
s_barrier
ds_read_b64_tr_b16 a[116:117], v4 offset:49152
ds_read_b64_tr_b16 a[118:119], v4 offset:51200
v_mfma_f32_16x16x32_bf16 v[28:31], a[84:87], v[100:103], v[28:31]
ds_read_b64_tr_b16 a[120:121], v5 offset:49152
ds_read_b64_tr_b16 a[122:123], v5 offset:51200
v_mfma_f32_16x16x32_bf16 v[36:39], a[88:91], v[100:103], v[36:39]
ds_read_b64_tr_b16 a[124:125], v6 offset:49152
ds_read_b64_tr_b16 a[126:127], v6 offset:51200
v_mfma_f32_16x16x32_bf16 v[32:35], a[88:91], v[68:71], v[32:35]
ds_read_b64_tr_b16 a[128:129], v7 offset:49152
ds_read_b64_tr_b16 a[130:131], v7 offset:51200
v_mfma_f32_16x16x32_bf16 v[40:43], a[92:95], v[68:71], v[40:43]
ds_read_b64_tr_b16 a[84:85], v4 offset:53248
ds_read_b64_tr_b16 a[86:87], v4 offset:55296
v_mfma_f32_16x16x32_bf16 v[44:47], a[92:95], v[100:103], v[44:47]
ds_read_b64_tr_b16 a[88:89], v5 offset:53248
ds_read_b64_tr_b16 a[90:91], v5 offset:55296
v_mfma_f32_16x16x32_bf16 v[52:55], a[96:99], v[100:103], v[52:55]
ds_read_b64_tr_b16 a[92:93], v6 offset:53248
ds_read_b64_tr_b16 a[94:95], v6 offset:55296
v_mfma_f32_16x16x32_bf16 v[48:51], a[96:99], v[68:71], v[48:51]
ds_read_b64_tr_b16 a[96:97], v7 offset:53248
ds_read_b64_tr_b16 a[98:99], v7 offset:55296
v_mfma_f32_16x16x32_bf16 v[24:27], a[100:103], v[84:87], v[24:27]
v_mfma_f32_16x16x32_bf16 v[28:31], a[100:103], v[116:119], v[28:31]
ds_read_b64_tr_b16 a[100:101], v4 offset:57344
ds_read_b64_tr_b16 a[102:103], v4 offset:59392
v_mfma_f32_16x16x32_bf16 v[36:39], a[104:107], v[116:119], v[36:39]
v_mfma_f32_16x16x32_bf16 v[32:35], a[104:107], v[84:87], v[32:35]
s_waitcnt lgkmcnt(12)
ds_read_b64_tr_b16 a[104:105], v5 offset:57344
ds_read_b64_tr_b16 a[106:107], v5 offset:59392
v_mfma_f32_16x16x32_bf16 v[40:43], a[108:111], v[84:87], v[40:43]
v_mfma_f32_16x16x32_bf16 v[44:47], a[108:111], v[116:119], v[44:47]
ds_read_b64_tr_b16 a[108:109], v6 offset:57344
ds_read_b64_tr_b16 a[110:111], v6 offset:59392
v_mfma_f32_16x16x32_bf16 v[52:55], a[112:115], v[116:119], v[52:55]
v_mfma_f32_16x16x32_bf16 v[48:51], a[112:115], v[84:87], v[48:51]
ds_read_b64_tr_b16 a[112:113], v7 offset:57344
ds_read_b64_tr_b16 a[114:115], v7 offset:59392
v_mfma_f32_16x16x32_bf16 v[24:27], a[116:119], v[72:75], v[24:27]
v_mov_b32 v17, 3
v_mfma_f32_16x16x32_bf16 v[28:31], a[116:119], v[104:107], v[28:31]
ds_read_b64_tr_b16 a[116:117], v4 offset:61440
ds_read_b64_tr_b16 a[118:119], v4 offset:63488
v_mfma_f32_16x16x32_bf16 v[36:39], a[120:123], v[104:107], v[36:39]
v_mfma_f32_16x16x32_bf16 v[32:35], a[120:123], v[72:75], v[32:35]
s_waitcnt vmcnt(0)
ds_read_b64_tr_b16 a[120:121], v5 offset:61440
buffer_store_dword v17, v11, s[12:15], s49 offen sc1
v_mfma_f32_16x16x32_bf16 v[40:43], a[124:127], v[72:75], v[40:43]
ds_read_b64_tr_b16 a[122:123], v5 offset:63488
v_mfma_f32_16x16x32_bf16 v[44:47], a[124:127], v[104:107], v[44:47]
s_waitcnt lgkmcnt(8)
ds_read_b64_tr_b16 a[124:125], v6 offset:61440
ds_read_b64_tr_b16 a[126:127], v6 offset:63488
v_mfma_f32_16x16x32_bf16 v[52:55], a[128:131], v[104:107], v[52:55]
v_mfma_f32_16x16x32_bf16 v[48:51], a[128:131], v[72:75], v[48:51]
ds_read_b64_tr_b16 a[128:129], v7 offset:61440
ds_read_b64_tr_b16 a[130:131], v7 offset:63488
v_mfma_f32_16x16x32_bf16 v[24:27], a[84:87], v[88:91], v[24:27]
v_mfma_f32_16x16x32_bf16 v[28:31], a[84:87], v[120:123], v[28:31]
v_mfma_f32_16x16x32_bf16 v[36:39], a[88:91], v[120:123], v[36:39]
v_mfma_f32_16x16x32_bf16 v[32:35], a[88:91], v[88:91], v[32:35]
v_mfma_f32_16x16x32_bf16 v[40:43], a[92:95], v[88:91], v[40:43]
v_mfma_f32_16x16x32_bf16 v[44:47], a[92:95], v[120:123], v[44:47]
v_mfma_f32_16x16x32_bf16 v[52:55], a[96:99], v[120:123], v[52:55]
v_mfma_f32_16x16x32_bf16 v[48:51], a[96:99], v[88:91], v[48:51]
v_mfma_f32_16x16x32_bf16 v[24:27], a[100:103], v[76:79], v[24:27]
s_barrier
ds_read_b64_tr_b16 a[84:85], v0 offset:0
ds_read_b64_tr_b16 a[86:87], v0 offset:2048
v_mfma_f32_16x16x32_bf16 v[28:31], a[100:103], v[108:111], v[28:31]
ds_read_b64_tr_b16 a[88:89], v1 offset:0
ds_read_b64_tr_b16 a[90:91], v1 offset:2048
v_mfma_f32_16x16x32_bf16 v[36:39], a[104:107], v[108:111], v[36:39]
ds_read_b64_tr_b16 a[92:93], v2 offset:0
ds_read_b64_tr_b16 a[94:95], v2 offset:2048
v_mfma_f32_16x16x32_bf16 v[32:35], a[104:107], v[76:79], v[32:35]
s_waitcnt lgkmcnt(6)
ds_read_b64_tr_b16 a[96:97], v3 offset:0
ds_read_b64_tr_b16 a[98:99], v3 offset:2048
v_mfma_f32_16x16x32_bf16 v[40:43], a[108:111], v[76:79], v[40:43]
ds_read_b64_tr_b16 a[100:101], v0 offset:4096
ds_read_b64_tr_b16 a[102:103], v0 offset:6144
v_mfma_f32_16x16x32_bf16 v[44:47], a[108:111], v[108:111], v[44:47]
ds_read_b64_tr_b16 a[104:105], v1 offset:4096
ds_read_b64_tr_b16 a[106:107], v1 offset:6144
v_mfma_f32_16x16x32_bf16 v[52:55], a[112:115], v[108:111], v[52:55]
ds_read_b64_tr_b16 a[108:109], v2 offset:4096
ds_read_b64_tr_b16 a[110:111], v2 offset:6144
v_mfma_f32_16x16x32_bf16 v[48:51], a[112:115], v[76:79], v[48:51]
ds_read_b64_tr_b16 a[112:113], v3 offset:4096
v_cmp_gt_u32_e64 vcc, 2, v16
v_mfma_f32_16x16x32_bf16 v[24:27], a[116:119], v[92:95], v[24:27]
s_and_b32 vcc_lo, vcc_lo, 0xffff
s_cbranch_scc1 k1_p2
k1_p2r:
buffer_load_dwordx4 a[32:35], v8, s[28:31], s57 offen sc1
v_mfma_f32_16x16x32_bf16 v[28:31], a[116:119], v[124:127], v[28:31]
s_mov_b32 s57, 75776
buffer_load_dwordx4 a[36:39], v8, s[28:31], s58 offen sc1
buffer_load_dwordx4 a[40:43], v8, s[28:31], s59 offen sc1
v_mfma_f32_16x16x32_bf16 v[36:39], a[120:123], v[124:127], v[36:39]
s_mov_b32 s58, 94208
s_mov_b32 s59, 112640
buffer_load_dwordx4 a[44:47], v8, s[28:31], s56 offen sc1
v_mfma_f32_16x16x32_bf16 v[32:35], a[120:123], v[92:95], v[32:35]
s_mov_b32 s56, 131072
ds_read_b64_tr_b16 a[114:115], v3 offset:6144
buffer_load_dwordx4 a[48:51], v8, s[28:31], s57 offen sc1
v_mfma_f32_16x16x32_bf16 v[40:43], a[124:127], v[92:95], v[40:43]
ds_read_b64_tr_b16 a[116:117], v0 offset:8192
ds_read_b64_tr_b16 a[118:119], v0 offset:10240
v_mfma_f32_16x16x32_bf16 v[44:47], a[124:127], v[124:127], v[44:47]
ds_read_b64_tr_b16 a[120:121], v1 offset:8192
ds_read_b64_tr_b16 a[122:123], v1 offset:10240
v_mfma_f32_16x16x32_bf16 v[52:55], a[128:131], v[124:127], v[52:55]
ds_read_b64_tr_b16 a[124:125], v2 offset:8192
ds_read_b64_tr_b16 a[126:127], v2 offset:10240
v_mfma_f32_16x16x32_bf16 v[48:51], a[128:131], v[92:95], v[48:51]
s_waitcnt lgkmcnt(8)
ds_read_b64_tr_b16 a[128:129], v3 offset:8192
ds_read_b64_tr_b16 a[130:131], v3 offset:10240
v_mfma_f32_16x16x32_bf16 v[128:131], a[84:87], v[64:67], 0
v_cvt_pk_bf16_f32 v192, v24, v25
v_cvt_pk_bf16_f32 v193, v26, v27
v_mfma_f32_16x16x32_bf16 v[132:135], a[84:87], v[96:99], 0
ds_read_b64_tr_b16 a[84:85], v0 offset:12288
buffer_load_dwordx4 a[52:55], v8, s[28:31], s58 offen sc1
v_mfma_f32_16x16x32_bf16 v[140:143], a[88:91], v[96:99], 0
ds_read_b64_tr_b16 a[86:87], v0 offset:14336
v_cvt_pk_bf16_f32 v196, v28, v29
v_mfma_f32_16x16x32_bf16 v[136:139], a[88:91], v[64:67], 0
ds_read_b64_tr_b16 a[88:89], v1 offset:12288
ds_read_b64_tr_b16 a[90:91], v1 offset:14336
v_mfma_f32_16x16x32_bf16 v[144:147], a[92:95], v[64:67], 0
v_cvt_pk_bf16_f32 v197, v30, v31
v_cvt_pk_bf16_f32 v198, v36, v37
v_mfma_f32_16x16x32_bf16 v[148:151], a[92:95], v[96:99], 0
ds_read_b64_tr_b16 a[92:93], v2 offset:12288
ds_read_b64_tr_b16 a[94:95], v2 offset:14336
v_mfma_f32_16x16x32_bf16 v[156:159], a[96:99], v[96:99], 0
v_cvt_pk_bf16_f32 v194, v32, v33
v_cvt_pk_bf16_f32 v199, v38, v39
v_mfma_f32_16x16x32_bf16 v[152:155], a[96:99], v[64:67], 0
buffer_load_dwordx4 a[56:59], v8, s[28:31], s59 offen sc1
buffer_store_dwordx4 v[196:199], v20, s[28:31], s54 offen offset:2048 sc1
v_mfma_f32_16x16x32_bf16 v[128:131], a[100:103], v[80:83], v[128:131]
ds_read_b64_tr_b16 a[96:97], v3 offset:12288
ds_read_b64_tr_b16 a[98:99], v3 offset:14336
v_mfma_f32_16x16x32_bf16 v[132:135], a[100:103], v[112:115], v[132:135]
v_cvt_pk_bf16_f32 v195, v34, v35
v_cvt_pk_bf16_f32 v200, v40, v41
v_mfma_f32_16x16x32_bf16 v[140:143], a[104:107], v[112:115], v[140:143]
buffer_store_dwordx4 v[192:195], v20, s[28:31], s51 offen offset:2048 sc1
v_cvt_pk_bf16_f32 v201, v42, v43
v_mfma_f32_16x16x32_bf16 v[136:139], a[104:107], v[80:83], v[136:139]
v_cvt_pk_bf16_f32 v204, v44, v45
v_cvt_pk_bf16_f32 v205, v46, v47
v_mfma_f32_16x16x32_bf16 v[144:147], a[108:111], v[80:83], v[144:147]
v_cvt_pk_bf16_f32 v206, v52, v53
v_mfma_f32_16x16x32_bf16 v[148:151], a[108:111], v[112:115], v[148:151]
s_waitcnt lgkmcnt(4)
buffer_load_dwordx4 a[60:63], v8, s[28:31], s56 offen sc1
v_cvt_pk_bf16_f32 v207, v54, v55
v_mfma_f32_16x16x32_bf16 v[156:159], a[112:115], v[112:115], v[156:159]
buffer_store_dwordx4 v[204:207], v20, s[28:31], s54 offen offset:2560 sc1
v_cvt_pk_bf16_f32 v202, v48, v49
v_mfma_f32_16x16x32_bf16 v[152:155], a[112:115], v[80:83], v[152:155]
v_cvt_pk_bf16_f32 v203, v50, v51
v_mfma_f32_16x16x32_bf16 v[128:131], a[116:119], v[68:71], v[128:131]
s_barrier
ds_read_b64_tr_b16 a[100:101], v0 offset:16384
buffer_store_dwordx4 v[200:203], v20, s[28:31], s51 offen offset:2560 sc1
v_mfma_f32_16x16x32_bf16 v[132:135], a[116:119], v[100:103], v[132:135]
ds_read_b64_tr_b16 a[102:103], v0 offset:18432
ds_read_b64_tr_b16 a[104:105], v1 offset:16384
v_mfma_f32_16x16x32_bf16 v[140:143], a[120:123], v[100:103], v[140:143]
ds_read_b64_tr_b16 a[106:107], v1 offset:18432
ds_read_b64_tr_b16 a[108:109], v2 offset:16384
v_mfma_f32_16x16x32_bf16 v[136:139], a[120:123], v[68:71], v[136:139]
ds_read_b64_tr_b16 a[110:111], v2 offset:18432
ds_read_b64_tr_b16 a[112:113], v3 offset:16384
v_mfma_f32_16x16x32_bf16 v[144:147], a[124:127], v[68:71], v[144:147]
ds_read_b64_tr_b16 a[114:115], v3 offset:18432
ds_read_b64_tr_b16 a[116:117], v0 offset:20480
v_mfma_f32_16x16x32_bf16 v[148:151], a[124:127], v[100:103], v[148:151]
ds_read_b64_tr_b16 a[118:119], v0 offset:22528
ds_read_b64_tr_b16 a[120:121], v1 offset:20480
v_mfma_f32_16x16x32_bf16 v[156:159], a[128:131], v[100:103], v[156:159]
ds_read_b64_tr_b16 a[122:123], v1 offset:22528
ds_read_b64_tr_b16 a[124:125], v2 offset:20480
v_mfma_f32_16x16x32_bf16 v[152:155], a[128:131], v[68:71], v[152:155]
ds_read_b64_tr_b16 a[126:127], v2 offset:22528
ds_read_b64_tr_b16 a[128:129], v3 offset:20480
v_mfma_f32_16x16x32_bf16 v[128:131], a[84:87], v[84:87], v[128:131]
ds_read_b64_tr_b16 a[130:131], v3 offset:22528
v_mfma_f32_16x16x32_bf16 v[132:135], a[84:87], v[116:119], v[132:135]
ds_read_b64_tr_b16 a[84:85], v0 offset:24576
ds_read_b64_tr_b16 a[86:87], v0 offset:26624
v_mfma_f32_16x16x32_bf16 v[140:143], a[88:91], v[116:119], v[140:143]
v_mfma_f32_16x16x32_bf16 v[136:139], a[88:91], v[84:87], v[136:139]
s_waitcnt lgkmcnt(13)
ds_read_b64_tr_b16 a[88:89], v1 offset:24576
ds_read_b64_tr_b16 a[90:91], v1 offset:26624
v_mfma_f32_16x16x32_bf16 v[144:147], a[92:95], v[84:87], v[144:147]
v_mfma_f32_16x16x32_bf16 v[148:151], a[92:95], v[116:119], v[148:151]
ds_read_b64_tr_b16 a[92:93], v2 offset:24576
ds_read_b64_tr_b16 a[94:95], v2 offset:26624
v_mfma_f32_16x16x32_bf16 v[156:159], a[96:99], v[116:119], v[156:159]
v_mfma_f32_16x16x32_bf16 v[152:155], a[96:99], v[84:87], v[152:155]
ds_read_b64_tr_b16 a[96:97], v3 offset:24576
buffer_load_dword v16, v10, s[12:15], s49 offen sc1
v_mfma_f32_16x16x32_bf16 v[128:131], a[100:103], v[72:75], v[128:131]
ds_read_b64_tr_b16 a[98:99], v3 offset:26624
v_mfma_f32_16x16x32_bf16 v[132:135], a[100:103], v[104:107], v[132:135]
ds_read_b64_tr_b16 a[100:101], v0 offset:28672
ds_read_b64_tr_b16 a[102:103], v0 offset:30720
v_mfma_f32_16x16x32_bf16 v[140:143], a[104:107], v[104:107], v[140:143]
v_mfma_f32_16x16x32_bf16 v[136:139], a[104:107], v[72:75], v[136:139]
s_waitcnt lgkmcnt(8)
ds_read_b64_tr_b16 a[104:105], v1 offset:28672
ds_read_b64_tr_b16 a[106:107], v1 offset:30720
v_mfma_f32_16x16x32_bf16 v[144:147], a[108:111], v[72:75], v[144:147]
v_mfma_f32_16x16x32_bf16 v[148:151], a[108:111], v[104:107], v[148:151]
ds_read_b64_tr_b16 a[108:109], v2 offset:28672
ds_read_b64_tr_b16 a[110:111], v2 offset:30720
v_mfma_f32_16x16x32_bf16 v[156:159], a[112:115], v[104:107], v[156:159]
v_mfma_f32_16x16x32_bf16 v[152:155], a[112:115], v[72:75], v[152:155]
ds_read_b64_tr_b16 a[112:113], v3 offset:28672
ds_read_b64_tr_b16 a[114:115], v3 offset:30720
v_mfma_f32_16x16x32_bf16 v[128:131], a[116:119], v[88:91], v[128:131]
v_mfma_f32_16x16x32_bf16 v[132:135], a[116:119], v[120:123], v[132:135]
v_mfma_f32_16x16x32_bf16 v[140:143], a[120:123], v[120:123], v[140:143]
v_mfma_f32_16x16x32_bf16 v[136:139], a[120:123], v[88:91], v[136:139]
v_mfma_f32_16x16x32_bf16 v[144:147], a[124:127], v[88:91], v[144:147]
v_mfma_f32_16x16x32_bf16 v[148:151], a[124:127], v[120:123], v[148:151]
v_mfma_f32_16x16x32_bf16 v[156:159], a[128:131], v[120:123], v[156:159]
v_mfma_f32_16x16x32_bf16 v[152:155], a[128:131], v[88:91], v[152:155]
v_mfma_f32_16x16x32_bf16 v[128:131], a[84:87], v[76:79], v[128:131]
s_barrier
ds_read_b64_tr_b16 a[116:117], v0 offset:32768
ds_read_b64_tr_b16 a[118:119], v0 offset:34816
v_mfma_f32_16x16x32_bf16 v[132:135], a[84:87], v[108:111], v[132:135]
s_waitcnt lgkmcnt(2)
ds_read_b64_tr_b16 a[120:121], v1 offset:32768
ds_read_b64_tr_b16 a[122:123], v1 offset:34816
v_mfma_f32_16x16x32_bf16 v[140:143], a[88:91], v[108:111], v[140:143]
ds_read_b64_tr_b16 a[124:125], v2 offset:32768
ds_read_b64_tr_b16 a[126:127], v2 offset:34816
v_mfma_f32_16x16x32_bf16 v[136:139], a[88:91], v[76:79], v[136:139]
ds_read_b64_tr_b16 a[128:129], v3 offset:32768
ds_read_b64_tr_b16 a[130:131], v3 offset:34816
v_mfma_f32_16x16x32_bf16 v[144:147], a[92:95], v[76:79], v[144:147]
ds_read_b64_tr_b16 a[84:85], v0 offset:36864
ds_read_b64_tr_b16 a[86:87], v0 offset:38912
v_mfma_f32_16x16x32_bf16 v[148:151], a[92:95], v[108:111], v[148:151]
ds_read_b64_tr_b16 a[88:89], v1 offset:36864
ds_read_b64_tr_b16 a[90:91], v1 offset:38912
v_mfma_f32_16x16x32_bf16 v[156:159], a[96:99], v[108:111], v[156:159]
ds_read_b64_tr_b16 a[92:93], v2 offset:36864
ds_read_b64_tr_b16 a[94:95], v2 offset:38912
v_mfma_f32_16x16x32_bf16 v[152:155], a[96:99], v[76:79], v[152:155]
ds_read_b64_tr_b16 a[96:97], v3 offset:36864
ds_read_b64_tr_b16 a[98:99], v3 offset:38912
v_mfma_f32_16x16x32_bf16 v[128:131], a[100:103], v[92:95], v[128:131]
v_mfma_f32_16x16x32_bf16 v[132:135], a[100:103], v[124:127], v[132:135]
ds_read_b64_tr_b16 a[100:101], v0 offset:40960
ds_read_b64_tr_b16 a[102:103], v0 offset:43008
v_mfma_f32_16x16x32_bf16 v[140:143], a[104:107], v[124:127], v[140:143]
s_nop 3
v_cvt_pk_bf16_f32 v208, v128, v129
v_cvt_pk_bf16_f32 v209, v130, v131
v_mfma_f32_16x16x32_bf16 v[136:139], a[104:107], v[92:95], v[136:139]
ds_read_b64_tr_b16 a[104:105], v1 offset:40960
ds_read_b64_tr_b16 a[106:107], v1 offset:43008
v_mfma_f32_16x16x32_bf16 v[144:147], a[108:111], v[92:95], v[144:147]
v_cvt_pk_bf16_f32 v212, v132, v133
v_cvt_pk_bf16_f32 v213, v134, v135
v_mfma_f32_16x16x32_bf16 v[148:151], a[108:111], v[124:127], v[148:151]
ds_read_b64_tr_b16 a[108:109], v2 offset:40960
ds_read_b64_tr_b16 a[110:111], v2 offset:43008
v_mfma_f32_16x16x32_bf16 v[156:159], a[112:115], v[124:127], v[156:159]
v_cvt_pk_bf16_f32 v210, v136, v137
v_cvt_pk_bf16_f32 v211, v138, v139
v_mfma_f32_16x16x32_bf16 v[152:155], a[112:115], v[92:95], v[152:155]
s_waitcnt lgkmcnt(8)
ds_read_b64_tr_b16 a[112:113], v3 offset:40960
ds_read_b64_tr_b16 a[114:115], v3 offset:43008
v_mfma_f32_16x16x32_bf16 v[24:27], a[116:119], v[64:67], 0
v_cvt_pk_bf16_f32 v214, v140, v141
v_cvt_pk_bf16_f32 v215, v142, v143
v_mfma_f32_16x16x32_bf16 v[28:31], a[116:119], v[96:99], 0
ds_read_b64_tr_b16 a[116:117], v0 offset:45056
ds_read_b64_tr_b16 a[118:119], v0 offset:47104
v_mfma_f32_16x16x32_bf16 v[36:39], a[120:123], v[96:99], 0
v_cvt_pk_bf16_f32 v216, v144, v145
v_cvt_pk_bf16_f32 v217, v146, v147
v_mfma_f32_16x16x32_bf16 v[32:35], a[120:123], v[64:67], 0
ds_read_b64_tr_b16 a[120:121], v1 offset:45056
buffer_store_dwordx4 v[208:211], v20, s[28:31], s51 offen offset:3072 sc1
v_mfma_f32_16x16x32_bf16 v[40:43], a[124:127], v[64:67], 0
ds_read_b64_tr_b16 a[122:123], v1 offset:47104
v_cvt_pk_bf16_f32 v218, v152, v153
v_mfma_f32_16x16x32_bf16 v[44:47], a[124:127], v[96:99], 0
ds_read_b64_tr_b16 a[124:125], v2 offset:45056
ds_read_b64_tr_b16 a[126:127], v2 offset:47104
v_mfma_f32_16x16x32_bf16 v[52:55], a[128:131], v[96:99], 0
buffer_store_dwordx4 v[212:215], v20, s[28:31], s54 offen offset:3072 sc1
v_cvt_pk_bf16_f32 v219, v154, v155
v_mfma_f32_16x16x32_bf16 v[48:51], a[128:131], v[64:67], 0
ds_read_b64_tr_b16 a[128:129], v3 offset:45056
ds_read_b64_tr_b16 a[130:131], v3 offset:47104
v_mfma_f32_16x16x32_bf16 v[24:27], a[84:87], v[80:83], v[24:27]
v_cvt_pk_bf16_f32 v220, v148, v149
v_cvt_pk_bf16_f32 v221, v150, v151
v_mfma_f32_16x16x32_bf16 v[28:31], a[84:87], v[112:115], v[28:31]
buffer_store_dwordx4 v[216:219], v20, s[28:31], s51 offen offset:3584 sc1
v_cvt_pk_bf16_f32 v222, v156, v157
v_mfma_f32_16x16x32_bf16 v[36:39], a[88:91], v[112:115], v[36:39]
v_cvt_pk_bf16_f32 v223, v158, v159
v_mfma_f32_16x16x32_bf16 v[32:35], a[88:91], v[80:83], v[32:35]
v_mfma_f32_16x16x32_bf16 v[40:43], a[92:95], v[80:83], v[40:43]
buffer_store_dwordx4 v[220:223], v20, s[28:31], s54 offen offset:3584 sc1
v_mfma_f32_16x16x32_bf16 v[44:47], a[92:95], v[112:115], v[44:47]
s_waitcnt lgkmcnt(4)
v_mfma_f32_16x16x32_bf16 v[52:55], a[96:99], v[112:115], v[52:55]
v_mfma_f32_16x16x32_bf16 v[48:51], a[96:99], v[80:83], v[48:51]
v_mfma_f32_16x16x32_bf16 v[24:27], a[100:103], v[68:71], v[24:27]
s_barrier
ds_read_b64_tr_b16 a[84:85], v0 offset:49152
ds_read_b64_tr_b16 a[86:87], v0 offset:51200
v_mfma_f32_16x16x32_bf16 v[28:31], a[100:103], v[100:103], v[28:31]
ds_read_b64_tr_b16 a[88:89], v1 offset:49152
ds_read_b64_tr_b16 a[90:91], v1 offset:51200
v_mfma_f32_16x16x32_bf16 v[36:39], a[104:107], v[100:103], v[36:39]
ds_read_b64_tr_b16 a[92:93], v2 offset:49152
ds_read_b64_tr_b16 a[94:95], v2 offset:51200
v_mfma_f32_16x16x32_bf16 v[32:35], a[104:107], v[68:71], v[32:35]
ds_read_b64_tr_b16 a[96:97], v3 offset:49152
ds_read_b64_tr_b16 a[98:99], v3 offset:51200
v_mfma_f32_16x16x32_bf16 v[40:43], a[108:111], v[68:71], v[40:43]
ds_read_b64_tr_b16 a[100:101], v0 offset:53248
ds_read_b64_tr_b16 a[102:103], v0 offset:55296
v_mfma_f32_16x16x32_bf16 v[44:47], a[108:111], v[100:103], v[44:47]
ds_read_b64_tr_b16 a[104:105], v1 offset:53248
ds_read_b64_tr_b16 a[106:107], v1 offset:55296
v_mfma_f32_16x16x32_bf16 v[52:55], a[112:115], v[100:103], v[52:55]
ds_read_b64_tr_b16 a[108:109], v2 offset:53248
ds_read_b64_tr_b16 a[110:111], v2 offset:55296
v_mfma_f32_16x16x32_bf16 v[48:51], a[112:115], v[68:71], v[48:51]
ds_read_b64_tr_b16 a[112:113], v3 offset:53248
ds_read_b64_tr_b16 a[114:115], v3 offset:55296
v_mfma_f32_16x16x32_bf16 v[24:27], a[116:119], v[84:87], v[24:27]
v_mfma_f32_16x16x32_bf16 v[28:31], a[116:119], v[116:119], v[28:31]
ds_read_b64_tr_b16 a[116:117], v0 offset:57344
ds_read_b64_tr_b16 a[118:119], v0 offset:59392
v_mfma_f32_16x16x32_bf16 v[36:39], a[120:123], v[116:119], v[36:39]
v_mfma_f32_16x16x32_bf16 v[32:35], a[120:123], v[84:87], v[32:35]
s_waitcnt lgkmcnt(12)
ds_read_b64_tr_b16 a[120:121], v1 offset:57344
ds_read_b64_tr_b16 a[122:123], v1 offset:59392
v_mfma_f32_16x16x32_bf16 v[40:43], a[124:127], v[84:87], v[40:43]
v_mfma_f32_16x16x32_bf16 v[44:47], a[124:127], v[116:119], v[44:47]
ds_read_b64_tr_b16 a[124:125], v2 offset:57344
ds_read_b64_tr_b16 a[126:127], v2 offset:59392
v_mfma_f32_16x16x32_bf16 v[52:55], a[128:131], v[116:119], v[52:55]
v_mfma_f32_16x16x32_bf16 v[48:51], a[128:131], v[84:87], v[48:51]
ds_read_b64_tr_b16 a[128:129], v3 offset:57344
ds_read_b64_tr_b16 a[130:131], v3 offset:59392
v_mfma_f32_16x16x32_bf16 v[24:27], a[84:87], v[72:75], v[24:27]
v_mfma_f32_16x16x32_bf16 v[28:31], a[84:87], v[104:107], v[28:31]
ds_read_b64_tr_b16 a[84:85], v0 offset:61440
ds_read_b64_tr_b16 a[86:87], v0 offset:63488
v_mfma_f32_16x16x32_bf16 v[36:39], a[88:91], v[104:107], v[36:39]
v_mfma_f32_16x16x32_bf16 v[32:35], a[88:91], v[72:75], v[32:35]
ds_read_b64_tr_b16 a[88:89], v1 offset:61440
ds_read_b64_tr_b16 a[90:91], v1 offset:63488
v_mfma_f32_16x16x32_bf16 v[40:43], a[92:95], v[72:75], v[40:43]
v_mfma_f32_16x16x32_bf16 v[44:47], a[92:95], v[104:107], v[44:47]
s_waitcnt lgkmcnt(8)
ds_read_b64_tr_b16 a[92:93], v2 offset:61440
ds_read_b64_tr_b16 a[94:95], v2 offset:63488
v_mfma_f32_16x16x32_bf16 v[52:55], a[96:99], v[104:107], v[52:55]
v_mfma_f32_16x16x32_bf16 v[48:51], a[96:99], v[72:75], v[48:51]
ds_read_b64_tr_b16 a[96:97], v3 offset:61440
ds_read_b64_tr_b16 a[98:99], v3 offset:63488
v_mfma_f32_16x16x32_bf16 v[24:27], a[100:103], v[88:91], v[24:27]
v_mfma_f32_16x16x32_bf16 v[28:31], a[100:103], v[120:123], v[28:31]
v_mfma_f32_16x16x32_bf16 v[36:39], a[104:107], v[120:123], v[36:39]
v_mfma_f32_16x16x32_bf16 v[32:35], a[104:107], v[88:91], v[32:35]
v_mfma_f32_16x16x32_bf16 v[40:43], a[108:111], v[88:91], v[40:43]
v_mfma_f32_16x16x32_bf16 v[44:47], a[108:111], v[120:123], v[44:47]
v_mfma_f32_16x16x32_bf16 v[52:55], a[112:115], v[120:123], v[52:55]
v_mfma_f32_16x16x32_bf16 v[48:51], a[112:115], v[88:91], v[48:51]
v_mfma_f32_16x16x32_bf16 v[24:27], a[116:119], v[76:79], v[24:27]
v_mfma_f32_16x16x32_bf16 v[28:31], a[116:119], v[108:111], v[28:31]
v_mfma_f32_16x16x32_bf16 v[36:39], a[120:123], v[108:111], v[36:39]
v_mfma_f32_16x16x32_bf16 v[32:35], a[120:123], v[76:79], v[32:35]
s_waitcnt lgkmcnt(0)
v_mfma_f32_16x16x32_bf16 v[40:43], a[124:127], v[76:79], v[40:43]
v_mfma_f32_16x16x32_bf16 v[44:47], a[124:127], v[108:111], v[44:47]
v_mfma_f32_16x16x32_bf16 v[52:55], a[128:131], v[108:111], v[52:55]
v_mfma_f32_16x16x32_bf16 v[48:51], a[128:131], v[76:79], v[48:51]
v_mfma_f32_16x16x32_bf16 v[24:27], a[84:87], v[92:95], v[24:27]
v_mfma_f32_16x16x32_bf16 v[28:31], a[84:87], v[124:127], v[28:31]
v_mfma_f32_16x16x32_bf16 v[36:39], a[88:91], v[124:127], v[36:39]
s_nop 5
v_cvt_pk_bf16_f32 v192, v24, v25
v_cvt_pk_bf16_f32 v193, v26, v27
v_mfma_f32_16x16x32_bf16 v[32:35], a[88:91], v[92:95], v[32:35]
v_cvt_pk_bf16_f32 v196, v28, v29
v_mfma_f32_16x16x32_bf16 v[40:43], a[92:95], v[92:95], v[40:43]
v_cvt_pk_bf16_f32 v197, v30, v31
v_cvt_pk_bf16_f32 v198, v36, v37
v_mfma_f32_16x16x32_bf16 v[44:47], a[92:95], v[124:127], v[44:47]
s_nop 2
v_cvt_pk_bf16_f32 v194, v32, v33
v_mfma_f32_16x16x32_bf16 v[52:55], a[96:99], v[124:127], v[52:55]
v_cvt_pk_bf16_f32 v195, v34, v35
v_cvt_pk_bf16_f32 v199, v38, v39
v_mfma_f32_16x16x32_bf16 v[48:51], a[96:99], v[92:95], v[48:51]
buffer_store_dwordx4 v[192:195], v20, s[28:31], s52 offen offset:0 sc1
buffer_store_dwordx4 v[196:199], v20, s[28:31], s55 offen offset:0 sc1
v_cvt_pk_bf16_f32 v200, v40, v41
v_cvt_pk_bf16_f32 v201, v42, v43
v_cvt_pk_bf16_f32 v204, v44, v45
v_cvt_pk_bf16_f32 v205, v46, v47
s_nop 1
v_cvt_pk_bf16_f32 v202, v48, v49
v_cvt_pk_bf16_f32 v203, v50, v51
v_cvt_pk_bf16_f32 v206, v52, v53
v_cvt_pk_bf16_f32 v207, v54, v55
buffer_store_dwordx4 v[200:203], v20, s[28:31], s52 offen offset:512 sc1
buffer_store_dwordx4 v[204:207], v20, s[28:31], s55 offen offset:512 sc1
v_mov_b32 v17, 4
s_waitcnt vmcnt(4)
buffer_store_dword v17, v11, s[12:15], s49 offen sc1
v_cmp_gt_u32 vcc, 3, v16
s_nop 0
s_and_b32 vcc_lo, vcc_lo, 0xffff
s_cbranch_scc1 k1_p3
k1_p3r:
s_movk_i32 s57, 4096
buffer_load_dwordx4 a[136:139], v8, s[28:31], s57 offen sc1
s_mov_b32 s58, 22528
buffer_load_dwordx4 a[140:143], v8, s[28:31], s58 offen sc1
s_mov_b32 s59, 40960
buffer_load_dwordx4 a[144:147], v8, s[28:31], s59 offen sc1
s_mov_b32 s56, 59392
buffer_load_dwordx4 a[148:151], v8, s[28:31], s56 offen sc1
s_mov_b32 s57, 77824
buffer_load_dwordx4 a[152:155], v8, s[28:31], s57 offen sc1
s_mov_b32 s58, 96256
buffer_load_dwordx4 a[156:159], v8, s[28:31], s58 offen sc1
s_mov_b32 s59, 114688
buffer_load_dwordx4 a[160:163], v8, s[28:31], s59 offen sc1
s_mov_b32 s56, 133120
buffer_load_dwordx4 a[164:167], v8, s[28:31], s56 offen sc1
v_accvgpr_read_b32 v236, a200
v_accvgpr_read_b32 v237, a201
v_accvgpr_read_b32 v238, a202
v_accvgpr_read_b32 v239, a203
v_accvgpr_read_b32 v240, a204
v_accvgpr_read_b32 v241, a205
v_accvgpr_read_b32 v242, a206
v_accvgpr_read_b32 v243, a207
v_accvgpr_read_b32 v244, a208
v_accvgpr_read_b32 v245, a209
v_accvgpr_read_b32 v246, a210
v_accvgpr_read_b32 v247, a211
v_accvgpr_read_b32 v248, a212
v_accvgpr_read_b32 v249, a213
v_accvgpr_read_b32 v250, a214
v_accvgpr_read_b32 v251, a215
v_add_f32 v236, v236, v240
v_add_f32 v244, v244, v248
v_add_f32 v237, v237, v241
v_add_f32 v245, v245, v249
v_add_f32 v238, v238, v242
v_add_f32 v246, v246, v250
v_add_f32 v239, v239, v243
v_add_f32 v247, v247, v251
v_add_f32 v236, v236, v244
v_add_f32 v237, v237, v245
v_add_f32 v238, v238, v246
v_add_f32 v239, v239, v247
v_cvt_pk_bf16_f32 v236, v236, v237
v_and_b32 v237, 0xffff0000, v236
v_lshlrev_b32_e64 v236, 16, v236
v_cvt_pk_bf16_f32 v238, v238, v239
v_and_b32 v239, 0xffff0000, v238
v_lshlrev_b32 v238, 16, v238
v_mul_f32 v236, v226, v236
v_mul_f32 v237, v226, v237
v_mul_f32 v238, v226, v238
v_mul_f32_e64 v239, v226, v239
ds_write_b128 v255, v[236:239]
v_accvgpr_read_b32 v236, a232
v_accvgpr_read_b32 v237, a233
v_accvgpr_read_b32 v238, a234
v_accvgpr_read_b32 v239, a235
v_accvgpr_read_b32 v240, a236
v_accvgpr_read_b32 v241, a237
v_accvgpr_read_b32 v242, a238
v_accvgpr_read_b32 v243, a239
v_accvgpr_read_b32 v244, a240
v_accvgpr_read_b32 v245, a241
v_accvgpr_read_b32 v246, a242
v_accvgpr_read_b32 v247, a243
v_accvgpr_read_b32 v248, a244
v_accvgpr_read_b32 v249, a245
v_accvgpr_read_b32 v250, a246
v_accvgpr_read_b32 v251, a247
v_add_f32 v236, v236, v240
v_add_f32 v244, v244, v248
v_add_f32 v237, v237, v241
v_add_f32 v245, v245, v249
v_add_f32 v238, v238, v242
v_add_f32 v246, v246, v250
v_add_f32 v239, v239, v243
v_add_f32 v247, v247, v251
v_add_f32 v236, v236, v244
v_add_f32 v237, v237, v245
v_add_f32 v238, v238, v246
v_add_f32 v239, v239, v247
v_cvt_pk_bf16_f32 v236, v236, v237
v_and_b32 v237, 0xffff0000, v236
v_lshlrev_b32_e64 v236, 16, v236
v_cvt_pk_bf16_f32 v238, v238, v239
v_and_b32 v239, 0xffff0000, v238
v_lshlrev_b32 v238, 16, v238
v_add_f32 v236, v224, v236
v_add_f32 v237, v224, v237
v_add_f32 v238, v224, v238
v_add_f32_e64 v239, v224, v239
v_cvt_pk_bf16_f32 v236, v236, v237
v_and_b32 v237, 0xffff0000, v236
v_lshlrev_b32_e64 v236, 16, v236
v_cvt_pk_bf16_f32 v238, v238, v239
v_and_b32 v239, 0xffff0000, v238
v_lshlrev_b32 v238, 16, v238
v_mul_f32 v236, v225, v236
v_mul_f32 v237, v225, v237
v_mul_f32 v238, v225, v238
v_mul_f32_e64 v239, v225, v239
ds_write_b128 v254, v[236:239]
v_accvgpr_read_b32 v232, a248
v_accvgpr_read_b32 v233, a249
v_accvgpr_read_b32 v234, a250
v_accvgpr_read_b32 v235, a251
v_add_f32 v232, v232, v233
v_add_f32 v234, v234, v235
v_add_f32_e64 v232, v232, v234
v_cvt_pk_bf16_f32 v232, v232, v232
v_lshlrev_b32_e64 v232, 16, v232
v_mul_f32 v232, 0x3f317218, v232
ds_write_b32 v227, v232
s_waitcnt lgkmcnt(0)
s_barrier
ds_read_b128 v[64:67], v22 offset:0
ds_read_b128 v[68:71], v22 offset:512
ds_read_b128 v[72:75], v22 offset:1024
ds_read_b128 v[76:79], v22 offset:1536
ds_read_b128 v[80:83], v22 offset:2048
ds_read_b128 v[84:87], v22 offset:2304
ds_read_b128 v[88:91], v22 offset:2816
ds_read_b128 v[92:95], v22 offset:3328
ds_read_b128 v[96:99], v22 offset:3840
ds_read_b128 v[100:103], v22 offset:4352
ds_read_b128 v[104:107], v22 offset:4608
ds_read_b128 v[108:111], v22 offset:5120
ds_read_b128 v[112:115], v22 offset:5632
ds_read_b128 v[116:119], v22 offset:6144
ds_read_b128 v[120:123], v22 offset:6656
v_mfma_f32_16x16x32_bf16 v[160:163], v[12:15], a[0:3], 0
v_mfma_f32_16x16x32_bf16 v[160:163], v[12:15], a[4:7], v[160:163]
v_mfma_f32_16x16x32_bf16 v[160:163], v[12:15], a[8:11], v[160:163]
v_mfma_f32_16x16x32_bf16 v[160:163], v[12:15], a[12:15], v[160:163]
v_mfma_f32_16x16x32_bf16 v[160:163], v[12:15], a[16:19], v[160:163]
v_mfma_f32_16x16x32_bf16 v[160:163], v[12:15], a[20:23], v[160:163]
v_mfma_f32_16x16x32_bf16 v[160:163], v[12:15], a[24:27], v[160:163]
v_mfma_f32_16x16x32_bf16 v[160:163], v[12:15], a[28:31], v[160:163]
s_waitcnt lgkmcnt(14)
v_and_b32 v25, 0xffff0000, v180
v_lshlrev_b32 v24, 16, v180
v_and_b32 v27, 0xffff0000, v181
v_lshlrev_b32 v26, 16, v181
s_nop 2
v_fmac_f32 v24, v160, v64
v_fmac_f32 v25, v161, v65
v_fmac_f32 v26, v162, v66
v_fmac_f32 v27, v163, v67
v_cvt_pk_bf16_f32 v180, v24, v25
v_cvt_pk_bf16_f32 v181, v26, v27
v_and_b32 v25, 0xffff0000, v180
v_lshlrev_b32_e64 v24, 16, v180
v_and_b32 v27, 0xffff0000, v181
v_lshlrev_b32_e64 v26, 16, v181
v_mfma_f32_16x16x32_bf16 v[164:167], v[12:15], a[32:35], 0
v_mfma_f32_16x16x32_bf16 v[164:167], v[12:15], a[36:39], v[164:167]
v_mfma_f32_16x16x32_bf16 v[164:167], v[12:15], a[40:43], v[164:167]
v_mfma_f32_16x16x32_bf16 v[164:167], v[12:15], a[44:47], v[164:167]
v_mfma_f32_16x16x32_bf16 v[164:167], v[12:15], a[48:51], v[164:167]
v_mfma_f32_16x16x32_bf16 v[164:167], v[12:15], a[52:55], v[164:167]
v_mfma_f32_16x16x32_bf16 v[164:167], v[12:15], a[56:59], v[164:167]
v_mfma_f32_16x16x32_bf16 v[164:167], v[12:15], a[60:63], v[164:167]
s_waitcnt lgkmcnt(0)
v_and_b32 v29, 0xffff0000, v182
v_lshlrev_b32 v28, 16, v182
v_and_b32 v31, 0xffff0000, v183
v_lshlrev_b32 v30, 16, v183
s_nop 2
v_fmac_f32 v28, v164, v68
v_fmac_f32 v29, v165, v69
v_fmac_f32 v30, v166, v70
v_fmac_f32 v31, v167, v71
v_cvt_pk_bf16_f32 v182, v28, v29
v_cvt_pk_bf16_f32 v183, v30, v31
v_and_b32 v29, 0xffff0000, v182
v_lshlrev_b32_e64 v28, 16, v182
v_and_b32 v31, 0xffff0000, v183
v_lshlrev_b32_e64 v30, 16, v183
buffer_load_dword v16, v10, s[12:15], s49 offen sc1
s_waitcnt vmcnt(8)
v_mfma_f32_16x16x32_bf16 v[168:171], v[12:15], a[136:139], 0
s_waitcnt vmcnt(7)
v_mfma_f32_16x16x32_bf16 v[168:171], v[12:15], a[140:143], v[168:171]
s_waitcnt vmcnt(6)
v_mfma_f32_16x16x32_bf16 v[168:171], v[12:15], a[144:147], v[168:171]
s_waitcnt vmcnt(5)
v_mfma_f32_16x16x32_bf16 v[168:171], v[12:15], a[148:151], v[168:171]
s_waitcnt vmcnt(4)
v_mfma_f32_16x16x32_bf16 v[168:171], v[12:15], a[152:155], v[168:171]
s_waitcnt vmcnt(3)
v_mfma_f32_16x16x32_bf16 v[168:171], v[12:15], a[156:159], v[168:171]
s_waitcnt vmcnt(2)
v_mfma_f32_16x16x32_bf16 v[168:171], v[12:15], a[160:163], v[168:171]
s_waitcnt vmcnt(1)
v_mfma_f32_16x16x32_bf16 v[168:171], v[12:15], a[164:167], v[168:171]
v_and_b32 v33, 0xffff0000, v184
v_lshlrev_b32_e64 v32, 16, v184
v_and_b32 v35, 0xffff0000, v185
v_lshlrev_b32 v34, 16, v185
s_nop 3
v_fmac_f32 v32, v168, v72
v_fmac_f32 v33, v169, v73
v_fmac_f32 v34, v170, v74
v_fmac_f32 v35, v171, v75
v_cvt_pk_bf16_f32 v184, v32, v33
v_cvt_pk_bf16_f32 v185, v34, v35
v_and_b32 v33, 0xffff0000, v184
v_lshlrev_b32_e64 v32, 16, v184
v_and_b32 v35, 0xffff0000, v185
v_lshlrev_b32 v34, 16, v185
s_waitcnt vmcnt(0)
v_cmp_gt_u32 vcc, 4, v16
s_nop 0
s_and_b32 vcc_lo, vcc_lo, 0xffff
s_cbranch_scc1 k1_p4
k1_p4r:
s_movk_i32 s57, 6144
buffer_load_dwordx4 a[168:171], v8, s[28:31], s57 offen sc1
s_mov_b32 s58, 24576
buffer_load_dwordx4 a[172:175], v8, s[28:31], s58 offen sc1
s_mov_b32 s59, 43008
buffer_load_dwordx4 a[176:179], v8, s[28:31], s59 offen sc1
s_mov_b32 s56, 61440
buffer_load_dwordx4 a[180:183], v8, s[28:31], s56 offen sc1
s_mov_b32 s57, 79872
buffer_load_dwordx4 a[184:187], v8, s[28:31], s57 offen sc1
s_mov_b32 s58, 98304
buffer_load_dwordx4 a[188:191], v8, s[28:31], s58 offen sc1
s_mov_b32 s59, 116736
buffer_load_dwordx4 a[192:195], v8, s[28:31], s59 offen sc1
s_mov_b32 s56, 135168
buffer_load_dwordx4 a[196:199], v8, s[28:31], s56 offen sc1
s_mov_b32 s57, 8192
buffer_load_dwordx4 a[200:203], v9, s[28:31], s57 offen sc1
s_mov_b32 s58, 26624
buffer_load_dwordx4 a[204:207], v9, s[28:31], s58 offen sc1
s_mov_b32 s59, 45056
buffer_load_dwordx4 a[208:211], v9, s[28:31], s59 offen sc1
s_mov_b32 s56, 63488
buffer_load_dwordx4 a[212:215], v9, s[28:31], s56 offen sc1
s_mov_b32 s57, 81920
buffer_load_dwordx4 a[216:219], v9, s[28:31], s57 offen sc1
s_mov_b32 s58, 100352
buffer_load_dwordx4 a[220:223], v9, s[28:31], s58 offen sc1
s_mov_b32 s59, 118784
buffer_load_dwordx4 a[224:227], v9, s[28:31], s59 offen sc1
s_mov_b32 s56, 137216
buffer_load_dwordx4 a[228:231], v9, s[28:31], s56 offen sc1
v_add_f32 v44, v24, v25
v_add_f32 v45, v26, v27
v_add_f32 v44, v44, v28
v_add_f32 v45, v45, v29
v_add_f32 v44, v44, v30
v_add_f32 v45, v45, v31
v_add_f32 v44, v44, v32
v_add_f32 v45, v45, v33
v_add_f32 v44, v44, v34
v_add_f32 v45, v45, v35
v_add_f32 v44, v44, v45
s_nop 1
v_add_f32_dpp v44, v44, v44 row_ror:8 row_mask:0xf bank_mask:0xf
v_mov_b32 v45, v44
s_nop 1
v_permlane16_swap_b32 v45, v44
v_add_f32 v44, v44, v45
v_mov_b32 v45, v44
s_nop 1
v_permlane32_swap_b32 v45, v44
v_add_f32 v44, v44, v45
ds_write_b32 v58, v44
s_waitcnt lgkmcnt(0)
s_barrier
ds_read_b128 v[48:51], v59
s_waitcnt lgkmcnt(0)
v_add_f32 v48, v48, v49
v_add_f32 v50, v50, v51
v_add_f32 v48, v48, v50
v_mul_f32 v46, 0xbb2aaaab, v48
v_mul_f32 v47, s70, v46
v_add_f32 v24, v24, v46
v_add_f32 v25, v25, v46
v_add_f32 v26, v26, v46
v_add_f32 v27, v27, v46
v_add_f32 v44, v24, v25
v_mul_f32 v45, v24, v24
v_fmac_f32 v45, v25, v25
v_add_f32 v44, v44, v26
v_fmac_f32 v45, v26, v26
v_add_f32 v44, v44, v27
v_fmac_f32 v45, v27, v27
v_add_f32 v28, v28, v46
v_add_f32 v29, v29, v46
v_add_f32 v30, v30, v46
v_add_f32 v31, v31, v46
v_add_f32 v44, v44, v28
v_fmac_f32 v45, v28, v28
v_add_f32 v44, v44, v29
v_fmac_f32 v45, v29, v29
v_add_f32 v44, v44, v30
v_fmac_f32 v45, v30, v30
v_add_f32 v44, v44, v31
v_fmac_f32 v45, v31, v31
v_add_f32 v32, v32, v46
v_add_f32 v33, v33, v46
v_add_f32 v34, v34, v46
v_add_f32 v35, v35, v46
v_add_f32 v44, v44, v32
v_fmac_f32 v45, v32, v32
v_add_f32 v44, v44, v33
v_fmac_f32 v45, v33, v33
v_add_f32 v44, v44, v34
v_fmac_f32 v45, v34, v34
v_add_f32 v44, v44, v35
v_fmac_f32 v45, v35, v35
s_waitcnt vmcnt(15)
v_mfma_f32_16x16x32_bf16 v[172:175], v[12:15], a[168:171], 0
s_waitcnt vmcnt(14)
v_mfma_f32_16x16x32_bf16 v[172:175], v[12:15], a[172:175], v[172:175]
s_waitcnt vmcnt(13)
v_mfma_f32_16x16x32_bf16 v[172:175], v[12:15], a[176:179], v[172:175]
s_waitcnt vmcnt(12)
v_mfma_f32_16x16x32_bf16 v[172:175], v[12:15], a[180:183], v[172:175]
s_waitcnt vmcnt(11)
v_mfma_f32_16x16x32_bf16 v[172:175], v[12:15], a[184:187], v[172:175]
s_waitcnt vmcnt(10)
v_mfma_f32_16x16x32_bf16 v[172:175], v[12:15], a[188:191], v[172:175]
s_waitcnt vmcnt(9)
v_mfma_f32_16x16x32_bf16 v[172:175], v[12:15], a[192:195], v[172:175]
s_waitcnt vmcnt(8)
v_mfma_f32_16x16x32_bf16 v[172:175], v[12:15], a[196:199], v[172:175]
v_and_b32 v37, 0xffff0000, v186
v_lshlrev_b32_e64 v36, 16, v186
v_and_b32 v39, 0xffff0000, v187
v_lshlrev_b32 v38, 16, v187
s_nop 3
v_fmac_f32 v36, v172, v76
v_fmac_f32 v37, v173, v77
v_fmac_f32 v38, v174, v78
v_fmac_f32 v39, v175, v79
v_cvt_pk_bf16_f32 v186, v36, v37
v_cvt_pk_bf16_f32 v187, v38, v39
v_and_b32 v37, 0xffff0000, v186
v_lshlrev_b32_e64 v36, 16, v186
v_and_b32 v39, 0xffff0000, v187
v_lshlrev_b32 v38, 16, v187
v_add_f32 v36, v36, v46
v_add_f32 v37, v37, v46
v_add_f32 v38, v38, v46
v_add_f32 v39, v39, v46
v_add_f32 v44, v44, v36
v_fmac_f32 v45, v36, v36
v_add_f32 v44, v44, v37
v_fmac_f32 v45, v37, v37
v_add_f32 v44, v44, v38
v_fmac_f32 v45, v38, v38
v_add_f32 v44, v44, v39
v_fmac_f32 v45, v39, v39
s_waitcnt vmcnt(7)
v_mfma_f32_16x16x32_bf16 v[176:179], v[12:15], a[200:203], 0
s_waitcnt vmcnt(6)
v_mfma_f32_16x16x32_bf16 v[176:179], v[12:15], a[204:207], v[176:179]
s_waitcnt vmcnt(5)
v_mfma_f32_16x16x32_bf16 v[176:179], v[12:15], a[208:211], v[176:179]
s_waitcnt vmcnt(4)
v_mfma_f32_16x16x32_bf16 v[176:179], v[12:15], a[212:215], v[176:179]
s_waitcnt vmcnt(3)
v_mfma_f32_16x16x32_bf16 v[176:179], v[12:15], a[216:219], v[176:179]
s_waitcnt vmcnt(2)
v_mfma_f32_16x16x32_bf16 v[176:179], v[12:15], a[220:223], v[176:179]
s_waitcnt vmcnt(1)
v_mfma_f32_16x16x32_bf16 v[176:179], v[12:15], a[224:227], v[176:179]
s_waitcnt vmcnt(0)
v_mfma_f32_16x16x32_bf16 v[176:179], v[12:15], a[228:231], v[176:179]
s_nop 7
v_cmp_u_f32_e64 vcc, v176, v176
s_nop 0
s_cbranch_vccnz k1_p5
k1_p5r:
v_and_b32 v41, 0xffff0000, v188
v_lshlrev_b32_e64 v40, 16, v188
v_and_b32 v43, 0xffff0000, v189
v_lshlrev_b32 v42, 16, v189
v_fmac_f32 v40, v176, v80
v_fmac_f32 v41, v177, v81
v_fmac_f32 v42, v178, v82
v_fmac_f32_e64 v43, v179, v83
v_cvt_pk_bf16_f32 v188, v40, v41
v_cvt_pk_bf16_f32 v189, v42, v43
v_and_b32 v41, 0xffff0000, v188
v_lshlrev_b32_e64 v40, 16, v188
v_and_b32 v43, 0xffff0000, v189
v_lshlrev_b32 v42, 16, v189
v_add_f32 v40, v40, v47
v_add_f32 v41, v41, v47
v_add_f32 v42, v42, v47
v_add_f32 v43, v43, v47
v_add_f32 v44, v44, v40
v_fmac_f32 v45, v40, v40
v_add_f32 v44, v44, v41
v_fmac_f32 v45, v41, v41
v_add_f32 v44, v44, v42
v_fmac_f32 v45, v42, v42
v_add_f32 v44, v44, v43
v_fmac_f32 v45, v43, v43
s_nop 1
v_permlane32_swap_b32 v44, v45
v_add_f32 v44, v44, v45
v_mov_b32 v45, v44
s_nop 1
v_permlane16_swap_b32_e64 v45, v44
v_add_f32 v44, v44, v45
s_nop 1
v_add_f32_dpp v44, v44, v44 row_ror:8 row_mask:0xf bank_mask:0xf
ds_write_b32 v58, v44 offset:256
s_waitcnt lgkmcnt(0)
s_barrier
ds_read_b128 v[48:51], v59 offset:256
ds_read_b128 v[52:55], v59 offset:384
s_mov_b32 s56, 4194304
s_mov_b32 s57, 4259840
s_mov_b32 s58, 4325376
v_mov_b32 v45, 0x3727c5ac
s_waitcnt lgkmcnt(1)
v_add_f32 v48, v48, v49
v_add_f32 v50, v50, v51
s_waitcnt lgkmcnt(0)
v_add_f32 v52, v52, v53
v_add_f32 v54, v54, v55
v_add_f32 v48, v48, v50
v_add_f32 v52, v52, v54
v_mul_f32 v48, 0x3ae38e39, v48
v_mul_f32 v52, 0x3ae38e39, v52
v_fma_f32 v52, -v48, v48, v52
v_max_f32 v52, 0, v52
v_add_f32 v45, v45, v52
v_rsq_f32 v45, v45
s_nop 0
v_mul_f32_e64 v44, -v48, v45
v_fma_f32 v24, v24, v45, v44
v_fma_f32 v25, v25, v45, v44
v_fma_f32 v26, v26, v45, v44
v_fma_f32 v27, v27, v45, v44
v_fma_f32 v24, v24, v104, v84
v_fma_f32 v25, v25, v105, v85
v_fma_f32 v26, v26, v106, v86
v_fma_f32 v27, v27, v107, v87
v_cvt_pk_bf16_f32 v128, v24, v25
v_cvt_pk_bf16_f32 v129, v26, v27
v_fma_f32 v28, v28, v45, v44
v_fma_f32 v29, v29, v45, v44
v_fma_f32 v30, v30, v45, v44
v_fma_f32 v31, v31, v45, v44
v_fma_f32 v28, v28, v108, v88
v_fma_f32 v29, v29, v109, v89
v_fma_f32 v30, v30, v110, v90
v_fma_f32 v31, v31, v111, v91
v_cvt_pk_bf16_f32 v130, v28, v29
v_cvt_pk_bf16_f32 v131, v30, v31
s_nop 0
v_permlane16_swap_b32 v128, v130
v_permlane16_swap_b32_e64 v129, v131
buffer_store_dwordx4 v[128:131], v23, s[12:15], s56 offen sc1
v_fma_f32 v32, v32, v45, v44
v_fma_f32 v33, v33, v45, v44
v_fma_f32 v34, v34, v45, v44
v_fma_f32 v35, v35, v45, v44
v_fma_f32 v32, v32, v112, v92
v_fma_f32 v33, v33, v113, v93
v_fma_f32 v34, v34, v114, v94
v_fma_f32 v35, v35, v115, v95
v_cvt_pk_bf16_f32 v132, v32, v33
v_cvt_pk_bf16_f32 v133, v34, v35
v_fma_f32 v36, v36, v45, v44
v_fma_f32 v37, v37, v45, v44
v_fma_f32 v38, v38, v45, v44
v_fma_f32 v39, v39, v45, v44
v_fma_f32 v36, v36, v116, v96
v_fma_f32 v37, v37, v117, v97
v_fma_f32 v38, v38, v118, v98
v_fma_f32 v39, v39, v119, v99
v_cvt_pk_bf16_f32 v134, v36, v37
v_cvt_pk_bf16_f32 v135, v38, v39
s_nop 0
v_permlane16_swap_b32 v132, v134
v_permlane16_swap_b32_e64 v133, v135
buffer_store_dwordx4 v[132:135], v23, s[12:15], s57 offen sc1
v_fma_f32 v40, v40, v45, v44
v_fma_f32 v41, v41, v45, v44
v_fma_f32 v42, v42, v45, v44
v_fma_f32 v43, v43, v45, v44
v_fma_f32 v40, v40, v120, v100
v_fma_f32 v41, v41, v121, v101
v_fma_f32 v42, v42, v122, v102
v_fma_f32 v43, v43, v123, v103
v_cvt_pk_bf16_f32 v136, v40, v41
v_cvt_pk_bf16_f32 v137, v42, v43
s_nop 0
v_permlane16_swap_b32 v136, v138
v_permlane16_swap_b32_e64 v137, v139
buffer_store_dwordx4 v[136:139], v56, s[12:15], s58 offen sc1
k3_start:
s_load_dwordx2 s[52:53], s[0:1], 88
s_mov_b64 s[32:33], s[12:13]
s_mov_b64 s[8:9], s[92:93]
s_mov_b64 s[12:13], s[94:95]
s_mov_b64 s[16:17], s[90:91]
v_mbcnt_lo_u32_b32 v96, -1, 0
v_mbcnt_hi_u32_b32 v96, -1, v96
v_and_b32 v97, 15, v96
v_lshrrev_b32 v98, 4, v96
v_lshrrev_b32 v99, 3, v96
v_and_b32 v101, 3, v99
s_lshl_b32 s72, s3, 3
v_add_u32 v99, s72, v99
v_lshlrev_b32 v100, 1, v98
v_and_b32 v102, 7, v96
v_xor_b32 v100, v100, v102
v_lshlrev_b32 v100, 4, v100
v_lshrrev_b32 v102, 2, v96
v_lshlrev_b32 v102, 7, v102
v_lshl_add_u32 v102, v101, 5, v102
v_and_b32 v101, 3, v96
v_lshl_add_u32 v0, v101, 3, v102
s_lshl_b32 s4, s3, 10
s_lshl_b32 s5, s3, 11
s_and_b32 s60, s6, 1
s_mul_i32 s61, s6, 576
s_lshl_b32 s72, s60, 6
s_add_u32 s72, s72, s61
v_mul_u32_u24 v101, 9216, v99
v_add_u32 v8, v101, v100
v_add_u32 v8, s72, v8
s_mul_i32 s72, s7, 147456
s_add_u32 s72, s72, s5
v_lshlrev_b32 v102, 4, v96
v_add_u32_e64 v12, s72, v102
s_mov_b32 s10, 5308416
s_mov_b32 s11, 0x20000
s_mov_b32 s14, 5308416
s_mov_b32 s15, 0x20000
s_add_u32 s24, s32, 4194304
s_addc_u32 s25, s33, 0
s_mov_b32 s26, 2359296
s_mov_b32 s27, 0x20000
s_mov_b32 s34, 3538944
s_mov_b32 s35, 0x20000
s_lshl_b32 s69, s7, 13
s_add_u32 s69, s69, 3276800
v_min_u32 v16, 1, v98
v_lshlrev_b32 v16, 30, v16
v_lshrrev_b32_e64 v17, 2, v97
v_lshl_add_u32 v17, s3, 2, v17
v_lshl_add_u32 v16, v17, 9, v16
v_and_b32_e64 v17, 3, v97
v_lshl_add_u32 v16, v17, 2, v16
v_and_b32_e64 v17, 1073741824, v11
v_lshl_add_u32 v17, s6, 9, v17
v_lshl_add_u32 v17, s3, 2, v17
s_mov_b32 s68, 0x8000
s_add_u32 m0, s4, 65536
s_mov_b32 s57, 0
buffer_load_dwordx4 v8, s[8:11], s57 offen lds
s_add_u32 m0, s4, 69632
s_mov_b32 s58, 0
buffer_load_dwordx4 v8, s[12:15], s58 offen lds
s_add_u32 m0, s4, 73728
s_mov_b32 s59, 128
buffer_load_dwordx4 v8, s[8:11], s59 offen lds
s_add_u32 m0, s4, 77824
s_mov_b32 s56, 128
buffer_load_dwordx4 v8, s[12:15], s56 offen lds
v_mov_b32_e64 v19, 1
s_waitcnt vmcnt(4)
buffer_store_dword v19, v17, s[32:35], s69 offen sc1
s_add_u32 m0, s4, 0
s_mov_b32 s57, 294912
buffer_load_dwordx4 v8, s[8:11], s57 offen lds
s_add_u32 m0, s4, 4096
s_mov_b32 s58, 294912
buffer_load_dwordx4 v8, s[12:15], s58 offen lds
s_add_u32 m0, s4, 8192
s_mov_b32 s59, 295040
buffer_load_dwordx4 v8, s[8:11], s59 offen lds
s_add_u32 m0, s4, 12288
s_mov_b32 s56, 295040
buffer_load_dwordx4 v8, s[12:15], s56 offen lds
s_add_u32 m0, s4, 16384
s_mov_b32 s57, 589824
buffer_load_dwordx4 v8, s[8:11], s57 offen lds
s_add_u32 m0, s4, 20480
s_mov_b32 s58, 589824
buffer_load_dwordx4 v8, s[12:15], s58 offen lds
s_add_u32 m0, s4, 24576
s_mov_b32 s59, 589952
buffer_load_dwordx4 v8, s[8:11], s59 offen lds
s_add_u32 m0, s4, 28672
s_mov_b32 s56, 589952
buffer_load_dwordx4 v8, s[12:15], s56 offen lds
s_add_u32 m0, s4, 32768
s_mov_b32 s57, 884736
buffer_load_dwordx4 v8, s[8:11], s57 offen lds
s_add_u32 m0, s4, 36864
s_mov_b32 s58, 884736
buffer_load_dwordx4 v8, s[12:15], s58 offen lds
s_add_u32 m0, s4, 40960
s_mov_b32 s59, 884864
buffer_load_dwordx4 v8, s[8:11], s59 offen lds
s_add_u32 m0, s4, 45056
s_mov_b32 s56, 884864
buffer_load_dwordx4 v8, s[12:15], s56 offen lds
s_add_u32 m0, s4, 49152
s_mov_b32 s57, 1179648
buffer_load_dwordx4 v8, s[8:11], s57 offen lds
s_add_u32 m0, s4, 53248
s_mov_b32 s58, 1179648
buffer_load_dwordx4 v8, s[12:15], s58 offen lds
s_add_u32 m0, s4, 57344
s_mov_b32 s59, 1179776
buffer_load_dwordx4 v8, s[8:11], s59 offen lds
s_add_u32 m0, s4, 61440
s_mov_b32 s56, 1179776
buffer_load_dwordx4 v8, s[12:15], s56 offen lds
s_waitcnt lgkmcnt(0)
s_mov_b32 s18, 5308416
s_mov_b32 s19, 0x20000
s_add_u32 s28, s32, 54525952
s_addc_u32 s29, s33, 0
s_mov_b32 s30, 37748736
s_mov_b32 s31, 0x20000
s_add_u32 s20, s32, 8388608
s_addc_u32 s21, s33, 0
s_mov_b32 s22, 3145728
s_mov_b32 s23, 0x20000
s_mov_b32 s34, 3538944
s_mov_b32 s35, 0x20000
s_mov_b32 s54, 2359296
s_mov_b32 s55, 0x20000
s_and_b32 s64, s3, 1
s_lshr_b32 s65, s3, 1
s_lshl_b32 s72, s64, 6
v_xor_b32 v0, s72, v0
v_xor_b32 v1, 32, v0
v_add_u32 v2, 0x10000, v0
v_add_u32 v3, 0x10000, v1
s_lshl_b32 s72, s65, 12
s_add_u32 s72, s72, 81920
v_add_u32 v4, s72, v102
v_add_u32 v5, 0x10000, v4
s_lshl_b32 s72, s64, 13
v_add_u32_e64 v6, s72, v4
s_lshl_b32 s72, s64, 3
v_add_u32 v7, s72, v5
s_xor_b32 s66, s60, 1
s_lshl_b32 s72, s66, 9
s_add_u32 s72, s72, s61
v_bfe_u32 v103, v100, 5, 1
v_mul_u32_u24 v103, 294912, v103
v_add_u32 v103, v103, v101
v_and_b32 v104, 16, v100
v_add_u32 v103, v103, v104
v_lshrrev_b32 v104, 6, v100
v_lshl_add_u32 v103, v104, 5, v103
v_add_u32_e64 v9, s72, v103
s_mul_i32 s62, s60, 36864
s_mul_i32 s63, s66, 294912
s_mul_i32 s72, s6, 288
v_add_u32_e64 v103, s72, v99
v_mul_u32_u24 v103, 1152, v103
v_add_u32_e64 v10, v103, v100
s_lshl1_add_u32 s72, s7, s65
s_lshl_b32 s72, s72, 3
v_bfe_u32 v103, v96, 3, 1
v_add_u32_e64 v103, s72, v103
v_mul_u32_u24 v103, 147456, v103
s_mul_i32 s72, s6, 9216
s_lshl_b32 s73, s64, 9
s_add_u32 s72, s72, s73
v_add_u32_e64 v103, s72, v103
v_lshl_add_u32 v103, v98, 7, v103
v_and_b32_e64 v104, 7, v96
v_lshl_add_u32 v11, v104, 4, v103
s_mov_b32 s40, 0
s_movk_i32 s41, 4096
s_mov_b32 s42, 8192
s_mov_b32 s43, 294912
s_mov_b32 s44, 299008
s_mov_b32 s45, 303104
s_mov_b32 s46, 589824
s_mov_b32 s47, 593920
s_mov_b32 s48, 598016
s_mov_b32 s49, 884736
s_mov_b32 s50, 888832
s_mov_b32 s51, 892928
v_lshl_add_u32 v103, s3, 6, v96
v_lshlrev_b32_e64 v13, 6, v103
v_min_u32 v104, 67, v103
v_lshlrev_b32_e64 v14, 6, v104
v_add_u32 v104, 256, v104
s_mul_i32 s67, s6, 331776
s_mul_i32 s72, s7, 20736
s_add_u32 s67, s67, s72
s_mul_i32 s72, s7, 331776
s_add_u32 s72, s72, s61
v_mul_u32_u24 v105, 57, v103
v_lshrrev_b32 v105, 9, v105
v_mul_u32_u24 v105, 8640, v105
v_lshl_add_u32 v103, v103, 6, v105
v_mul_u32_u24 v105, 57, v104
v_lshrrev_b32 v105, 9, v105
v_mul_u32_u24 v105, 8640, v105
v_lshl_add_u32 v104, v104, 6, v105
buffer_load_dword v18, v16, s[32:35], s69 offen sc1
s_waitcnt vmcnt(0)
v_cmp_gt_u32_e64 vcc, 1, v18
s_nop 0
s_and_b32 vcc_lo, vcc_lo, 0xffff
s_cbranch_scc1 k2_p1
k2_p1r:
s_add_u32 m0, s5, 81920
s_mov_b32 s57, 0
buffer_load_dwordx4 v12, s[24:27], s57 offen sc1 lds
buffer_load_dwordx4 v12, s[24:27], s57 offen offset:1024 sc1 lds
s_add_u32 m0, s5, 90112
s_mov_b32 s58, 8192
buffer_load_dwordx4 v12, s[24:27], s58 offen sc1 lds
buffer_load_dwordx4 v12, s[24:27], s58 offen offset:1024 sc1 lds
s_add_u32 m0, s5, 98304
s_mov_b32 s59, 16384
buffer_load_dwordx4 v12, s[24:27], s59 offen sc1 lds
buffer_load_dwordx4 v12, s[24:27], s59 offen offset:1024 sc1 lds
s_add_u32 m0, s5, 106496
s_mov_b32 s56, 24576
buffer_load_dwordx4 v12, s[24:27], s56 offen sc1 lds
buffer_load_dwordx4 v12, s[24:27], s56 offen offset:1024 sc1 lds
s_add_u32 m0, s5, 114688
s_mov_b32 s57, 32768
buffer_load_dwordx4 v12, s[24:27], s57 offen sc1 lds
buffer_load_dwordx4 v12, s[24:27], s57 offen offset:1024 sc1 lds
s_add_u32 m0, s5, 122880
s_mov_b32 s58, 40960
buffer_load_dwordx4 v12, s[24:27], s58 offen sc1 lds
buffer_load_dwordx4 v12, s[24:27], s58 offen offset:1024 sc1 lds
s_add_u32 m0, s5, 131072
s_mov_b32 s59, 49152
buffer_load_dwordx4 v12, s[24:27], s59 offen sc1 lds
buffer_load_dwordx4 v12, s[24:27], s59 offen offset:1024 sc1 lds
s_add_u32 m0, s5, 139264
s_mov_b32 s56, 57344
buffer_load_dwordx4 v12, s[24:27], s56 offen sc1 lds
buffer_load_dwordx4 v12, s[24:27], s56 offen offset:1024 sc1 lds
s_add_u32 m0, s5, 147456
s_mov_b32 s57, 65536
buffer_load_dwordx4 v12, s[24:27], s57 offen sc1 lds
buffer_load_dwordx4 v12, s[24:27], s57 offen offset:1024 sc1 lds
buffer_store_dwordx4 v[180:183], v57, s[20:23], s40 offen
buffer_store_dwordx4 v[184:187], v57, s[20:23], s41 offen
buffer_store_dwordx2 v[188:189], v57, s[20:23], s42 offen
s_add_u32 m0, s4, 65536
s_mov_b32 s58, 1474560
s_mov_b32 s59, 1474560
s_mov_b32 s56, 1474688
s_mov_b32 s57, 1474688
s_waitcnt vmcnt(19)
s_barrier
ds_read_b128 a[0:3], v4 offset:0
ds_read_b128 a[4:7], v4 offset:1024
ds_read_b64_tr_b16 v[48:49], v2 offset:0
ds_read_b64_tr_b16 v[50:51], v2 offset:2048
s_movk_i32 s70, 11520
ds_read_b128 a[8:11], v4 offset:2048
ds_read_b128 a[12:15], v4 offset:3072
ds_read_b64_tr_b16 v[52:53], v3 offset:0
ds_read_b64_tr_b16 v[54:55], v3 offset:2048
ds_read_b64_tr_b16 v[56:57], v2 offset:4096
ds_read_b64_tr_b16 v[58:59], v2 offset:6144
ds_read_b64_tr_b16 v[60:61], v3 offset:4096
ds_read_b64_tr_b16 v[62:63], v3 offset:6144
ds_read_b64_tr_b16 v[64:65], v2 offset:8192
ds_read_b64_tr_b16 v[66:67], v2 offset:10240
ds_read_b64_tr_b16 v[68:69], v3 offset:8192
ds_read_b64_tr_b16 v[70:71], v3 offset:10240
ds_read_b64_tr_b16 v[72:73], v2 offset:12288
ds_read_b64_tr_b16 v[74:75], v2 offset:14336
ds_read_b64_tr_b16 v[76:77], v3 offset:12288
ds_read_b64_tr_b16 v[78:79], v3 offset:14336
s_waitcnt lgkmcnt(15)
v_mfma_f32_16x16x32_bf16 v[96:99], v[48:51], a[0:3], 0
v_mfma_f32_16x16x32_bf16 v[100:103], v[48:51], a[4:7], 0
v_mfma_f32_16x16x32_bf16 v[104:107], v[48:51], a[8:11], 0
s_waitcnt lgkmcnt(14)
v_mfma_f32_16x16x32_bf16 v[108:111], v[48:51], a[12:15], 0
s_waitcnt lgkmcnt(12)
v_mfma_f32_16x16x32_bf16 v[140:143], v[52:55], a[12:15], 0
v_mfma_f32_16x16x32_bf16 v[136:139], v[52:55], a[8:11], 0
v_mfma_f32_16x16x32_bf16 v[132:135], v[52:55], a[4:7], 0
v_mfma_f32_16x16x32_bf16 v[128:131], v[52:55], a[0:3], 0
s_waitcnt lgkmcnt(10)
v_mfma_f32_16x16x32_bf16 v[112:115], v[56:59], a[0:3], 0
v_mfma_f32_16x16x32_bf16 v[116:119], v[56:59], a[4:7], 0
v_mfma_f32_16x16x32_bf16 v[120:123], v[56:59], a[8:11], 0
v_mfma_f32_16x16x32_bf16 v[124:127], v[56:59], a[12:15], 0
s_waitcnt lgkmcnt(0)
v_mfma_f32_16x16x32_bf16 v[156:159], v[60:63], a[12:15], 0
v_mfma_f32_16x16x32_bf16 v[152:155], v[60:63], a[8:11], 0
v_mfma_f32_16x16x32_bf16 v[148:151], v[60:63], a[4:7], 0
v_mfma_f32_16x16x32_bf16 v[144:147], v[60:63], a[0:3], 0
v_mfma_f32_16x16x32_bf16 v[160:163], v[64:67], a[0:3], 0
s_waitcnt vmcnt(17)
s_barrier
ds_read_b128 a[16:19], v4 offset:8192
ds_read_b64_tr_b16 v[48:49], v0 offset:0
v_mfma_f32_16x16x32_bf16 v[164:167], v[64:67], a[4:7], 0
ds_read_b128 a[20:23], v4 offset:9216
ds_read_b64_tr_b16 v[50:51], v0 offset:2048
v_mfma_f32_16x16x32_bf16 v[168:171], v[64:67], a[8:11], 0
ds_read_b128 a[24:27], v4 offset:10240
ds_read_b128 a[28:31], v4 offset:11264
v_mfma_f32_16x16x32_bf16 v[172:175], v[64:67], a[12:15], 0
ds_read_b64_tr_b16 v[52:53], v1 offset:0
ds_read_b64_tr_b16 v[54:55], v1 offset:2048
v_mfma_f32_16x16x32_bf16 v[204:207], v[68:71], a[12:15], 0
ds_read_b64_tr_b16 v[56:57], v0 offset:4096
ds_read_b64_tr_b16 v[58:59], v0 offset:6144
v_mfma_f32_16x16x32_bf16 v[200:203], v[68:71], a[8:11], 0
ds_read_b64_tr_b16 v[60:61], v1 offset:4096
ds_read_b64_tr_b16 v[62:63], v1 offset:6144
v_mfma_f32_16x16x32_bf16 v[196:199], v[68:71], a[4:7], 0
ds_read_b64_tr_b16 v[64:65], v0 offset:8192
ds_read_b64_tr_b16 v[66:67], v0 offset:10240
v_mfma_f32_16x16x32_bf16 v[192:195], v[68:71], a[0:3], 0
ds_read_b64_tr_b16 v[68:69], v1 offset:8192
ds_read_b64_tr_b16 v[70:71], v1 offset:10240
v_mfma_f32_16x16x32_bf16 v[176:179], v[72:75], a[0:3], 0
v_mfma_f32_16x16x32_bf16 v[180:183], v[72:75], a[4:7], 0
v_mfma_f32_16x16x32_bf16 v[184:187], v[72:75], a[8:11], 0
v_mfma_f32_16x16x32_bf16 v[188:191], v[72:75], a[12:15], 0
ds_read_b64_tr_b16 v[72:73], v0 offset:12288
ds_read_b64_tr_b16 v[74:75], v0 offset:14336
v_mfma_f32_16x16x32_bf16 v[220:223], v[76:79], a[12:15], 0
v_mfma_f32_16x16x32_bf16 v[216:219], v[76:79], a[8:11], 0
v_mfma_f32_16x16x32_bf16 v[212:215], v[76:79], a[4:7], 0
v_mfma_f32_16x16x32_bf16 v[208:211], v[76:79], a[0:3], 0
s_waitcnt lgkmcnt(4)
ds_read_b64_tr_b16 v[76:77], v1 offset:12288
ds_read_b64_tr_b16 v[78:79], v1 offset:14336
v_mfma_f32_16x16x32_bf16 v[96:99], v[48:51], a[16:19], v[96:99]
v_mfma_f32_16x16x32_bf16 v[100:103], v[48:51], a[20:23], v[100:103]
v_mfma_f32_16x16x32_bf16 v[104:107], v[48:51], a[24:27], v[104:107]
v_mfma_f32_16x16x32_bf16 v[108:111], v[48:51], a[28:31], v[108:111]
v_mfma_f32_16x16x32_bf16 v[140:143], v[52:55], a[28:31], v[140:143]
v_mfma_f32_16x16x32_bf16 v[136:139], v[52:55], a[24:27], v[136:139]
v_mfma_f32_16x16x32_bf16 v[132:135], v[52:55], a[20:23], v[132:135]
v_mfma_f32_16x16x32_bf16 v[128:131], v[52:55], a[16:19], v[128:131]
v_mfma_f32_16x16x32_bf16 v[112:115], v[56:59], a[16:19], v[112:115]
v_mfma_f32_16x16x32_bf16 v[116:119], v[56:59], a[20:23], v[116:119]
v_mfma_f32_16x16x32_bf16 v[120:123], v[56:59], a[24:27], v[120:123]
v_mfma_f32_16x16x32_bf16 v[124:127], v[56:59], a[28:31], v[124:127]
v_mfma_f32_16x16x32_bf16 v[156:159], v[60:63], a[28:31], v[156:159]
v_mfma_f32_16x16x32_bf16 v[152:155], v[60:63], a[24:27], v[152:155]
v_mfma_f32_16x16x32_bf16 v[148:151], v[60:63], a[20:23], v[148:151]
v_mfma_f32_16x16x32_bf16 v[144:147], v[60:63], a[16:19], v[144:147]
v_mfma_f32_16x16x32_bf16 v[160:163], v[64:67], a[16:19], v[160:163]
s_waitcnt vmcnt(15)
s_barrier
ds_read_b128 a[32:35], v4 offset:16384
ds_read_b64_tr_b16 v[48:49], v0 offset:16384
v_mfma_f32_16x16x32_bf16 v[164:167], v[64:67], a[20:23], v[164:167]
ds_read_b128 a[36:39], v4 offset:17408
ds_read_b64_tr_b16 v[50:51], v0 offset:18432
v_mfma_f32_16x16x32_bf16 v[168:171], v[64:67], a[24:27], v[168:171]
ds_read_b128 a[40:43], v4 offset:18432
ds_read_b128 a[44:47], v4 offset:19456
v_mfma_f32_16x16x32_bf16 v[172:175], v[64:67], a[28:31], v[172:175]
s_waitcnt lgkmcnt(6)
ds_read_b64_tr_b16 v[52:53], v1 offset:16384
ds_read_b64_tr_b16 v[54:55], v1 offset:18432
v_mfma_f32_16x16x32_bf16 v[204:207], v[68:71], a[28:31], v[204:207]
ds_read_b64_tr_b16 v[56:57], v0 offset:20480
ds_read_b64_tr_b16 v[58:59], v0 offset:22528
v_mfma_f32_16x16x32_bf16 v[200:203], v[68:71], a[24:27], v[200:203]
ds_read_b64_tr_b16 v[60:61], v1 offset:20480
ds_read_b64_tr_b16 v[62:63], v1 offset:22528
v_mfma_f32_16x16x32_bf16 v[196:199], v[68:71], a[20:23], v[196:199]
ds_read_b64_tr_b16 v[64:65], v0 offset:24576
ds_read_b64_tr_b16 v[66:67], v0 offset:26624
v_mfma_f32_16x16x32_bf16 v[192:195], v[68:71], a[16:19], v[192:195]
ds_read_b64_tr_b16 v[68:69], v1 offset:24576
ds_read_b64_tr_b16 v[70:71], v1 offset:26624
v_mfma_f32_16x16x32_bf16 v[176:179], v[72:75], a[16:19], v[176:179]
v_mfma_f32_16x16x32_bf16 v[180:183], v[72:75], a[20:23], v[180:183]
v_mfma_f32_16x16x32_bf16 v[184:187], v[72:75], a[24:27], v[184:187]
v_mfma_f32_16x16x32_bf16 v[188:191], v[72:75], a[28:31], v[188:191]
ds_read_b64_tr_b16 v[72:73], v0 offset:28672
ds_read_b64_tr_b16 v[74:75], v0 offset:30720
v_mfma_f32_16x16x32_bf16 v[220:223], v[76:79], a[28:31], v[220:223]
v_mfma_f32_16x16x32_bf16 v[216:219], v[76:79], a[24:27], v[216:219]
v_mfma_f32_16x16x32_bf16 v[212:215], v[76:79], a[20:23], v[212:215]
v_mfma_f32_16x16x32_bf16 v[208:211], v[76:79], a[16:19], v[208:211]
s_waitcnt lgkmcnt(4)
ds_read_b64_tr_b16 v[76:77], v1 offset:28672
buffer_load_dwordx4 v8, s[8:11], s58 offen lds
v_mfma_f32_16x16x32_bf16 v[96:99], v[48:51], a[32:35], v[96:99]
s_add_u32 m0, s4, 69632
s_mov_b32 s58, 73728
ds_read_b64_tr_b16 v[78:79], v1 offset:30720
v_mfma_f32_16x16x32_bf16 v[100:103], v[48:51], a[36:39], v[100:103]
buffer_load_dwordx4 v8, s[12:15], s59 offen lds
v_mfma_f32_16x16x32_bf16 v[104:107], v[48:51], a[40:43], v[104:107]
s_add_u32 m0, s4, 73728
s_mov_b32 s59, 1769472
v_mfma_f32_16x16x32_bf16 v[108:111], v[48:51], a[44:47], v[108:111]
buffer_load_dwordx4 v8, s[8:11], s56 offen lds
v_mfma_f32_16x16x32_bf16 v[140:143], v[52:55], a[44:47], v[140:143]
s_add_u32 m0, s4, 77824
s_mov_b32 s56, 1769472
v_mfma_f32_16x16x32_bf16 v[136:139], v[52:55], a[40:43], v[136:139]
buffer_load_dwordx4 v8, s[12:15], s57 offen lds
v_mfma_f32_16x16x32_bf16 v[132:135], v[52:55], a[36:39], v[132:135]
s_add_u32 m0, s5, 81920
s_mov_b32 s57, 1769600
v_mfma_f32_16x16x32_bf16 v[128:131], v[52:55], a[32:35], v[128:131]
buffer_load_dwordx4 v12, s[24:27], s58 offen sc1 lds
v_mfma_f32_16x16x32_bf16 v[112:115], v[56:59], a[32:35], v[112:115]
v_mfma_f32_16x16x32_bf16 v[116:119], v[56:59], a[36:39], v[116:119]
buffer_load_dwordx4 v12, s[24:27], s58 offen offset:1024 sc1 lds
v_mfma_f32_16x16x32_bf16 v[120:123], v[56:59], a[40:43], v[120:123]
s_add_u32 m0, s4, 0
s_mov_b32 s58, 1769600
v_mfma_f32_16x16x32_bf16 v[124:127], v[56:59], a[44:47], v[124:127]
v_mfma_f32_16x16x32_bf16 v[156:159], v[60:63], a[44:47], v[156:159]
v_mfma_f32_16x16x32_bf16 v[152:155], v[60:63], a[40:43], v[152:155]
v_mfma_f32_16x16x32_bf16 v[148:151], v[60:63], a[36:39], v[148:151]
v_mfma_f32_16x16x32_bf16 v[144:147], v[60:63], a[32:35], v[144:147]
v_mfma_f32_16x16x32_bf16 v[160:163], v[64:67], a[32:35], v[160:163]
s_waitcnt vmcnt(19)
s_barrier
ds_read_b128 a[48:51], v4 offset:24576
ds_read_b64_tr_b16 v[48:49], v0 offset:32768
v_mfma_f32_16x16x32_bf16 v[164:167], v[64:67], a[36:39], v[164:167]
ds_read_b128 a[52:55], v4 offset:25600
ds_read_b64_tr_b16 v[50:51], v0 offset:34816
v_mfma_f32_16x16x32_bf16 v[168:171], v[64:67], a[40:43], v[168:171]
ds_read_b128 a[56:59], v4 offset:26624
ds_read_b128 a[60:63], v4 offset:27648
v_mfma_f32_16x16x32_bf16 v[172:175], v[64:67], a[44:47], v[172:175]
s_waitcnt lgkmcnt(6)
ds_read_b64_tr_b16 v[52:53], v1 offset:32768
ds_read_b64_tr_b16 v[54:55], v1 offset:34816
v_mfma_f32_16x16x32_bf16 v[204:207], v[68:71], a[44:47], v[204:207]
ds_read_b64_tr_b16 v[56:57], v0 offset:36864
ds_read_b64_tr_b16 v[58:59], v0 offset:38912
v_mfma_f32_16x16x32_bf16 v[200:203], v[68:71], a[40:43], v[200:203]
ds_read_b64_tr_b16 v[60:61], v1 offset:36864
ds_read_b64_tr_b16 v[62:63], v1 offset:38912
v_mfma_f32_16x16x32_bf16 v[196:199], v[68:71], a[36:39], v[196:199]
ds_read_b64_tr_b16 v[64:65], v0 offset:40960
ds_read_b64_tr_b16 v[66:67], v0 offset:43008
v_mfma_f32_16x16x32_bf16 v[192:195], v[68:71], a[32:35], v[192:195]
ds_read_b64_tr_b16 v[68:69], v1 offset:40960
ds_read_b64_tr_b16 v[70:71], v1 offset:43008
v_mfma_f32_16x16x32_bf16 v[176:179], v[72:75], a[32:35], v[176:179]
v_mfma_f32_16x16x32_bf16 v[180:183], v[72:75], a[36:39], v[180:183]
v_mfma_f32_16x16x32_bf16 v[184:187], v[72:75], a[40:43], v[184:187]
v_mfma_f32_16x16x32_bf16 v[188:191], v[72:75], a[44:47], v[188:191]
ds_read_b64_tr_b16 v[72:73], v0 offset:45056
ds_read_b64_tr_b16 v[74:75], v0 offset:47104
v_mfma_f32_16x16x32_bf16 v[220:223], v[76:79], a[44:47], v[220:223]
v_mfma_f32_16x16x32_bf16 v[216:219], v[76:79], a[40:43], v[216:219]
v_mfma_f32_16x16x32_bf16 v[212:215], v[76:79], a[36:39], v[212:215]
v_mfma_f32_16x16x32_bf16 v[208:211], v[76:79], a[32:35], v[208:211]
s_waitcnt lgkmcnt(4)
ds_read_b64_tr_b16 v[76:77], v1 offset:45056
buffer_load_dwordx4 v8, s[8:11], s59 offen lds
v_mfma_f32_16x16x32_bf16 v[96:99], v[48:51], a[48:51], v[96:99]
s_add_u32 m0, s4, 4096
s_mov_b32 s59, 81920
ds_read_b64_tr_b16 v[78:79], v1 offset:47104
v_mfma_f32_16x16x32_bf16 v[100:103], v[48:51], a[52:55], v[100:103]
buffer_load_dwordx4 v8, s[12:15], s56 offen lds
v_mfma_f32_16x16x32_bf16 v[104:107], v[48:51], a[56:59], v[104:107]
s_add_u32 m0, s4, 8192
s_mov_b32 s56, 2064384
v_mfma_f32_16x16x32_bf16 v[108:111], v[48:51], a[60:63], v[108:111]
buffer_load_dwordx4 v8, s[8:11], s57 offen lds
v_mfma_f32_16x16x32_bf16 v[140:143], v[52:55], a[60:63], v[140:143]
s_add_u32 m0, s4, 12288
s_mov_b32 s57, 2064384
v_mfma_f32_16x16x32_bf16 v[136:139], v[52:55], a[56:59], v[136:139]
buffer_load_dwordx4 v8, s[12:15], s58 offen lds
v_mfma_f32_16x16x32_bf16 v[132:135], v[52:55], a[52:55], v[132:135]
s_add_u32 m0, s5, 90112
s_mov_b32 s58, 2064512
v_mfma_f32_16x16x32_bf16 v[128:131], v[52:55], a[48:51], v[128:131]
buffer_load_dwordx4 v12, s[24:27], s59 offen sc1 lds
v_mfma_f32_16x16x32_bf16 v[112:115], v[56:59], a[48:51], v[112:115]
v_mfma_f32_16x16x32_bf16 v[116:119], v[56:59], a[52:55], v[116:119]
buffer_load_dwordx4 v12, s[24:27], s59 offen offset:1024 sc1 lds
v_mfma_f32_16x16x32_bf16 v[120:123], v[56:59], a[56:59], v[120:123]
s_add_u32 m0, s4, 16384
s_mov_b32 s59, 2064512
v_mfma_f32_16x16x32_bf16 v[124:127], v[56:59], a[60:63], v[124:127]
v_mfma_f32_16x16x32_bf16 v[156:159], v[60:63], a[60:63], v[156:159]
v_mfma_f32_16x16x32_bf16 v[152:155], v[60:63], a[56:59], v[152:155]
v_mfma_f32_16x16x32_bf16 v[148:151], v[60:63], a[52:55], v[148:151]
v_mfma_f32_16x16x32_bf16 v[144:147], v[60:63], a[48:51], v[144:147]
v_mfma_f32_16x16x32_bf16 v[160:163], v[64:67], a[48:51], v[160:163]
s_waitcnt vmcnt(23)
s_barrier
ds_read_b128 a[64:67], v4 offset:32768
ds_read_b64_tr_b16 v[48:49], v0 offset:49152
v_mfma_f32_16x16x32_bf16 v[164:167], v[64:67], a[52:55], v[164:167]
ds_read_b128 a[68:71], v4 offset:33792
ds_read_b64_tr_b16 v[50:51], v0 offset:51200
v_mfma_f32_16x16x32_bf16 v[168:171], v[64:67], a[56:59], v[168:171]
ds_read_b128 a[72:75], v4 offset:34816
ds_read_b128 a[76:79], v4 offset:35840
v_mfma_f32_16x16x32_bf16 v[172:175], v[64:67], a[60:63], v[172:175]
s_waitcnt lgkmcnt(6)
ds_read_b64_tr_b16 v[52:53], v1 offset:49152
ds_read_b64_tr_b16 v[54:55], v1 offset:51200
v_mfma_f32_16x16x32_bf16 v[204:207], v[68:71], a[60:63], v[204:207]
ds_read_b64_tr_b16 v[56:57], v0 offset:53248
ds_read_b64_tr_b16 v[58:59], v0 offset:55296
v_mfma_f32_16x16x32_bf16 v[200:203], v[68:71], a[56:59], v[200:203]
ds_read_b64_tr_b16 v[60:61], v1 offset:53248
ds_read_b64_tr_b16 v[62:63], v1 offset:55296
v_mfma_f32_16x16x32_bf16 v[196:199], v[68:71], a[52:55], v[196:199]
ds_read_b64_tr_b16 v[64:65], v0 offset:57344
ds_read_b64_tr_b16 v[66:67], v0 offset:59392
v_mfma_f32_16x16x32_bf16 v[192:195], v[68:71], a[48:51], v[192:195]
ds_read_b64_tr_b16 v[68:69], v1 offset:57344
ds_read_b64_tr_b16 v[70:71], v1 offset:59392
v_mfma_f32_16x16x32_bf16 v[176:179], v[72:75], a[48:51], v[176:179]
v_mfma_f32_16x16x32_bf16 v[180:183], v[72:75], a[52:55], v[180:183]
v_mfma_f32_16x16x32_bf16 v[184:187], v[72:75], a[56:59], v[184:187]
v_mfma_f32_16x16x32_bf16 v[188:191], v[72:75], a[60:63], v[188:191]
ds_read_b64_tr_b16 v[72:73], v0 offset:61440
ds_read_b64_tr_b16 v[74:75], v0 offset:63488
v_mfma_f32_16x16x32_bf16 v[220:223], v[76:79], a[60:63], v[220:223]
v_mfma_f32_16x16x32_bf16 v[216:219], v[76:79], a[56:59], v[216:219]
v_mfma_f32_16x16x32_bf16 v[212:215], v[76:79], a[52:55], v[212:215]
v_mfma_f32_16x16x32_bf16 v[208:211], v[76:79], a[48:51], v[208:211]
s_waitcnt lgkmcnt(4)
ds_read_b64_tr_b16 v[76:77], v1 offset:61440
buffer_load_dwordx4 v8, s[8:11], s56 offen lds
v_mfma_f32_16x16x32_bf16 v[96:99], v[48:51], a[64:67], v[96:99]
s_add_u32 m0, s4, 20480
s_mov_b32 s56, 90112
ds_read_b64_tr_b16 v[78:79], v1 offset:63488
v_mfma_f32_16x16x32_bf16 v[100:103], v[48:51], a[68:71], v[100:103]
buffer_load_dwordx4 v8, s[12:15], s57 offen lds
v_mfma_f32_16x16x32_bf16 v[104:107], v[48:51], a[72:75], v[104:107]
s_add_u32 m0, s4, 24576
s_mov_b32 s57, 2359296
v_mfma_f32_16x16x32_bf16 v[108:111], v[48:51], a[76:79], v[108:111]
buffer_load_dwordx4 v8, s[8:11], s58 offen lds
v_mfma_f32_16x16x32_bf16 v[140:143], v[52:55], a[76:79], v[140:143]
s_add_u32 m0, s4, 28672
s_mov_b32 s58, 2359296
v_mfma_f32_16x16x32_bf16 v[136:139], v[52:55], a[72:75], v[136:139]
buffer_load_dwordx4 v8, s[12:15], s59 offen lds
v_mfma_f32_16x16x32_bf16 v[132:135], v[52:55], a[68:71], v[132:135]
s_add_u32 m0, s5, 98304
s_mov_b32 s59, 2359424
v_mfma_f32_16x16x32_bf16 v[128:131], v[52:55], a[64:67], v[128:131]
buffer_load_dwordx4 v12, s[24:27], s56 offen sc1 lds
v_mfma_f32_16x16x32_bf16 v[112:115], v[56:59], a[64:67], v[112:115]
v_mfma_f32_16x16x32_bf16 v[116:119], v[56:59], a[68:71], v[116:119]
buffer_load_dwordx4 v12, s[24:27], s56 offen offset:1024 sc1 lds
v_mfma_f32_16x16x32_bf16 v[120:123], v[56:59], a[72:75], v[120:123]
s_add_u32 m0, s4, 32768
s_mov_b32 s56, 2359424
v_mfma_f32_16x16x32_bf16 v[124:127], v[56:59], a[76:79], v[124:127]
v_mfma_f32_16x16x32_bf16 v[156:159], v[60:63], a[76:79], v[156:159]
v_mfma_f32_16x16x32_bf16 v[152:155], v[60:63], a[72:75], v[152:155]
v_mfma_f32_16x16x32_bf16 v[148:151], v[60:63], a[68:71], v[148:151]
v_mfma_f32_16x16x32_bf16 v[144:147], v[60:63], a[64:67], v[144:147]
v_mfma_f32_16x16x32_bf16 v[160:163], v[64:67], a[64:67], v[160:163]
v_mfma_f32_16x16x32_bf16 v[164:167], v[64:67], a[68:71], v[164:167]
v_mfma_f32_16x16x32_bf16 v[168:171], v[64:67], a[72:75], v[168:171]
v_mfma_f32_16x16x32_bf16 v[172:175], v[64:67], a[76:79], v[172:175]
s_waitcnt lgkmcnt(0)
v_mfma_f32_16x16x32_bf16 v[204:207], v[68:71], a[76:79], v[204:207]
v_mfma_f32_16x16x32_bf16 v[200:203], v[68:71], a[72:75], v[200:203]
s_waitcnt vmcnt(14)
s_barrier
ds_read_b128 a[80:83], v4 offset:40960
ds_read_b64_tr_b16 v[48:49], v2 offset:0
v_mfma_f32_16x16x32_bf16 v[196:199], v[68:71], a[68:71], v[196:199]
ds_read_b128 a[84:87], v4 offset:41984
ds_read_b64_tr_b16 v[50:51], v2 offset:2048
v_mfma_f32_16x16x32_bf16 v[192:195], v[68:71], a[64:67], v[192:195]
ds_read_b128 a[88:91], v4 offset:43008
ds_read_b128 a[92:95], v4 offset:44032
v_mfma_f32_16x16x32_bf16 v[176:179], v[72:75], a[64:67], v[176:179]
ds_read_b64_tr_b16 v[52:53], v3 offset:0
ds_read_b64_tr_b16 v[54:55], v3 offset:2048
v_mfma_f32_16x16x32_bf16 v[180:183], v[72:75], a[68:71], v[180:183]
ds_read_b64_tr_b16 v[56:57], v2 offset:4096
ds_read_b64_tr_b16 v[58:59], v2 offset:6144
v_mfma_f32_16x16x32_bf16 v[184:187], v[72:75], a[72:75], v[184:187]
ds_read_b64_tr_b16 v[60:61], v3 offset:4096
ds_read_b64_tr_b16 v[62:63], v3 offset:6144
v_mfma_f32_16x16x32_bf16 v[188:191], v[72:75], a[76:79], v[188:191]
ds_read_b64_tr_b16 v[64:65], v2 offset:8192
ds_read_b64_tr_b16 v[66:67], v2 offset:10240
v_mfma_f32_16x16x32_bf16 v[220:223], v[76:79], a[76:79], v[220:223]
ds_read_b64_tr_b16 v[68:69], v3 offset:8192
ds_read_b64_tr_b16 v[70:71], v3 offset:10240
v_mfma_f32_16x16x32_bf16 v[216:219], v[76:79], a[72:75], v[216:219]
ds_read_b64_tr_b16 v[72:73], v2 offset:12288
ds_read_b64_tr_b16 v[74:75], v2 offset:14336
v_mfma_f32_16x16x32_bf16 v[212:215], v[76:79], a[68:71], v[212:215]
v_mfma_f32_16x16x32_bf16 v[208:211], v[76:79], a[64:67], v[208:211]
s_waitcnt lgkmcnt(14)
ds_read_b64_tr_b16 v[76:77], v3 offset:12288
buffer_load_dwordx4 v8, s[8:11], s57 offen lds
v_mfma_f32_16x16x32_bf16 v[96:99], v[48:51], a[80:83], v[96:99]
s_add_u32 m0, s4, 36864
s_mov_b32 s57, 98304
ds_read_b64_tr_b16 v[78:79], v3 offset:14336
v_mfma_f32_16x16x32_bf16 v[100:103], v[48:51], a[84:87], v[100:103]
s_waitcnt lgkmcnt(12)
buffer_load_dwordx4 v8, s[12:15], s58 offen lds
v_mfma_f32_16x16x32_bf16 v[104:107], v[48:51], a[88:91], v[104:107]
s_add_u32 m0, s4, 40960
s_mov_b32 s58, 2654208
v_mfma_f32_16x16x32_bf16 v[108:111], v[48:51], a[92:95], v[108:111]
buffer_load_dwordx4 v8, s[8:11], s59 offen lds
v_mfma_f32_16x16x32_bf16 v[140:143], v[52:55], a[92:95], v[140:143]
s_add_u32 m0, s4, 45056
s_mov_b32 s59, 2654208
v_mfma_f32_16x16x32_bf16 v[136:139], v[52:55], a[88:91], v[136:139]
buffer_load_dwordx4 v8, s[12:15], s56 offen lds
v_mfma_f32_16x16x32_bf16 v[132:135], v[52:55], a[84:87], v[132:135]
s_add_u32 m0, s5, 106496
s_mov_b32 s56, 2654336
v_mfma_f32_16x16x32_bf16 v[128:131], v[52:55], a[80:83], v[128:131]
s_waitcnt lgkmcnt(2)
buffer_load_dwordx4 v12, s[24:27], s57 offen sc1 lds
v_mfma_f32_16x16x32_bf16 v[112:115], v[56:59], a[80:83], v[112:115]
v_mfma_f32_16x16x32_bf16 v[116:119], v[56:59], a[84:87], v[116:119]
buffer_load_dwordx4 v12, s[24:27], s57 offen offset:1024 sc1 lds
v_mfma_f32_16x16x32_bf16 v[120:123], v[56:59], a[88:91], v[120:123]
s_add_u32 m0, s4, 49152
s_mov_b32 s57, 2654336
v_mfma_f32_16x16x32_bf16 v[124:127], v[56:59], a[92:95], v[124:127]
v_mfma_f32_16x16x32_bf16 v[156:159], v[60:63], a[92:95], v[156:159]
v_mfma_f32_16x16x32_bf16 v[152:155], v[60:63], a[88:91], v[152:155]
v_mfma_f32_16x16x32_bf16 v[148:151], v[60:63], a[84:87], v[148:151]
v_mfma_f32_16x16x32_bf16 v[144:147], v[60:63], a[80:83], v[144:147]
v_mfma_f32_16x16x32_bf16 v[160:163], v[64:67], a[80:83], v[160:163]
v_mfma_f32_16x16x32_bf16 v[164:167], v[64:67], a[84:87], v[164:167]
v_mfma_f32_16x16x32_bf16 v[168:171], v[64:67], a[88:91], v[168:171]
v_mfma_f32_16x16x32_bf16 v[172:175], v[64:67], a[92:95], v[172:175]
v_mfma_f32_16x16x32_bf16 v[204:207], v[68:71], a[92:95], v[204:207]
v_mfma_f32_16x16x32_bf16 v[200:203], v[68:71], a[88:91], v[200:203]
s_waitcnt vmcnt(14)
s_barrier
ds_read_b128 a[96:99], v4 offset:49152
ds_read_b64_tr_b16 v[48:49], v0 offset:0
v_mfma_f32_16x16x32_bf16 v[196:199], v[68:71], a[84:87], v[196:199]
ds_read_b128 a[100:103], v4 offset:50176
ds_read_b64_tr_b16 v[50:51], v0 offset:2048
v_mfma_f32_16x16x32_bf16 v[192:195], v[68:71], a[80:83], v[192:195]
ds_read_b128 a[104:107], v4 offset:51200
ds_read_b128 a[108:111], v4 offset:52224
v_mfma_f32_16x16x32_bf16 v[176:179], v[72:75], a[80:83], v[176:179]
ds_read_b64_tr_b16 v[52:53], v1 offset:0
ds_read_b64_tr_b16 v[54:55], v1 offset:2048
v_mfma_f32_16x16x32_bf16 v[180:183], v[72:75], a[84:87], v[180:183]
ds_read_b64_tr_b16 v[56:57], v0 offset:4096
ds_read_b64_tr_b16 v[58:59], v0 offset:6144
v_mfma_f32_16x16x32_bf16 v[184:187], v[72:75], a[88:91], v[184:187]
ds_read_b64_tr_b16 v[60:61], v1 offset:4096
ds_read_b64_tr_b16 v[62:63], v1 offset:6144
v_mfma_f32_16x16x32_bf16 v[188:191], v[72:75], a[92:95], v[188:191]
s_waitcnt lgkmcnt(12)
ds_read_b64_tr_b16 v[64:65], v0 offset:8192
ds_read_b64_tr_b16 v[66:67], v0 offset:10240
v_mfma_f32_16x16x32_bf16 v[220:223], v[76:79], a[92:95], v[220:223]
ds_read_b64_tr_b16 v[68:69], v1 offset:8192
ds_read_b64_tr_b16 v[70:71], v1 offset:10240
v_mfma_f32_16x16x32_bf16 v[216:219], v[76:79], a[88:91], v[216:219]
ds_read_b64_tr_b16 v[72:73], v0 offset:12288
ds_read_b64_tr_b16 v[74:75], v0 offset:14336
v_mfma_f32_16x16x32_bf16 v[212:215], v[76:79], a[84:87], v[212:215]
v_mfma_f32_16x16x32_bf16 v[208:211], v[76:79], a[80:83], v[208:211]
s_waitcnt lgkmcnt(14)
ds_read_b64_tr_b16 v[76:77], v1 offset:12288
buffer_load_dwordx4 v8, s[8:11], s58 offen lds
v_mfma_f32_16x16x32_bf16 v[96:99], v[48:51], a[96:99], v[96:99]
s_add_u32 m0, s4, 53248
s_mov_b32 s58, 106496
ds_read_b64_tr_b16 v[78:79], v1 offset:14336
v_mfma_f32_16x16x32_bf16 v[100:103], v[48:51], a[100:103], v[100:103]
s_waitcnt lgkmcnt(12)
buffer_load_dwordx4 v8, s[12:15], s59 offen lds
v_mfma_f32_16x16x32_bf16 v[104:107], v[48:51], a[104:107], v[104:107]
s_add_u32 m0, s4, 57344
s_mov_b32 s59, 2949120
v_mfma_f32_16x16x32_bf16 v[108:111], v[48:51], a[108:111], v[108:111]
buffer_load_dwordx4 v8, s[8:11], s56 offen lds
v_mfma_f32_16x16x32_bf16 v[140:143], v[52:55], a[108:111], v[140:143]
s_add_u32 m0, s4, 61440
s_mov_b32 s56, 2949120
v_mfma_f32_16x16x32_bf16 v[136:139], v[52:55], a[104:107], v[136:139]
buffer_load_dwordx4 v8, s[12:15], s57 offen lds
v_mfma_f32_16x16x32_bf16 v[132:135], v[52:55], a[100:103], v[132:135]
s_add_u32 m0, s5, 114688
s_mov_b32 s57, 2949248
v_mfma_f32_16x16x32_bf16 v[128:131], v[52:55], a[96:99], v[128:131]
s_waitcnt lgkmcnt(2)
buffer_load_dwordx4 v12, s[24:27], s58 offen sc1 lds
v_mfma_f32_16x16x32_bf16 v[112:115], v[56:59], a[96:99], v[112:115]
v_mfma_f32_16x16x32_bf16 v[116:119], v[56:59], a[100:103], v[116:119]
buffer_load_dwordx4 v12, s[24:27], s58 offen offset:1024 sc1 lds
v_mfma_f32_16x16x32_bf16 v[120:123], v[56:59], a[104:107], v[120:123]
s_add_u32 m0, s4, 65536
s_mov_b32 s58, 2949248
v_mfma_f32_16x16x32_bf16 v[124:127], v[56:59], a[108:111], v[124:127]
v_mfma_f32_16x16x32_bf16 v[156:159], v[60:63], a[108:111], v[156:159]
v_mfma_f32_16x16x32_bf16 v[152:155], v[60:63], a[104:107], v[152:155]
v_mfma_f32_16x16x32_bf16 v[148:151], v[60:63], a[100:103], v[148:151]
v_mfma_f32_16x16x32_bf16 v[144:147], v[60:63], a[96:99], v[144:147]
v_mfma_f32_16x16x32_bf16 v[160:163], v[64:67], a[96:99], v[160:163]
v_mfma_f32_16x16x32_bf16 v[164:167], v[64:67], a[100:103], v[164:167]
v_mfma_f32_16x16x32_bf16 v[168:171], v[64:67], a[104:107], v[168:171]
v_mfma_f32_16x16x32_bf16 v[172:175], v[64:67], a[108:111], v[172:175]
v_mfma_f32_16x16x32_bf16 v[204:207], v[68:71], a[108:111], v[204:207]
v_mfma_f32_16x16x32_bf16 v[200:203], v[68:71], a[104:107], v[200:203]
s_waitcnt vmcnt(14)
s_barrier
ds_read_b128 a[112:115], v4 offset:57344
ds_read_b64_tr_b16 v[48:49], v0 offset:16384
v_mfma_f32_16x16x32_bf16 v[196:199], v[68:71], a[100:103], v[196:199]
ds_read_b128 a[116:119], v4 offset:58368
ds_read_b64_tr_b16 v[50:51], v0 offset:18432
v_mfma_f32_16x16x32_bf16 v[192:195], v[68:71], a[96:99], v[192:195]
ds_read_b128 a[120:123], v4 offset:59392
ds_read_b128 a[124:127], v4 offset:60416
v_mfma_f32_16x16x32_bf16 v[176:179], v[72:75], a[96:99], v[176:179]
ds_read_b64_tr_b16 v[52:53], v1 offset:16384
ds_read_b64_tr_b16 v[54:55], v1 offset:18432
v_mfma_f32_16x16x32_bf16 v[180:183], v[72:75], a[100:103], v[180:183]
ds_read_b64_tr_b16 v[56:57], v0 offset:20480
ds_read_b64_tr_b16 v[58:59], v0 offset:22528
v_mfma_f32_16x16x32_bf16 v[184:187], v[72:75], a[104:107], v[184:187]
ds_read_b64_tr_b16 v[60:61], v1 offset:20480
ds_read_b64_tr_b16 v[62:63], v1 offset:22528
v_mfma_f32_16x16x32_bf16 v[188:191], v[72:75], a[108:111], v[188:191]
s_waitcnt lgkmcnt(12)
ds_read_b64_tr_b16 v[64:65], v0 offset:24576
ds_read_b64_tr_b16 v[66:67], v0 offset:26624
v_mfma_f32_16x16x32_bf16 v[220:223], v[76:79], a[108:111], v[220:223]
ds_read_b64_tr_b16 v[68:69], v1 offset:24576
ds_read_b64_tr_b16 v[70:71], v1 offset:26624
v_mfma_f32_16x16x32_bf16 v[216:219], v[76:79], a[104:107], v[216:219]
ds_read_b64_tr_b16 v[72:73], v0 offset:28672
ds_read_b64_tr_b16 v[74:75], v0 offset:30720
v_mfma_f32_16x16x32_bf16 v[212:215], v[76:79], a[100:103], v[212:215]
v_mfma_f32_16x16x32_bf16 v[208:211], v[76:79], a[96:99], v[208:211]
s_waitcnt lgkmcnt(14)
ds_read_b64_tr_b16 v[76:77], v1 offset:28672
buffer_load_dwordx4 v8, s[8:11], s59 offen lds
v_mfma_f32_16x16x32_bf16 v[96:99], v[48:51], a[112:115], v[96:99]
s_add_u32 m0, s4, 69632
s_mov_b32 s59, 114688
ds_read_b64_tr_b16 v[78:79], v1 offset:30720
v_mfma_f32_16x16x32_bf16 v[100:103], v[48:51], a[116:119], v[100:103]
s_waitcnt lgkmcnt(12)
buffer_load_dwordx4 v8, s[12:15], s56 offen lds
v_mfma_f32_16x16x32_bf16 v[104:107], v[48:51], a[120:123], v[104:107]
s_add_u32 m0, s4, 73728
s_mov_b32 s56, 3244032
v_mfma_f32_16x16x32_bf16 v[108:111], v[48:51], a[124:127], v[108:111]
buffer_load_dwordx4 v8, s[8:11], s57 offen lds
v_mfma_f32_16x16x32_bf16 v[140:143], v[52:55], a[124:127], v[140:143]
s_add_u32 m0, s4, 77824
s_mov_b32 s57, 3244032
v_mfma_f32_16x16x32_bf16 v[136:139], v[52:55], a[120:123], v[136:139]
buffer_load_dwordx4 v8, s[12:15], s58 offen lds
v_mfma_f32_16x16x32_bf16 v[132:135], v[52:55], a[116:119], v[132:135]
s_add_u32 m0, s5, 122880
s_mov_b32 s58, 3244160
v_mfma_f32_16x16x32_bf16 v[128:131], v[52:55], a[112:115], v[128:131]
s_waitcnt lgkmcnt(2)
buffer_load_dwordx4 v12, s[24:27], s59 offen sc1 lds
v_mfma_f32_16x16x32_bf16 v[112:115], v[56:59], a[112:115], v[112:115]
v_mfma_f32_16x16x32_bf16 v[116:119], v[56:59], a[116:119], v[116:119]
buffer_load_dwordx4 v12, s[24:27], s59 offen offset:1024 sc1 lds
v_mfma_f32_16x16x32_bf16 v[120:123], v[56:59], a[120:123], v[120:123]
s_add_u32 m0, s4, 0
s_mov_b32 s59, 3244160
v_mfma_f32_16x16x32_bf16 v[124:127], v[56:59], a[124:127], v[124:127]
v_mfma_f32_16x16x32_bf16 v[156:159], v[60:63], a[124:127], v[156:159]
v_mfma_f32_16x16x32_bf16 v[152:155], v[60:63], a[120:123], v[152:155]
v_mfma_f32_16x16x32_bf16 v[148:151], v[60:63], a[116:119], v[148:151]
v_mfma_f32_16x16x32_bf16 v[144:147], v[60:63], a[112:115], v[144:147]
v_mfma_f32_16x16x32_bf16 v[160:163], v[64:67], a[112:115], v[160:163]
v_mfma_f32_16x16x32_bf16 v[164:167], v[64:67], a[116:119], v[164:167]
v_mfma_f32_16x16x32_bf16 v[168:171], v[64:67], a[120:123], v[168:171]
v_mfma_f32_16x16x32_bf16 v[172:175], v[64:67], a[124:127], v[172:175]
v_mfma_f32_16x16x32_bf16 v[204:207], v[68:71], a[124:127], v[204:207]
v_mfma_f32_16x16x32_bf16 v[200:203], v[68:71], a[120:123], v[200:203]
s_waitcnt vmcnt(14)
s_barrier
ds_read_b128 a[128:131], v5 offset:0
ds_read_b64_tr_b16 v[48:49], v0 offset:32768
v_mfma_f32_16x16x32_bf16 v[196:199], v[68:71], a[116:119], v[196:199]
ds_read_b128 a[132:135], v5 offset:1024
ds_read_b64_tr_b16 v[50:51], v0 offset:34816
v_mfma_f32_16x16x32_bf16 v[192:195], v[68:71], a[112:115], v[192:195]
ds_read_b128 a[136:139], v5 offset:2048
ds_read_b128 a[140:143], v5 offset:3072
v_mfma_f32_16x16x32_bf16 v[176:179], v[72:75], a[112:115], v[176:179]
ds_read_b64_tr_b16 v[52:53], v1 offset:32768
ds_read_b64_tr_b16 v[54:55], v1 offset:34816
v_mfma_f32_16x16x32_bf16 v[180:183], v[72:75], a[116:119], v[180:183]
ds_read_b64_tr_b16 v[56:57], v0 offset:36864
ds_read_b64_tr_b16 v[58:59], v0 offset:38912
v_mfma_f32_16x16x32_bf16 v[184:187], v[72:75], a[120:123], v[184:187]
ds_read_b64_tr_b16 v[60:61], v1 offset:36864
ds_read_b64_tr_b16 v[62:63], v1 offset:38912
v_mfma_f32_16x16x32_bf16 v[188:191], v[72:75], a[124:127], v[188:191]
s_waitcnt lgkmcnt(12)
ds_read_b64_tr_b16 v[64:65], v0 offset:40960
ds_read_b64_tr_b16 v[66:67], v0 offset:43008
v_mfma_f32_16x16x32_bf16 v[220:223], v[76:79], a[124:127], v[220:223]
ds_read_b64_tr_b16 v[68:69], v1 offset:40960
ds_read_b64_tr_b16 v[70:71], v1 offset:43008
v_mfma_f32_16x16x32_bf16 v[216:219], v[76:79], a[120:123], v[216:219]
ds_read_b64_tr_b16 v[72:73], v0 offset:45056
ds_read_b64_tr_b16 v[74:75], v0 offset:47104
v_mfma_f32_16x16x32_bf16 v[212:215], v[76:79], a[116:119], v[212:215]
v_mfma_f32_16x16x32_bf16 v[208:211], v[76:79], a[112:115], v[208:211]
s_waitcnt lgkmcnt(14)
ds_read_b64_tr_b16 v[76:77], v1 offset:45056
buffer_load_dwordx4 v8, s[8:11], s56 offen lds
v_mfma_f32_16x16x32_bf16 v[96:99], v[48:51], a[128:131], v[96:99]
s_add_u32 m0, s4, 4096
s_mov_b32 s56, 122880
ds_read_b64_tr_b16 v[78:79], v1 offset:47104
v_mfma_f32_16x16x32_bf16 v[100:103], v[48:51], a[132:135], v[100:103]
s_waitcnt lgkmcnt(12)
buffer_load_dwordx4 v8, s[12:15], s57 offen lds
v_mfma_f32_16x16x32_bf16 v[104:107], v[48:51], a[136:139], v[104:107]
s_add_u32 m0, s4, 8192
s_mov_b32 s57, 3538944
v_mfma_f32_16x16x32_bf16 v[108:111], v[48:51], a[140:143], v[108:111]
buffer_load_dwordx4 v8, s[8:11], s58 offen lds
v_mfma_f32_16x16x32_bf16 v[140:143], v[52:55], a[140:143], v[140:143]
s_add_u32 m0, s4, 12288
s_mov_b32 s58, 3538944
v_mfma_f32_16x16x32_bf16 v[136:139], v[52:55], a[136:139], v[136:139]
buffer_load_dwordx4 v8, s[12:15], s59 offen lds
v_mfma_f32_16x16x32_bf16 v[132:135], v[52:55], a[132:135], v[132:135]
s_add_u32 m0, s5, 131072
s_mov_b32 s59, 3539072
v_mfma_f32_16x16x32_bf16 v[128:131], v[52:55], a[128:131], v[128:131]
s_waitcnt lgkmcnt(2)
buffer_load_dwordx4 v12, s[24:27], s56 offen sc1 lds
v_mfma_f32_16x16x32_bf16 v[112:115], v[56:59], a[128:131], v[112:115]
v_mfma_f32_16x16x32_bf16 v[116:119], v[56:59], a[132:135], v[116:119]
buffer_load_dwordx4 v12, s[24:27], s56 offen offset:1024 sc1 lds
v_mfma_f32_16x16x32_bf16 v[120:123], v[56:59], a[136:139], v[120:123]
s_add_u32 m0, s4, 16384
s_mov_b32 s56, 3539072
v_mfma_f32_16x16x32_bf16 v[124:127], v[56:59], a[140:143], v[124:127]
v_mfma_f32_16x16x32_bf16 v[156:159], v[60:63], a[140:143], v[156:159]
v_mfma_f32_16x16x32_bf16 v[152:155], v[60:63], a[136:139], v[152:155]
v_mfma_f32_16x16x32_bf16 v[148:151], v[60:63], a[132:135], v[148:151]
v_mfma_f32_16x16x32_bf16 v[144:147], v[60:63], a[128:131], v[144:147]
v_mfma_f32_16x16x32_bf16 v[160:163], v[64:67], a[128:131], v[160:163]
v_mfma_f32_16x16x32_bf16 v[164:167], v[64:67], a[132:135], v[164:167]
v_mfma_f32_16x16x32_bf16 v[168:171], v[64:67], a[136:139], v[168:171]
v_mfma_f32_16x16x32_bf16 v[172:175], v[64:67], a[140:143], v[172:175]
v_mfma_f32_16x16x32_bf16 v[204:207], v[68:71], a[140:143], v[204:207]
v_mfma_f32_16x16x32_bf16 v[200:203], v[68:71], a[136:139], v[200:203]
s_waitcnt vmcnt(14)
s_barrier
ds_read_b128 a[144:147], v4 offset:0
ds_read_b64_tr_b16 v[48:49], v0 offset:49152
v_mfma_f32_16x16x32_bf16 v[196:199], v[68:71], a[132:135], v[196:199]
ds_read_b128 a[148:151], v4 offset:1024
ds_read_b64_tr_b16 v[50:51], v0 offset:51200
v_mfma_f32_16x16x32_bf16 v[192:195], v[68:71], a[128:131], v[192:195]
ds_read_b128 a[152:155], v4 offset:2048
ds_read_b128 a[156:159], v4 offset:3072
v_mfma_f32_16x16x32_bf16 v[176:179], v[72:75], a[128:131], v[176:179]
ds_read_b64_tr_b16 v[52:53], v1 offset:49152
ds_read_b64_tr_b16 v[54:55], v1 offset:51200
v_mfma_f32_16x16x32_bf16 v[180:183], v[72:75], a[132:135], v[180:183]
ds_read_b64_tr_b16 v[56:57], v0 offset:53248
ds_read_b64_tr_b16 v[58:59], v0 offset:55296
v_mfma_f32_16x16x32_bf16 v[184:187], v[72:75], a[136:139], v[184:187]
ds_read_b64_tr_b16 v[60:61], v1 offset:53248
ds_read_b64_tr_b16 v[62:63], v1 offset:55296
v_mfma_f32_16x16x32_bf16 v[188:191], v[72:75], a[140:143], v[188:191]
s_waitcnt lgkmcnt(12)
ds_read_b64_tr_b16 v[64:65], v0 offset:57344
ds_read_b64_tr_b16 v[66:67], v0 offset:59392
v_mfma_f32_16x16x32_bf16 v[220:223], v[76:79], a[140:143], v[220:223]
ds_read_b64_tr_b16 v[68:69], v1 offset:57344
ds_read_b64_tr_b16 v[70:71], v1 offset:59392
v_mfma_f32_16x16x32_bf16 v[216:219], v[76:79], a[136:139], v[216:219]
ds_read_b64_tr_b16 v[72:73], v0 offset:61440
ds_read_b64_tr_b16 v[74:75], v0 offset:63488
v_mfma_f32_16x16x32_bf16 v[212:215], v[76:79], a[132:135], v[212:215]
v_mfma_f32_16x16x32_bf16 v[208:211], v[76:79], a[128:131], v[208:211]
s_waitcnt lgkmcnt(14)
ds_read_b64_tr_b16 v[76:77], v1 offset:61440
buffer_load_dwordx4 v8, s[8:11], s57 offen lds
v_mfma_f32_16x16x32_bf16 v[96:99], v[48:51], a[144:147], v[96:99]
s_add_u32 m0, s4, 20480
s_mov_b32 s57, 131072
ds_read_b64_tr_b16 v[78:79], v1 offset:63488
v_mfma_f32_16x16x32_bf16 v[100:103], v[48:51], a[148:151], v[100:103]
s_waitcnt lgkmcnt(12)
buffer_load_dwordx4 v8, s[12:15], s58 offen lds
v_mfma_f32_16x16x32_bf16 v[104:107], v[48:51], a[152:155], v[104:107]
s_add_u32 m0, s4, 24576
s_mov_b32 s58, 3833856
v_mfma_f32_16x16x32_bf16 v[108:111], v[48:51], a[156:159], v[108:111]
buffer_load_dwordx4 v8, s[8:11], s59 offen lds
v_mfma_f32_16x16x32_bf16 v[140:143], v[52:55], a[156:159], v[140:143]
s_add_u32 m0, s4, 28672
s_mov_b32 s59, 3833856
v_mfma_f32_16x16x32_bf16 v[136:139], v[52:55], a[152:155], v[136:139]
buffer_load_dwordx4 v8, s[12:15], s56 offen lds
v_mfma_f32_16x16x32_bf16 v[132:135], v[52:55], a[148:151], v[132:135]
s_add_u32 m0, s5, 139264
s_mov_b32 s56, 3833984
v_mfma_f32_16x16x32_bf16 v[128:131], v[52:55], a[144:147], v[128:131]
s_waitcnt lgkmcnt(2)
buffer_load_dwordx4 v12, s[24:27], s57 offen sc1 lds
v_mfma_f32_16x16x32_bf16 v[112:115], v[56:59], a[144:147], v[112:115]
v_mfma_f32_16x16x32_bf16 v[116:119], v[56:59], a[148:151], v[116:119]
buffer_load_dwordx4 v12, s[24:27], s57 offen offset:1024 sc1 lds
v_mfma_f32_16x16x32_bf16 v[120:123], v[56:59], a[152:155], v[120:123]
s_add_u32 m0, s4, 32768
s_mov_b32 s57, 3833984
v_mfma_f32_16x16x32_bf16 v[124:127], v[56:59], a[156:159], v[124:127]
v_mfma_f32_16x16x32_bf16 v[156:159], v[60:63], a[156:159], v[156:159]
v_mfma_f32_16x16x32_bf16 v[152:155], v[60:63], a[152:155], v[152:155]
v_mfma_f32_16x16x32_bf16 v[148:151], v[60:63], a[148:151], v[148:151]
v_mfma_f32_16x16x32_bf16 v[144:147], v[60:63], a[144:147], v[144:147]
v_mfma_f32_16x16x32_bf16 v[160:163], v[64:67], a[144:147], v[160:163]
v_mfma_f32_16x16x32_bf16 v[164:167], v[64:67], a[148:151], v[164:167]
v_mfma_f32_16x16x32_bf16 v[168:171], v[64:67], a[152:155], v[168:171]
v_mfma_f32_16x16x32_bf16 v[172:175], v[64:67], a[156:159], v[172:175]
v_mfma_f32_16x16x32_bf16 v[204:207], v[68:71], a[156:159], v[204:207]
v_mfma_f32_16x16x32_bf16 v[200:203], v[68:71], a[152:155], v[200:203]
s_waitcnt vmcnt(14)
s_barrier
ds_read_b128 a[160:163], v4 offset:8192
ds_read_b64_tr_b16 v[48:49], v2 offset:0
v_mfma_f32_16x16x32_bf16 v[196:199], v[68:71], a[148:151], v[196:199]
ds_read_b128 a[164:167], v4 offset:9216
ds_read_b64_tr_b16 v[50:51], v2 offset:2048
v_mfma_f32_16x16x32_bf16 v[192:195], v[68:71], a[144:147], v[192:195]
ds_read_b128 a[168:171], v4 offset:10240
ds_read_b128 a[172:175], v4 offset:11264
v_mfma_f32_16x16x32_bf16 v[176:179], v[72:75], a[144:147], v[176:179]
ds_read_b64_tr_b16 v[52:53], v3 offset:0
ds_read_b64_tr_b16 v[54:55], v3 offset:2048
v_mfma_f32_16x16x32_bf16 v[180:183], v[72:75], a[148:151], v[180:183]
ds_read_b64_tr_b16 v[56:57], v2 offset:4096
ds_read_b64_tr_b16 v[58:59], v2 offset:6144
v_mfma_f32_16x16x32_bf16 v[184:187], v[72:75], a[152:155], v[184:187]
ds_read_b64_tr_b16 v[60:61], v3 offset:4096
ds_read_b64_tr_b16 v[62:63], v3 offset:6144
v_mfma_f32_16x16x32_bf16 v[188:191], v[72:75], a[156:159], v[188:191]
s_waitcnt lgkmcnt(12)
ds_read_b64_tr_b16 v[64:65], v2 offset:8192
ds_read_b64_tr_b16 v[66:67], v2 offset:10240
v_mfma_f32_16x16x32_bf16 v[220:223], v[76:79], a[156:159], v[220:223]
ds_read_b64_tr_b16 v[68:69], v3 offset:8192
ds_read_b64_tr_b16 v[70:71], v3 offset:10240
v_mfma_f32_16x16x32_bf16 v[216:219], v[76:79], a[152:155], v[216:219]
ds_read_b64_tr_b16 v[72:73], v2 offset:12288
ds_read_b64_tr_b16 v[74:75], v2 offset:14336
v_mfma_f32_16x16x32_bf16 v[212:215], v[76:79], a[148:151], v[212:215]
v_mfma_f32_16x16x32_bf16 v[208:211], v[76:79], a[144:147], v[208:211]
s_waitcnt lgkmcnt(14)
ds_read_b64_tr_b16 v[76:77], v3 offset:12288
buffer_load_dwordx4 v8, s[8:11], s58 offen lds
v_mfma_f32_16x16x32_bf16 v[96:99], v[48:51], a[160:163], v[96:99]
s_add_u32 m0, s4, 36864
s_mov_b32 s58, 139264
ds_read_b64_tr_b16 v[78:79], v3 offset:14336
v_mfma_f32_16x16x32_bf16 v[100:103], v[48:51], a[164:167], v[100:103]
s_waitcnt lgkmcnt(12)
buffer_load_dwordx4 v8, s[12:15], s59 offen lds
v_mfma_f32_16x16x32_bf16 v[104:107], v[48:51], a[168:171], v[104:107]
s_add_u32 m0, s4, 40960
s_mov_b32 s59, 4128768
v_mfma_f32_16x16x32_bf16 v[108:111], v[48:51], a[172:175], v[108:111]
buffer_load_dwordx4 v8, s[8:11], s56 offen lds
v_mfma_f32_16x16x32_bf16 v[140:143], v[52:55], a[172:175], v[140:143]
s_add_u32 m0, s4, 45056
s_mov_b32 s56, 4128768
v_mfma_f32_16x16x32_bf16 v[136:139], v[52:55], a[168:171], v[136:139]
buffer_load_dwordx4 v8, s[12:15], s57 offen lds
v_mfma_f32_16x16x32_bf16 v[132:135], v[52:55], a[164:167], v[132:135]
s_add_u32 m0, s5, 147456
s_mov_b32 s57, 4128896
v_mfma_f32_16x16x32_bf16 v[128:131], v[52:55], a[160:163], v[128:131]
s_waitcnt lgkmcnt(2)
buffer_load_dwordx4 v12, s[24:27], s58 offen sc1 lds
v_mfma_f32_16x16x32_bf16 v[112:115], v[56:59], a[160:163], v[112:115]
v_mfma_f32_16x16x32_bf16 v[116:119], v[56:59], a[164:167], v[116:119]
buffer_load_dwordx4 v12, s[24:27], s58 offen offset:1024 sc1 lds
v_mfma_f32_16x16x32_bf16 v[120:123], v[56:59], a[168:171], v[120:123]
s_add_u32 m0, s4, 49152
s_mov_b32 s58, 4128896
v_mfma_f32_16x16x32_bf16 v[124:127], v[56:59], a[172:175], v[124:127]
v_mfma_f32_16x16x32_bf16 v[156:159], v[60:63], a[172:175], v[156:159]
v_mfma_f32_16x16x32_bf16 v[152:155], v[60:63], a[168:171], v[152:155]
v_mfma_f32_16x16x32_bf16 v[148:151], v[60:63], a[164:167], v[148:151]
v_mfma_f32_16x16x32_bf16 v[144:147], v[60:63], a[160:163], v[144:147]
v_mfma_f32_16x16x32_bf16 v[160:163], v[64:67], a[160:163], v[160:163]
v_mfma_f32_16x16x32_bf16 v[164:167], v[64:67], a[164:167], v[164:167]
v_mfma_f32_16x16x32_bf16 v[168:171], v[64:67], a[168:171], v[168:171]
v_mfma_f32_16x16x32_bf16 v[172:175], v[64:67], a[172:175], v[172:175]
v_mfma_f32_16x16x32_bf16 v[204:207], v[68:71], a[172:175], v[204:207]
v_mfma_f32_16x16x32_bf16 v[200:203], v[68:71], a[168:171], v[200:203]
s_waitcnt vmcnt(14)
s_barrier
ds_read_b128 a[176:179], v4 offset:16384
ds_read_b64_tr_b16 v[48:49], v0 offset:0
v_mfma_f32_16x16x32_bf16 v[196:199], v[68:71], a[164:167], v[196:199]
ds_read_b128 a[180:183], v4 offset:17408
ds_read_b64_tr_b16 v[50:51], v0 offset:2048
v_mfma_f32_16x16x32_bf16 v[192:195], v[68:71], a[160:163], v[192:195]
ds_read_b128 a[184:187], v4 offset:18432
ds_read_b128 a[188:191], v4 offset:19456
v_mfma_f32_16x16x32_bf16 v[176:179], v[72:75], a[160:163], v[176:179]
ds_read_b64_tr_b16 v[52:53], v1 offset:0
ds_read_b64_tr_b16 v[54:55], v1 offset:2048
v_mfma_f32_16x16x32_bf16 v[180:183], v[72:75], a[164:167], v[180:183]
ds_read_b64_tr_b16 v[56:57], v0 offset:4096
ds_read_b64_tr_b16 v[58:59], v0 offset:6144
v_mfma_f32_16x16x32_bf16 v[184:187], v[72:75], a[168:171], v[184:187]
ds_read_b64_tr_b16 v[60:61], v1 offset:4096
ds_read_b64_tr_b16 v[62:63], v1 offset:6144
v_mfma_f32_16x16x32_bf16 v[188:191], v[72:75], a[172:175], v[188:191]
s_waitcnt lgkmcnt(12)
ds_read_b64_tr_b16 v[64:65], v0 offset:8192
ds_read_b64_tr_b16 v[66:67], v0 offset:10240
v_mfma_f32_16x16x32_bf16 v[220:223], v[76:79], a[172:175], v[220:223]
ds_read_b64_tr_b16 v[68:69], v1 offset:8192
ds_read_b64_tr_b16 v[70:71], v1 offset:10240
v_mfma_f32_16x16x32_bf16 v[216:219], v[76:79], a[168:171], v[216:219]
ds_read_b64_tr_b16 v[72:73], v0 offset:12288
ds_read_b64_tr_b16 v[74:75], v0 offset:14336
v_mfma_f32_16x16x32_bf16 v[212:215], v[76:79], a[164:167], v[212:215]
v_mfma_f32_16x16x32_bf16 v[208:211], v[76:79], a[160:163], v[208:211]
s_waitcnt lgkmcnt(14)
ds_read_b64_tr_b16 v[76:77], v1 offset:12288
buffer_load_dwordx4 v8, s[8:11], s59 offen lds
v_mfma_f32_16x16x32_bf16 v[96:99], v[48:51], a[176:179], v[96:99]
s_add_u32 m0, s4, 53248
s_mov_b32 s59, 4423680
ds_read_b64_tr_b16 v[78:79], v1 offset:14336
v_mfma_f32_16x16x32_bf16 v[100:103], v[48:51], a[180:183], v[100:103]
s_waitcnt lgkmcnt(12)
buffer_load_dwordx4 v8, s[12:15], s56 offen lds
v_mfma_f32_16x16x32_bf16 v[104:107], v[48:51], a[184:187], v[104:107]
s_add_u32 m0, s4, 57344
s_mov_b32 s56, 4423680
v_mfma_f32_16x16x32_bf16 v[108:111], v[48:51], a[188:191], v[108:111]
buffer_load_dwordx4 v8, s[8:11], s57 offen lds
v_mfma_f32_16x16x32_bf16 v[140:143], v[52:55], a[188:191], v[140:143]
s_add_u32 m0, s4, 61440
s_mov_b32 s57, 4423808
v_mfma_f32_16x16x32_bf16 v[136:139], v[52:55], a[184:187], v[136:139]
buffer_load_dwordx4 v8, s[12:15], s58 offen lds
v_mfma_f32_16x16x32_bf16 v[132:135], v[52:55], a[180:183], v[132:135]
s_add_u32 m0, s4, 65536
s_mov_b32 s58, 4423808
v_mfma_f32_16x16x32_bf16 v[128:131], v[52:55], a[176:179], v[128:131]
s_waitcnt lgkmcnt(2)
v_mfma_f32_16x16x32_bf16 v[112:115], v[56:59], a[176:179], v[112:115]
v_mfma_f32_16x16x32_bf16 v[116:119], v[56:59], a[180:183], v[116:119]
v_mfma_f32_16x16x32_bf16 v[120:123], v[56:59], a[184:187], v[120:123]
v_mfma_f32_16x16x32_bf16 v[124:127], v[56:59], a[188:191], v[124:127]
v_mfma_f32_16x16x32_bf16 v[156:159], v[60:63], a[188:191], v[156:159]
v_mfma_f32_16x16x32_bf16 v[152:155], v[60:63], a[184:187], v[152:155]
v_mfma_f32_16x16x32_bf16 v[148:151], v[60:63], a[180:183], v[148:151]
v_mfma_f32_16x16x32_bf16 v[144:147], v[60:63], a[176:179], v[144:147]
v_mfma_f32_16x16x32_bf16 v[160:163], v[64:67], a[176:179], v[160:163]
v_mfma_f32_16x16x32_bf16 v[164:167], v[64:67], a[180:183], v[164:167]
v_mfma_f32_16x16x32_bf16 v[168:171], v[64:67], a[184:187], v[168:171]
v_mfma_f32_16x16x32_bf16 v[172:175], v[64:67], a[188:191], v[172:175]
v_mfma_f32_16x16x32_bf16 v[204:207], v[68:71], a[188:191], v[204:207]
v_mfma_f32_16x16x32_bf16 v[200:203], v[68:71], a[184:187], v[200:203]
s_waitcnt vmcnt(12)
s_barrier
ds_read_b128 a[192:195], v4 offset:24576
ds_read_b64_tr_b16 v[48:49], v0 offset:16384
v_mfma_f32_16x16x32_bf16 v[196:199], v[68:71], a[180:183], v[196:199]
ds_read_b128 a[196:199], v4 offset:25600
ds_read_b64_tr_b16 v[50:51], v0 offset:18432
v_mfma_f32_16x16x32_bf16 v[192:195], v[68:71], a[176:179], v[192:195]
ds_read_b128 a[200:203], v4 offset:26624
ds_read_b128 a[204:207], v4 offset:27648
v_mfma_f32_16x16x32_bf16 v[176:179], v[72:75], a[176:179], v[176:179]
ds_read_b64_tr_b16 v[52:53], v1 offset:16384
ds_read_b64_tr_b16 v[54:55], v1 offset:18432
v_mfma_f32_16x16x32_bf16 v[180:183], v[72:75], a[180:183], v[180:183]
ds_read_b64_tr_b16 v[56:57], v0 offset:20480
ds_read_b64_tr_b16 v[58:59], v0 offset:22528
v_mfma_f32_16x16x32_bf16 v[184:187], v[72:75], a[184:187], v[184:187]
ds_read_b64_tr_b16 v[60:61], v1 offset:20480
ds_read_b64_tr_b16 v[62:63], v1 offset:22528
v_mfma_f32_16x16x32_bf16 v[188:191], v[72:75], a[188:191], v[188:191]
s_waitcnt lgkmcnt(12)
ds_read_b64_tr_b16 v[64:65], v0 offset:24576
ds_read_b64_tr_b16 v[66:67], v0 offset:26624
v_mfma_f32_16x16x32_bf16 v[220:223], v[76:79], a[188:191], v[220:223]
ds_read_b64_tr_b16 v[68:69], v1 offset:24576
ds_read_b64_tr_b16 v[70:71], v1 offset:26624
v_mfma_f32_16x16x32_bf16 v[216:219], v[76:79], a[184:187], v[216:219]
ds_read_b64_tr_b16 v[72:73], v0 offset:28672
ds_read_b64_tr_b16 v[74:75], v0 offset:30720
v_mfma_f32_16x16x32_bf16 v[212:215], v[76:79], a[180:183], v[212:215]
v_mfma_f32_16x16x32_bf16 v[208:211], v[76:79], a[176:179], v[208:211]
s_waitcnt lgkmcnt(14)
ds_read_b64_tr_b16 v[76:77], v1 offset:28672
buffer_load_dwordx4 v8, s[8:11], s59 offen lds
v_mfma_f32_16x16x32_bf16 v[96:99], v[48:51], a[192:195], v[96:99]
s_add_u32 m0, s4, 69632
s_mov_b32 s59, 4718592
ds_read_b64_tr_b16 v[78:79], v1 offset:30720
v_mfma_f32_16x16x32_bf16 v[100:103], v[48:51], a[196:199], v[100:103]
s_waitcnt lgkmcnt(12)
buffer_load_dwordx4 v8, s[12:15], s56 offen lds
v_mfma_f32_16x16x32_bf16 v[104:107], v[48:51], a[200:203], v[104:107]
s_add_u32 m0, s4, 73728
s_mov_b32 s56, 4718592
v_mfma_f32_16x16x32_bf16 v[108:111], v[48:51], a[204:207], v[108:111]
buffer_load_dwordx4 v8, s[8:11], s57 offen lds
v_mfma_f32_16x16x32_bf16 v[140:143], v[52:55], a[204:207], v[140:143]
s_add_u32 m0, s4, 77824
s_mov_b32 s57, 4718720
v_mfma_f32_16x16x32_bf16 v[136:139], v[52:55], a[200:203], v[136:139]
buffer_load_dwordx4 v8, s[12:15], s58 offen lds
v_mfma_f32_16x16x32_bf16 v[132:135], v[52:55], a[196:199], v[132:135]
s_add_u32 m0, s4, 0
s_mov_b32 s58, 4718720
v_mfma_f32_16x16x32_bf16 v[128:131], v[52:55], a[192:195], v[128:131]
s_waitcnt lgkmcnt(2)
v_mfma_f32_16x16x32_bf16 v[112:115], v[56:59], a[192:195], v[112:115]
v_mfma_f32_16x16x32_bf16 v[116:119], v[56:59], a[196:199], v[116:119]
v_mfma_f32_16x16x32_bf16 v[120:123], v[56:59], a[200:203], v[120:123]
v_mfma_f32_16x16x32_bf16 v[124:127], v[56:59], a[204:207], v[124:127]
v_mfma_f32_16x16x32_bf16 v[156:159], v[60:63], a[204:207], v[156:159]
v_mfma_f32_16x16x32_bf16 v[152:155], v[60:63], a[200:203], v[152:155]
v_mfma_f32_16x16x32_bf16 v[148:151], v[60:63], a[196:199], v[148:151]
v_mfma_f32_16x16x32_bf16 v[144:147], v[60:63], a[192:195], v[144:147]
v_mfma_f32_16x16x32_bf16 v[160:163], v[64:67], a[192:195], v[160:163]
v_mfma_f32_16x16x32_bf16 v[164:167], v[64:67], a[196:199], v[164:167]
v_mfma_f32_16x16x32_bf16 v[168:171], v[64:67], a[200:203], v[168:171]
v_mfma_f32_16x16x32_bf16 v[172:175], v[64:67], a[204:207], v[172:175]
v_mfma_f32_16x16x32_bf16 v[204:207], v[68:71], a[204:207], v[204:207]
v_mfma_f32_16x16x32_bf16 v[200:203], v[68:71], a[200:203], v[200:203]
s_waitcnt vmcnt(10)
s_barrier
ds_read_b128 a[208:211], v4 offset:32768
ds_read_b64_tr_b16 v[48:49], v0 offset:32768
v_mfma_f32_16x16x32_bf16 v[196:199], v[68:71], a[196:199], v[196:199]
ds_read_b128 a[212:215], v4 offset:33792
ds_read_b64_tr_b16 v[50:51], v0 offset:34816
v_mfma_f32_16x16x32_bf16 v[192:195], v[68:71], a[192:195], v[192:195]
ds_read_b128 a[216:219], v4 offset:34816
ds_read_b128 a[220:223], v4 offset:35840
v_mfma_f32_16x16x32_bf16 v[176:179], v[72:75], a[192:195], v[176:179]
ds_read_b64_tr_b16 v[52:53], v1 offset:32768
ds_read_b64_tr_b16 v[54:55], v1 offset:34816
v_mfma_f32_16x16x32_bf16 v[180:183], v[72:75], a[196:199], v[180:183]
ds_read_b64_tr_b16 v[56:57], v0 offset:36864
ds_read_b64_tr_b16 v[58:59], v0 offset:38912
v_mfma_f32_16x16x32_bf16 v[184:187], v[72:75], a[200:203], v[184:187]
ds_read_b64_tr_b16 v[60:61], v1 offset:36864
ds_read_b64_tr_b16 v[62:63], v1 offset:38912
v_mfma_f32_16x16x32_bf16 v[188:191], v[72:75], a[204:207], v[188:191]
s_waitcnt lgkmcnt(12)
ds_read_b64_tr_b16 v[64:65], v0 offset:40960
ds_read_b64_tr_b16 v[66:67], v0 offset:43008
v_mfma_f32_16x16x32_bf16 v[220:223], v[76:79], a[204:207], v[220:223]
ds_read_b64_tr_b16 v[68:69], v1 offset:40960
ds_read_b64_tr_b16 v[70:71], v1 offset:43008
v_mfma_f32_16x16x32_bf16 v[216:219], v[76:79], a[200:203], v[216:219]
ds_read_b64_tr_b16 v[72:73], v0 offset:45056
ds_read_b64_tr_b16 v[74:75], v0 offset:47104
v_mfma_f32_16x16x32_bf16 v[212:215], v[76:79], a[196:199], v[212:215]
v_mfma_f32_16x16x32_bf16 v[208:211], v[76:79], a[192:195], v[208:211]
s_waitcnt lgkmcnt(14)
ds_read_b64_tr_b16 v[76:77], v1 offset:45056
buffer_load_dwordx4 v8, s[8:11], s59 offen lds
v_mfma_f32_16x16x32_bf16 v[96:99], v[48:51], a[208:211], v[96:99]
s_add_u32 m0, s4, 4096
s_mov_b32 s59, 5013504
ds_read_b64_tr_b16 v[78:79], v1 offset:47104
v_mfma_f32_16x16x32_bf16 v[100:103], v[48:51], a[212:215], v[100:103]
s_waitcnt lgkmcnt(12)
buffer_load_dwordx4 v8, s[12:15], s56 offen lds
v_mfma_f32_16x16x32_bf16 v[104:107], v[48:51], a[216:219], v[104:107]
s_add_u32 m0, s4, 8192
s_mov_b32 s56, 5013504
v_mfma_f32_16x16x32_bf16 v[108:111], v[48:51], a[220:223], v[108:111]
buffer_load_dwordx4 v8, s[8:11], s57 offen lds
v_mfma_f32_16x16x32_bf16 v[140:143], v[52:55], a[220:223], v[140:143]
s_add_u32 m0, s4, 12288
s_mov_b32 s57, 5013632
v_mfma_f32_16x16x32_bf16 v[136:139], v[52:55], a[216:219], v[136:139]
buffer_load_dwordx4 v8, s[12:15], s58 offen lds
v_mfma_f32_16x16x32_bf16 v[132:135], v[52:55], a[212:215], v[132:135]
s_add_u32 m0, s4, 16384
s_mov_b32 s58, 5013632
v_mfma_f32_16x16x32_bf16 v[128:131], v[52:55], a[208:211], v[128:131]
s_waitcnt lgkmcnt(2)
v_mfma_f32_16x16x32_bf16 v[112:115], v[56:59], a[208:211], v[112:115]
v_mfma_f32_16x16x32_bf16 v[116:119], v[56:59], a[212:215], v[116:119]
v_mfma_f32_16x16x32_bf16 v[120:123], v[56:59], a[216:219], v[120:123]
v_mfma_f32_16x16x32_bf16 v[124:127], v[56:59], a[220:223], v[124:127]
v_mfma_f32_16x16x32_bf16 v[156:159], v[60:63], a[220:223], v[156:159]
v_mfma_f32_16x16x32_bf16 v[152:155], v[60:63], a[216:219], v[152:155]
v_mfma_f32_16x16x32_bf16 v[148:151], v[60:63], a[212:215], v[148:151]
v_mfma_f32_16x16x32_bf16 v[144:147], v[60:63], a[208:211], v[144:147]
v_mfma_f32_16x16x32_bf16 v[160:163], v[64:67], a[208:211], v[160:163]
v_mfma_f32_16x16x32_bf16 v[164:167], v[64:67], a[212:215], v[164:167]
v_mfma_f32_16x16x32_bf16 v[168:171], v[64:67], a[216:219], v[168:171]
v_mfma_f32_16x16x32_bf16 v[172:175], v[64:67], a[220:223], v[172:175]
v_mfma_f32_16x16x32_bf16 v[204:207], v[68:71], a[220:223], v[204:207]
v_mfma_f32_16x16x32_bf16 v[200:203], v[68:71], a[216:219], v[200:203]
s_waitcnt vmcnt(8)
s_barrier
ds_read_b128 a[224:227], v4 offset:40960
ds_read_b64_tr_b16 v[48:49], v0 offset:49152
v_mfma_f32_16x16x32_bf16 v[196:199], v[68:71], a[212:215], v[196:199]
ds_read_b128 a[228:231], v4 offset:41984
ds_read_b64_tr_b16 v[50:51], v0 offset:51200
v_mfma_f32_16x16x32_bf16 v[192:195], v[68:71], a[208:211], v[192:195]
ds_read_b128 a[232:235], v4 offset:43008
ds_read_b128 a[236:239], v4 offset:44032
v_mfma_f32_16x16x32_bf16 v[176:179], v[72:75], a[208:211], v[176:179]
ds_read_b64_tr_b16 v[52:53], v1 offset:49152
ds_read_b64_tr_b16 v[54:55], v1 offset:51200
v_mfma_f32_16x16x32_bf16 v[180:183], v[72:75], a[212:215], v[180:183]
ds_read_b64_tr_b16 v[56:57], v0 offset:53248
ds_read_b64_tr_b16 v[58:59], v0 offset:55296
v_mfma_f32_16x16x32_bf16 v[184:187], v[72:75], a[216:219], v[184:187]
ds_read_b64_tr_b16 v[60:61], v1 offset:53248
ds_read_b64_tr_b16 v[62:63], v1 offset:55296
v_mfma_f32_16x16x32_bf16 v[188:191], v[72:75], a[220:223], v[188:191]
s_waitcnt lgkmcnt(12)
ds_read_b64_tr_b16 v[64:65], v0 offset:57344
ds_read_b64_tr_b16 v[66:67], v0 offset:59392
v_mfma_f32_16x16x32_bf16 v[220:223], v[76:79], a[220:223], v[220:223]
ds_read_b64_tr_b16 v[68:69], v1 offset:57344
ds_read_b64_tr_b16 v[70:71], v1 offset:59392
v_mfma_f32_16x16x32_bf16 v[216:219], v[76:79], a[216:219], v[216:219]
ds_read_b64_tr_b16 v[72:73], v0 offset:61440
ds_read_b64_tr_b16 v[74:75], v0 offset:63488
v_mfma_f32_16x16x32_bf16 v[212:215], v[76:79], a[212:215], v[212:215]
v_mfma_f32_16x16x32_bf16 v[208:211], v[76:79], a[208:211], v[208:211]
s_waitcnt lgkmcnt(14)
ds_read_b64_tr_b16 v[76:77], v1 offset:61440
buffer_load_dwordx4 v8, s[8:11], s59 offen lds
v_mfma_f32_16x16x32_bf16 v[96:99], v[48:51], a[224:227], v[96:99]
s_add_u32 m0, s4, 20480
s_mov_b32 s59, 0
ds_read_b64_tr_b16 v[78:79], v1 offset:63488
v_mfma_f32_16x16x32_bf16 v[100:103], v[48:51], a[228:231], v[100:103]
s_waitcnt lgkmcnt(12)
buffer_load_dwordx4 v8, s[12:15], s56 offen lds
v_mfma_f32_16x16x32_bf16 v[104:107], v[48:51], a[232:235], v[104:107]
s_add_u32 m0, s4, 24576
s_mov_b32 s56, 0
v_mfma_f32_16x16x32_bf16 v[108:111], v[48:51], a[236:239], v[108:111]
buffer_load_dwordx4 v8, s[8:11], s57 offen lds
v_mfma_f32_16x16x32_bf16 v[140:143], v[52:55], a[236:239], v[140:143]
s_add_u32 m0, s4, 28672
s_mov_b32 s57, 589824
v_mfma_f32_16x16x32_bf16 v[136:139], v[52:55], a[232:235], v[136:139]
buffer_load_dwordx4 v8, s[12:15], s58 offen lds
v_mfma_f32_16x16x32_bf16 v[132:135], v[52:55], a[228:231], v[132:135]
s_add_u32 m0, s4, 32768
s_mov_b32 s58, 589824
v_mfma_f32_16x16x32_bf16 v[128:131], v[52:55], a[224:227], v[128:131]
s_waitcnt lgkmcnt(2)
v_mfma_f32_16x16x32_bf16 v[112:115], v[56:59], a[224:227], v[112:115]
v_mfma_f32_16x16x32_bf16 v[116:119], v[56:59], a[228:231], v[116:119]
v_mfma_f32_16x16x32_bf16 v[120:123], v[56:59], a[232:235], v[120:123]
v_mfma_f32_16x16x32_bf16 v[124:127], v[56:59], a[236:239], v[124:127]
v_mfma_f32_16x16x32_bf16 v[156:159], v[60:63], a[236:239], v[156:159]
v_mfma_f32_16x16x32_bf16 v[152:155], v[60:63], a[232:235], v[152:155]
v_mfma_f32_16x16x32_bf16 v[148:151], v[60:63], a[228:231], v[148:151]
v_mfma_f32_16x16x32_bf16 v[144:147], v[60:63], a[224:227], v[144:147]
v_mfma_f32_16x16x32_bf16 v[160:163], v[64:67], a[224:227], v[160:163]
v_mfma_f32_16x16x32_bf16 v[164:167], v[64:67], a[228:231], v[164:167]
v_mfma_f32_16x16x32_bf16 v[168:171], v[64:67], a[232:235], v[168:171]
v_mfma_f32_16x16x32_bf16 v[172:175], v[64:67], a[236:239], v[172:175]
v_mfma_f32_16x16x32_bf16 v[204:207], v[68:71], a[236:239], v[204:207]
v_mfma_f32_16x16x32_bf16 v[200:203], v[68:71], a[232:235], v[200:203]
s_waitcnt vmcnt(8)
s_barrier
ds_read_b128 a[240:243], v4 offset:49152
ds_read_b64_tr_b16 v[48:49], v2 offset:0
v_mfma_f32_16x16x32_bf16 v[196:199], v[68:71], a[228:231], v[196:199]
ds_read_b128 a[244:247], v4 offset:50176
ds_read_b64_tr_b16 v[50:51], v2 offset:2048
v_mfma_f32_16x16x32_bf16 v[192:195], v[68:71], a[224:227], v[192:195]
ds_read_b128 a[248:251], v4 offset:51200
ds_read_b128 a[252:255], v4 offset:52224
v_mfma_f32_16x16x32_bf16 v[176:179], v[72:75], a[224:227], v[176:179]
ds_read_b64_tr_b16 v[52:53], v3 offset:0
ds_read_b64_tr_b16 v[54:55], v3 offset:2048
v_mfma_f32_16x16x32_bf16 v[180:183], v[72:75], a[228:231], v[180:183]
ds_read_b64_tr_b16 v[56:57], v2 offset:4096
ds_read_b64_tr_b16 v[58:59], v2 offset:6144
v_mfma_f32_16x16x32_bf16 v[184:187], v[72:75], a[232:235], v[184:187]
ds_read_b64_tr_b16 v[60:61], v3 offset:4096
ds_read_b64_tr_b16 v[62:63], v3 offset:6144
v_mfma_f32_16x16x32_bf16 v[188:191], v[72:75], a[236:239], v[188:191]
s_waitcnt lgkmcnt(12)
ds_read_b64_tr_b16 v[64:65], v2 offset:8192
ds_read_b64_tr_b16 v[66:67], v2 offset:10240
v_mfma_f32_16x16x32_bf16 v[220:223], v[76:79], a[236:239], v[220:223]
ds_read_b64_tr_b16 v[68:69], v3 offset:8192
ds_read_b64_tr_b16 v[70:71], v3 offset:10240
v_mfma_f32_16x16x32_bf16 v[216:219], v[76:79], a[232:235], v[216:219]
ds_read_b64_tr_b16 v[72:73], v2 offset:12288
ds_read_b64_tr_b16 v[74:75], v2 offset:14336
v_mfma_f32_16x16x32_bf16 v[212:215], v[76:79], a[228:231], v[212:215]
v_mfma_f32_16x16x32_bf16 v[208:211], v[76:79], a[224:227], v[208:211]
s_waitcnt lgkmcnt(14)
ds_read_b64_tr_b16 v[76:77], v3 offset:12288
buffer_load_dwordx4 v9, s[8:11], s59 offen lds
v_mfma_f32_16x16x32_bf16 v[96:99], v[48:51], a[240:243], v[96:99]
s_add_u32 m0, s4, 36864
s_mov_b32 s59, 1179648
ds_read_b64_tr_b16 v[78:79], v3 offset:14336
v_mfma_f32_16x16x32_bf16 v[100:103], v[48:51], a[244:247], v[100:103]
s_waitcnt lgkmcnt(12)
buffer_load_dwordx4 v9, s[12:15], s56 offen lds
v_mfma_f32_16x16x32_bf16 v[104:107], v[48:51], a[248:251], v[104:107]
s_add_u32 m0, s4, 40960
s_mov_b32 s56, 1179648
v_mfma_f32_16x16x32_bf16 v[108:111], v[48:51], a[252:255], v[108:111]
buffer_load_dwordx4 v9, s[8:11], s57 offen lds
v_mfma_f32_16x16x32_bf16 v[140:143], v[52:55], a[252:255], v[140:143]
s_add_u32 m0, s4, 45056
s_mov_b32 s57, 1769472
v_mfma_f32_16x16x32_bf16 v[136:139], v[52:55], a[248:251], v[136:139]
buffer_load_dwordx4 v9, s[12:15], s58 offen lds
v_mfma_f32_16x16x32_bf16 v[132:135], v[52:55], a[244:247], v[132:135]
s_add_u32 m0, s4, 49152
s_mov_b32 s58, 1769472
v_mfma_f32_16x16x32_bf16 v[128:131], v[52:55], a[240:243], v[128:131]
s_waitcnt lgkmcnt(2)
v_mfma_f32_16x16x32_bf16 v[112:115], v[56:59], a[240:243], v[112:115]
v_mfma_f32_16x16x32_bf16 v[116:119], v[56:59], a[244:247], v[116:119]
v_mfma_f32_16x16x32_bf16 v[120:123], v[56:59], a[248:251], v[120:123]
v_mfma_f32_16x16x32_bf16 v[124:127], v[56:59], a[252:255], v[124:127]
v_mfma_f32_16x16x32_bf16 v[156:159], v[60:63], a[252:255], v[156:159]
v_mfma_f32_16x16x32_bf16 v[152:155], v[60:63], a[248:251], v[152:155]
v_mfma_f32_16x16x32_bf16 v[148:151], v[60:63], a[244:247], v[148:151]
v_mfma_f32_16x16x32_bf16 v[144:147], v[60:63], a[240:243], v[144:147]
v_mfma_f32_16x16x32_bf16 v[160:163], v[64:67], a[240:243], v[160:163]
v_mfma_f32_16x16x32_bf16 v[164:167], v[64:67], a[244:247], v[164:167]
v_mfma_f32_16x16x32_bf16 v[168:171], v[64:67], a[248:251], v[168:171]
v_mfma_f32_16x16x32_bf16 v[172:175], v[64:67], a[252:255], v[172:175]
v_mfma_f32_16x16x32_bf16 v[204:207], v[68:71], a[252:255], v[204:207]
v_mfma_f32_16x16x32_bf16 v[200:203], v[68:71], a[248:251], v[200:203]
s_waitcnt vmcnt(8)
s_barrier
ds_read_b128 v[16:19], v4 offset:57344
ds_read_b64_tr_b16 v[48:49], v0 offset:0
v_mfma_f32_16x16x32_bf16 v[196:199], v[68:71], a[244:247], v[196:199]
ds_read_b128 v[20:23], v4 offset:58368
ds_read_b64_tr_b16 v[50:51], v0 offset:2048
v_mfma_f32_16x16x32_bf16 v[192:195], v[68:71], a[240:243], v[192:195]
ds_read_b128 v[24:27], v4 offset:59392
ds_read_b128 v[28:31], v4 offset:60416
v_mfma_f32_16x16x32_bf16 v[176:179], v[72:75], a[240:243], v[176:179]
ds_read_b64_tr_b16 v[52:53], v1 offset:0
ds_read_b64_tr_b16 v[54:55], v1 offset:2048
v_mfma_f32_16x16x32_bf16 v[180:183], v[72:75], a[244:247], v[180:183]
ds_read_b64_tr_b16 v[56:57], v0 offset:4096
ds_read_b64_tr_b16 v[58:59], v0 offset:6144
v_mfma_f32_16x16x32_bf16 v[184:187], v[72:75], a[248:251], v[184:187]
ds_read_b64_tr_b16 v[60:61], v1 offset:4096
ds_read_b64_tr_b16 v[62:63], v1 offset:6144
v_mfma_f32_16x16x32_bf16 v[188:191], v[72:75], a[252:255], v[188:191]
s_waitcnt lgkmcnt(12)
ds_read_b64_tr_b16 v[64:65], v0 offset:8192
ds_read_b64_tr_b16 v[66:67], v0 offset:10240
v_mfma_f32_16x16x32_bf16 v[220:223], v[76:79], a[252:255], v[220:223]
ds_read_b64_tr_b16 v[68:69], v1 offset:8192
ds_read_b64_tr_b16 v[70:71], v1 offset:10240
v_mfma_f32_16x16x32_bf16 v[216:219], v[76:79], a[248:251], v[216:219]
ds_read_b64_tr_b16 v[72:73], v0 offset:12288
ds_read_b64_tr_b16 v[74:75], v0 offset:14336
v_mfma_f32_16x16x32_bf16 v[212:215], v[76:79], a[244:247], v[212:215]
v_mfma_f32_16x16x32_bf16 v[208:211], v[76:79], a[240:243], v[208:211]
s_waitcnt lgkmcnt(14)
ds_read_b64_tr_b16 v[76:77], v1 offset:12288
buffer_load_dwordx4 v9, s[8:11], s59 offen lds
v_mfma_f32_16x16x32_bf16 v[96:99], v[48:51], v[16:19], v[96:99]
s_add_u32 m0, s4, 53248
s_mov_b32 s59, 2359296
ds_read_b64_tr_b16 v[78:79], v1 offset:14336
v_mfma_f32_16x16x32_bf16 v[100:103], v[48:51], v[20:23], v[100:103]
s_waitcnt lgkmcnt(12)
buffer_load_dwordx4 v9, s[12:15], s56 offen lds
v_mfma_f32_16x16x32_bf16 v[104:107], v[48:51], v[24:27], v[104:107]
s_add_u32 m0, s4, 57344
s_mov_b32 s56, 2359296
v_mfma_f32_16x16x32_bf16 v[108:111], v[48:51], v[28:31], v[108:111]
buffer_load_dwordx4 v9, s[8:11], s57 offen lds
v_mfma_f32_16x16x32_bf16 v[140:143], v[52:55], v[28:31], v[140:143]
s_add_u32 m0, s4, 61440
s_mov_b32 s57, 2949120
v_mfma_f32_16x16x32_bf16 v[136:139], v[52:55], v[24:27], v[136:139]
buffer_load_dwordx4 v9, s[12:15], s58 offen lds
v_mfma_f32_16x16x32_bf16 v[132:135], v[52:55], v[20:23], v[132:135]
s_add_u32 m0, s4, 65536
s_mov_b32 s58, 2949120
v_mfma_f32_16x16x32_bf16 v[128:131], v[52:55], v[16:19], v[128:131]
s_waitcnt lgkmcnt(2)
v_mfma_f32_16x16x32_bf16 v[112:115], v[56:59], v[16:19], v[112:115]
v_mfma_f32_16x16x32_bf16 v[116:119], v[56:59], v[20:23], v[116:119]
v_mfma_f32_16x16x32_bf16 v[120:123], v[56:59], v[24:27], v[120:123]
v_mfma_f32_16x16x32_bf16 v[124:127], v[56:59], v[28:31], v[124:127]
v_mfma_f32_16x16x32_bf16 v[156:159], v[60:63], v[28:31], v[156:159]
v_mfma_f32_16x16x32_bf16 v[152:155], v[60:63], v[24:27], v[152:155]
v_mfma_f32_16x16x32_bf16 v[148:151], v[60:63], v[20:23], v[148:151]
v_mfma_f32_16x16x32_bf16 v[144:147], v[60:63], v[16:19], v[144:147]
v_mfma_f32_16x16x32_bf16 v[160:163], v[64:67], v[16:19], v[160:163]
v_mfma_f32_16x16x32_bf16 v[164:167], v[64:67], v[20:23], v[164:167]
v_mfma_f32_16x16x32_bf16 v[168:171], v[64:67], v[24:27], v[168:171]
v_mfma_f32_16x16x32_bf16 v[172:175], v[64:67], v[28:31], v[172:175]
v_mfma_f32_16x16x32_bf16 v[204:207], v[68:71], v[28:31], v[204:207]
v_mfma_f32_16x16x32_bf16 v[200:203], v[68:71], v[24:27], v[200:203]
s_waitcnt vmcnt(8)
s_barrier
ds_read_b128 v[32:35], v5 offset:0
ds_read_b64_tr_b16 v[48:49], v0 offset:16384
v_mfma_f32_16x16x32_bf16 v[196:199], v[68:71], v[20:23], v[196:199]
ds_read_b128 v[36:39], v5 offset:1024
ds_read_b64_tr_b16 v[50:51], v0 offset:18432
v_mfma_f32_16x16x32_bf16 v[192:195], v[68:71], v[16:19], v[192:195]
ds_read_b128 v[40:43], v5 offset:2048
ds_read_b128 v[44:47], v5 offset:3072
v_mfma_f32_16x16x32_bf16 v[176:179], v[72:75], v[16:19], v[176:179]
ds_read_b64_tr_b16 v[52:53], v1 offset:16384
ds_read_b64_tr_b16 v[54:55], v1 offset:18432
v_mfma_f32_16x16x32_bf16 v[180:183], v[72:75], v[20:23], v[180:183]
ds_read_b64_tr_b16 v[56:57], v0 offset:20480
ds_read_b64_tr_b16 v[58:59], v0 offset:22528
v_mfma_f32_16x16x32_bf16 v[184:187], v[72:75], v[24:27], v[184:187]
ds_read_b64_tr_b16 v[60:61], v1 offset:20480
ds_read_b64_tr_b16 v[62:63], v1 offset:22528
v_mfma_f32_16x16x32_bf16 v[188:191], v[72:75], v[28:31], v[188:191]
s_waitcnt lgkmcnt(12)
ds_read_b64_tr_b16 v[64:65], v0 offset:24576
ds_read_b64_tr_b16 v[66:67], v0 offset:26624
v_mfma_f32_16x16x32_bf16 v[220:223], v[76:79], v[28:31], v[220:223]
ds_read_b64_tr_b16 v[68:69], v1 offset:24576
ds_read_b64_tr_b16 v[70:71], v1 offset:26624
v_mfma_f32_16x16x32_bf16 v[216:219], v[76:79], v[24:27], v[216:219]
ds_read_b64_tr_b16 v[72:73], v0 offset:28672
ds_read_b64_tr_b16 v[74:75], v0 offset:30720
v_mfma_f32_16x16x32_bf16 v[212:215], v[76:79], v[20:23], v[212:215]
v_mfma_f32_16x16x32_bf16 v[208:211], v[76:79], v[16:19], v[208:211]
s_waitcnt lgkmcnt(14)
ds_read_b64_tr_b16 v[76:77], v1 offset:28672
buffer_load_dwordx4 v9, s[8:11], s59 offen lds
v_mfma_f32_16x16x32_bf16 v[96:99], v[48:51], v[32:35], v[96:99]
s_add_u32 m0, s4, 69632
s_mov_b32 s59, 3538944
ds_read_b64_tr_b16 v[78:79], v1 offset:30720
v_mfma_f32_16x16x32_bf16 v[100:103], v[48:51], v[36:39], v[100:103]
s_waitcnt lgkmcnt(12)
buffer_load_dwordx4 v9, s[12:15], s56 offen lds
v_mfma_f32_16x16x32_bf16 v[104:107], v[48:51], v[40:43], v[104:107]
s_add_u32 m0, s4, 73728
s_mov_b32 s56, 3538944
v_mfma_f32_16x16x32_bf16 v[108:111], v[48:51], v[44:47], v[108:111]
buffer_load_dwordx4 v9, s[8:11], s57 offen lds
v_mfma_f32_16x16x32_bf16 v[140:143], v[52:55], v[44:47], v[140:143]
s_add_u32 m0, s4, 77824
s_mov_b32 s57, 4128768
v_mfma_f32_16x16x32_bf16 v[136:139], v[52:55], v[40:43], v[136:139]
buffer_load_dwordx4 v9, s[12:15], s58 offen lds
v_mfma_f32_16x16x32_bf16 v[132:135], v[52:55], v[36:39], v[132:135]
s_add_u32 m0, s4, 0
s_mov_b32 s58, 4128768
v_mfma_f32_16x16x32_bf16 v[128:131], v[52:55], v[32:35], v[128:131]
s_waitcnt lgkmcnt(2)
v_exp_f32_e64 v96, -v96
v_mfma_f32_16x16x32_bf16 v[112:115], v[56:59], v[32:35], v[112:115]
v_exp_f32_e64 v97, -v97
v_mfma_f32_16x16x32_bf16 v[116:119], v[56:59], v[36:39], v[116:119]
v_exp_f32_e64 v98, -v98
v_mfma_f32_16x16x32_bf16 v[120:123], v[56:59], v[40:43], v[120:123]
v_exp_f32_e64 v99, -v99
v_mfma_f32_16x16x32_bf16 v[124:127], v[56:59], v[44:47], v[124:127]
v_add_f32 v96, 1.0, v96
v_add_f32_e64 v97, 1.0, v97
v_mfma_f32_16x16x32_bf16 v[156:159], v[60:63], v[44:47], v[156:159]
v_add_f32_e64 v98, 1.0, v98
v_mfma_f32_16x16x32_bf16 v[152:155], v[60:63], v[40:43], v[152:155]
v_add_f32_e64 v99, 1.0, v99
v_mfma_f32_16x16x32_bf16 v[148:151], v[60:63], v[36:39], v[148:151]
v_exp_f32_e64 v100, -v100
v_mfma_f32_16x16x32_bf16 v[144:147], v[60:63], v[32:35], v[144:147]
v_exp_f32_e64 v101, -v101
v_mfma_f32_16x16x32_bf16 v[160:163], v[64:67], v[32:35], v[160:163]
v_exp_f32_e64 v102, -v102
v_mfma_f32_16x16x32_bf16 v[164:167], v[64:67], v[36:39], v[164:167]
v_exp_f32_e64 v103, -v103
v_mfma_f32_16x16x32_bf16 v[168:171], v[64:67], v[40:43], v[168:171]
v_rcp_f32_e64 v96, v96
v_mfma_f32_16x16x32_bf16 v[172:175], v[64:67], v[44:47], v[172:175]
v_rcp_f32_e64 v97, v97
v_mfma_f32_16x16x32_bf16 v[204:207], v[68:71], v[44:47], v[204:207]
v_rcp_f32_e64 v98, v98
v_mfma_f32_16x16x32_bf16 v[200:203], v[68:71], v[40:43], v[200:203]
s_waitcnt vmcnt(8)
s_barrier
ds_read_b64_tr_b16 v[48:49], v0 offset:32768
ds_read_b64_tr_b16 v[50:51], v0 offset:34816
v_mfma_f32_16x16x32_bf16 v[196:199], v[68:71], v[36:39], v[196:199]
ds_read_b64_tr_b16 v[52:53], v0 offset:36864
v_add_f32_e64 v100, 1.0, v100
v_mfma_f32_16x16x32_bf16 v[192:195], v[68:71], v[32:35], v[192:195]
ds_read_b64_tr_b16 v[54:55], v0 offset:38912
v_add_f32_e64 v101, 1.0, v101
v_mfma_f32_16x16x32_bf16 v[176:179], v[72:75], v[32:35], v[176:179]
ds_read_b64_tr_b16 v[56:57], v1 offset:32768
v_add_f32_e64 v102, 1.0, v102
v_mfma_f32_16x16x32_bf16 v[180:183], v[72:75], v[36:39], v[180:183]
ds_read_b64_tr_b16 v[58:59], v1 offset:34816
v_add_f32_e64 v103, 1.0, v103
v_mfma_f32_16x16x32_bf16 v[184:187], v[72:75], v[40:43], v[184:187]
ds_read_b64_tr_b16 v[60:61], v1 offset:36864
v_mul_f32 v96, v96, v112
v_mfma_f32_16x16x32_bf16 v[188:191], v[72:75], v[44:47], v[188:191]
s_waitcnt lgkmcnt(7)
ds_read_b64_tr_b16 v[62:63], v1 offset:38912
v_mul_f32_e64 v97, v97, v113
v_mfma_f32_16x16x32_bf16 v[220:223], v[76:79], v[44:47], v[220:223]
ds_read_b64_tr_b16 v[64:65], v0 offset:40960
v_mul_f32 v98, v98, v114
v_mfma_f32_16x16x32_bf16 v[216:219], v[76:79], v[40:43], v[216:219]
ds_read_b64_tr_b16 v[66:67], v0 offset:43008
v_cvt_pk_bf16_f32 v80, v96, v97
v_mfma_f32_16x16x32_bf16 v[212:215], v[76:79], v[36:39], v[212:215]
ds_read_b64_tr_b16 v[68:69], v0 offset:45056
ds_read_b64_tr_b16 v[70:71], v0 offset:47104
v_mfma_f32_16x16x32_bf16 v[208:211], v[76:79], v[32:35], v[208:211]
s_waitcnt lgkmcnt(9)
ds_read_b64_tr_b16 v[72:73], v1 offset:40960
buffer_load_dwordx4 v9, s[8:11], s59 offen lds
v_mfma_f32_16x16x32_bf16 v[224:227], v[48:51], a[0:3], 0
s_add_u32 m0, s4, 4096
s_mov_b32 s59, 4718592
ds_read_b64_tr_b16 v[74:75], v1 offset:43008
v_mfma_f32_16x16x32_bf16 v[228:231], v[48:51], a[4:7], 0
ds_read_b64_tr_b16 v[76:77], v1 offset:45056
buffer_load_dwordx4 v9, s[12:15], s56 offen lds
v_mfma_f32_16x16x32_bf16 v[232:235], v[48:51], a[8:11], 0
s_add_u32 m0, s4, 8192
s_mov_b32 s56, 4718592
ds_read_b64_tr_b16 v[78:79], v1 offset:47104
v_mfma_f32_16x16x32_bf16 v[236:239], v[48:51], a[12:15], 0
s_waitcnt lgkmcnt(9)
buffer_load_dwordx4 v9, s[8:11], s57 offen lds
v_mfma_f32_16x16x32_bf16 v[252:255], v[52:55], a[12:15], 0
s_add_u32 m0, s4, 12288
s_movk_i32 s57, 256
v_mfma_f32_16x16x32_bf16 v[248:251], v[52:55], a[8:11], 0
buffer_load_dwordx4 v9, s[12:15], s58 offen lds
v_mfma_f32_16x16x32_bf16 v[244:247], v[52:55], a[4:7], 0
s_add_u32 m0, s4, 16384
s_mov_b32 s58, 256
v_mfma_f32_16x16x32_bf16 v[240:243], v[52:55], a[0:3], 0
v_rcp_f32_e64 v99, v99
v_mfma_f32_16x16x32_bf16 v[224:227], v[56:59], a[16:19], v[224:227]
v_exp_f32_e64 v104, -v104
v_mfma_f32_16x16x32_bf16 v[228:231], v[56:59], a[20:23], v[228:231]
v_exp_f32_e64 v105, -v105
v_mfma_f32_16x16x32_bf16 v[232:235], v[56:59], a[24:27], v[232:235]
v_exp_f32_e64 v106, -v106
v_mfma_f32_16x16x32_bf16 v[236:239], v[56:59], a[28:31], v[236:239]
s_waitcnt lgkmcnt(0)
v_exp_f32_e64 v107, -v107
v_mfma_f32_16x16x32_bf16 v[252:255], v[60:63], a[28:31], v[252:255]
v_mul_f32 v99, v99, v115
v_cvt_pk_bf16_f32 v81, v98, v99
v_mfma_f32_16x16x32_bf16 v[248:251], v[60:63], a[24:27], v[248:251]
v_rcp_f32_e64 v100, v100
v_mfma_f32_16x16x32_bf16 v[244:247], v[60:63], a[20:23], v[244:247]
v_rcp_f32_e64 v101, v101
v_mfma_f32_16x16x32_bf16 v[240:243], v[60:63], a[16:19], v[240:243]
v_rcp_f32_e64 v102, v102
v_mfma_f32_16x16x32_bf16 v[224:227], v[64:67], a[32:35], v[224:227]
v_rcp_f32_e64 v103, v103
v_mfma_f32_16x16x32_bf16 v[228:231], v[64:67], a[36:39], v[228:231]
v_add_f32 v104, 1.0, v104
v_add_f32 v105, 1.0, v105
v_mfma_f32_16x16x32_bf16 v[232:235], v[64:67], a[40:43], v[232:235]
v_add_f32_e64 v106, 1.0, v106
v_mfma_f32_16x16x32_bf16 v[236:239], v[64:67], a[44:47], v[236:239]
v_mul_f32 v100, v100, v116
v_add_f32 v107, 1.0, v107
v_mfma_f32_16x16x32_bf16 v[252:255], v[68:71], a[44:47], v[252:255]
v_exp_f32_e64 v108, -v108
v_mfma_f32_16x16x32_bf16 v[248:251], v[68:71], a[40:43], v[248:251]
s_waitcnt vmcnt(8)
s_barrier
ds_read_b64_tr_b16 v[48:49], v0 offset:49152
ds_read_b64_tr_b16 v[50:51], v0 offset:51200
v_mfma_f32_16x16x32_bf16 v[244:247], v[68:71], a[36:39], v[244:247]
ds_read_b64_tr_b16 v[52:53], v0 offset:53248
v_mul_f32_e64 v101, v101, v117
v_mfma_f32_16x16x32_bf16 v[240:243], v[68:71], a[32:35], v[240:243]
ds_read_b64_tr_b16 v[54:55], v0 offset:55296
v_mul_f32_e64 v102, v102, v118
v_mfma_f32_16x16x32_bf16 v[224:227], v[72:75], a[48:51], v[224:227]
ds_read_b64_tr_b16 v[56:57], v1 offset:49152
v_mul_f32_e64 v103, v103, v119
v_mfma_f32_16x16x32_bf16 v[228:231], v[72:75], a[52:55], v[228:231]
ds_read_b64_tr_b16 v[58:59], v1 offset:51200
v_cvt_pk_bf16_f32 v84, v100, v101
v_mfma_f32_16x16x32_bf16 v[232:235], v[72:75], a[56:59], v[232:235]
ds_read_b64_tr_b16 v[60:61], v1 offset:53248
v_cvt_pk_bf16_f32 v85, v102, v103
v_mfma_f32_16x16x32_bf16 v[236:239], v[72:75], a[60:63], v[236:239]
ds_read_b64_tr_b16 v[62:63], v1 offset:55296
v_add_f32 v108, 1.0, v108
v_mfma_f32_16x16x32_bf16 v[252:255], v[76:79], a[60:63], v[252:255]
ds_read_b64_tr_b16 v[64:65], v0 offset:57344
ds_read_b64_tr_b16 v[66:67], v0 offset:59392
v_mfma_f32_16x16x32_bf16 v[248:251], v[76:79], a[56:59], v[248:251]
ds_read_b64_tr_b16 v[68:69], v0 offset:61440
ds_read_b64_tr_b16 v[70:71], v0 offset:63488
v_mfma_f32_16x16x32_bf16 v[244:247], v[76:79], a[52:55], v[244:247]
v_exp_f32_e64 v109, -v109
v_mfma_f32_16x16x32_bf16 v[240:243], v[76:79], a[48:51], v[240:243]
s_waitcnt lgkmcnt(9)
ds_read_b64_tr_b16 v[72:73], v1 offset:57344
buffer_load_dwordx4 v9, s[8:11], s59 offen lds
v_mfma_f32_16x16x32_bf16 v[224:227], v[48:51], a[64:67], v[224:227]
s_add_u32 m0, s4, 20480
s_mov_b32 s59, 295168
ds_read_b64_tr_b16 v[74:75], v1 offset:59392
v_mfma_f32_16x16x32_bf16 v[228:231], v[48:51], a[68:71], v[228:231]
ds_read_b64_tr_b16 v[76:77], v1 offset:61440
buffer_load_dwordx4 v9, s[12:15], s56 offen lds
v_mfma_f32_16x16x32_bf16 v[232:235], v[48:51], a[72:75], v[232:235]
s_add_u32 m0, s4, 24576
s_mov_b32 s56, 295168
ds_read_b64_tr_b16 v[78:79], v1 offset:63488
v_mfma_f32_16x16x32_bf16 v[236:239], v[48:51], a[76:79], v[236:239]
s_waitcnt lgkmcnt(9)
buffer_load_dwordx4 v8, s[8:11], s57 offen lds
v_add_f32 v109, 1.0, v109
v_mfma_f32_16x16x32_bf16 v[252:255], v[52:55], a[76:79], v[252:255]
s_add_u32 m0, s4, 28672
s_mov_b32 s57, 590080
v_mfma_f32_16x16x32_bf16 v[248:251], v[52:55], a[72:75], v[248:251]
buffer_load_dwordx4 v8, s[12:15], s58 offen lds
v_mfma_f32_16x16x32_bf16 v[244:247], v[52:55], a[68:71], v[244:247]
s_add_u32 m0, s4, 32768
s_mov_b32 s58, 590080
v_mfma_f32_16x16x32_bf16 v[240:243], v[52:55], a[64:67], v[240:243]
v_exp_f32_e64 v110, -v110
v_mfma_f32_16x16x32_bf16 v[224:227], v[56:59], a[80:83], v[224:227]
v_exp_f32_e64 v111, -v111
v_mfma_f32_16x16x32_bf16 v[228:231], v[56:59], a[84:87], v[228:231]
v_rcp_f32_e64 v104, v104
v_mfma_f32_16x16x32_bf16 v[232:235], v[56:59], a[88:91], v[232:235]
v_rcp_f32_e64 v105, v105
v_mfma_f32_16x16x32_bf16 v[236:239], v[56:59], a[92:95], v[236:239]
s_waitcnt lgkmcnt(0)
v_rcp_f32 v106, v106
v_mfma_f32_16x16x32_bf16 v[252:255], v[60:63], a[92:95], v[252:255]
v_rcp_f32_e64 v107, v107
v_mfma_f32_16x16x32_bf16 v[248:251], v[60:63], a[88:91], v[248:251]
v_add_f32 v110, 1.0, v110
v_add_f32 v111, 1.0, v111
v_mfma_f32_16x16x32_bf16 v[244:247], v[60:63], a[84:87], v[244:247]
v_exp_f32_e64 v140, -v140
v_mfma_f32_16x16x32_bf16 v[240:243], v[60:63], a[80:83], v[240:243]
v_exp_f32_e64 v141, -v141
v_mfma_f32_16x16x32_bf16 v[224:227], v[64:67], a[96:99], v[224:227]
v_exp_f32_e64 v142, -v142
v_mfma_f32_16x16x32_bf16 v[228:231], v[64:67], a[100:103], v[228:231]
v_exp_f32_e64 v143, -v143
v_mfma_f32_16x16x32_bf16 v[232:235], v[64:67], a[104:107], v[232:235]
v_mul_f32 v104, v104, v120
v_mul_f32 v105, v105, v121
v_mfma_f32_16x16x32_bf16 v[236:239], v[64:67], a[108:111], v[236:239]
v_mul_f32_e64 v106, v106, v122
v_mfma_f32_16x16x32_bf16 v[252:255], v[68:71], a[108:111], v[252:255]
v_mul_f32_e64 v107, v107, v123
v_cvt_pk_bf16_f32 v88, v104, v105
v_mfma_f32_16x16x32_bf16 v[248:251], v[68:71], a[104:107], v[248:251]
s_waitcnt vmcnt(8)
s_barrier
ds_read_b64_tr_b16 v[48:49], v2 offset:0
ds_read_b64_tr_b16 v[50:51], v2 offset:2048
v_mfma_f32_16x16x32_bf16 v[244:247], v[68:71], a[100:103], v[244:247]
ds_read_b64_tr_b16 v[52:53], v2 offset:4096
v_cvt_pk_bf16_f32 v89, v106, v107
v_mfma_f32_16x16x32_bf16 v[240:243], v[68:71], a[96:99], v[240:243]
ds_read_b64_tr_b16 v[54:55], v2 offset:6144
v_add_f32_e64 v140, 1.0, v140
v_mfma_f32_16x16x32_bf16 v[224:227], v[72:75], a[112:115], v[224:227]
ds_read_b64_tr_b16 v[56:57], v3 offset:0
v_add_f32_e64 v141, 1.0, v141
v_mfma_f32_16x16x32_bf16 v[228:231], v[72:75], a[116:119], v[228:231]
ds_read_b64_tr_b16 v[58:59], v3 offset:2048
v_add_f32_e64 v142, 1.0, v142
v_mfma_f32_16x16x32_bf16 v[232:235], v[72:75], a[120:123], v[232:235]
ds_read_b64_tr_b16 v[60:61], v3 offset:4096
v_add_f32_e64 v143, 1.0, v143
v_mfma_f32_16x16x32_bf16 v[236:239], v[72:75], a[124:127], v[236:239]
ds_read_b64_tr_b16 v[62:63], v3 offset:6144
ds_read_b64_tr_b16 v[64:65], v2 offset:8192
v_mfma_f32_16x16x32_bf16 v[252:255], v[76:79], a[124:127], v[252:255]
ds_read_b64_tr_b16 v[66:67], v2 offset:10240
ds_read_b64_tr_b16 v[68:69], v2 offset:12288
v_mfma_f32_16x16x32_bf16 v[248:251], v[76:79], a[120:123], v[248:251]
v_rcp_f32_e64 v108, v108
v_mfma_f32_16x16x32_bf16 v[244:247], v[76:79], a[116:119], v[244:247]
ds_read_b64_tr_b16 v[70:71], v2 offset:14336
v_mul_f32 v108, v108, v124
v_mfma_f32_16x16x32_bf16 v[240:243], v[76:79], a[112:115], v[240:243]
s_waitcnt lgkmcnt(9)
ds_read_b64_tr_b16 v[72:73], v3 offset:8192
buffer_load_dwordx4 v8, s[8:11], s59 offen lds
v_mfma_f32_16x16x32_bf16 v[224:227], v[48:51], a[128:131], v[224:227]
s_add_u32 m0, s4, 36864
s_mov_b32 s59, 884992
ds_read_b64_tr_b16 v[74:75], v3 offset:10240
v_mfma_f32_16x16x32_bf16 v[228:231], v[48:51], a[132:135], v[228:231]
ds_read_b64_tr_b16 v[76:77], v3 offset:12288
buffer_load_dwordx4 v8, s[12:15], s56 offen lds
v_mfma_f32_16x16x32_bf16 v[232:235], v[48:51], a[136:139], v[232:235]
s_add_u32 m0, s4, 40960
s_mov_b32 s56, 884992
ds_read_b64_tr_b16 v[78:79], v3 offset:14336
v_mfma_f32_16x16x32_bf16 v[236:239], v[48:51], a[140:143], v[236:239]
s_waitcnt lgkmcnt(9)
buffer_load_dwordx4 v8, s[8:11], s57 offen lds
v_mfma_f32_16x16x32_bf16 v[252:255], v[52:55], a[140:143], v[252:255]
s_add_u32 m0, s4, 45056
s_mov_b32 s57, 1179904
v_mfma_f32_16x16x32_bf16 v[248:251], v[52:55], a[136:139], v[248:251]
buffer_load_dwordx4 v8, s[12:15], s58 offen lds
v_mfma_f32_16x16x32_bf16 v[244:247], v[52:55], a[132:135], v[244:247]
s_add_u32 m0, s4, 49152
s_mov_b32 s58, 1179904
v_mfma_f32_16x16x32_bf16 v[240:243], v[52:55], a[128:131], v[240:243]
v_rcp_f32 v109, v109
v_mfma_f32_16x16x32_bf16 v[224:227], v[56:59], a[144:147], v[224:227]
v_rcp_f32_e64 v110, v110
v_mfma_f32_16x16x32_bf16 v[228:231], v[56:59], a[148:151], v[228:231]
v_rcp_f32 v111, v111
v_mfma_f32_16x16x32_bf16 v[232:235], v[56:59], a[152:155], v[232:235]
v_exp_f32_e64 v136, -v136
v_mfma_f32_16x16x32_bf16 v[236:239], v[56:59], a[156:159], v[236:239]
s_waitcnt lgkmcnt(0)
v_exp_f32_e64 v137, -v137
v_mfma_f32_16x16x32_bf16 v[252:255], v[60:63], a[156:159], v[252:255]
v_exp_f32_e64 v138, -v138
v_mfma_f32_16x16x32_bf16 v[248:251], v[60:63], a[152:155], v[248:251]
v_exp_f32_e64 v139, -v139
v_mfma_f32_16x16x32_bf16 v[244:247], v[60:63], a[148:151], v[244:247]
v_mul_f32 v109, v109, v125
v_mul_f32 v110, v110, v126
v_mfma_f32_16x16x32_bf16 v[240:243], v[60:63], a[144:147], v[240:243]
v_mul_f32_e64 v111, v111, v127
v_mfma_f32_16x16x32_bf16 v[224:227], v[64:67], a[160:163], v[224:227]
v_rcp_f32_e64 v140, v140
v_mfma_f32_16x16x32_bf16 v[228:231], v[64:67], a[164:167], v[228:231]
v_rcp_f32_e64 v141, v141
v_mfma_f32_16x16x32_bf16 v[232:235], v[64:67], a[168:171], v[232:235]
v_rcp_f32_e64 v142, v142
v_mfma_f32_16x16x32_bf16 v[236:239], v[64:67], a[172:175], v[236:239]
v_rcp_f32_e64 v143, v143
v_mfma_f32_16x16x32_bf16 v[252:255], v[68:71], a[172:175], v[252:255]
v_cvt_pk_bf16_f32 v92, v108, v109
v_cvt_pk_bf16_f32 v93, v110, v111
v_mfma_f32_16x16x32_bf16 v[248:251], v[68:71], a[168:171], v[248:251]
s_waitcnt vmcnt(8)
s_barrier
ds_read_b64_tr_b16 v[48:49], v0 offset:0
ds_read_b64_tr_b16 v[50:51], v0 offset:2048
v_mfma_f32_16x16x32_bf16 v[244:247], v[68:71], a[164:167], v[244:247]
ds_read_b64_tr_b16 v[52:53], v0 offset:4096
v_add_f32_e64 v136, 1.0, v136
v_mfma_f32_16x16x32_bf16 v[240:243], v[68:71], a[160:163], v[240:243]
ds_read_b64_tr_b16 v[54:55], v0 offset:6144
v_add_f32_e64 v137, 1.0, v137
v_mfma_f32_16x16x32_bf16 v[224:227], v[72:75], a[176:179], v[224:227]
ds_read_b64_tr_b16 v[56:57], v1 offset:0
v_add_f32_e64 v138, 1.0, v138
v_mfma_f32_16x16x32_bf16 v[228:231], v[72:75], a[180:183], v[228:231]
ds_read_b64_tr_b16 v[58:59], v1 offset:2048
v_add_f32_e64 v139, 1.0, v139
v_mfma_f32_16x16x32_bf16 v[232:235], v[72:75], a[184:187], v[232:235]
ds_read_b64_tr_b16 v[60:61], v1 offset:4096
v_mul_f32_e64 v140, v140, v156
v_mfma_f32_16x16x32_bf16 v[236:239], v[72:75], a[188:191], v[236:239]
ds_read_b64_tr_b16 v[62:63], v1 offset:6144
v_mul_f32_e64 v141, v141, v157
v_mfma_f32_16x16x32_bf16 v[252:255], v[76:79], a[188:191], v[252:255]
ds_read_b64_tr_b16 v[64:65], v0 offset:8192
v_mul_f32_e64 v142, v142, v158
v_mfma_f32_16x16x32_bf16 v[248:251], v[76:79], a[184:187], v[248:251]
ds_read_b64_tr_b16 v[66:67], v0 offset:10240
v_mul_f32_e64 v143, v143, v159
v_mfma_f32_16x16x32_bf16 v[244:247], v[76:79], a[180:183], v[244:247]
ds_read_b64_tr_b16 v[68:69], v0 offset:12288
v_cvt_pk_bf16_f32 v94, v140, v141
v_mfma_f32_16x16x32_bf16 v[240:243], v[76:79], a[176:179], v[240:243]
s_waitcnt lgkmcnt(8)
ds_read_b64_tr_b16 v[70:71], v0 offset:14336
buffer_load_dwordx4 v8, s[8:11], s59 offen lds
v_mfma_f32_16x16x32_bf16 v[224:227], v[48:51], a[192:195], v[224:227]
s_add_u32 m0, s4, 53248
s_mov_b32 s59, 1474816
ds_read_b64_tr_b16 v[72:73], v1 offset:8192
v_mfma_f32_16x16x32_bf16 v[228:231], v[48:51], a[196:199], v[228:231]
ds_read_b64_tr_b16 v[74:75], v1 offset:10240
buffer_load_dwordx4 v8, s[12:15], s56 offen lds
v_mfma_f32_16x16x32_bf16 v[232:235], v[48:51], a[200:203], v[232:235]
s_add_u32 m0, s4, 57344
s_mov_b32 s56, 1474816
ds_read_b64_tr_b16 v[76:77], v1 offset:12288
v_mfma_f32_16x16x32_bf16 v[236:239], v[48:51], a[204:207], v[236:239]
s_waitcnt lgkmcnt(8)
ds_read_b64_tr_b16 v[78:79], v1 offset:14336
buffer_load_dwordx4 v8, s[8:11], s57 offen lds
v_mfma_f32_16x16x32_bf16 v[252:255], v[52:55], a[204:207], v[252:255]
s_add_u32 m0, s4, 61440
s_mov_b32 s57, 1769728
v_cvt_pk_bf16_f32 v95, v142, v143
v_mfma_f32_16x16x32_bf16 v[248:251], v[52:55], a[200:203], v[248:251]
buffer_load_dwordx4 v8, s[12:15], s58 offen lds
v_mfma_f32_16x16x32_bf16 v[244:247], v[52:55], a[196:199], v[244:247]
s_add_u32 m0, s4, 65536
s_mov_b32 s58, 1769728
v_mfma_f32_16x16x32_bf16 v[240:243], v[52:55], a[192:195], v[240:243]
v_exp_f32_e64 v132, -v132
v_mfma_f32_16x16x32_bf16 v[224:227], v[56:59], a[208:211], v[224:227]
v_exp_f32_e64 v133, -v133
v_mfma_f32_16x16x32_bf16 v[228:231], v[56:59], a[212:215], v[228:231]
v_exp_f32_e64 v134, -v134
v_mfma_f32_16x16x32_bf16 v[232:235], v[56:59], a[216:219], v[232:235]
v_exp_f32_e64 v135, -v135
v_mfma_f32_16x16x32_bf16 v[236:239], v[56:59], a[220:223], v[236:239]
s_waitcnt lgkmcnt(1)
v_rcp_f32 v136, v136
v_mfma_f32_16x16x32_bf16 v[252:255], v[60:63], a[220:223], v[252:255]
v_rcp_f32_e64 v137, v137
v_mfma_f32_16x16x32_bf16 v[248:251], v[60:63], a[216:219], v[248:251]
v_rcp_f32_e64 v138, v138
v_mfma_f32_16x16x32_bf16 v[244:247], v[60:63], a[212:215], v[244:247]
v_rcp_f32_e64 v139, v139
v_mfma_f32_16x16x32_bf16 v[240:243], v[60:63], a[208:211], v[240:243]
v_exp_f32_e64 v128, -v128
v_mfma_f32_16x16x32_bf16 v[224:227], v[64:67], a[224:227], v[224:227]
v_exp_f32_e64 v129, -v129
v_mfma_f32_16x16x32_bf16 v[228:231], v[64:67], a[228:231], v[228:231]
v_exp_f32_e64 v130, -v130
v_mfma_f32_16x16x32_bf16 v[232:235], v[64:67], a[232:235], v[232:235]
v_exp_f32_e64 v131, -v131
v_mfma_f32_16x16x32_bf16 v[236:239], v[64:67], a[236:239], v[236:239]
v_add_f32 v132, 1.0, v132
v_add_f32 v133, 1.0, v133
v_mfma_f32_16x16x32_bf16 v[252:255], v[68:71], a[236:239], v[252:255]
v_add_f32_e64 v134, 1.0, v134
v_mfma_f32_16x16x32_bf16 v[248:251], v[68:71], a[232:235], v[248:251]
s_waitcnt vmcnt(8)
s_barrier
ds_read_b64_tr_b16 v[48:49], v0 offset:16384
ds_read_b64_tr_b16 v[50:51], v0 offset:18432
v_mfma_f32_16x16x32_bf16 v[244:247], v[68:71], a[228:231], v[244:247]
ds_read_b64_tr_b16 v[52:53], v0 offset:20480
v_add_f32_e64 v135, 1.0, v135
v_mfma_f32_16x16x32_bf16 v[240:243], v[68:71], a[224:227], v[240:243]
ds_read_b64_tr_b16 v[54:55], v0 offset:22528
v_mul_f32_e64 v136, v136, v152
v_mfma_f32_16x16x32_bf16 v[224:227], v[72:75], a[240:243], v[224:227]
ds_read_b64_tr_b16 v[56:57], v1 offset:16384
v_mul_f32_e64 v137, v137, v153
v_mfma_f32_16x16x32_bf16 v[228:231], v[72:75], a[244:247], v[228:231]
ds_read_b64_tr_b16 v[58:59], v1 offset:18432
v_mul_f32_e64 v138, v138, v154
v_mfma_f32_16x16x32_bf16 v[232:235], v[72:75], a[248:251], v[232:235]
ds_read_b64_tr_b16 v[60:61], v1 offset:20480
v_mul_f32 v139, v139, v155
v_mfma_f32_16x16x32_bf16 v[236:239], v[72:75], a[252:255], v[236:239]
s_waitcnt lgkmcnt(7)
ds_read_b64_tr_b16 v[62:63], v1 offset:22528
v_cvt_pk_bf16_f32 v90, v136, v137
v_mfma_f32_16x16x32_bf16 v[252:255], v[76:79], a[252:255], v[252:255]
ds_read_b64_tr_b16 v[64:65], v0 offset:24576
v_cvt_pk_bf16_f32 v91, v138, v139
v_mfma_f32_16x16x32_bf16 v[248:251], v[76:79], a[248:251], v[248:251]
ds_read_b64_tr_b16 v[66:67], v0 offset:26624
v_add_f32_e64 v128, 1.0, v128
v_mfma_f32_16x16x32_bf16 v[244:247], v[76:79], a[244:247], v[244:247]
ds_read_b64_tr_b16 v[68:69], v1 offset:24576
v_add_f32 v129, 1.0, v129
v_mfma_f32_16x16x32_bf16 v[240:243], v[76:79], a[240:243], v[240:243]
s_waitcnt lgkmcnt(8)
ds_read_b64_tr_b16 v[70:71], v1 offset:26624
buffer_load_dwordx4 v8, s[8:11], s59 offen lds
v_mfma_f32_16x16x32_bf16 v[224:227], v[48:51], v[16:19], v[224:227]
s_add_u32 m0, s4, 69632
s_mov_b32 s59, 2064640
ds_read_b64_tr_b16 v[72:73], v0 offset:28672
v_mfma_f32_16x16x32_bf16 v[228:231], v[48:51], v[20:23], v[228:231]
ds_read_b64_tr_b16 v[74:75], v0 offset:30720
buffer_load_dwordx4 v8, s[12:15], s56 offen lds
v_mfma_f32_16x16x32_bf16 v[232:235], v[48:51], v[24:27], v[232:235]
s_add_u32 m0, s4, 73728
s_mov_b32 s56, 2064640
ds_read_b64_tr_b16 v[76:77], v1 offset:28672
v_mfma_f32_16x16x32_bf16 v[236:239], v[48:51], v[28:31], v[236:239]
s_waitcnt lgkmcnt(8)
ds_read_b64_tr_b16 v[78:79], v1 offset:30720
buffer_load_dwordx4 v8, s[8:11], s57 offen lds
v_mfma_f32_16x16x32_bf16 v[252:255], v[52:55], v[28:31], v[252:255]
s_add_u32 m0, s4, 77824
s_mov_b32 s57, 2359552
v_add_f32 v130, 1.0, v130
v_mfma_f32_16x16x32_bf16 v[248:251], v[52:55], v[24:27], v[248:251]
buffer_load_dwordx4 v8, s[12:15], s58 offen lds
v_add_f32 v131, 1.0, v131
v_mfma_f32_16x16x32_bf16 v[244:247], v[52:55], v[20:23], v[244:247]
s_add_u32 m0, s4, 0
s_mov_b32 s58, 2359552
v_mfma_f32_16x16x32_bf16 v[240:243], v[52:55], v[16:19], v[240:243]
v_rcp_f32_e64 v132, v132
v_mfma_f32_16x16x32_bf16 v[224:227], v[56:59], v[32:35], v[224:227]
v_rcp_f32_e64 v133, v133
v_mfma_f32_16x16x32_bf16 v[228:231], v[56:59], v[36:39], v[228:231]
v_rcp_f32_e64 v134, v134
v_mfma_f32_16x16x32_bf16 v[232:235], v[56:59], v[40:43], v[232:235]
v_rcp_f32_e64 v135, v135
v_mfma_f32_16x16x32_bf16 v[236:239], v[56:59], v[44:47], v[236:239]
s_waitcnt lgkmcnt(1)
v_rcp_f32 v128, v128
v_mfma_f32_16x16x32_bf16 v[252:255], v[60:63], v[44:47], v[252:255]
v_rcp_f32_e64 v129, v129
v_mfma_f32_16x16x32_bf16 v[248:251], v[60:63], v[40:43], v[248:251]
v_rcp_f32_e64 v130, v130
v_mfma_f32_16x16x32_bf16 v[244:247], v[60:63], v[36:39], v[244:247]
v_rcp_f32_e64 v131, v131
v_mfma_f32_16x16x32_bf16 v[240:243], v[60:63], v[32:35], v[240:243]
v_mul_f32 v132, v132, v148
v_mul_f32 v133, v133, v149
v_mfma_f32_16x16x32_bf16 v[96:99], v[64:67], a[0:3], 0
v_mul_f32_e64 v134, v134, v150
v_mfma_f32_16x16x32_bf16 v[100:103], v[64:67], a[4:7], 0
v_mul_f32_e64 v135, v135, v151
v_cvt_pk_bf16_f32 v86, v132, v133
v_mfma_f32_16x16x32_bf16 v[104:107], v[64:67], a[8:11], 0
v_cvt_pk_bf16_f32 v87, v134, v135
v_mfma_f32_16x16x32_bf16 v[108:111], v[64:67], a[12:15], 0
v_mul_f32 v128, v128, v144
v_mul_f32 v129, v129, v145
v_mfma_f32_16x16x32_bf16 v[140:143], v[68:71], a[12:15], 0
v_mul_f32 v130, v130, v146
v_mul_f32 v131, v131, v147
v_mfma_f32_16x16x32_bf16 v[136:139], v[68:71], a[8:11], 0
s_waitcnt vmcnt(8)
s_barrier
v_cvt_pk_bf16_f32 v82, v128, v129
v_cvt_pk_bf16_f32 v83, v130, v131
v_mfma_f32_16x16x32_bf16 v[132:135], v[68:71], a[4:7], 0
ds_read_b64_tr_b16 v[48:49], v0 offset:32768
ds_read_b64_tr_b16 v[50:51], v0 offset:34816
v_mfma_f32_16x16x32_bf16 v[128:131], v[68:71], a[0:3], 0
ds_read_b64_tr_b16 v[52:53], v1 offset:32768
ds_read_b64_tr_b16 v[54:55], v1 offset:34816
v_mfma_f32_16x16x32_bf16 v[112:115], v[72:75], a[0:3], 0
v_exp_f32_e64 v160, -v160
v_mfma_f32_16x16x32_bf16 v[116:119], v[72:75], a[4:7], 0
ds_read_b64_tr_b16 v[56:57], v0 offset:36864
v_add_f32 v160, 1.0, v160
v_mfma_f32_16x16x32_bf16 v[120:123], v[72:75], a[8:11], 0
ds_read_b64_tr_b16 v[58:59], v0 offset:38912
ds_read_b64_tr_b16 v[60:61], v1 offset:36864
v_mfma_f32_16x16x32_bf16 v[124:127], v[72:75], a[12:15], 0
s_waitcnt lgkmcnt(7)
ds_read_b64_tr_b16 v[62:63], v1 offset:38912
ds_read_b64_tr_b16 v[64:65], v0 offset:40960
v_mfma_f32_16x16x32_bf16 v[156:159], v[76:79], a[12:15], 0
v_exp_f32_e64 v161, -v161
v_mfma_f32_16x16x32_bf16 v[152:155], v[76:79], a[8:11], 0
ds_read_b64_tr_b16 v[66:67], v0 offset:43008
v_add_f32_e64 v161, 1.0, v161
v_mfma_f32_16x16x32_bf16 v[148:151], v[76:79], a[4:7], 0
ds_read_b64_tr_b16 v[68:69], v1 offset:40960
ds_read_b64_tr_b16 v[70:71], v1 offset:43008
v_mfma_f32_16x16x32_bf16 v[144:147], v[76:79], a[0:3], 0
s_waitcnt lgkmcnt(10)
ds_read_b64_tr_b16 v[72:73], v0 offset:45056
buffer_load_dwordx4 v8, s[8:11], s59 offen lds
v_mfma_f32_16x16x32_bf16 v[96:99], v[48:51], a[16:19], v[96:99]
s_add_u32 m0, s4, 4096
s_mov_b32 s59, 2654464
ds_read_b64_tr_b16 v[74:75], v0 offset:47104
v_mfma_f32_16x16x32_bf16 v[100:103], v[48:51], a[20:23], v[100:103]
ds_read_b64_tr_b16 v[76:77], v1 offset:45056
buffer_load_dwordx4 v8, s[12:15], s56 offen lds
v_mfma_f32_16x16x32_bf16 v[104:107], v[48:51], a[24:27], v[104:107]
s_add_u32 m0, s4, 8192
s_mov_b32 s56, 2654464
ds_read_b64_tr_b16 v[78:79], v1 offset:47104
v_mfma_f32_16x16x32_bf16 v[108:111], v[48:51], a[28:31], v[108:111]
s_waitcnt lgkmcnt(9)
buffer_load_dwordx4 v8, s[8:11], s57 offen lds
v_mfma_f32_16x16x32_bf16 v[140:143], v[52:55], a[28:31], v[140:143]
s_add_u32 m0, s4, 12288
s_mov_b32 s57, 2949376
v_mfma_f32_16x16x32_bf16 v[136:139], v[52:55], a[24:27], v[136:139]
buffer_load_dwordx4 v8, s[12:15], s58 offen lds
v_mfma_f32_16x16x32_bf16 v[132:135], v[52:55], a[20:23], v[132:135]
s_add_u32 m0, s4, 16384
s_mov_b32 s58, 2949376
v_mfma_f32_16x16x32_bf16 v[128:131], v[52:55], a[16:19], v[128:131]
v_exp_f32_e64 v162, -v162
v_mfma_f32_16x16x32_bf16 v[112:115], v[56:59], a[16:19], v[112:115]
v_exp_f32_e64 v163, -v163
v_mfma_f32_16x16x32_bf16 v[116:119], v[56:59], a[20:23], v[116:119]
v_add_f32_e64 v162, 1.0, v162
v_add_f32 v163, 1.0, v163
v_mfma_f32_16x16x32_bf16 v[120:123], v[56:59], a[24:27], v[120:123]
v_exp_f32_e64 v164, -v164
v_mfma_f32_16x16x32_bf16 v[124:127], v[56:59], a[28:31], v[124:127]
s_waitcnt lgkmcnt(0)
v_exp_f32_e64 v165, -v165
v_mfma_f32_16x16x32_bf16 v[156:159], v[60:63], a[28:31], v[156:159]
v_exp_f32_e64 v166, -v166
v_mfma_f32_16x16x32_bf16 v[152:155], v[60:63], a[24:27], v[152:155]
v_exp_f32_e64 v167, -v167
v_mfma_f32_16x16x32_bf16 v[148:151], v[60:63], a[20:23], v[148:151]
v_rcp_f32_e64 v160, v160
v_mfma_f32_16x16x32_bf16 v[144:147], v[60:63], a[16:19], v[144:147]
v_rcp_f32_e64 v161, v161
v_mfma_f32_16x16x32_bf16 v[96:99], v[64:67], a[32:35], v[96:99]
v_rcp_f32_e64 v162, v162
v_mfma_f32_16x16x32_bf16 v[100:103], v[64:67], a[36:39], v[100:103]
v_rcp_f32_e64 v163, v163
v_mfma_f32_16x16x32_bf16 v[104:107], v[64:67], a[40:43], v[104:107]
v_add_f32 v164, 1.0, v164
v_add_f32 v165, 1.0, v165
v_mfma_f32_16x16x32_bf16 v[108:111], v[64:67], a[44:47], v[108:111]
v_add_f32_e64 v166, 1.0, v166
v_mfma_f32_16x16x32_bf16 v[140:143], v[68:71], a[44:47], v[140:143]
v_mul_f32 v160, v160, v176
v_add_f32 v167, 1.0, v167
v_mfma_f32_16x16x32_bf16 v[136:139], v[68:71], a[40:43], v[136:139]
s_waitcnt vmcnt(8)
s_barrier
ds_read_b64_tr_b16 v[48:49], v0 offset:49152
ds_read_b64_tr_b16 v[50:51], v0 offset:51200
v_mfma_f32_16x16x32_bf16 v[132:135], v[68:71], a[36:39], v[132:135]
ds_read_b64_tr_b16 v[52:53], v1 offset:49152
v_mul_f32_e64 v161, v161, v177
v_mfma_f32_16x16x32_bf16 v[128:131], v[68:71], a[32:35], v[128:131]
ds_read_b64_tr_b16 v[54:55], v1 offset:51200
v_mul_f32_e64 v162, v162, v178
v_mfma_f32_16x16x32_bf16 v[112:115], v[72:75], a[32:35], v[112:115]
ds_read_b64_tr_b16 v[56:57], v0 offset:53248
v_mul_f32_e64 v163, v163, v179
v_mfma_f32_16x16x32_bf16 v[116:119], v[72:75], a[36:39], v[116:119]
ds_read_b64_tr_b16 v[58:59], v0 offset:55296
ds_read_b64_tr_b16 v[60:61], v1 offset:53248
v_mfma_f32_16x16x32_bf16 v[120:123], v[72:75], a[40:43], v[120:123]
ds_read_b64_tr_b16 v[62:63], v1 offset:55296
ds_read_b64_tr_b16 v[64:65], v0 offset:57344
v_mfma_f32_16x16x32_bf16 v[124:127], v[72:75], a[44:47], v[124:127]
v_exp_f32_e64 v168, -v168
v_mfma_f32_16x16x32_bf16 v[156:159], v[76:79], a[44:47], v[156:159]
ds_read_b64_tr_b16 v[66:67], v0 offset:59392
v_add_f32_e64 v168, 1.0, v168
v_mfma_f32_16x16x32_bf16 v[152:155], v[76:79], a[40:43], v[152:155]
ds_read_b64_tr_b16 v[68:69], v1 offset:57344
ds_read_b64_tr_b16 v[70:71], v1 offset:59392
v_mfma_f32_16x16x32_bf16 v[148:151], v[76:79], a[36:39], v[148:151]
ds_read_b64_tr_b16 v[72:73], v0 offset:61440
ds_read_b64_tr_b16 v[74:75], v0 offset:63488
v_mfma_f32_16x16x32_bf16 v[144:147], v[76:79], a[32:35], v[144:147]
s_waitcnt lgkmcnt(11)
ds_read_b64_tr_b16 v[76:77], v1 offset:61440
buffer_load_dwordx4 v8, s[8:11], s59 offen lds
v_mfma_f32_16x16x32_bf16 v[96:99], v[48:51], a[48:51], v[96:99]
s_add_u32 m0, s4, 20480
s_mov_b32 s59, 3244288
ds_read_b64_tr_b16 v[78:79], v1 offset:63488
v_mfma_f32_16x16x32_bf16 v[100:103], v[48:51], a[52:55], v[100:103]
buffer_load_dwordx4 v8, s[12:15], s56 offen lds
v_mfma_f32_16x16x32_bf16 v[104:107], v[48:51], a[56:59], v[104:107]
s_add_u32 m0, s4, 24576
s_mov_b32 s56, 3244288
v_mfma_f32_16x16x32_bf16 v[108:111], v[48:51], a[60:63], v[108:111]
s_waitcnt lgkmcnt(7)
buffer_load_dwordx4 v8, s[8:11], s57 offen lds
v_mfma_f32_16x16x32_bf16 v[140:143], v[52:55], a[60:63], v[140:143]
s_add_u32 m0, s4, 28672
s_mov_b32 s57, 3539200
v_mfma_f32_16x16x32_bf16 v[136:139], v[52:55], a[56:59], v[136:139]
buffer_load_dwordx4 v8, s[12:15], s58 offen lds
v_mfma_f32_16x16x32_bf16 v[132:135], v[52:55], a[52:55], v[132:135]
s_add_u32 m0, s4, 32768
s_mov_b32 s58, 3539200
v_mfma_f32_16x16x32_bf16 v[128:131], v[52:55], a[48:51], v[128:131]
v_exp_f32_e64 v169, -v169
v_mfma_f32_16x16x32_bf16 v[112:115], v[56:59], a[48:51], v[112:115]
v_exp_f32_e64 v170, -v170
v_mfma_f32_16x16x32_bf16 v[116:119], v[56:59], a[52:55], v[116:119]
v_exp_f32_e64 v171, -v171
v_mfma_f32_16x16x32_bf16 v[120:123], v[56:59], a[56:59], v[120:123]
ds_write_b128 v6, v[80:83] offset:0
v_mfma_f32_16x16x32_bf16 v[124:127], v[56:59], a[60:63], v[124:127]
v_rcp_f32_e64 v164, v164
v_mfma_f32_16x16x32_bf16 v[156:159], v[60:63], a[60:63], v[156:159]
v_rcp_f32_e64 v165, v165
v_mfma_f32_16x16x32_bf16 v[152:155], v[60:63], a[56:59], v[152:155]
v_rcp_f32_e64 v166, v166
v_mfma_f32_16x16x32_bf16 v[148:151], v[60:63], a[52:55], v[148:151]
v_rcp_f32 v167, v167
v_mfma_f32_16x16x32_bf16 v[144:147], v[60:63], a[48:51], v[144:147]
s_waitcnt lgkmcnt(1)
v_cvt_pk_bf16_f32 v80, v160, v161
v_cvt_pk_bf16_f32 v81, v162, v163
v_mfma_f32_16x16x32_bf16 v[96:99], v[64:67], a[64:67], v[96:99]
v_add_f32_e64 v169, 1.0, v169
v_mfma_f32_16x16x32_bf16 v[100:103], v[64:67], a[68:71], v[100:103]
v_add_f32 v170, 1.0, v170
v_add_f32 v171, 1.0, v171
v_mfma_f32_16x16x32_bf16 v[104:107], v[64:67], a[72:75], v[104:107]
v_exp_f32_e64 v172, -v172
v_mfma_f32_16x16x32_bf16 v[108:111], v[64:67], a[76:79], v[108:111]
v_exp_f32_e64 v173, -v173
v_mfma_f32_16x16x32_bf16 v[140:143], v[68:71], a[76:79], v[140:143]
v_exp_f32_e64 v174, -v174
v_mfma_f32_16x16x32_bf16 v[136:139], v[68:71], a[72:75], v[136:139]
s_waitcnt vmcnt(8)
s_barrier
ds_read_b64_tr_b16 v[48:49], v2 offset:0
ds_read_b64_tr_b16 v[50:51], v2 offset:2048
v_mfma_f32_16x16x32_bf16 v[132:135], v[68:71], a[68:71], v[132:135]
ds_read_b64_tr_b16 v[52:53], v3 offset:0
v_mul_f32_e64 v164, v164, v180
v_mfma_f32_16x16x32_bf16 v[128:131], v[68:71], a[64:67], v[128:131]
ds_read_b64_tr_b16 v[54:55], v3 offset:2048
v_mul_f32_e64 v165, v165, v181
v_mfma_f32_16x16x32_bf16 v[112:115], v[72:75], a[64:67], v[112:115]
ds_read_b64_tr_b16 v[56:57], v2 offset:4096
v_mul_f32_e64 v166, v166, v182
v_mfma_f32_16x16x32_bf16 v[116:119], v[72:75], a[68:71], v[116:119]
ds_read_b64_tr_b16 v[58:59], v2 offset:6144
v_mul_f32_e64 v167, v167, v183
v_mfma_f32_16x16x32_bf16 v[120:123], v[72:75], a[72:75], v[120:123]
ds_read_b64_tr_b16 v[60:61], v3 offset:4096
v_add_f32_e64 v172, 1.0, v172
v_mfma_f32_16x16x32_bf16 v[124:127], v[72:75], a[76:79], v[124:127]
ds_read_b64_tr_b16 v[62:63], v3 offset:6144
v_add_f32_e64 v173, 1.0, v173
v_mfma_f32_16x16x32_bf16 v[156:159], v[76:79], a[76:79], v[156:159]
ds_read_b64_tr_b16 v[64:65], v2 offset:8192
v_add_f32_e64 v174, 1.0, v174
v_mfma_f32_16x16x32_bf16 v[152:155], v[76:79], a[72:75], v[152:155]
ds_read_b64_tr_b16 v[66:67], v2 offset:10240
ds_read_b64_tr_b16 v[68:69], v3 offset:8192
v_mfma_f32_16x16x32_bf16 v[148:151], v[76:79], a[68:71], v[148:151]
ds_read_b64_tr_b16 v[70:71], v3 offset:10240
ds_read_b64_tr_b16 v[72:73], v2 offset:12288
v_mfma_f32_16x16x32_bf16 v[144:147], v[76:79], a[64:67], v[144:147]
s_waitcnt lgkmcnt(10)
ds_read_b64_tr_b16 v[74:75], v2 offset:14336
buffer_load_dwordx4 v8, s[8:11], s59 offen lds
v_mfma_f32_16x16x32_bf16 v[96:99], v[48:51], a[80:83], v[96:99]
s_add_u32 m0, s4, 36864
s_mov_b32 s59, 3834112
ds_read_b64_tr_b16 v[76:77], v3 offset:12288
v_mfma_f32_16x16x32_bf16 v[100:103], v[48:51], a[84:87], v[100:103]
ds_read_b64_tr_b16 v[78:79], v3 offset:14336
buffer_load_dwordx4 v8, s[12:15], s56 offen lds
v_mfma_f32_16x16x32_bf16 v[104:107], v[48:51], a[88:91], v[104:107]
s_add_u32 m0, s4, 40960
s_mov_b32 s56, 3834112
v_mfma_f32_16x16x32_bf16 v[108:111], v[48:51], a[92:95], v[108:111]
s_waitcnt lgkmcnt(9)
buffer_load_dwordx4 v8, s[8:11], s57 offen lds
v_mfma_f32_16x16x32_bf16 v[140:143], v[52:55], a[92:95], v[140:143]
s_add_u32 m0, s4, 45056
s_mov_b32 s57, 4129024
v_mfma_f32_16x16x32_bf16 v[136:139], v[52:55], a[88:91], v[136:139]
buffer_load_dwordx4 v8, s[12:15], s58 offen lds
v_mfma_f32_16x16x32_bf16 v[132:135], v[52:55], a[84:87], v[132:135]
s_add_u32 m0, s4, 49152
s_mov_b32 s58, 4129024
v_mfma_f32_16x16x32_bf16 v[128:131], v[52:55], a[80:83], v[128:131]
v_exp_f32_e64 v175, -v175
v_mfma_f32_16x16x32_bf16 v[112:115], v[56:59], a[80:83], v[112:115]
ds_write_b128 v6, v[84:87] offset:1024
v_mfma_f32_16x16x32_bf16 v[116:119], v[56:59], a[84:87], v[116:119]
v_rcp_f32_e64 v168, v168
v_mfma_f32_16x16x32_bf16 v[120:123], v[56:59], a[88:91], v[120:123]
v_rcp_f32_e64 v169, v169
v_mfma_f32_16x16x32_bf16 v[124:127], v[56:59], a[92:95], v[124:127]
s_waitcnt lgkmcnt(1)
v_rcp_f32 v170, v170
v_mfma_f32_16x16x32_bf16 v[156:159], v[60:63], a[92:95], v[156:159]
v_rcp_f32_e64 v171, v171
v_mfma_f32_16x16x32_bf16 v[152:155], v[60:63], a[88:91], v[152:155]
v_cvt_pk_bf16_f32 v84, v164, v165
v_cvt_pk_bf16_f32 v85, v166, v167
v_mfma_f32_16x16x32_bf16 v[148:151], v[60:63], a[84:87], v[148:151]
v_add_f32_e64 v175, 1.0, v175
v_mfma_f32_16x16x32_bf16 v[144:147], v[60:63], a[80:83], v[144:147]
v_exp_f32_e64 v204, -v204
v_mfma_f32_16x16x32_bf16 v[96:99], v[64:67], a[96:99], v[96:99]
v_exp_f32_e64 v205, -v205
v_mfma_f32_16x16x32_bf16 v[100:103], v[64:67], a[100:103], v[100:103]
v_exp_f32_e64 v206, -v206
v_mfma_f32_16x16x32_bf16 v[104:107], v[64:67], a[104:107], v[104:107]
v_exp_f32_e64 v207, -v207
v_mfma_f32_16x16x32_bf16 v[108:111], v[64:67], a[108:111], v[108:111]
ds_write_b128 v6, v[88:91] offset:2048
v_mfma_f32_16x16x32_bf16 v[140:143], v[68:71], a[108:111], v[140:143]
v_mul_f32 v168, v168, v184
v_mul_f32 v169, v169, v185
v_mfma_f32_16x16x32_bf16 v[136:139], v[68:71], a[104:107], v[136:139]
s_waitcnt vmcnt(8)
s_barrier
ds_read_b64_tr_b16 v[48:49], v0 offset:0
ds_read_b64_tr_b16 v[50:51], v0 offset:2048
v_mfma_f32_16x16x32_bf16 v[132:135], v[68:71], a[100:103], v[132:135]
ds_read_b64_tr_b16 v[52:53], v1 offset:0
v_mul_f32_e64 v170, v170, v186
v_mfma_f32_16x16x32_bf16 v[128:131], v[68:71], a[96:99], v[128:131]
ds_read_b64_tr_b16 v[54:55], v1 offset:2048
v_mul_f32_e64 v171, v171, v187
v_mfma_f32_16x16x32_bf16 v[112:115], v[72:75], a[96:99], v[112:115]
ds_read_b64_tr_b16 v[56:57], v0 offset:4096
v_cvt_pk_bf16_f32 v88, v168, v169
v_mfma_f32_16x16x32_bf16 v[116:119], v[72:75], a[100:103], v[116:119]
ds_read_b64_tr_b16 v[58:59], v0 offset:6144
v_cvt_pk_bf16_f32 v89, v170, v171
v_mfma_f32_16x16x32_bf16 v[120:123], v[72:75], a[104:107], v[120:123]
ds_read_b64_tr_b16 v[60:61], v1 offset:4096
v_add_f32_e64 v204, 1.0, v204
v_mfma_f32_16x16x32_bf16 v[124:127], v[72:75], a[108:111], v[124:127]
ds_read_b64_tr_b16 v[62:63], v1 offset:6144
v_add_f32_e64 v205, 1.0, v205
v_mfma_f32_16x16x32_bf16 v[156:159], v[76:79], a[108:111], v[156:159]
ds_read_b64_tr_b16 v[64:65], v0 offset:8192
v_add_f32_e64 v206, 1.0, v206
v_mfma_f32_16x16x32_bf16 v[152:155], v[76:79], a[104:107], v[152:155]
ds_read_b64_tr_b16 v[66:67], v0 offset:10240
v_add_f32 v207, 1.0, v207
v_mfma_f32_16x16x32_bf16 v[148:151], v[76:79], a[100:103], v[148:151]
ds_read_b64_tr_b16 v[68:69], v1 offset:8192
ds_read_b64_tr_b16 v[70:71], v1 offset:10240
v_mfma_f32_16x16x32_bf16 v[144:147], v[76:79], a[96:99], v[144:147]
s_waitcnt lgkmcnt(9)
ds_read_b64_tr_b16 v[72:73], v0 offset:12288
buffer_load_dwordx4 v8, s[8:11], s59 offen lds
v_mfma_f32_16x16x32_bf16 v[96:99], v[48:51], a[112:115], v[96:99]
s_add_u32 m0, s4, 53248
s_mov_b32 s59, 4423936
ds_read_b64_tr_b16 v[74:75], v0 offset:14336
v_mfma_f32_16x16x32_bf16 v[100:103], v[48:51], a[116:119], v[100:103]
ds_read_b64_tr_b16 v[76:77], v1 offset:12288
buffer_load_dwordx4 v8, s[12:15], s56 offen lds
v_mfma_f32_16x16x32_bf16 v[104:107], v[48:51], a[120:123], v[104:107]
s_add_u32 m0, s4, 57344
s_mov_b32 s56, 4423936
ds_read_b64_tr_b16 v[78:79], v1 offset:14336
v_mfma_f32_16x16x32_bf16 v[108:111], v[48:51], a[124:127], v[108:111]
s_waitcnt lgkmcnt(9)
buffer_load_dwordx4 v8, s[8:11], s57 offen lds
v_mfma_f32_16x16x32_bf16 v[140:143], v[52:55], a[124:127], v[140:143]
s_add_u32 m0, s4, 61440
s_mov_b32 s57, 4718848
v_mfma_f32_16x16x32_bf16 v[136:139], v[52:55], a[120:123], v[136:139]
buffer_load_dwordx4 v8, s[12:15], s58 offen lds
v_mfma_f32_16x16x32_bf16 v[132:135], v[52:55], a[116:119], v[132:135]
s_add_u32 m0, s4, 65536
s_mov_b32 s58, 4718848
v_mfma_f32_16x16x32_bf16 v[128:131], v[52:55], a[112:115], v[128:131]
v_rcp_f32 v172, v172
v_mfma_f32_16x16x32_bf16 v[112:115], v[56:59], a[112:115], v[112:115]
v_rcp_f32_e64 v173, v173
v_mfma_f32_16x16x32_bf16 v[116:119], v[56:59], a[116:119], v[116:119]
v_rcp_f32_e64 v174, v174
v_mfma_f32_16x16x32_bf16 v[120:123], v[56:59], a[120:123], v[120:123]
v_rcp_f32 v175, v175
v_mfma_f32_16x16x32_bf16 v[124:127], v[56:59], a[124:127], v[124:127]
s_waitcnt lgkmcnt(0)
v_exp_f32_e64 v200, -v200
v_mfma_f32_16x16x32_bf16 v[156:159], v[60:63], a[124:127], v[156:159]
v_exp_f32_e64 v201, -v201
v_mfma_f32_16x16x32_bf16 v[152:155], v[60:63], a[120:123], v[152:155]
v_exp_f32_e64 v202, -v202
v_mfma_f32_16x16x32_bf16 v[148:151], v[60:63], a[116:119], v[148:151]
v_exp_f32_e64 v203, -v203
v_mfma_f32_16x16x32_bf16 v[144:147], v[60:63], a[112:115], v[144:147]
ds_write_b128 v6, v[92:95] offset:3072
v_mfma_f32_16x16x32_bf16 v[96:99], v[64:67], a[128:131], v[96:99]
v_mul_f32 v172, v172, v188
v_mul_f32 v173, v173, v189
v_mfma_f32_16x16x32_bf16 v[100:103], v[64:67], a[132:135], v[100:103]
v_mul_f32_e64 v174, v174, v190
v_mfma_f32_16x16x32_bf16 v[104:107], v[64:67], a[136:139], v[104:107]
v_mul_f32_e64 v175, v175, v191
v_cvt_pk_bf16_f32 v92, v172, v173
v_mfma_f32_16x16x32_bf16 v[108:111], v[64:67], a[140:143], v[108:111]
v_rcp_f32_e64 v204, v204
v_mfma_f32_16x16x32_bf16 v[140:143], v[68:71], a[140:143], v[140:143]
v_rcp_f32_e64 v205, v205
v_mfma_f32_16x16x32_bf16 v[136:139], v[68:71], a[136:139], v[136:139]
s_waitcnt vmcnt(8)
s_barrier
ds_read_b64_tr_b16 v[48:49], v0 offset:16384
ds_read_b64_tr_b16 v[50:51], v0 offset:18432
v_mfma_f32_16x16x32_bf16 v[132:135], v[68:71], a[132:135], v[132:135]
ds_read_b64_tr_b16 v[52:53], v1 offset:16384
v_cvt_pk_bf16_f32 v93, v174, v175
v_mfma_f32_16x16x32_bf16 v[128:131], v[68:71], a[128:131], v[128:131]
ds_read_b64_tr_b16 v[54:55], v1 offset:18432
v_add_f32_e64 v200, 1.0, v200
v_mfma_f32_16x16x32_bf16 v[112:115], v[72:75], a[128:131], v[112:115]
ds_read_b64_tr_b16 v[56:57], v0 offset:20480
v_add_f32_e64 v201, 1.0, v201
v_mfma_f32_16x16x32_bf16 v[116:119], v[72:75], a[132:135], v[116:119]
ds_read_b64_tr_b16 v[58:59], v0 offset:22528
v_add_f32_e64 v202, 1.0, v202
v_mfma_f32_16x16x32_bf16 v[120:123], v[72:75], a[136:139], v[120:123]
ds_read_b64_tr_b16 v[60:61], v1 offset:20480
v_add_f32_e64 v203, 1.0, v203
v_mfma_f32_16x16x32_bf16 v[124:127], v[72:75], a[140:143], v[124:127]
ds_read_b64_tr_b16 v[62:63], v1 offset:22528
v_mul_f32_e64 v204, v204, v220
v_mfma_f32_16x16x32_bf16 v[156:159], v[76:79], a[140:143], v[156:159]
ds_read_b64_tr_b16 v[64:65], v0 offset:24576
v_mul_f32 v205, v205, v221
v_mfma_f32_16x16x32_bf16 v[152:155], v[76:79], a[136:139], v[152:155]
ds_read_b64_tr_b16 v[66:67], v0 offset:26624
v_cvt_pk_bf16_f32 v94, v204, v205
v_mfma_f32_16x16x32_bf16 v[148:151], v[76:79], a[132:135], v[148:151]
ds_read_b64_tr_b16 v[68:69], v1 offset:24576
ds_read_b64_tr_b16 v[70:71], v1 offset:26624
v_mfma_f32_16x16x32_bf16 v[144:147], v[76:79], a[128:131], v[144:147]
s_waitcnt lgkmcnt(9)
ds_read_b64_tr_b16 v[72:73], v0 offset:28672
buffer_load_dwordx4 v8, s[8:11], s59 offen lds
v_mfma_f32_16x16x32_bf16 v[96:99], v[48:51], a[144:147], v[96:99]
s_add_u32 m0, s4, 69632
s_mov_b32 s59, 5013760
ds_read_b64_tr_b16 v[74:75], v0 offset:30720
v_mfma_f32_16x16x32_bf16 v[100:103], v[48:51], a[148:151], v[100:103]
ds_read_b64_tr_b16 v[76:77], v1 offset:28672
buffer_load_dwordx4 v8, s[12:15], s56 offen lds
v_mfma_f32_16x16x32_bf16 v[104:107], v[48:51], a[152:155], v[104:107]
s_add_u32 m0, s4, 73728
s_mov_b32 s56, 5013760
ds_read_b64_tr_b16 v[78:79], v1 offset:30720
v_mfma_f32_16x16x32_bf16 v[108:111], v[48:51], a[156:159], v[108:111]
s_waitcnt lgkmcnt(9)
buffer_load_dwordx4 v8, s[8:11], s57 offen lds
v_mfma_f32_16x16x32_bf16 v[140:143], v[52:55], a[156:159], v[140:143]
s_add_u32 m0, s4, 77824
s_movk_i32 s57, 384
v_mfma_f32_16x16x32_bf16 v[136:139], v[52:55], a[152:155], v[136:139]
buffer_load_dwordx4 v8, s[12:15], s58 offen lds
v_mfma_f32_16x16x32_bf16 v[132:135], v[52:55], a[148:151], v[132:135]
s_add_u32 m0, s4, 0
s_movk_i32 s58, 384
v_mfma_f32_16x16x32_bf16 v[128:131], v[52:55], a[144:147], v[128:131]
v_rcp_f32_e64 v206, v206
v_mfma_f32_16x16x32_bf16 v[112:115], v[56:59], a[144:147], v[112:115]
v_rcp_f32_e64 v207, v207
v_mfma_f32_16x16x32_bf16 v[116:119], v[56:59], a[148:151], v[116:119]
v_exp_f32_e64 v196, -v196
v_mfma_f32_16x16x32_bf16 v[120:123], v[56:59], a[152:155], v[120:123]
v_exp_f32_e64 v197, -v197
v_mfma_f32_16x16x32_bf16 v[124:127], v[56:59], a[156:159], v[124:127]
s_waitcnt lgkmcnt(0)
v_exp_f32_e64 v198, -v198
v_mfma_f32_16x16x32_bf16 v[156:159], v[60:63], a[156:159], v[156:159]
v_exp_f32_e64 v199, -v199
v_mfma_f32_16x16x32_bf16 v[152:155], v[60:63], a[152:155], v[152:155]
v_rcp_f32 v200, v200
v_mfma_f32_16x16x32_bf16 v[148:151], v[60:63], a[148:151], v[148:151]
v_rcp_f32_e64 v201, v201
v_mfma_f32_16x16x32_bf16 v[144:147], v[60:63], a[144:147], v[144:147]
v_rcp_f32_e64 v202, v202
v_mfma_f32_16x16x32_bf16 v[96:99], v[64:67], a[160:163], v[96:99]
v_rcp_f32_e64 v203, v203
v_mfma_f32_16x16x32_bf16 v[100:103], v[64:67], a[164:167], v[100:103]
v_mul_f32 v206, v206, v222
v_mul_f32 v207, v207, v223
v_mfma_f32_16x16x32_bf16 v[104:107], v[64:67], a[168:171], v[104:107]
v_cvt_pk_bf16_f32 v95, v206, v207
v_mfma_f32_16x16x32_bf16 v[108:111], v[64:67], a[172:175], v[108:111]
v_exp_f32_e64 v192, -v192
v_mfma_f32_16x16x32_bf16 v[140:143], v[68:71], a[172:175], v[140:143]
v_exp_f32_e64 v193, -v193
v_mfma_f32_16x16x32_bf16 v[136:139], v[68:71], a[168:171], v[136:139]
s_waitcnt vmcnt(8)
s_barrier
ds_read_b64_tr_b16 v[48:49], v0 offset:32768
ds_read_b64_tr_b16 v[50:51], v0 offset:34816
v_mfma_f32_16x16x32_bf16 v[132:135], v[68:71], a[164:167], v[132:135]
ds_read_b64_tr_b16 v[52:53], v1 offset:32768
v_add_f32_e64 v196, 1.0, v196
v_mfma_f32_16x16x32_bf16 v[128:131], v[68:71], a[160:163], v[128:131]
ds_read_b64_tr_b16 v[54:55], v1 offset:34816
v_add_f32_e64 v197, 1.0, v197
v_mfma_f32_16x16x32_bf16 v[112:115], v[72:75], a[160:163], v[112:115]
ds_read_b64_tr_b16 v[56:57], v0 offset:36864
v_add_f32_e64 v198, 1.0, v198
v_mfma_f32_16x16x32_bf16 v[116:119], v[72:75], a[164:167], v[116:119]
ds_read_b64_tr_b16 v[58:59], v0 offset:38912
v_add_f32_e64 v199, 1.0, v199
v_mfma_f32_16x16x32_bf16 v[120:123], v[72:75], a[168:171], v[120:123]
ds_read_b64_tr_b16 v[60:61], v1 offset:36864
v_mul_f32_e64 v200, v200, v216
v_mfma_f32_16x16x32_bf16 v[124:127], v[72:75], a[172:175], v[124:127]
ds_read_b64_tr_b16 v[62:63], v1 offset:38912
v_mul_f32_e64 v201, v201, v217
v_mfma_f32_16x16x32_bf16 v[156:159], v[76:79], a[172:175], v[156:159]
ds_read_b64_tr_b16 v[64:65], v0 offset:40960
v_mul_f32_e64 v202, v202, v218
v_mfma_f32_16x16x32_bf16 v[152:155], v[76:79], a[168:171], v[152:155]
ds_read_b64_tr_b16 v[66:67], v0 offset:43008
v_mul_f32 v203, v203, v219
v_mfma_f32_16x16x32_bf16 v[148:151], v[76:79], a[164:167], v[148:151]
ds_read_b64_tr_b16 v[68:69], v1 offset:40960
v_cvt_pk_bf16_f32 v90, v200, v201
v_mfma_f32_16x16x32_bf16 v[144:147], v[76:79], a[160:163], v[144:147]
s_waitcnt lgkmcnt(8)
ds_read_b64_tr_b16 v[70:71], v1 offset:43008
buffer_load_dwordx4 v8, s[8:11], s59 offen lds
v_mfma_f32_16x16x32_bf16 v[96:99], v[48:51], a[176:179], v[96:99]
s_add_u32 m0, s4, 4096
s_mov_b32 s59, 295296
ds_read_b64_tr_b16 v[72:73], v0 offset:45056
v_mfma_f32_16x16x32_bf16 v[100:103], v[48:51], a[180:183], v[100:103]
ds_read_b64_tr_b16 v[74:75], v0 offset:47104
buffer_load_dwordx4 v8, s[12:15], s56 offen lds
v_mfma_f32_16x16x32_bf16 v[104:107], v[48:51], a[184:187], v[104:107]
s_add_u32 m0, s4, 8192
s_mov_b32 s56, 295296
ds_read_b64_tr_b16 v[76:77], v1 offset:45056
v_mfma_f32_16x16x32_bf16 v[108:111], v[48:51], a[188:191], v[108:111]
s_waitcnt lgkmcnt(8)
ds_read_b64_tr_b16 v[78:79], v1 offset:47104
buffer_load_dwordx4 v8, s[8:11], s57 offen lds
v_mfma_f32_16x16x32_bf16 v[140:143], v[52:55], a[188:191], v[140:143]
s_add_u32 m0, s4, 12288
s_mov_b32 s57, 590208
v_cvt_pk_bf16_f32 v91, v202, v203
v_mfma_f32_16x16x32_bf16 v[136:139], v[52:55], a[184:187], v[136:139]
buffer_load_dwordx4 v8, s[12:15], s58 offen lds
v_add_f32 v192, 1.0, v192
v_mfma_f32_16x16x32_bf16 v[132:135], v[52:55], a[180:183], v[132:135]
s_add_u32 m0, s4, 16384
s_mov_b32 s58, 590208
v_add_f32_e64 v193, 1.0, v193
v_mfma_f32_16x16x32_bf16 v[128:131], v[52:55], a[176:179], v[128:131]
v_exp_f32_e64 v194, -v194
v_mfma_f32_16x16x32_bf16 v[112:115], v[56:59], a[176:179], v[112:115]
v_exp_f32_e64 v195, -v195
v_mfma_f32_16x16x32_bf16 v[116:119], v[56:59], a[180:183], v[116:119]
v_rcp_f32_e64 v196, v196
v_mfma_f32_16x16x32_bf16 v[120:123], v[56:59], a[184:187], v[120:123]
v_rcp_f32_e64 v197, v197
v_mfma_f32_16x16x32_bf16 v[124:127], v[56:59], a[188:191], v[124:127]
s_waitcnt lgkmcnt(1)
v_rcp_f32 v198, v198
v_mfma_f32_16x16x32_bf16 v[156:159], v[60:63], a[188:191], v[156:159]
v_rcp_f32_e64 v199, v199
v_mfma_f32_16x16x32_bf16 v[152:155], v[60:63], a[184:187], v[152:155]
v_add_f32 v194, 1.0, v194
v_add_f32 v195, 1.0, v195
v_mfma_f32_16x16x32_bf16 v[148:151], v[60:63], a[180:183], v[148:151]
v_rcp_f32_e64 v192, v192
v_mfma_f32_16x16x32_bf16 v[144:147], v[60:63], a[176:179], v[144:147]
v_rcp_f32_e64 v193, v193
v_mfma_f32_16x16x32_bf16 v[96:99], v[64:67], a[192:195], v[96:99]
v_rcp_f32_e64 v194, v194
v_mfma_f32_16x16x32_bf16 v[100:103], v[64:67], a[196:199], v[100:103]
v_rcp_f32_e64 v195, v195
v_mfma_f32_16x16x32_bf16 v[104:107], v[64:67], a[200:203], v[104:107]
v_mul_f32 v196, v196, v212
v_mul_f32 v197, v197, v213
v_mfma_f32_16x16x32_bf16 v[108:111], v[64:67], a[204:207], v[108:111]
v_mul_f32_e64 v198, v198, v214
v_mfma_f32_16x16x32_bf16 v[140:143], v[68:71], a[204:207], v[140:143]
v_mul_f32_e64 v199, v199, v215
v_cvt_pk_bf16_f32 v86, v196, v197
v_mfma_f32_16x16x32_bf16 v[136:139], v[68:71], a[200:203], v[136:139]
s_waitcnt vmcnt(8)
s_barrier
ds_read_b64_tr_b16 v[48:49], v0 offset:49152
ds_read_b64_tr_b16 v[50:51], v0 offset:51200
v_mfma_f32_16x16x32_bf16 v[132:135], v[68:71], a[196:199], v[132:135]
ds_read_b64_tr_b16 v[52:53], v1 offset:49152
v_cvt_pk_bf16_f32 v87, v198, v199
v_mfma_f32_16x16x32_bf16 v[128:131], v[68:71], a[192:195], v[128:131]
ds_read_b64_tr_b16 v[54:55], v1 offset:51200
v_mul_f32_e64 v192, v192, v208
v_mfma_f32_16x16x32_bf16 v[112:115], v[72:75], a[192:195], v[112:115]
ds_read_b64_tr_b16 v[56:57], v0 offset:53248
v_mul_f32_e64 v193, v193, v209
v_mfma_f32_16x16x32_bf16 v[116:119], v[72:75], a[196:199], v[116:119]
ds_read_b64_tr_b16 v[58:59], v0 offset:55296
v_mul_f32_e64 v194, v194, v210
v_mfma_f32_16x16x32_bf16 v[120:123], v[72:75], a[200:203], v[120:123]
ds_read_b64_tr_b16 v[60:61], v1 offset:53248
v_mul_f32_e64 v195, v195, v211
v_mfma_f32_16x16x32_bf16 v[124:127], v[72:75], a[204:207], v[124:127]
s_waitcnt lgkmcnt(7)
ds_read_b64_tr_b16 v[62:63], v1 offset:55296
v_cvt_pk_bf16_f32 v82, v192, v193
v_mfma_f32_16x16x32_bf16 v[156:159], v[76:79], a[204:207], v[156:159]
ds_read_b64_tr_b16 v[64:65], v0 offset:57344
v_cvt_pk_bf16_f32 v83, v194, v195
v_mfma_f32_16x16x32_bf16 v[152:155], v[76:79], a[200:203], v[152:155]
ds_read_b64_tr_b16 v[66:67], v0 offset:59392
ds_read_b64_tr_b16 v[68:69], v1 offset:57344
v_mfma_f32_16x16x32_bf16 v[148:151], v[76:79], a[196:199], v[148:151]
ds_read_b64_tr_b16 v[70:71], v1 offset:59392
ds_read_b64_tr_b16 v[72:73], v0 offset:61440
v_mfma_f32_16x16x32_bf16 v[144:147], v[76:79], a[192:195], v[144:147]
s_waitcnt lgkmcnt(10)
ds_read_b64_tr_b16 v[74:75], v0 offset:63488
buffer_load_dwordx4 v8, s[8:11], s59 offen lds
v_mfma_f32_16x16x32_bf16 v[96:99], v[48:51], a[208:211], v[96:99]
s_add_u32 m0, s4, 20480
s_mov_b32 s59, 885120
ds_read_b64_tr_b16 v[76:77], v1 offset:61440
v_mfma_f32_16x16x32_bf16 v[100:103], v[48:51], a[212:215], v[100:103]
ds_read_b64_tr_b16 v[78:79], v1 offset:63488
buffer_load_dwordx4 v8, s[12:15], s56 offen lds
v_mfma_f32_16x16x32_bf16 v[104:107], v[48:51], a[216:219], v[104:107]
s_add_u32 m0, s4, 24576
s_mov_b32 s56, 885120
v_mfma_f32_16x16x32_bf16 v[108:111], v[48:51], a[220:223], v[108:111]
s_waitcnt lgkmcnt(9)
buffer_load_dwordx4 v8, s[8:11], s57 offen lds
v_mfma_f32_16x16x32_bf16 v[140:143], v[52:55], a[220:223], v[140:143]
s_add_u32 m0, s4, 28672
s_mov_b32 s57, 1180032
v_mfma_f32_16x16x32_bf16 v[136:139], v[52:55], a[216:219], v[136:139]
buffer_load_dwordx4 v8, s[12:15], s58 offen lds
v_mfma_f32_16x16x32_bf16 v[132:135], v[52:55], a[212:215], v[132:135]
s_add_u32 m0, s4, 32768
s_mov_b32 s58, 1180032
v_mfma_f32_16x16x32_bf16 v[128:131], v[52:55], a[208:211], v[128:131]
v_exp_f32_e64 v224, -v224
v_mfma_f32_16x16x32_bf16 v[112:115], v[56:59], a[208:211], v[112:115]
v_exp_f32_e64 v225, -v225
v_mfma_f32_16x16x32_bf16 v[116:119], v[56:59], a[212:215], v[116:119]
v_exp_f32_e64 v226, -v226
v_mfma_f32_16x16x32_bf16 v[120:123], v[56:59], a[216:219], v[120:123]
v_exp_f32_e64 v227, -v227
v_mfma_f32_16x16x32_bf16 v[124:127], v[56:59], a[220:223], v[124:127]
s_waitcnt lgkmcnt(0)
v_exp_f32_e64 v228, -v228
v_mfma_f32_16x16x32_bf16 v[156:159], v[60:63], a[220:223], v[156:159]
v_exp_f32_e64 v229, -v229
v_mfma_f32_16x16x32_bf16 v[152:155], v[60:63], a[216:219], v[152:155]
v_exp_f32_e64 v230, -v230
v_mfma_f32_16x16x32_bf16 v[148:151], v[60:63], a[212:215], v[148:151]
v_exp_f32_e64 v231, -v231
v_mfma_f32_16x16x32_bf16 v[144:147], v[60:63], a[208:211], v[144:147]
v_exp_f32_e64 v232, -v232
v_mfma_f32_16x16x32_bf16 v[96:99], v[64:67], a[224:227], v[96:99]
v_exp_f32_e64 v233, -v233
v_mfma_f32_16x16x32_bf16 v[100:103], v[64:67], a[228:231], v[100:103]
v_exp_f32_e64 v234, -v234
v_mfma_f32_16x16x32_bf16 v[104:107], v[64:67], a[232:235], v[104:107]
v_exp_f32_e64 v235, -v235
v_mfma_f32_16x16x32_bf16 v[108:111], v[64:67], a[236:239], v[108:111]
v_exp_f32_e64 v236, -v236
v_mfma_f32_16x16x32_bf16 v[140:143], v[68:71], a[236:239], v[140:143]
v_exp_f32_e64 v237, -v237
v_mfma_f32_16x16x32_bf16 v[136:139], v[68:71], a[232:235], v[136:139]
s_waitcnt vmcnt(8)
s_barrier
ds_read_b64_tr_b16 v[48:49], v2 offset:0
ds_read_b64_tr_b16 v[50:51], v2 offset:2048
v_mfma_f32_16x16x32_bf16 v[132:135], v[68:71], a[228:231], v[132:135]
ds_read_b64_tr_b16 v[52:53], v3 offset:0
v_add_f32_e64 v224, 1.0, v224
v_mfma_f32_16x16x32_bf16 v[128:131], v[68:71], a[224:227], v[128:131]
ds_read_b64_tr_b16 v[54:55], v3 offset:2048
v_add_f32_e64 v225, 1.0, v225
v_mfma_f32_16x16x32_bf16 v[112:115], v[72:75], a[224:227], v[112:115]
ds_read_b64_tr_b16 v[56:57], v2 offset:4096
v_add_f32_e64 v226, 1.0, v226
v_mfma_f32_16x16x32_bf16 v[116:119], v[72:75], a[228:231], v[116:119]
ds_read_b64_tr_b16 v[58:59], v2 offset:6144
v_add_f32_e64 v227, 1.0, v227
v_mfma_f32_16x16x32_bf16 v[120:123], v[72:75], a[232:235], v[120:123]
ds_read_b64_tr_b16 v[60:61], v3 offset:4096
v_add_f32_e64 v228, 1.0, v228
v_mfma_f32_16x16x32_bf16 v[124:127], v[72:75], a[236:239], v[124:127]
ds_read_b64_tr_b16 v[62:63], v3 offset:6144
v_add_f32_e64 v229, 1.0, v229
v_mfma_f32_16x16x32_bf16 v[156:159], v[76:79], a[236:239], v[156:159]
ds_read_b64_tr_b16 v[64:65], v2 offset:8192
v_add_f32_e64 v230, 1.0, v230
v_mfma_f32_16x16x32_bf16 v[152:155], v[76:79], a[232:235], v[152:155]
ds_read_b64_tr_b16 v[66:67], v2 offset:10240
v_add_f32_e64 v231, 1.0, v231
v_mfma_f32_16x16x32_bf16 v[148:151], v[76:79], a[228:231], v[148:151]
ds_read_b64_tr_b16 v[68:69], v3 offset:8192
v_add_f32 v232, 1.0, v232
v_mfma_f32_16x16x32_bf16 v[144:147], v[76:79], a[224:227], v[144:147]
s_waitcnt lgkmcnt(8)
ds_read_b64_tr_b16 v[70:71], v3 offset:10240
buffer_load_dwordx4 v8, s[8:11], s59 offen lds
v_mfma_f32_16x16x32_bf16 v[96:99], v[48:51], a[240:243], v[96:99]
s_add_u32 m0, s4, 36864
s_mov_b32 s59, 1474944
ds_read_b64_tr_b16 v[72:73], v2 offset:12288
v_mfma_f32_16x16x32_bf16 v[100:103], v[48:51], a[244:247], v[100:103]
ds_read_b64_tr_b16 v[74:75], v2 offset:14336
buffer_load_dwordx4 v8, s[12:15], s56 offen lds
v_mfma_f32_16x16x32_bf16 v[104:107], v[48:51], a[248:251], v[104:107]
s_add_u32 m0, s4, 40960
s_mov_b32 s56, 1474944
ds_read_b64_tr_b16 v[76:77], v3 offset:12288
v_mfma_f32_16x16x32_bf16 v[108:111], v[48:51], a[252:255], v[108:111]
s_waitcnt lgkmcnt(8)
ds_read_b64_tr_b16 v[78:79], v3 offset:14336
buffer_load_dwordx4 v8, s[8:11], s57 offen lds
v_mfma_f32_16x16x32_bf16 v[140:143], v[52:55], a[252:255], v[140:143]
s_add_u32 m0, s4, 45056
s_mov_b32 s57, 1769856
v_add_f32 v233, 1.0, v233
v_mfma_f32_16x16x32_bf16 v[136:139], v[52:55], a[248:251], v[136:139]
buffer_load_dwordx4 v8, s[12:15], s58 offen lds
v_add_f32_e64 v234, 1.0, v234
v_mfma_f32_16x16x32_bf16 v[132:135], v[52:55], a[244:247], v[132:135]
s_add_u32 m0, s4, 49152
s_mov_b32 s58, 1769856
v_add_f32_e64 v235, 1.0, v235
v_mfma_f32_16x16x32_bf16 v[128:131], v[52:55], a[240:243], v[128:131]
v_exp_f32_e64 v238, -v238
v_mfma_f32_16x16x32_bf16 v[112:115], v[56:59], a[240:243], v[112:115]
v_exp_f32_e64 v239, -v239
v_mfma_f32_16x16x32_bf16 v[116:119], v[56:59], a[244:247], v[116:119]
v_add_f32 v236, 1.0, v236
v_add_f32 v237, 1.0, v237
v_mfma_f32_16x16x32_bf16 v[120:123], v[56:59], a[248:251], v[120:123]
v_add_f32_e64 v238, 1.0, v238
v_mfma_f32_16x16x32_bf16 v[124:127], v[56:59], a[252:255], v[124:127]
s_waitcnt lgkmcnt(1)
v_add_f32 v239, 1.0, v239
v_mfma_f32_16x16x32_bf16 v[156:159], v[60:63], a[252:255], v[156:159]
v_rcp_f32_e64 v224, v224
v_mfma_f32_16x16x32_bf16 v[152:155], v[60:63], a[248:251], v[152:155]
v_rcp_f32_e64 v225, v225
v_mfma_f32_16x16x32_bf16 v[148:151], v[60:63], a[244:247], v[148:151]
v_rcp_f32_e64 v226, v226
v_mfma_f32_16x16x32_bf16 v[144:147], v[60:63], a[240:243], v[144:147]
v_rcp_f32_e64 v227, v227
v_mfma_f32_16x16x32_bf16 v[96:99], v[64:67], v[16:19], v[96:99]
v_rcp_f32_e64 v228, v228
v_mfma_f32_16x16x32_bf16 v[100:103], v[64:67], v[20:23], v[100:103]
v_rcp_f32_e64 v229, v229
v_mfma_f32_16x16x32_bf16 v[104:107], v[64:67], v[24:27], v[104:107]
v_rcp_f32_e64 v230, v230
v_mfma_f32_16x16x32_bf16 v[108:111], v[64:67], v[28:31], v[108:111]
v_rcp_f32_e64 v231, v231
v_mfma_f32_16x16x32_bf16 v[140:143], v[68:71], v[28:31], v[140:143]
v_rcp_f32_e64 v232, v232
v_mfma_f32_16x16x32_bf16 v[136:139], v[68:71], v[24:27], v[136:139]
s_waitcnt vmcnt(8)
s_barrier
ds_read_b64_tr_b16 v[48:49], v0 offset:0
ds_read_b64_tr_b16 v[50:51], v0 offset:2048
v_mfma_f32_16x16x32_bf16 v[132:135], v[68:71], v[20:23], v[132:135]
ds_read_b64_tr_b16 v[52:53], v1 offset:0
v_mul_f32_e64 v224, v224, v240
v_mfma_f32_16x16x32_bf16 v[128:131], v[68:71], v[16:19], v[128:131]
ds_read_b64_tr_b16 v[54:55], v1 offset:2048
v_mul_f32_e64 v225, v225, v241
v_mfma_f32_16x16x32_bf16 v[112:115], v[72:75], v[16:19], v[112:115]
ds_read_b64_tr_b16 v[56:57], v0 offset:4096
v_mul_f32_e64 v226, v226, v242
v_mfma_f32_16x16x32_bf16 v[116:119], v[72:75], v[20:23], v[116:119]
ds_read_b64_tr_b16 v[58:59], v0 offset:6144
v_mul_f32_e64 v227, v227, v243
v_mfma_f32_16x16x32_bf16 v[120:123], v[72:75], v[24:27], v[120:123]
ds_read_b64_tr_b16 v[60:61], v1 offset:4096
v_mul_f32 v228, v228, v244
v_mfma_f32_16x16x32_bf16 v[124:127], v[72:75], v[28:31], v[124:127]
s_waitcnt lgkmcnt(7)
ds_read_b64_tr_b16 v[62:63], v1 offset:6144
v_mul_f32_e64 v229, v229, v245
v_mfma_f32_16x16x32_bf16 v[156:159], v[76:79], v[28:31], v[156:159]
ds_read_b64_tr_b16 v[64:65], v0 offset:8192
v_mul_f32_e64 v230, v230, v246
v_mfma_f32_16x16x32_bf16 v[152:155], v[76:79], v[24:27], v[152:155]
ds_read_b64_tr_b16 v[66:67], v0 offset:10240
v_mul_f32_e64 v231, v231, v247
v_mfma_f32_16x16x32_bf16 v[148:151], v[76:79], v[20:23], v[148:151]
ds_read_b64_tr_b16 v[68:69], v1 offset:8192
v_mul_f32 v232, v232, v248
v_mfma_f32_16x16x32_bf16 v[144:147], v[76:79], v[16:19], v[144:147]
s_waitcnt lgkmcnt(8)
ds_read_b64_tr_b16 v[70:71], v1 offset:10240
buffer_load_dwordx4 v8, s[8:11], s59 offen lds
v_mfma_f32_16x16x32_bf16 v[96:99], v[48:51], v[32:35], v[96:99]
s_add_u32 m0, s4, 53248
s_mov_b32 s59, 2064768
ds_read_b64_tr_b16 v[72:73], v0 offset:12288
v_mfma_f32_16x16x32_bf16 v[100:103], v[48:51], v[36:39], v[100:103]
ds_read_b64_tr_b16 v[74:75], v0 offset:14336
buffer_load_dwordx4 v8, s[12:15], s56 offen lds
v_mfma_f32_16x16x32_bf16 v[104:107], v[48:51], v[40:43], v[104:107]
s_add_u32 m0, s4, 57344
s_mov_b32 s56, 2064768
ds_read_b64_tr_b16 v[76:77], v1 offset:12288
v_mfma_f32_16x16x32_bf16 v[108:111], v[48:51], v[44:47], v[108:111]
s_waitcnt lgkmcnt(8)
ds_read_b64_tr_b16 v[78:79], v1 offset:14336
buffer_load_dwordx4 v8, s[8:11], s57 offen lds
v_mfma_f32_16x16x32_bf16 v[140:143], v[52:55], v[44:47], v[140:143]
s_add_u32 m0, s4, 61440
s_mov_b32 s57, 2359680
v_mfma_f32_16x16x32_bf16 v[136:139], v[52:55], v[40:43], v[136:139]
buffer_load_dwordx4 v8, s[12:15], s58 offen lds
v_mfma_f32_16x16x32_bf16 v[132:135], v[52:55], v[36:39], v[132:135]
s_add_u32 m0, s4, 65536
s_mov_b32 s58, 2359680
v_mfma_f32_16x16x32_bf16 v[128:131], v[52:55], v[32:35], v[128:131]
s_lshr_b32 s71, s6, 3
v_rcp_f32_e64 v233, v233
v_mfma_f32_16x16x32_bf16 v[112:115], v[56:59], v[32:35], v[112:115]
s_and_b32 s72, s3, 1
v_rcp_f32 v234, v234
v_mfma_f32_16x16x32_bf16 v[116:119], v[56:59], v[36:39], v[116:119]
s_lshl1_add_u32 s71, s71, s72
v_rcp_f32 v235, v235
v_mfma_f32_16x16x32_bf16 v[120:123], v[56:59], v[40:43], v[120:123]
s_lshl_b32 s69, s7, 13
v_rcp_f32 v236, v236
v_mfma_f32_16x16x32_bf16 v[124:127], v[56:59], v[44:47], v[124:127]
s_waitcnt lgkmcnt(1)
s_add_u32 s69, s69, 3407872
v_rcp_f32 v237, v237
v_mfma_f32_16x16x32_bf16 v[156:159], v[60:63], v[44:47], v[156:159]
s_mov_b32 s68, 0x8000
v_rcp_f32_e64 v238, v238
v_mfma_f32_16x16x32_bf16 v[152:155], v[60:63], v[40:43], v[152:155]
v_rcp_f32_e64 v239, v239
v_mfma_f32_16x16x32_bf16 v[148:151], v[60:63], v[36:39], v[148:151]
ds_write_b128 v6, v[80:83] offset:16384
v_mfma_f32_16x16x32_bf16 v[144:147], v[60:63], v[32:35], v[144:147]
ds_write_b128 v6, v[84:87] offset:17408
v_mfma_f32_16x16x32_bf16 v[160:163], v[64:67], a[0:3], 0
ds_write_b128 v6, v[88:91] offset:18432
v_mfma_f32_16x16x32_bf16 v[164:167], v[64:67], a[4:7], 0
ds_write_b128 v6, v[92:95] offset:19456
v_mfma_f32_16x16x32_bf16 v[168:171], v[64:67], a[8:11], 0
v_mul_f32 v233, v233, v249
v_mul_f32 v234, v234, v250
v_mfma_f32_16x16x32_bf16 v[172:175], v[64:67], a[12:15], 0
v_mul_f32_e64 v235, v235, v251
v_mfma_f32_16x16x32_bf16 v[204:207], v[68:71], a[12:15], 0
v_mul_f32 v236, v236, v252
v_mul_f32 v237, v237, v253
v_mfma_f32_16x16x32_bf16 v[200:203], v[68:71], a[8:11], 0
s_waitcnt vmcnt(8)
s_barrier
ds_read_b64_tr_b16 v[48:49], v0 offset:16384
ds_read_b64_tr_b16 v[50:51], v0 offset:18432
v_mfma_f32_16x16x32_bf16 v[196:199], v[68:71], a[4:7], 0
ds_read_b64_tr_b16 v[52:53], v1 offset:16384
v_mul_f32_e64 v238, v238, v254
v_mfma_f32_16x16x32_bf16 v[192:195], v[68:71], a[0:3], 0
ds_read_b64_tr_b16 v[54:55], v1 offset:18432
v_mul_f32 v239, v239, v255
v_mfma_f32_16x16x32_bf16 v[176:179], v[72:75], a[0:3], 0
ds_read_b64_tr_b16 v[56:57], v0 offset:20480
v_cvt_pk_bf16_f32 v80, v224, v225
v_mfma_f32_16x16x32_bf16 v[180:183], v[72:75], a[4:7], 0
ds_read_b64_tr_b16 v[58:59], v0 offset:22528
v_cvt_pk_bf16_f32 v81, v226, v227
v_mfma_f32_16x16x32_bf16 v[184:187], v[72:75], a[8:11], 0
ds_read_b64_tr_b16 v[60:61], v1 offset:20480
v_cvt_pk_bf16_f32 v84, v228, v229
v_mfma_f32_16x16x32_bf16 v[188:191], v[72:75], a[12:15], 0
s_waitcnt lgkmcnt(7)
ds_read_b64_tr_b16 v[62:63], v1 offset:22528
v_cvt_pk_bf16_f32 v85, v230, v231
v_mfma_f32_16x16x32_bf16 v[220:223], v[76:79], a[12:15], 0
ds_read_b64_tr_b16 v[64:65], v0 offset:24576
v_cvt_pk_bf16_f32 v88, v232, v233
v_mfma_f32_16x16x32_bf16 v[216:219], v[76:79], a[8:11], 0
ds_read_b64_tr_b16 v[66:67], v0 offset:26624
v_cvt_pk_bf16_f32 v89, v234, v235
v_mfma_f32_16x16x32_bf16 v[212:215], v[76:79], a[4:7], 0
ds_read_b64_tr_b16 v[68:69], v1 offset:24576
v_cvt_pk_bf16_f32 v92, v236, v237
v_mfma_f32_16x16x32_bf16 v[208:211], v[76:79], a[0:3], 0
s_waitcnt lgkmcnt(8)
ds_read_b64_tr_b16 v[70:71], v1 offset:26624
buffer_load_dwordx4 v8, s[8:11], s59 offen lds
v_mfma_f32_16x16x32_bf16 v[160:163], v[48:51], a[16:19], v[160:163]
s_add_u32 m0, s4, 69632
s_mov_b32 s59, 2654592
v_cvt_pk_bf16_f32 v93, v238, v239
v_mfma_f32_16x16x32_bf16 v[164:167], v[48:51], a[20:23], v[164:167]
ds_read_b64_tr_b16 v[72:73], v0 offset:28672
buffer_load_dwordx4 v8, s[12:15], s56 offen lds
v_mfma_f32_16x16x32_bf16 v[168:171], v[48:51], a[24:27], v[168:171]
s_add_u32 m0, s4, 73728
s_mov_b32 s56, 2654592
ds_read_b64_tr_b16 v[74:75], v0 offset:30720
v_mfma_f32_16x16x32_bf16 v[172:175], v[48:51], a[28:31], v[172:175]
s_waitcnt lgkmcnt(7)
ds_read_b64_tr_b16 v[76:77], v1 offset:28672
buffer_load_dwordx4 v8, s[8:11], s57 offen lds
v_mfma_f32_16x16x32_bf16 v[204:207], v[52:55], a[28:31], v[204:207]
s_add_u32 m0, s4, 77824
s_mov_b32 s57, 2949504
ds_read_b64_tr_b16 v[78:79], v1 offset:30720
v_mfma_f32_16x16x32_bf16 v[200:203], v[52:55], a[24:27], v[200:203]
buffer_load_dwordx4 v8, s[12:15], s58 offen lds
v_mbcnt_lo_u32_b32 v228, -1, 0
v_mfma_f32_16x16x32_bf16 v[196:199], v[52:55], a[20:23], v[196:199]
s_add_u32 m0, s4, 0
s_mov_b32 s58, 2949504
v_mbcnt_hi_u32_b32 v228, -1, v228
v_mfma_f32_16x16x32_bf16 v[192:195], v[52:55], a[16:19], v[192:195]
ds_write_b64 v7, v[80:81] offset:0
v_mfma_f32_16x16x32_bf16 v[176:179], v[56:59], a[16:19], v[176:179]
ds_write_b64 v7, v[84:85] offset:1024
v_mfma_f32_16x16x32_bf16 v[180:183], v[56:59], a[20:23], v[180:183]
ds_write_b64 v7, v[88:89] offset:2048
v_mfma_f32_16x16x32_bf16 v[184:187], v[56:59], a[24:27], v[184:187]
ds_write_b64 v7, v[92:93] offset:3072
v_mfma_f32_16x16x32_bf16 v[188:191], v[56:59], a[28:31], v[188:191]
s_waitcnt lgkmcnt(6)
v_exp_f32_e64 v96, -v96
v_mfma_f32_16x16x32_bf16 v[220:223], v[60:63], a[28:31], v[220:223]
v_exp_f32_e64 v97, -v97
v_mfma_f32_16x16x32_bf16 v[216:219], v[60:63], a[24:27], v[216:219]
v_exp_f32_e64 v98, -v98
v_mfma_f32_16x16x32_bf16 v[212:215], v[60:63], a[20:23], v[212:215]
v_exp_f32_e64 v99, -v99
v_mfma_f32_16x16x32_bf16 v[208:211], v[60:63], a[16:19], v[208:211]
v_exp_f32_e64 v128, -v128
v_mfma_f32_16x16x32_bf16 v[160:163], v[64:67], a[32:35], v[160:163]
v_exp_f32_e64 v129, -v129
v_mfma_f32_16x16x32_bf16 v[164:167], v[64:67], a[36:39], v[164:167]
v_exp_f32_e64 v130, -v130
v_mfma_f32_16x16x32_bf16 v[168:171], v[64:67], a[40:43], v[168:171]
v_exp_f32_e64 v131, -v131
v_mfma_f32_16x16x32_bf16 v[172:175], v[64:67], a[44:47], v[172:175]
v_exp_f32_e64 v100, -v100
v_mfma_f32_16x16x32_bf16 v[204:207], v[68:71], a[44:47], v[204:207]
v_exp_f32_e64 v101, -v101
v_mfma_f32_16x16x32_bf16 v[200:203], v[68:71], a[40:43], v[200:203]
s_waitcnt vmcnt(8) lgkmcnt(0)
s_barrier
ds_read_b64_tr_b16 v[48:49], v0 offset:32768
ds_read_b64_tr_b16 v[50:51], v0 offset:34816
v_mfma_f32_16x16x32_bf16 v[196:199], v[68:71], a[36:39], v[196:199]
ds_read_b64_tr_b16 v[52:53], v1 offset:32768
v_add_f32_e64 v96, 1.0, v96
v_mfma_f32_16x16x32_bf16 v[192:195], v[68:71], a[32:35], v[192:195]
ds_read_b64_tr_b16 v[54:55], v1 offset:34816
v_add_f32_e64 v97, 1.0, v97
v_mfma_f32_16x16x32_bf16 v[176:179], v[72:75], a[32:35], v[176:179]
ds_read_b64_tr_b16 v[56:57], v0 offset:36864
v_add_f32_e64 v98, 1.0, v98
v_mfma_f32_16x16x32_bf16 v[180:183], v[72:75], a[36:39], v[180:183]
ds_read_b64_tr_b16 v[58:59], v0 offset:38912
v_add_f32_e64 v99, 1.0, v99
v_mfma_f32_16x16x32_bf16 v[184:187], v[72:75], a[40:43], v[184:187]
ds_read_b64_tr_b16 v[60:61], v1 offset:36864
v_add_f32_e64 v128, 1.0, v128
v_mfma_f32_16x16x32_bf16 v[188:191], v[72:75], a[44:47], v[188:191]
ds_read_b64_tr_b16 v[62:63], v1 offset:38912
v_add_f32_e64 v129, 1.0, v129
v_mfma_f32_16x16x32_bf16 v[220:223], v[76:79], a[44:47], v[220:223]
ds_read_b64_tr_b16 v[64:65], v0 offset:40960
v_add_f32_e64 v130, 1.0, v130
v_mfma_f32_16x16x32_bf16 v[216:219], v[76:79], a[40:43], v[216:219]
ds_read_b64_tr_b16 v[66:67], v0 offset:43008
v_add_f32_e64 v131, 1.0, v131
v_mfma_f32_16x16x32_bf16 v[212:215], v[76:79], a[36:39], v[212:215]
ds_read_b64_tr_b16 v[68:69], v1 offset:40960
v_add_f32 v100, 1.0, v100
v_mfma_f32_16x16x32_bf16 v[208:211], v[76:79], a[32:35], v[208:211]
s_waitcnt lgkmcnt(8)
ds_read_b64_tr_b16 v[70:71], v1 offset:43008
buffer_load_dwordx4 v8, s[8:11], s59 offen lds
v_mfma_f32_16x16x32_bf16 v[160:163], v[48:51], a[48:51], v[160:163]
s_add_u32 m0, s4, 4096
s_mov_b32 s59, 3244416
ds_read_b64_tr_b16 v[72:73], v0 offset:45056
v_mfma_f32_16x16x32_bf16 v[164:167], v[48:51], a[52:55], v[164:167]
ds_read_b64_tr_b16 v[74:75], v0 offset:47104
buffer_load_dwordx4 v8, s[12:15], s56 offen lds
v_mfma_f32_16x16x32_bf16 v[168:171], v[48:51], a[56:59], v[168:171]
s_add_u32 m0, s4, 8192
s_mov_b32 s56, 3244416
ds_read_b64_tr_b16 v[76:77], v1 offset:45056
v_mfma_f32_16x16x32_bf16 v[172:175], v[48:51], a[60:63], v[172:175]
s_waitcnt lgkmcnt(8)
ds_read_b64_tr_b16 v[78:79], v1 offset:47104
buffer_load_dwordx4 v8, s[8:11], s57 offen lds
v_mfma_f32_16x16x32_bf16 v[204:207], v[52:55], a[60:63], v[204:207]
s_add_u32 m0, s4, 12288
s_mov_b32 s57, 3539328
v_add_f32_e64 v101, 1.0, v101
v_mfma_f32_16x16x32_bf16 v[200:203], v[52:55], a[56:59], v[200:203]
ds_read_b128 a[0:3], v4 offset:0
buffer_load_dwordx4 v8, s[12:15], s58 offen lds
v_mfma_f32_16x16x32_bf16 v[196:199], v[52:55], a[52:55], v[196:199]
s_add_u32 m0, s4, 16384
s_mov_b32 s58, 3539328
ds_read_b128 a[4:7], v4 offset:1024
v_mfma_f32_16x16x32_bf16 v[192:195], v[52:55], a[48:51], v[192:195]
v_exp_f32_e64 v102, -v102
v_mfma_f32_16x16x32_bf16 v[176:179], v[56:59], a[48:51], v[176:179]
v_exp_f32_e64 v103, -v103
v_mfma_f32_16x16x32_bf16 v[180:183], v[56:59], a[52:55], v[180:183]
v_exp_f32_e64 v132, -v132
v_mfma_f32_16x16x32_bf16 v[184:187], v[56:59], a[56:59], v[184:187]
v_exp_f32_e64 v133, -v133
v_mfma_f32_16x16x32_bf16 v[188:191], v[56:59], a[60:63], v[188:191]
s_waitcnt lgkmcnt(3)
v_exp_f32_e64 v134, -v134
v_mfma_f32_16x16x32_bf16 v[220:223], v[60:63], a[60:63], v[220:223]
v_exp_f32_e64 v135, -v135
v_mfma_f32_16x16x32_bf16 v[216:219], v[60:63], a[56:59], v[216:219]
v_exp_f32_e64 v104, -v104
v_mfma_f32_16x16x32_bf16 v[212:215], v[60:63], a[52:55], v[212:215]
v_exp_f32_e64 v105, -v105
v_mfma_f32_16x16x32_bf16 v[208:211], v[60:63], a[48:51], v[208:211]
v_exp_f32_e64 v106, -v106
v_mfma_f32_16x16x32_bf16 v[160:163], v[64:67], a[64:67], v[160:163]
v_exp_f32_e64 v107, -v107
v_mfma_f32_16x16x32_bf16 v[164:167], v[64:67], a[68:71], v[164:167]
v_exp_f32_e64 v136, -v136
v_mfma_f32_16x16x32_bf16 v[168:171], v[64:67], a[72:75], v[168:171]
v_exp_f32_e64 v137, -v137
v_mfma_f32_16x16x32_bf16 v[172:175], v[64:67], a[76:79], v[172:175]
v_exp_f32_e64 v138, -v138
v_mfma_f32_16x16x32_bf16 v[204:207], v[68:71], a[76:79], v[204:207]
v_exp_f32_e64 v139, -v139
v_mfma_f32_16x16x32_bf16 v[200:203], v[68:71], a[72:75], v[200:203]
s_waitcnt vmcnt(8)
s_barrier
ds_read_b64_tr_b16 v[48:49], v0 offset:49152
ds_read_b64_tr_b16 v[50:51], v0 offset:51200
v_mfma_f32_16x16x32_bf16 v[196:199], v[68:71], a[68:71], v[196:199]
ds_read_b64_tr_b16 v[52:53], v1 offset:49152
v_add_f32_e64 v102, 1.0, v102
v_mfma_f32_16x16x32_bf16 v[192:195], v[68:71], a[64:67], v[192:195]
ds_read_b64_tr_b16 v[54:55], v1 offset:51200
v_add_f32_e64 v103, 1.0, v103
v_mfma_f32_16x16x32_bf16 v[176:179], v[72:75], a[64:67], v[176:179]
ds_read_b64_tr_b16 v[56:57], v0 offset:53248
v_add_f32_e64 v132, 1.0, v132
v_mfma_f32_16x16x32_bf16 v[180:183], v[72:75], a[68:71], v[180:183]
ds_read_b64_tr_b16 v[58:59], v0 offset:55296
v_add_f32_e64 v133, 1.0, v133
v_mfma_f32_16x16x32_bf16 v[184:187], v[72:75], a[72:75], v[184:187]
ds_read_b64_tr_b16 v[60:61], v1 offset:53248
v_add_f32 v134, 1.0, v134
v_mfma_f32_16x16x32_bf16 v[188:191], v[72:75], a[76:79], v[188:191]
s_waitcnt lgkmcnt(7)
ds_read_b64_tr_b16 v[62:63], v1 offset:55296
v_add_f32_e64 v135, 1.0, v135
v_mfma_f32_16x16x32_bf16 v[220:223], v[76:79], a[76:79], v[220:223]
ds_read_b64_tr_b16 v[64:65], v0 offset:57344
v_add_f32_e64 v104, 1.0, v104
v_mfma_f32_16x16x32_bf16 v[216:219], v[76:79], a[72:75], v[216:219]
ds_read_b64_tr_b16 v[66:67], v0 offset:59392
v_add_f32_e64 v105, 1.0, v105
v_mfma_f32_16x16x32_bf16 v[212:215], v[76:79], a[68:71], v[212:215]
ds_read_b64_tr_b16 v[68:69], v1 offset:57344
v_add_f32 v106, 1.0, v106
v_mfma_f32_16x16x32_bf16 v[208:211], v[76:79], a[64:67], v[208:211]
s_waitcnt lgkmcnt(8)
ds_read_b64_tr_b16 v[70:71], v1 offset:59392
buffer_load_dwordx4 v8, s[8:11], s59 offen lds
v_mfma_f32_16x16x32_bf16 v[160:163], v[48:51], a[80:83], v[160:163]
s_add_u32 m0, s4, 20480
s_mov_b32 s59, 3834240
ds_read_b64_tr_b16 v[72:73], v0 offset:61440
v_mfma_f32_16x16x32_bf16 v[164:167], v[48:51], a[84:87], v[164:167]
ds_read_b64_tr_b16 v[74:75], v0 offset:63488
buffer_load_dwordx4 v8, s[12:15], s56 offen lds
v_mfma_f32_16x16x32_bf16 v[168:171], v[48:51], a[88:91], v[168:171]
s_add_u32 m0, s4, 24576
s_mov_b32 s56, 3834240
ds_read_b64_tr_b16 v[76:77], v1 offset:61440
v_mfma_f32_16x16x32_bf16 v[172:175], v[48:51], a[92:95], v[172:175]
s_waitcnt lgkmcnt(8)
ds_read_b64_tr_b16 v[78:79], v1 offset:63488
buffer_load_dwordx4 v8, s[8:11], s57 offen lds
v_mfma_f32_16x16x32_bf16 v[204:207], v[52:55], a[92:95], v[204:207]
s_add_u32 m0, s4, 28672
s_mov_b32 s57, 4129152
v_add_f32 v107, 1.0, v107
v_mfma_f32_16x16x32_bf16 v[200:203], v[52:55], a[88:91], v[200:203]
buffer_load_dwordx4 v8, s[12:15], s58 offen lds
v_add_f32_e64 v136, 1.0, v136
v_mfma_f32_16x16x32_bf16 v[196:199], v[52:55], a[84:87], v[196:199]
s_add_u32 m0, s4, 32768
s_mov_b32 s58, 4129152
v_add_f32_e64 v137, 1.0, v137
v_mfma_f32_16x16x32_bf16 v[192:195], v[52:55], a[80:83], v[192:195]
v_exp_f32_e64 v108, -v108
v_mfma_f32_16x16x32_bf16 v[176:179], v[56:59], a[80:83], v[176:179]
v_exp_f32_e64 v109, -v109
v_mfma_f32_16x16x32_bf16 v[180:183], v[56:59], a[84:87], v[180:183]
v_exp_f32_e64 v110, -v110
v_mfma_f32_16x16x32_bf16 v[184:187], v[56:59], a[88:91], v[184:187]
v_exp_f32_e64 v111, -v111
v_mfma_f32_16x16x32_bf16 v[188:191], v[56:59], a[92:95], v[188:191]
s_waitcnt lgkmcnt(1)
v_exp_f32_e64 v140, -v140
v_mfma_f32_16x16x32_bf16 v[220:223], v[60:63], a[92:95], v[220:223]
v_exp_f32_e64 v141, -v141
v_mfma_f32_16x16x32_bf16 v[216:219], v[60:63], a[88:91], v[216:219]
v_exp_f32_e64 v142, -v142
v_mfma_f32_16x16x32_bf16 v[212:215], v[60:63], a[84:87], v[212:215]
v_exp_f32_e64 v143, -v143
v_mfma_f32_16x16x32_bf16 v[208:211], v[60:63], a[80:83], v[208:211]
v_add_f32 v138, 1.0, v138
v_add_f32_e64 v139, 1.0, v139
v_mfma_f32_16x16x32_bf16 v[160:163], v[64:67], a[96:99], v[160:163]
ds_read_b128 a[8:11], v4 offset:2048
v_add_f32_e64 v108, 1.0, v108
v_mfma_f32_16x16x32_bf16 v[164:167], v[64:67], a[100:103], v[164:167]
v_add_f32 v109, 1.0, v109
v_add_f32 v110, 1.0, v110
v_mfma_f32_16x16x32_bf16 v[168:171], v[64:67], a[104:107], v[168:171]
ds_read_b128 a[12:15], v4 offset:3072
v_add_f32_e64 v111, 1.0, v111
v_mfma_f32_16x16x32_bf16 v[172:175], v[64:67], a[108:111], v[172:175]
v_add_f32 v140, 1.0, v140
v_add_f32 v141, 1.0, v141
v_mfma_f32_16x16x32_bf16 v[204:207], v[68:71], a[108:111], v[204:207]
ds_read_b128 a[16:19], v4 offset:8192
v_add_f32_e64 v142, 1.0, v142
v_mfma_f32_16x16x32_bf16 v[200:203], v[68:71], a[104:107], v[200:203]
s_waitcnt vmcnt(8)
s_barrier
ds_read_b64_tr_b16 v[48:49], v2 offset:0
ds_read_b64_tr_b16 v[50:51], v2 offset:2048
v_mfma_f32_16x16x32_bf16 v[196:199], v[68:71], a[100:103], v[196:199]
v_lshrrev_b32 v229, 4, v228
v_add_f32 v143, 1.0, v143
v_mfma_f32_16x16x32_bf16 v[192:195], v[68:71], a[96:99], v[192:195]
ds_read_b64_tr_b16 v[52:53], v3 offset:0
v_min_u32_e64 v229, 1, v229
v_mfma_f32_16x16x32_bf16 v[176:179], v[72:75], a[96:99], v[176:179]
ds_read_b64_tr_b16 v[54:55], v3 offset:2048
v_lshlrev_b32_e64 v229, 30, v229
v_mfma_f32_16x16x32_bf16 v[180:183], v[72:75], a[100:103], v[180:183]
ds_read_b64_tr_b16 v[56:57], v2 offset:4096
v_lshl_add_u32 v12, v228, 9, v229
v_mfma_f32_16x16x32_bf16 v[184:187], v[72:75], a[104:107], v[184:187]
ds_read_b64_tr_b16 v[58:59], v2 offset:6144
v_min_u32 v228, 1, v228
v_mfma_f32_16x16x32_bf16 v[188:191], v[72:75], a[108:111], v[188:191]
s_waitcnt lgkmcnt(7)
ds_read_b64_tr_b16 v[60:61], v3 offset:4096
v_lshlrev_b32_e64 v228, 30, v228
v_mfma_f32_16x16x32_bf16 v[220:223], v[76:79], a[108:111], v[220:223]
ds_read_b64_tr_b16 v[62:63], v3 offset:6144
v_lshl_add_u32 v228, s6, 9, v228
v_mfma_f32_16x16x32_bf16 v[216:219], v[76:79], a[104:107], v[216:219]
ds_read_b64_tr_b16 v[64:65], v2 offset:8192
v_lshl_add_u32 v13, s3, 7, v228
v_mfma_f32_16x16x32_bf16 v[212:215], v[76:79], a[100:103], v[212:215]
ds_read_b64_tr_b16 v[66:67], v2 offset:10240
v_lshl_add_u32 v12, s71, 7, v12
v_mfma_f32_16x16x32_bf16 v[208:211], v[76:79], a[96:99], v[208:211]
s_waitcnt lgkmcnt(8)
ds_read_b64_tr_b16 v[68:69], v3 offset:8192
buffer_load_dwordx4 v8, s[8:11], s59 offen lds
v_mfma_f32_16x16x32_bf16 v[160:163], v[48:51], a[112:115], v[160:163]
s_add_u32 m0, s4, 36864
s_mov_b32 s59, 4424064
ds_read_b64_tr_b16 v[70:71], v3 offset:10240
v_mfma_f32_16x16x32_bf16 v[164:167], v[48:51], a[116:119], v[164:167]
ds_read_b64_tr_b16 v[72:73], v2 offset:12288
buffer_load_dwordx4 v8, s[12:15], s56 offen lds
v_mfma_f32_16x16x32_bf16 v[168:171], v[48:51], a[120:123], v[168:171]
s_add_u32 m0, s4, 40960
s_mov_b32 s56, 4424064
ds_read_b64_tr_b16 v[74:75], v2 offset:14336
v_mfma_f32_16x16x32_bf16 v[172:175], v[48:51], a[124:127], v[172:175]
s_waitcnt lgkmcnt(8)
ds_read_b64_tr_b16 v[76:77], v3 offset:12288
buffer_load_dwordx4 v8, s[8:11], s57 offen lds
v_mfma_f32_16x16x32_bf16 v[204:207], v[52:55], a[124:127], v[204:207]
s_add_u32 m0, s4, 45056
s_mov_b32 s57, 4718976
ds_read_b64_tr_b16 v[78:79], v3 offset:14336
v_mfma_f32_16x16x32_bf16 v[200:203], v[52:55], a[120:123], v[200:203]
ds_read_b128 a[20:23], v4 offset:9216
buffer_load_dwordx4 v8, s[12:15], s58 offen lds
v_mfma_f32_16x16x32_bf16 v[196:199], v[52:55], a[116:119], v[196:199]
s_add_u32 m0, s4, 49152
s_mov_b32 s58, 4718976
ds_read_b128 a[24:27], v4 offset:10240
v_mfma_f32_16x16x32_bf16 v[192:195], v[52:55], a[112:115], v[192:195]
v_rcp_f32_e64 v96, v96
v_mfma_f32_16x16x32_bf16 v[176:179], v[56:59], a[112:115], v[176:179]
v_rcp_f32_e64 v97, v97
v_mfma_f32_16x16x32_bf16 v[180:183], v[56:59], a[116:119], v[180:183]
v_rcp_f32_e64 v98, v98
v_mfma_f32_16x16x32_bf16 v[184:187], v[56:59], a[120:123], v[184:187]
v_rcp_f32_e64 v99, v99
v_mfma_f32_16x16x32_bf16 v[188:191], v[56:59], a[124:127], v[188:191]
s_waitcnt lgkmcnt(4)
v_rcp_f32 v128, v128
v_mfma_f32_16x16x32_bf16 v[220:223], v[60:63], a[124:127], v[220:223]
v_rcp_f32_e64 v129, v129
v_mfma_f32_16x16x32_bf16 v[216:219], v[60:63], a[120:123], v[216:219]
v_rcp_f32_e64 v130, v130
v_mfma_f32_16x16x32_bf16 v[212:215], v[60:63], a[116:119], v[212:215]
v_rcp_f32_e64 v131, v131
v_mfma_f32_16x16x32_bf16 v[208:211], v[60:63], a[112:115], v[208:211]
v_rcp_f32_e64 v100, v100
v_mfma_f32_16x16x32_bf16 v[160:163], v[64:67], a[128:131], v[160:163]
v_rcp_f32_e64 v101, v101
v_mfma_f32_16x16x32_bf16 v[164:167], v[64:67], a[132:135], v[164:167]
v_rcp_f32_e64 v102, v102
v_mfma_f32_16x16x32_bf16 v[168:171], v[64:67], a[136:139], v[168:171]
v_rcp_f32_e64 v103, v103
v_mfma_f32_16x16x32_bf16 v[172:175], v[64:67], a[140:143], v[172:175]
v_rcp_f32_e64 v132, v132
v_mfma_f32_16x16x32_bf16 v[204:207], v[68:71], a[140:143], v[204:207]
v_rcp_f32_e64 v133, v133
v_mfma_f32_16x16x32_bf16 v[200:203], v[68:71], a[136:139], v[200:203]
s_waitcnt vmcnt(8)
s_barrier
ds_read_b64_tr_b16 v[48:49], v0 offset:0
ds_read_b64_tr_b16 v[50:51], v0 offset:2048
v_mfma_f32_16x16x32_bf16 v[196:199], v[68:71], a[132:135], v[196:199]
ds_read_b64_tr_b16 v[52:53], v1 offset:0
v_mul_f32_e64 v96, v96, v112
v_mfma_f32_16x16x32_bf16 v[192:195], v[68:71], a[128:131], v[192:195]
ds_read_b64_tr_b16 v[54:55], v1 offset:2048
v_mul_f32_e64 v97, v97, v113
v_mfma_f32_16x16x32_bf16 v[176:179], v[72:75], a[128:131], v[176:179]
ds_read_b64_tr_b16 v[56:57], v0 offset:4096
v_mul_f32_e64 v98, v98, v114
v_mfma_f32_16x16x32_bf16 v[180:183], v[72:75], a[132:135], v[180:183]
ds_read_b64_tr_b16 v[58:59], v0 offset:6144
v_mul_f32_e64 v99, v99, v115
v_mfma_f32_16x16x32_bf16 v[184:187], v[72:75], a[136:139], v[184:187]
ds_read_b64_tr_b16 v[60:61], v1 offset:4096
v_mul_f32 v128, v128, v144
v_mfma_f32_16x16x32_bf16 v[188:191], v[72:75], a[140:143], v[188:191]
s_waitcnt lgkmcnt(7)
ds_read_b64_tr_b16 v[62:63], v1 offset:6144
v_mul_f32_e64 v129, v129, v145
v_mfma_f32_16x16x32_bf16 v[220:223], v[76:79], a[140:143], v[220:223]
ds_read_b64_tr_b16 v[64:65], v0 offset:8192
v_mul_f32_e64 v130, v130, v146
v_mfma_f32_16x16x32_bf16 v[216:219], v[76:79], a[136:139], v[216:219]
ds_read_b64_tr_b16 v[66:67], v0 offset:10240
v_mul_f32_e64 v131, v131, v147
v_mfma_f32_16x16x32_bf16 v[212:215], v[76:79], a[132:135], v[212:215]
ds_read_b64_tr_b16 v[68:69], v1 offset:8192
v_mul_f32 v100, v100, v116
v_mfma_f32_16x16x32_bf16 v[208:211], v[76:79], a[128:131], v[208:211]
s_waitcnt lgkmcnt(8)
ds_read_b64_tr_b16 v[70:71], v1 offset:10240
buffer_load_dwordx4 v8, s[8:11], s59 offen lds
v_mfma_f32_16x16x32_bf16 v[160:163], v[48:51], a[144:147], v[160:163]
s_add_u32 m0, s4, 53248
s_mov_b32 s59, 5013888
ds_read_b64_tr_b16 v[72:73], v0 offset:12288
v_mfma_f32_16x16x32_bf16 v[164:167], v[48:51], a[148:151], v[164:167]
ds_read_b64_tr_b16 v[74:75], v0 offset:14336
buffer_load_dwordx4 v8, s[12:15], s56 offen lds
v_mfma_f32_16x16x32_bf16 v[168:171], v[48:51], a[152:155], v[168:171]
s_add_u32 m0, s4, 57344
s_mov_b32 s56, 5013888
ds_read_b64_tr_b16 v[76:77], v1 offset:12288
v_mfma_f32_16x16x32_bf16 v[172:175], v[48:51], a[156:159], v[172:175]
s_waitcnt lgkmcnt(8)
ds_read_b64_tr_b16 v[78:79], v1 offset:14336
buffer_load_dwordx4 v8, s[8:11], s57 offen lds
v_mfma_f32_16x16x32_bf16 v[204:207], v[52:55], a[156:159], v[204:207]
s_add_u32 m0, s4, 61440
s_add_u32 s57, s62, 0
v_mul_f32_e64 v101, v101, v117
v_mfma_f32_16x16x32_bf16 v[200:203], v[52:55], a[152:155], v[200:203]
buffer_load_dwordx4 v8, s[12:15], s58 offen lds
v_mul_f32_e64 v102, v102, v118
v_mfma_f32_16x16x32_bf16 v[196:199], v[52:55], a[148:151], v[196:199]
s_add_u32 m0, s4, 65536
s_add_u32 s58, s62, 36864
v_mul_f32_e64 v103, v103, v119
v_mfma_f32_16x16x32_bf16 v[192:195], v[52:55], a[144:147], v[192:195]
v_rcp_f32_e64 v134, v134
v_mfma_f32_16x16x32_bf16 v[176:179], v[56:59], a[144:147], v[176:179]
v_rcp_f32_e64 v135, v135
v_mfma_f32_16x16x32_bf16 v[180:183], v[56:59], a[148:151], v[180:183]
v_rcp_f32_e64 v104, v104
v_mfma_f32_16x16x32_bf16 v[184:187], v[56:59], a[152:155], v[184:187]
v_rcp_f32_e64 v105, v105
v_mfma_f32_16x16x32_bf16 v[188:191], v[56:59], a[156:159], v[188:191]
s_waitcnt lgkmcnt(1)
v_rcp_f32 v106, v106
v_mfma_f32_16x16x32_bf16 v[220:223], v[60:63], a[156:159], v[220:223]
v_rcp_f32_e64 v107, v107
v_mfma_f32_16x16x32_bf16 v[216:219], v[60:63], a[152:155], v[216:219]
v_rcp_f32_e64 v136, v136
v_mfma_f32_16x16x32_bf16 v[212:215], v[60:63], a[148:151], v[212:215]
v_rcp_f32_e64 v137, v137
v_mfma_f32_16x16x32_bf16 v[208:211], v[60:63], a[144:147], v[208:211]
v_rcp_f32_e64 v138, v138
v_mfma_f32_16x16x32_bf16 v[160:163], v[64:67], a[160:163], v[160:163]
v_rcp_f32_e64 v139, v139
v_mfma_f32_16x16x32_bf16 v[164:167], v[64:67], a[164:167], v[164:167]
v_rcp_f32_e64 v108, v108
v_mfma_f32_16x16x32_bf16 v[168:171], v[64:67], a[168:171], v[168:171]
v_rcp_f32_e64 v109, v109
v_mfma_f32_16x16x32_bf16 v[172:175], v[64:67], a[172:175], v[172:175]
v_rcp_f32_e64 v110, v110
v_mfma_f32_16x16x32_bf16 v[204:207], v[68:71], a[172:175], v[204:207]
v_rcp_f32_e64 v111, v111
v_mfma_f32_16x16x32_bf16 v[200:203], v[68:71], a[168:171], v[200:203]
s_waitcnt vmcnt(8)
s_barrier
ds_read_b64_tr_b16 v[48:49], v0 offset:16384
ds_read_b64_tr_b16 v[50:51], v0 offset:18432
v_mfma_f32_16x16x32_bf16 v[196:199], v[68:71], a[164:167], v[196:199]
ds_read_b64_tr_b16 v[52:53], v1 offset:16384
v_mul_f32_e64 v132, v132, v148
v_mfma_f32_16x16x32_bf16 v[192:195], v[68:71], a[160:163], v[192:195]
ds_read_b64_tr_b16 v[54:55], v1 offset:18432
v_mul_f32_e64 v133, v133, v149
v_mfma_f32_16x16x32_bf16 v[176:179], v[72:75], a[160:163], v[176:179]
ds_read_b64_tr_b16 v[56:57], v0 offset:20480
v_mul_f32_e64 v134, v134, v150
v_mfma_f32_16x16x32_bf16 v[180:183], v[72:75], a[164:167], v[180:183]
ds_read_b64_tr_b16 v[58:59], v0 offset:22528
v_mul_f32_e64 v135, v135, v151
v_mfma_f32_16x16x32_bf16 v[184:187], v[72:75], a[168:171], v[184:187]
ds_read_b64_tr_b16 v[60:61], v1 offset:20480
v_mul_f32 v104, v104, v120
v_mfma_f32_16x16x32_bf16 v[188:191], v[72:75], a[172:175], v[188:191]
s_waitcnt lgkmcnt(7)
ds_read_b64_tr_b16 v[62:63], v1 offset:22528
v_mul_f32_e64 v105, v105, v121
v_mfma_f32_16x16x32_bf16 v[220:223], v[76:79], a[172:175], v[220:223]
ds_read_b64_tr_b16 v[64:65], v0 offset:24576
v_mul_f32_e64 v106, v106, v122
v_mfma_f32_16x16x32_bf16 v[216:219], v[76:79], a[168:171], v[216:219]
ds_read_b64_tr_b16 v[66:67], v0 offset:26624
v_mul_f32_e64 v107, v107, v123
v_mfma_f32_16x16x32_bf16 v[212:215], v[76:79], a[164:167], v[212:215]
ds_read_b64_tr_b16 v[68:69], v1 offset:24576
v_mul_f32 v136, v136, v152
v_mfma_f32_16x16x32_bf16 v[208:211], v[76:79], a[160:163], v[208:211]
s_waitcnt lgkmcnt(8)
ds_read_b64_tr_b16 v[70:71], v1 offset:26624
buffer_load_dwordx4 v8, s[8:11], s59 offen lds
v_mfma_f32_16x16x32_bf16 v[160:163], v[48:51], a[176:179], v[160:163]
s_add_u32 m0, s4, 69632
s_add_u32 s59, s62, 73728
ds_read_b64_tr_b16 v[72:73], v0 offset:28672
v_mfma_f32_16x16x32_bf16 v[164:167], v[48:51], a[180:183], v[164:167]
ds_read_b64_tr_b16 v[74:75], v0 offset:30720
buffer_load_dwordx4 v8, s[12:15], s56 offen lds
v_mfma_f32_16x16x32_bf16 v[168:171], v[48:51], a[184:187], v[168:171]
s_add_u32 m0, s4, 73728
s_add_u32 s56, s62, 110592
ds_read_b64_tr_b16 v[76:77], v1 offset:28672
v_mfma_f32_16x16x32_bf16 v[172:175], v[48:51], a[188:191], v[172:175]
s_waitcnt lgkmcnt(8)
ds_read_b64_tr_b16 v[78:79], v1 offset:30720
buffer_load_dwordx4 v10, s[16:19], s57 offen lds
v_mfma_f32_16x16x32_bf16 v[204:207], v[52:55], a[188:191], v[204:207]
s_add_u32 m0, s4, 77824
s_add_u32 s57, s63, 0
v_mul_f32_e64 v137, v137, v153
v_mfma_f32_16x16x32_bf16 v[200:203], v[52:55], a[184:187], v[200:203]
buffer_load_dwordx4 v10, s[16:19], s58 offen lds
v_mul_f32 v138, v138, v154
v_mfma_f32_16x16x32_bf16 v[196:199], v[52:55], a[180:183], v[196:199]
s_add_u32 m0, s4, 0
s_add_u32 s58, s62, 147456
v_mul_f32_e64 v139, v139, v155
v_mfma_f32_16x16x32_bf16 v[192:195], v[52:55], a[176:179], v[192:195]
v_rcp_f32_e64 v140, v140
v_mfma_f32_16x16x32_bf16 v[176:179], v[56:59], a[176:179], v[176:179]
v_rcp_f32_e64 v141, v141
v_mfma_f32_16x16x32_bf16 v[180:183], v[56:59], a[180:183], v[180:183]
v_rcp_f32_e64 v142, v142
v_mfma_f32_16x16x32_bf16 v[184:187], v[56:59], a[184:187], v[184:187]
v_rcp_f32_e64 v143, v143
v_mfma_f32_16x16x32_bf16 v[188:191], v[56:59], a[188:191], v[188:191]
s_waitcnt lgkmcnt(1)
v_mul_f32 v108, v108, v124
v_mul_f32_e64 v109, v109, v125
v_mfma_f32_16x16x32_bf16 v[220:223], v[60:63], a[188:191], v[220:223]
ds_read_b128 a[28:31], v4 offset:11264
v_mul_f32_e64 v110, v110, v126
v_mfma_f32_16x16x32_bf16 v[216:219], v[60:63], a[184:187], v[216:219]
v_mul_f32 v111, v111, v127
v_mul_f32 v140, v140, v156
v_mfma_f32_16x16x32_bf16 v[212:215], v[60:63], a[180:183], v[212:215]
ds_read_b128 a[32:35], v4 offset:16384
v_mul_f32_e64 v141, v141, v157
v_mfma_f32_16x16x32_bf16 v[208:211], v[60:63], a[176:179], v[208:211]
v_mul_f32 v142, v142, v158
v_mul_f32 v143, v143, v159
v_mfma_f32_16x16x32_bf16 v[160:163], v[64:67], a[192:195], v[160:163]
ds_read_b128 a[36:39], v4 offset:17408
v_cvt_pk_bf16_f32 v80, v96, v97
v_mfma_f32_16x16x32_bf16 v[164:167], v[64:67], a[196:199], v[164:167]
v_cvt_pk_bf16_f32 v81, v98, v99
v_cvt_pk_bf16_f32 v82, v128, v129
v_mfma_f32_16x16x32_bf16 v[168:171], v[64:67], a[200:203], v[168:171]
ds_read_b128 a[40:43], v4 offset:18432
v_cvt_pk_bf16_f32 v83, v130, v131
v_mfma_f32_16x16x32_bf16 v[172:175], v[64:67], a[204:207], v[172:175]
v_cvt_pk_bf16_f32 v84, v100, v101
v_cvt_pk_bf16_f32 v85, v102, v103
v_mfma_f32_16x16x32_bf16 v[204:207], v[68:71], a[204:207], v[204:207]
ds_read_b128 a[44:47], v4 offset:19456
v_cvt_pk_bf16_f32 v86, v132, v133
v_mfma_f32_16x16x32_bf16 v[200:203], v[68:71], a[200:203], v[200:203]
s_waitcnt vmcnt(8)
s_barrier
ds_read_b64_tr_b16 v[48:49], v0 offset:32768
ds_read_b64_tr_b16 v[50:51], v0 offset:34816
v_mfma_f32_16x16x32_bf16 v[196:199], v[68:71], a[196:199], v[196:199]
v_cvt_pk_bf16_f32 v87, v134, v135
v_cvt_pk_bf16_f32 v88, v104, v105
v_mfma_f32_16x16x32_bf16 v[192:195], v[68:71], a[192:195], v[192:195]
ds_read_b64_tr_b16 v[52:53], v1 offset:32768
v_cvt_pk_bf16_f32 v89, v106, v107
v_mfma_f32_16x16x32_bf16 v[176:179], v[72:75], a[192:195], v[176:179]
ds_read_b64_tr_b16 v[54:55], v1 offset:34816
v_cvt_pk_bf16_f32 v90, v136, v137
v_mfma_f32_16x16x32_bf16 v[180:183], v[72:75], a[196:199], v[180:183]
ds_read_b64_tr_b16 v[56:57], v0 offset:36864
v_cvt_pk_bf16_f32 v91, v138, v139
v_mfma_f32_16x16x32_bf16 v[184:187], v[72:75], a[200:203], v[184:187]
ds_read_b64_tr_b16 v[58:59], v0 offset:38912
v_cvt_pk_bf16_f32 v92, v108, v109
v_mfma_f32_16x16x32_bf16 v[188:191], v[72:75], a[204:207], v[188:191]
s_waitcnt lgkmcnt(7)
ds_read_b64_tr_b16 v[60:61], v1 offset:36864
v_cvt_pk_bf16_f32 v93, v110, v111
v_mfma_f32_16x16x32_bf16 v[220:223], v[76:79], a[204:207], v[220:223]
ds_read_b64_tr_b16 v[62:63], v1 offset:38912
v_cvt_pk_bf16_f32 v94, v140, v141
v_mfma_f32_16x16x32_bf16 v[216:219], v[76:79], a[200:203], v[216:219]
ds_read_b64_tr_b16 v[64:65], v0 offset:40960
v_cvt_pk_bf16_f32 v95, v142, v143
v_mfma_f32_16x16x32_bf16 v[212:215], v[76:79], a[196:199], v[212:215]
ds_read_b64_tr_b16 v[66:67], v0 offset:43008
ds_read_b64_tr_b16 v[68:69], v1 offset:40960
v_mfma_f32_16x16x32_bf16 v[208:211], v[76:79], a[192:195], v[208:211]
s_waitcnt lgkmcnt(9)
ds_read_b64_tr_b16 v[70:71], v1 offset:43008
buffer_load_dwordx4 v10, s[16:19], s59 offen lds
v_mfma_f32_16x16x32_bf16 v[160:163], v[48:51], a[208:211], v[160:163]
s_add_u32 m0, s4, 4096
s_add_u32 s59, s62, 184320
ds_read_b64_tr_b16 v[72:73], v0 offset:45056
v_mfma_f32_16x16x32_bf16 v[164:167], v[48:51], a[212:215], v[164:167]
ds_read_b64_tr_b16 v[74:75], v0 offset:47104
buffer_load_dwordx4 v10, s[16:19], s56 offen lds
v_mfma_f32_16x16x32_bf16 v[168:171], v[48:51], a[216:219], v[168:171]
s_add_u32 m0, s4, 8192
s_add_u32 s56, s62, 128
ds_read_b64_tr_b16 v[76:77], v1 offset:45056
v_mfma_f32_16x16x32_bf16 v[172:175], v[48:51], a[220:223], v[172:175]
s_waitcnt lgkmcnt(9)
ds_read_b64_tr_b16 v[78:79], v1 offset:47104
buffer_load_dwordx4 v10, s[16:19], s57 offen lds
v_mfma_f32_16x16x32_bf16 v[204:207], v[52:55], a[220:223], v[204:207]
s_add_u32 m0, s4, 12288
s_add_u32 s57, s62, 36992
ds_read_b128 a[48:51], v4 offset:24576
v_mfma_f32_16x16x32_bf16 v[200:203], v[52:55], a[216:219], v[200:203]
ds_read_b128 a[52:55], v4 offset:25600
buffer_load_dwordx4 v10, s[16:19], s58 offen lds
v_mfma_f32_16x16x32_bf16 v[196:199], v[52:55], a[212:215], v[196:199]
s_add_u32 m0, s4, 16384
s_add_u32 s58, s62, 73856
ds_read_b128 a[56:59], v4 offset:26624
v_mfma_f32_16x16x32_bf16 v[192:195], v[52:55], a[208:211], v[192:195]
ds_write_b128 v6, v[80:83] offset:32768
v_mfma_f32_16x16x32_bf16 v[176:179], v[56:59], a[208:211], v[176:179]
ds_write_b128 v6, v[84:87] offset:33792
v_mfma_f32_16x16x32_bf16 v[180:183], v[56:59], a[212:215], v[180:183]
ds_write_b128 v6, v[88:91] offset:34816
v_mfma_f32_16x16x32_bf16 v[184:187], v[56:59], a[216:219], v[184:187]
ds_write_b128 v6, v[92:95] offset:35840
v_mfma_f32_16x16x32_bf16 v[188:191], v[56:59], a[220:223], v[188:191]
s_waitcnt lgkmcnt(8)
ds_read_b128 a[60:63], v4 offset:27648
ds_read_b128 a[128:131], v5 offset:0
v_mfma_f32_16x16x32_bf16 v[220:223], v[60:63], a[220:223], v[220:223]
ds_read_b128 a[132:135], v5 offset:1024
ds_read_b128 a[136:139], v5 offset:2048
v_mfma_f32_16x16x32_bf16 v[216:219], v[60:63], a[216:219], v[216:219]
ds_read_b128 a[140:143], v5 offset:3072
v_add_u32 v5, 0x20000, v1
v_mfma_f32_16x16x32_bf16 v[212:215], v[60:63], a[212:215], v[212:215]
v_mfma_f32_16x16x32_bf16 v[208:211], v[60:63], a[208:211], v[208:211]
v_mfma_f32_16x16x32_bf16 v[160:163], v[64:67], a[224:227], v[160:163]
v_mfma_f32_16x16x32_bf16 v[164:167], v[64:67], a[228:231], v[164:167]
v_mfma_f32_16x16x32_bf16 v[168:171], v[64:67], a[232:235], v[168:171]
v_mfma_f32_16x16x32_bf16 v[172:175], v[64:67], a[236:239], v[172:175]
v_mfma_f32_16x16x32_bf16 v[204:207], v[68:71], a[236:239], v[204:207]
v_mfma_f32_16x16x32_bf16 v[200:203], v[68:71], a[232:235], v[200:203]
s_waitcnt vmcnt(8) lgkmcnt(1)
s_barrier
ds_read_b64_tr_b16 v[48:49], v0 offset:49152
ds_read_b64_tr_b16 v[50:51], v0 offset:51200
v_mfma_f32_16x16x32_bf16 v[196:199], v[68:71], a[228:231], v[196:199]
ds_read_b64_tr_b16 v[52:53], v1 offset:49152
ds_read_b64_tr_b16 v[54:55], v1 offset:51200
v_mfma_f32_16x16x32_bf16 v[192:195], v[68:71], a[224:227], v[192:195]
ds_read_b64_tr_b16 v[56:57], v0 offset:53248
ds_read_b64_tr_b16 v[58:59], v0 offset:55296
v_mfma_f32_16x16x32_bf16 v[176:179], v[72:75], a[224:227], v[176:179]
ds_read_b64_tr_b16 v[60:61], v1 offset:53248
ds_read_b64_tr_b16 v[62:63], v1 offset:55296
v_mfma_f32_16x16x32_bf16 v[180:183], v[72:75], a[228:231], v[180:183]
ds_read_b64_tr_b16 v[64:65], v0 offset:57344
ds_read_b64_tr_b16 v[66:67], v0 offset:59392
v_mfma_f32_16x16x32_bf16 v[184:187], v[72:75], a[232:235], v[184:187]
ds_read_b64_tr_b16 v[68:69], v1 offset:57344
ds_read_b64_tr_b16 v[70:71], v1 offset:59392
v_mfma_f32_16x16x32_bf16 v[188:191], v[72:75], a[236:239], v[188:191]
ds_read_b64_tr_b16 v[72:73], v0 offset:61440
ds_read_b64_tr_b16 v[74:75], v0 offset:63488
v_mfma_f32_16x16x32_bf16 v[220:223], v[76:79], a[236:239], v[220:223]
ds_read_b128 a[64:67], v4 offset:32768
ds_read_b128 a[68:71], v4 offset:33792
v_mfma_f32_16x16x32_bf16 v[216:219], v[76:79], a[232:235], v[216:219]
ds_read_b128 a[72:75], v4 offset:34816
ds_read_b128 a[76:79], v4 offset:35840
v_mfma_f32_16x16x32_bf16 v[212:215], v[76:79], a[228:231], v[212:215]
ds_read_b128 a[80:83], v4 offset:40960
ds_read_b128 a[84:87], v4 offset:41984
v_mfma_f32_16x16x32_bf16 v[208:211], v[76:79], a[224:227], v[208:211]
s_waitcnt lgkmcnt(15)
ds_read_b64_tr_b16 v[76:77], v1 offset:61440
buffer_load_dwordx4 v10, s[16:19], s59 offen lds
v_mfma_f32_16x16x32_bf16 v[160:163], v[48:51], a[240:243], v[160:163]
s_add_u32 m0, s4, 20480
s_add_u32 s59, s62, 110720
ds_read_b64_tr_b16 v[78:79], v1 offset:63488
v_mfma_f32_16x16x32_bf16 v[164:167], v[48:51], a[244:247], v[164:167]
ds_read_b128 a[88:91], v4 offset:43008
buffer_load_dwordx4 v10, s[16:19], s56 offen lds
v_mfma_f32_16x16x32_bf16 v[168:171], v[48:51], a[248:251], v[168:171]
s_add_u32 m0, s4, 24576
s_add_u32 s56, s63, 128
ds_read_b128 a[92:95], v4 offset:44032
v_mfma_f32_16x16x32_bf16 v[172:175], v[48:51], a[252:255], v[172:175]
buffer_load_dwordx4 v10, s[16:19], s57 offen lds
v_mfma_f32_16x16x32_bf16 v[204:207], v[52:55], a[252:255], v[204:207]
s_add_u32 m0, s4, 28672
s_add_u32 s57, s62, 147584
v_mfma_f32_16x16x32_bf16 v[200:203], v[52:55], a[248:251], v[200:203]
buffer_load_dwordx4 v10, s[16:19], s58 offen lds
v_mfma_f32_16x16x32_bf16 v[196:199], v[52:55], a[244:247], v[196:199]
s_add_u32 m0, s4, 32768
s_add_u32 s58, s62, 184448
v_mfma_f32_16x16x32_bf16 v[192:195], v[52:55], a[240:243], v[192:195]
s_waitcnt lgkmcnt(4)
v_mfma_f32_16x16x32_bf16 v[176:179], v[56:59], a[240:243], v[176:179]
v_mfma_f32_16x16x32_bf16 v[180:183], v[56:59], a[244:247], v[180:183]
v_mfma_f32_16x16x32_bf16 v[184:187], v[56:59], a[248:251], v[184:187]
v_mfma_f32_16x16x32_bf16 v[188:191], v[56:59], a[252:255], v[188:191]
v_mfma_f32_16x16x32_bf16 v[220:223], v[60:63], a[252:255], v[220:223]
v_mfma_f32_16x16x32_bf16 v[216:219], v[60:63], a[248:251], v[216:219]
v_mfma_f32_16x16x32_bf16 v[212:215], v[60:63], a[244:247], v[212:215]
v_mfma_f32_16x16x32_bf16 v[208:211], v[60:63], a[240:243], v[208:211]
v_mfma_f32_16x16x32_bf16 v[160:163], v[64:67], v[16:19], v[160:163]
v_mfma_f32_16x16x32_bf16 v[164:167], v[64:67], v[20:23], v[164:167]
v_mfma_f32_16x16x32_bf16 v[168:171], v[64:67], v[24:27], v[168:171]
v_mfma_f32_16x16x32_bf16 v[172:175], v[64:67], v[28:31], v[172:175]
v_mfma_f32_16x16x32_bf16 v[204:207], v[68:71], v[28:31], v[204:207]
v_mfma_f32_16x16x32_bf16 v[200:203], v[68:71], v[24:27], v[200:203]
s_waitcnt vmcnt(8)
s_barrier
ds_read_b64_tr_b16 v[48:49], v2 offset:0
ds_read_b64_tr_b16 v[50:51], v2 offset:2048
v_mfma_f32_16x16x32_bf16 v[196:199], v[68:71], v[20:23], v[196:199]
ds_read_b64_tr_b16 v[52:53], v3 offset:0
ds_read_b64_tr_b16 v[54:55], v3 offset:2048
v_mfma_f32_16x16x32_bf16 v[192:195], v[68:71], v[16:19], v[192:195]
ds_read_b64_tr_b16 v[56:57], v2 offset:4096
ds_read_b64_tr_b16 v[58:59], v2 offset:6144
v_mfma_f32_16x16x32_bf16 v[176:179], v[72:75], v[16:19], v[176:179]
ds_read_b64_tr_b16 v[60:61], v3 offset:4096
ds_read_b64_tr_b16 v[62:63], v3 offset:6144
v_mfma_f32_16x16x32_bf16 v[180:183], v[72:75], v[20:23], v[180:183]
ds_read_b64_tr_b16 v[64:65], v2 offset:8192
ds_read_b64_tr_b16 v[66:67], v2 offset:10240
v_mfma_f32_16x16x32_bf16 v[184:187], v[72:75], v[24:27], v[184:187]
ds_read_b64_tr_b16 v[68:69], v3 offset:8192
ds_read_b64_tr_b16 v[70:71], v3 offset:10240
v_mfma_f32_16x16x32_bf16 v[188:191], v[72:75], v[28:31], v[188:191]
s_waitcnt lgkmcnt(12)
ds_read_b64_tr_b16 v[72:73], v2 offset:12288
ds_read_b64_tr_b16 v[74:75], v2 offset:14336
v_mfma_f32_16x16x32_bf16 v[220:223], v[76:79], v[28:31], v[220:223]
v_mfma_f32_16x16x32_bf16 v[216:219], v[76:79], v[24:27], v[216:219]
v_mfma_f32_16x16x32_bf16 v[212:215], v[76:79], v[20:23], v[212:215]
v_mfma_f32_16x16x32_bf16 v[208:211], v[76:79], v[16:19], v[208:211]
s_waitcnt lgkmcnt(10)
ds_read_b64_tr_b16 v[76:77], v3 offset:12288
buffer_load_dwordx4 v10, s[16:19], s59 offen lds
v_mfma_f32_16x16x32_bf16 v[160:163], v[48:51], v[32:35], v[160:163]
s_add_u32 m0, s4, 36864
s_add_u32 s59, s62, 221184
ds_read_b64_tr_b16 v[78:79], v3 offset:14336
v_mfma_f32_16x16x32_bf16 v[164:167], v[48:51], v[36:39], v[164:167]
buffer_load_dwordx4 v10, s[16:19], s56 offen lds
v_mfma_f32_16x16x32_bf16 v[168:171], v[48:51], v[40:43], v[168:171]
s_add_u32 m0, s4, 40960
s_add_u32 s56, s62, 258048
v_mfma_f32_16x16x32_bf16 v[172:175], v[48:51], v[44:47], v[172:175]
buffer_load_dwordx4 v10, s[16:19], s57 offen lds
v_mfma_f32_16x16x32_bf16 v[204:207], v[52:55], v[44:47], v[204:207]
s_add_u32 m0, s4, 45056
s_add_u32 s57, s62, 221312
v_mfma_f32_16x16x32_bf16 v[200:203], v[52:55], v[40:43], v[200:203]
buffer_load_dwordx4 v10, s[16:19], s58 offen lds
v_mfma_f32_16x16x32_bf16 v[196:199], v[52:55], v[36:39], v[196:199]
s_add_u32 m0, s4, 49152
s_add_u32 s58, s62, 258176
v_mfma_f32_16x16x32_bf16 v[192:195], v[52:55], v[32:35], v[192:195]
s_waitcnt lgkmcnt(2)
v_exp_f32_e64 v160, -v160
v_mfma_f32_16x16x32_bf16 v[176:179], v[56:59], v[32:35], v[176:179]
v_exp_f32_e64 v161, -v161
v_mfma_f32_16x16x32_bf16 v[180:183], v[56:59], v[36:39], v[180:183]
v_exp_f32_e64 v162, -v162
v_mfma_f32_16x16x32_bf16 v[184:187], v[56:59], v[40:43], v[184:187]
v_exp_f32_e64 v163, -v163
v_mfma_f32_16x16x32_bf16 v[188:191], v[56:59], v[44:47], v[188:191]
v_exp_f32_e64 v192, -v192
v_mfma_f32_16x16x32_bf16 v[220:223], v[60:63], v[44:47], v[220:223]
v_exp_f32_e64 v193, -v193
v_mfma_f32_16x16x32_bf16 v[216:219], v[60:63], v[40:43], v[216:219]
v_exp_f32_e64 v194, -v194
v_mfma_f32_16x16x32_bf16 v[212:215], v[60:63], v[36:39], v[212:215]
v_exp_f32_e64 v195, -v195
v_mfma_f32_16x16x32_bf16 v[208:211], v[60:63], v[32:35], v[208:211]
v_exp_f32_e64 v164, -v164
v_mfma_f32_16x16x32_bf16 v[224:227], v[64:67], a[0:3], 0
v_exp_f32_e64 v165, -v165
v_mfma_f32_16x16x32_bf16 v[228:231], v[64:67], a[4:7], 0
v_exp_f32_e64 v166, -v166
v_mfma_f32_16x16x32_bf16 v[232:235], v[64:67], a[8:11], 0
v_exp_f32_e64 v167, -v167
v_mfma_f32_16x16x32_bf16 v[236:239], v[64:67], a[12:15], 0
v_exp_f32_e64 v196, -v196
v_mfma_f32_16x16x32_bf16 v[252:255], v[68:71], a[12:15], 0
v_exp_f32_e64 v197, -v197
v_mfma_f32_16x16x32_bf16 v[248:251], v[68:71], a[8:11], 0
s_waitcnt vmcnt(8)
s_barrier
ds_read_b64_tr_b16 v[48:49], v0 offset:0
ds_read_b64_tr_b16 v[50:51], v0 offset:2048
v_mfma_f32_16x16x32_bf16 v[244:247], v[68:71], a[4:7], 0
ds_read_b64_tr_b16 v[52:53], v1 offset:0
ds_read_b64_tr_b16 v[54:55], v1 offset:2048
v_mfma_f32_16x16x32_bf16 v[240:243], v[68:71], a[0:3], 0
ds_read_b64_tr_b16 v[56:57], v0 offset:4096
ds_read_b64_tr_b16 v[58:59], v0 offset:6144
v_mfma_f32_16x16x32_bf16 v[224:227], v[72:75], a[16:19], v[224:227]
ds_read_b64_tr_b16 v[60:61], v1 offset:4096
ds_read_b64_tr_b16 v[62:63], v1 offset:6144
v_mfma_f32_16x16x32_bf16 v[228:231], v[72:75], a[20:23], v[228:231]
ds_read_b64_tr_b16 v[64:65], v0 offset:8192
ds_read_b64_tr_b16 v[66:67], v0 offset:10240
v_mfma_f32_16x16x32_bf16 v[232:235], v[72:75], a[24:27], v[232:235]
ds_read_b64_tr_b16 v[68:69], v1 offset:8192
ds_read_b64_tr_b16 v[70:71], v1 offset:10240
v_mfma_f32_16x16x32_bf16 v[236:239], v[72:75], a[28:31], v[236:239]
s_waitcnt lgkmcnt(12)
ds_read_b64_tr_b16 v[72:73], v0 offset:12288
ds_read_b64_tr_b16 v[74:75], v0 offset:14336
v_mfma_f32_16x16x32_bf16 v[252:255], v[76:79], a[28:31], v[252:255]
v_exp_f32_e64 v198, -v198
v_mfma_f32_16x16x32_bf16 v[248:251], v[76:79], a[24:27], v[248:251]
v_exp_f32_e64 v199, -v199
v_mfma_f32_16x16x32_bf16 v[244:247], v[76:79], a[20:23], v[244:247]
v_exp_f32_e64 v168, -v168
v_mfma_f32_16x16x32_bf16 v[240:243], v[76:79], a[16:19], v[240:243]
s_waitcnt lgkmcnt(10)
ds_read_b64_tr_b16 v[76:77], v1 offset:12288
buffer_load_dwordx4 v10, s[16:19], s59 offen lds
v_mfma_f32_16x16x32_bf16 v[224:227], v[48:51], a[32:35], v[224:227]
s_add_u32 m0, s4, 53248
s_add_u32 s59, s62, 256
ds_read_b64_tr_b16 v[78:79], v1 offset:14336
v_mfma_f32_16x16x32_bf16 v[228:231], v[48:51], a[36:39], v[228:231]
buffer_load_dwordx4 v10, s[16:19], s56 offen lds
v_add_f32 v160, 1.0, v160
v_mfma_f32_16x16x32_bf16 v[232:235], v[48:51], a[40:43], v[232:235]
s_add_u32 m0, s4, 57344
s_add_u32 s56, s62, 37120
v_add_f32_e64 v161, 1.0, v161
v_mfma_f32_16x16x32_bf16 v[236:239], v[48:51], a[44:47], v[236:239]
buffer_load_dwordx4 v10, s[16:19], s57 offen lds
v_add_f32_e64 v162, 1.0, v162
v_mfma_f32_16x16x32_bf16 v[252:255], v[52:55], a[44:47], v[252:255]
s_add_u32 m0, s4, 61440
s_add_u32 s57, s62, 73984
v_add_f32_e64 v163, 1.0, v163
v_mfma_f32_16x16x32_bf16 v[248:251], v[52:55], a[40:43], v[248:251]
buffer_load_dwordx4 v10, s[16:19], s58 offen lds
v_add_f32_e64 v192, 1.0, v192
v_mfma_f32_16x16x32_bf16 v[244:247], v[52:55], a[36:39], v[244:247]
s_add_u32 m0, s4, 65536
s_add_u32 s58, s62, 110848
v_add_f32 v193, 1.0, v193
v_mfma_f32_16x16x32_bf16 v[240:243], v[52:55], a[32:35], v[240:243]
s_waitcnt lgkmcnt(2)
v_exp_f32_e64 v169, -v169
v_mfma_f32_16x16x32_bf16 v[224:227], v[56:59], a[48:51], v[224:227]
v_exp_f32_e64 v170, -v170
v_mfma_f32_16x16x32_bf16 v[228:231], v[56:59], a[52:55], v[228:231]
v_exp_f32_e64 v171, -v171
v_mfma_f32_16x16x32_bf16 v[232:235], v[56:59], a[56:59], v[232:235]
v_exp_f32_e64 v200, -v200
v_mfma_f32_16x16x32_bf16 v[236:239], v[56:59], a[60:63], v[236:239]
v_exp_f32_e64 v201, -v201
v_mfma_f32_16x16x32_bf16 v[252:255], v[60:63], a[60:63], v[252:255]
v_exp_f32_e64 v202, -v202
v_mfma_f32_16x16x32_bf16 v[248:251], v[60:63], a[56:59], v[248:251]
v_exp_f32_e64 v203, -v203
v_mfma_f32_16x16x32_bf16 v[244:247], v[60:63], a[52:55], v[244:247]
v_exp_f32_e64 v172, -v172
v_mfma_f32_16x16x32_bf16 v[240:243], v[60:63], a[48:51], v[240:243]
v_exp_f32_e64 v173, -v173
v_mfma_f32_16x16x32_bf16 v[224:227], v[64:67], a[128:131], v[224:227]
v_exp_f32_e64 v174, -v174
v_mfma_f32_16x16x32_bf16 v[228:231], v[64:67], a[132:135], v[228:231]
v_exp_f32_e64 v175, -v175
v_mfma_f32_16x16x32_bf16 v[232:235], v[64:67], a[136:139], v[232:235]
v_exp_f32_e64 v204, -v204
v_mfma_f32_16x16x32_bf16 v[236:239], v[64:67], a[140:143], v[236:239]
v_exp_f32_e64 v205, -v205
v_mfma_f32_16x16x32_bf16 v[252:255], v[68:71], a[140:143], v[252:255]
v_exp_f32_e64 v206, -v206
v_mfma_f32_16x16x32_bf16 v[248:251], v[68:71], a[136:139], v[248:251]
s_waitcnt vmcnt(8)
s_barrier
ds_read_b64_tr_b16 v[48:49], v0 offset:16384
ds_read_b64_tr_b16 v[50:51], v0 offset:18432
v_mfma_f32_16x16x32_bf16 v[244:247], v[68:71], a[132:135], v[244:247]
ds_read_b64_tr_b16 v[52:53], v1 offset:16384
ds_read_b64_tr_b16 v[54:55], v1 offset:18432
v_mfma_f32_16x16x32_bf16 v[240:243], v[68:71], a[128:131], v[240:243]
ds_read_b64_tr_b16 v[56:57], v0 offset:20480
ds_read_b64_tr_b16 v[58:59], v0 offset:22528
v_mfma_f32_16x16x32_bf16 v[224:227], v[72:75], a[64:67], v[224:227]
ds_read_b64_tr_b16 v[60:61], v1 offset:20480
ds_read_b64_tr_b16 v[62:63], v1 offset:22528
v_mfma_f32_16x16x32_bf16 v[228:231], v[72:75], a[68:71], v[228:231]
ds_read_b64_tr_b16 v[64:65], v0 offset:24576
ds_read_b64_tr_b16 v[66:67], v0 offset:26624
v_mfma_f32_16x16x32_bf16 v[232:235], v[72:75], a[72:75], v[232:235]
ds_read_b64_tr_b16 v[68:69], v1 offset:24576
ds_read_b64_tr_b16 v[70:71], v1 offset:26624
v_mfma_f32_16x16x32_bf16 v[236:239], v[72:75], a[76:79], v[236:239]
s_waitcnt lgkmcnt(12)
ds_read_b64_tr_b16 v[72:73], v0 offset:28672
ds_read_b64_tr_b16 v[74:75], v0 offset:30720
v_mfma_f32_16x16x32_bf16 v[252:255], v[76:79], a[76:79], v[252:255]
v_exp_f32_e64 v207, -v207
v_mfma_f32_16x16x32_bf16 v[248:251], v[76:79], a[72:75], v[248:251]
v_add_f32 v194, 1.0, v194
v_add_f32_e64 v195, 1.0, v195
v_mfma_f32_16x16x32_bf16 v[244:247], v[76:79], a[68:71], v[244:247]
v_add_f32 v164, 1.0, v164
v_mfma_f32_16x16x32_bf16 v[240:243], v[76:79], a[64:67], v[240:243]
s_waitcnt lgkmcnt(10)
ds_read_b64_tr_b16 v[76:77], v1 offset:28672
buffer_load_dwordx4 v10, s[16:19], s59 offen lds
v_mfma_f32_16x16x32_bf16 v[224:227], v[48:51], a[80:83], v[224:227]
s_add_u32 m0, s4, 69632
s_add_u32 s59, s62, 147712
ds_read_b64_tr_b16 v[78:79], v1 offset:30720
v_mfma_f32_16x16x32_bf16 v[228:231], v[48:51], a[84:87], v[228:231]
buffer_load_dwordx4 v10, s[16:19], s56 offen lds
v_add_f32_e64 v165, 1.0, v165
v_mfma_f32_16x16x32_bf16 v[232:235], v[48:51], a[88:91], v[232:235]
s_add_u32 m0, s4, 73728
s_add_u32 s56, s62, 184576
v_add_f32_e64 v166, 1.0, v166
v_mfma_f32_16x16x32_bf16 v[236:239], v[48:51], a[92:95], v[236:239]
buffer_load_dwordx4 v10, s[16:19], s57 offen lds
v_add_f32_e64 v167, 1.0, v167
v_mfma_f32_16x16x32_bf16 v[252:255], v[52:55], a[92:95], v[252:255]
s_add_u32 m0, s4, 77824
s_add_u32 s57, s62, 221440
v_add_f32_e64 v196, 1.0, v196
v_mfma_f32_16x16x32_bf16 v[248:251], v[52:55], a[88:91], v[248:251]
buffer_load_dwordx4 v10, s[16:19], s58 offen lds
v_add_f32 v197, 1.0, v197
v_mfma_f32_16x16x32_bf16 v[244:247], v[52:55], a[84:87], v[244:247]
s_add_u32 m0, s4, 0
s_add_u32 s58, s62, 258304
v_add_f32_e64 v198, 1.0, v198
v_mfma_f32_16x16x32_bf16 v[240:243], v[52:55], a[80:83], v[240:243]
s_waitcnt lgkmcnt(2)
v_add_f32 v199, 1.0, v199
v_add_f32_e64 v168, 1.0, v168
v_mfma_f32_16x16x32_bf16 v[96:99], v[56:59], a[0:3], 0
v_add_f32_e64 v169, 1.0, v169
v_mfma_f32_16x16x32_bf16 v[100:103], v[56:59], a[4:7], 0
v_add_f32 v170, 1.0, v170
v_add_f32 v171, 1.0, v171
v_mfma_f32_16x16x32_bf16 v[104:107], v[56:59], a[8:11], 0
v_add_f32_e64 v200, 1.0, v200
v_mfma_f32_16x16x32_bf16 v[108:111], v[56:59], a[12:15], 0
v_add_f32 v201, 1.0, v201
v_add_f32 v202, 1.0, v202
v_mfma_f32_16x16x32_bf16 v[124:127], v[60:63], a[12:15], 0
v_add_f32_e64 v203, 1.0, v203
v_mfma_f32_16x16x32_bf16 v[120:123], v[60:63], a[8:11], 0
v_add_f32 v172, 1.0, v172
v_add_f32 v173, 1.0, v173
v_mfma_f32_16x16x32_bf16 v[116:119], v[60:63], a[4:7], 0
v_add_f32_e64 v174, 1.0, v174
v_mfma_f32_16x16x32_bf16 v[112:115], v[60:63], a[0:3], 0
v_add_f32 v175, 1.0, v175
v_add_f32 v204, 1.0, v204
v_mfma_f32_16x16x32_bf16 v[96:99], v[64:67], a[16:19], v[96:99]
v_add_f32_e64 v205, 1.0, v205
v_mfma_f32_16x16x32_bf16 v[100:103], v[64:67], a[20:23], v[100:103]
v_add_f32 v206, 1.0, v206
v_add_f32 v207, 1.0, v207
v_mfma_f32_16x16x32_bf16 v[104:107], v[64:67], a[24:27], v[104:107]
v_rcp_f32_e64 v160, v160
v_mfma_f32_16x16x32_bf16 v[108:111], v[64:67], a[28:31], v[108:111]
v_rcp_f32_e64 v161, v161
v_mfma_f32_16x16x32_bf16 v[124:127], v[68:71], a[28:31], v[124:127]
v_rcp_f32_e64 v162, v162
v_mfma_f32_16x16x32_bf16 v[120:123], v[68:71], a[24:27], v[120:123]
s_waitcnt vmcnt(8)
s_barrier
ds_read_b64_tr_b16 v[48:49], v0 offset:32768
ds_read_b64_tr_b16 v[50:51], v0 offset:34816
v_mfma_f32_16x16x32_bf16 v[116:119], v[68:71], a[20:23], v[116:119]
ds_read_b64_tr_b16 v[52:53], v1 offset:32768
ds_read_b64_tr_b16 v[54:55], v1 offset:34816
v_mfma_f32_16x16x32_bf16 v[112:115], v[68:71], a[16:19], v[112:115]
ds_read_b64_tr_b16 v[56:57], v0 offset:36864
ds_read_b64_tr_b16 v[58:59], v0 offset:38912
v_mfma_f32_16x16x32_bf16 v[96:99], v[72:75], a[32:35], v[96:99]
ds_read_b64_tr_b16 v[60:61], v1 offset:36864
ds_read_b64_tr_b16 v[62:63], v1 offset:38912
v_mfma_f32_16x16x32_bf16 v[100:103], v[72:75], a[36:39], v[100:103]
ds_read_b64_tr_b16 v[64:65], v0 offset:40960
ds_read_b64_tr_b16 v[66:67], v0 offset:43008
v_mfma_f32_16x16x32_bf16 v[104:107], v[72:75], a[40:43], v[104:107]
ds_read_b64_tr_b16 v[68:69], v1 offset:40960
ds_read_b64_tr_b16 v[70:71], v1 offset:43008
v_mfma_f32_16x16x32_bf16 v[108:111], v[72:75], a[44:47], v[108:111]
s_waitcnt lgkmcnt(12)
v_rcp_f32 v163, v163
v_mfma_f32_16x16x32_bf16 v[124:127], v[76:79], a[44:47], v[124:127]
v_rcp_f32_e64 v192, v192
v_mfma_f32_16x16x32_bf16 v[120:123], v[76:79], a[40:43], v[120:123]
v_rcp_f32_e64 v193, v193
v_mfma_f32_16x16x32_bf16 v[116:119], v[76:79], a[36:39], v[116:119]
v_rcp_f32 v194, v194
v_mfma_f32_16x16x32_bf16 v[112:115], v[76:79], a[32:35], v[112:115]
s_waitcnt lgkmcnt(8)
buffer_load_dwordx4 v10, s[16:19], s59 offen lds
v_mul_f32_e64 v160, v160, v176
v_mfma_f32_16x16x32_bf16 v[96:99], v[48:51], a[48:51], v[96:99]
s_add_u32 m0, s4, 4096
s_add_u32 s59, s63, 256
v_mul_f32_e64 v161, v161, v177
v_mfma_f32_16x16x32_bf16 v[100:103], v[48:51], a[52:55], v[100:103]
buffer_load_dwordx4 v10, s[16:19], s56 offen lds
v_mul_f32_e64 v162, v162, v178
v_mfma_f32_16x16x32_bf16 v[104:107], v[48:51], a[56:59], v[104:107]
s_add_u32 m0, s4, 8192
s_add_u32 s56, s62, 384
v_mul_f32_e64 v163, v163, v179
v_mfma_f32_16x16x32_bf16 v[108:111], v[48:51], a[60:63], v[108:111]
buffer_load_dwordx4 v10, s[16:19], s57 offen lds
v_mul_f32_e64 v192, v192, v208
v_mfma_f32_16x16x32_bf16 v[124:127], v[52:55], a[60:63], v[124:127]
s_add_u32 m0, s4, 12288
s_add_u32 s57, s62, 37248
v_mul_f32_e64 v193, v193, v209
v_mfma_f32_16x16x32_bf16 v[120:123], v[52:55], a[56:59], v[120:123]
buffer_load_dwordx4 v10, s[16:19], s58 offen lds
v_mul_f32_e64 v194, v194, v210
v_mfma_f32_16x16x32_bf16 v[116:119], v[52:55], a[52:55], v[116:119]
s_add_u32 m0, s4, 16384
s_add_u32 s58, s62, 74112
v_cvt_pk_bf16_f32 v80, v160, v161
v_mfma_f32_16x16x32_bf16 v[112:115], v[52:55], a[48:51], v[112:115]
s_waitcnt lgkmcnt(0)
v_rcp_f32 v195, v195
v_mfma_f32_16x16x32_bf16 v[96:99], v[56:59], a[128:131], v[96:99]
v_rcp_f32_e64 v164, v164
v_mfma_f32_16x16x32_bf16 v[100:103], v[56:59], a[132:135], v[100:103]
v_rcp_f32_e64 v165, v165
v_mfma_f32_16x16x32_bf16 v[104:107], v[56:59], a[136:139], v[104:107]
v_rcp_f32_e64 v166, v166
v_mfma_f32_16x16x32_bf16 v[108:111], v[56:59], a[140:143], v[108:111]
v_rcp_f32_e64 v167, v167
v_mfma_f32_16x16x32_bf16 v[124:127], v[60:63], a[140:143], v[124:127]
v_rcp_f32_e64 v196, v196
v_mfma_f32_16x16x32_bf16 v[120:123], v[60:63], a[136:139], v[120:123]
v_rcp_f32_e64 v197, v197
v_mfma_f32_16x16x32_bf16 v[116:119], v[60:63], a[132:135], v[116:119]
v_rcp_f32_e64 v198, v198
v_mfma_f32_16x16x32_bf16 v[112:115], v[60:63], a[128:131], v[112:115]
v_rcp_f32_e64 v199, v199
v_mfma_f32_16x16x32_bf16 v[96:99], v[64:67], a[64:67], v[96:99]
v_rcp_f32_e64 v168, v168
v_mfma_f32_16x16x32_bf16 v[100:103], v[64:67], a[68:71], v[100:103]
v_rcp_f32_e64 v169, v169
v_mfma_f32_16x16x32_bf16 v[104:107], v[64:67], a[72:75], v[104:107]
v_rcp_f32_e64 v170, v170
v_mfma_f32_16x16x32_bf16 v[108:111], v[64:67], a[76:79], v[108:111]
v_rcp_f32_e64 v171, v171
v_mfma_f32_16x16x32_bf16 v[124:127], v[68:71], a[76:79], v[124:127]
v_rcp_f32_e64 v200, v200
v_mfma_f32_16x16x32_bf16 v[120:123], v[68:71], a[72:75], v[120:123]
v_rcp_f32_e64 v201, v201
v_mfma_f32_16x16x32_bf16 v[116:119], v[68:71], a[68:71], v[116:119]
v_rcp_f32_e64 v202, v202
v_mfma_f32_16x16x32_bf16 v[112:115], v[68:71], a[64:67], v[112:115]
v_rcp_f32 v203, v203
v_rcp_f32 v172, v172
v_rcp_f32 v173, v173
v_rcp_f32 v174, v174
v_rcp_f32 v175, v175
v_rcp_f32 v204, v204
v_rcp_f32 v205, v205
v_rcp_f32 v206, v206
v_rcp_f32 v207, v207
v_mul_f32 v195, v195, v211
v_mul_f32 v164, v164, v180
v_mul_f32 v165, v165, v181
v_mul_f32 v166, v166, v182
v_mul_f32 v167, v167, v183
v_mul_f32 v196, v196, v212
v_mul_f32 v197, v197, v213
v_mul_f32 v198, v198, v214
v_mul_f32 v199, v199, v215
v_mul_f32 v168, v168, v184
v_mul_f32 v169, v169, v185
v_mul_f32 v170, v170, v186
v_mul_f32 v171, v171, v187
v_mul_f32 v200, v200, v216
v_mul_f32 v201, v201, v217
v_mul_f32 v202, v202, v218
v_mul_f32 v203, v203, v219
v_mul_f32 v172, v172, v188
v_mul_f32 v173, v173, v189
v_mul_f32 v174, v174, v190
v_mul_f32 v175, v175, v191
v_mul_f32 v204, v204, v220
v_mul_f32 v205, v205, v221
v_mul_f32_e64 v206, v206, v222
v_cvt_pk_bf16_f32 v81, v162, v163
v_cvt_pk_bf16_f32 v82, v192, v193
v_cvt_pk_bf16_f32 v83, v194, v195
v_mul_f32_e64 v207, v207, v223
v_cvt_pk_bf16_f32 v84, v164, v165
v_cvt_pk_bf16_f32 v85, v166, v167
v_cvt_pk_bf16_f32 v86, v196, v197
v_cvt_pk_bf16_f32 v87, v198, v199
v_cvt_pk_bf16_f32 v88, v168, v169
v_cvt_pk_bf16_f32 v89, v170, v171
v_cvt_pk_bf16_f32 v90, v200, v201
v_cvt_pk_bf16_f32 v91, v202, v203
v_cvt_pk_bf16_f32 v92, v172, v173
v_cvt_pk_bf16_f32 v93, v174, v175
v_cvt_pk_bf16_f32 v94, v204, v205
v_cvt_pk_bf16_f32 v95, v206, v207
ds_write_b128 v6, v[80:83] offset:49152
ds_read_b64_tr_b16 v[72:73], v0 offset:45056
ds_read_b64_tr_b16 v[74:75], v0 offset:47104
ds_write_b128 v6, v[84:87] offset:50176
ds_write_b128 v6, v[88:91] offset:51200
ds_write_b128 v6, v[92:95] offset:52224
ds_read_b64_tr_b16 v[76:77], v1 offset:45056
ds_read_b64_tr_b16 v[78:79], v1 offset:47104
s_waitcnt lgkmcnt(5)
v_mfma_f32_16x16x32_bf16 v[96:99], v[72:75], a[80:83], v[96:99]
v_mfma_f32_16x16x32_bf16 v[100:103], v[72:75], a[84:87], v[100:103]
s_waitcnt vmcnt(8) lgkmcnt(2)
s_barrier
ds_read_b128 a[96:99], v4 offset:49152
ds_read_b64_tr_b16 v[48:49], v0 offset:49152
v_mfma_f32_16x16x32_bf16 v[104:107], v[72:75], a[88:91], v[104:107]
ds_read_b128 a[100:103], v4 offset:50176
ds_read_b64_tr_b16 v[50:51], v0 offset:51200
v_mfma_f32_16x16x32_bf16 v[108:111], v[72:75], a[92:95], v[108:111]
s_waitcnt lgkmcnt(4)
ds_read_b128 a[104:107], v4 offset:51200
ds_read_b128 a[108:111], v4 offset:52224
v_mfma_f32_16x16x32_bf16 v[124:127], v[76:79], a[92:95], v[124:127]
ds_read_b64_tr_b16 v[52:53], v1 offset:49152
ds_read_b64_tr_b16 v[54:55], v1 offset:51200
v_mfma_f32_16x16x32_bf16 v[120:123], v[76:79], a[88:91], v[120:123]
ds_read_b128 a[112:115], v4 offset:57344
ds_read_b64_tr_b16 v[56:57], v0 offset:53248
v_mfma_f32_16x16x32_bf16 v[116:119], v[76:79], a[84:87], v[116:119]
ds_read_b128 a[116:119], v4 offset:58368
ds_read_b64_tr_b16 v[58:59], v0 offset:55296
v_mfma_f32_16x16x32_bf16 v[112:115], v[76:79], a[80:83], v[112:115]
ds_read_b128 a[120:123], v4 offset:59392
buffer_load_dwordx4 v10, s[16:19], s59 offen lds
s_add_u32 m0, s4, 20480
s_add_u32 s59, s62, 110976
ds_read_b128 a[124:127], v4 offset:60416
ds_read_b64_tr_b16 v[60:61], v1 offset:53248
ds_read_b64_tr_b16 v[62:63], v1 offset:55296
ds_read_b64_tr_b16 v[64:65], v0 offset:57344
ds_read_b64_tr_b16 v[66:67], v0 offset:59392
ds_read_b64_tr_b16 v[68:69], v1 offset:57344
buffer_load_dwordx4 v10, s[16:19], s56 offen lds
s_waitcnt lgkmcnt(15)
v_mfma_f32_16x16x32_bf16 v[224:227], v[48:51], a[96:99], v[224:227]
s_add_u32 m0, s4, 24576
s_add_u32 s56, s62, 147840
ds_read_b64_tr_b16 v[70:71], v1 offset:59392
v_mfma_f32_16x16x32_bf16 v[228:231], v[48:51], a[100:103], v[228:231]
s_waitcnt lgkmcnt(15)
ds_read_b64_tr_b16 v[72:73], v0 offset:61440
buffer_load_dwordx4 v10, s[16:19], s57 offen lds
v_mfma_f32_16x16x32_bf16 v[232:235], v[48:51], a[104:107], v[232:235]
s_waitcnt lgkmcnt(15)
s_add_u32 m0, s4, 28672
s_add_u32 s57, s62, 184704
ds_read_b64_tr_b16 v[74:75], v0 offset:63488
v_mfma_f32_16x16x32_bf16 v[236:239], v[48:51], a[108:111], v[236:239]
s_waitcnt lgkmcnt(14)
ds_read_b64_tr_b16 v[76:77], v1 offset:61440
buffer_load_dwordx4 v10, s[16:19], s58 offen lds
v_mfma_f32_16x16x32_bf16 v[252:255], v[52:55], a[108:111], v[252:255]
s_add_u32 m0, s4, 32768
s_add_u32 s58, s62, 221568
ds_read_b64_tr_b16 v[78:79], v1 offset:63488
v_mfma_f32_16x16x32_bf16 v[248:251], v[52:55], a[104:107], v[248:251]
v_add_u32 v4, 0x20000, v0
v_mfma_f32_16x16x32_bf16 v[244:247], v[52:55], a[100:103], v[244:247]
v_mfma_f32_16x16x32_bf16 v[240:243], v[52:55], a[96:99], v[240:243]
s_waitcnt lgkmcnt(12)
v_mfma_f32_16x16x32_bf16 v[224:227], v[56:59], a[112:115], v[224:227]
v_mfma_f32_16x16x32_bf16 v[228:231], v[56:59], a[116:119], v[228:231]
s_waitcnt lgkmcnt(4)
v_mfma_f32_16x16x32_bf16 v[232:235], v[56:59], a[120:123], v[232:235]
s_nop 4
v_cvt_pk_bf16_f32 v80, v224, v225
v_cvt_pk_bf16_f32 v81, v226, v227
v_mfma_f32_16x16x32_bf16 v[236:239], v[56:59], a[124:127], v[236:239]
v_cvt_pk_bf16_f32 v84, v228, v229
v_mfma_f32_16x16x32_bf16 v[252:255], v[60:63], a[124:127], v[252:255]
v_cvt_pk_bf16_f32 v85, v230, v231
v_cvt_pk_bf16_f32 v88, v232, v233
v_mfma_f32_16x16x32_bf16 v[248:251], v[60:63], a[120:123], v[248:251]
v_cvt_pk_bf16_f32 v89, v234, v235
v_mfma_f32_16x16x32_bf16 v[244:247], v[60:63], a[116:119], v[244:247]
s_nop 0
v_cvt_pk_bf16_f32 v92, v236, v237
v_cvt_pk_bf16_f32 v93, v238, v239
v_mfma_f32_16x16x32_bf16 v[240:243], v[60:63], a[112:115], v[240:243]
v_cvt_pk_bf16_f32 v94, v252, v253
v_mfma_f32_16x16x32_bf16 v[96:99], v[64:67], a[96:99], v[96:99]
s_waitcnt vmcnt(8)
s_barrier
ds_read_b64_tr_b16 v[48:49], v2 offset:0
ds_read_b64_tr_b16 v[50:51], v2 offset:2048
v_mfma_f32_16x16x32_bf16 v[100:103], v[64:67], a[100:103], v[100:103]
s_mul_i32 s72, s2, 147456
ds_read_b64_tr_b16 v[52:53], v3 offset:0
ds_read_b64_tr_b16 v[54:55], v3 offset:2048
v_mfma_f32_16x16x32_bf16 v[104:107], v[64:67], a[104:107], v[104:107]
s_lshl_b32 s73, s3, 9
ds_read_b64_tr_b16 v[56:57], v2 offset:4096
ds_read_b64_tr_b16 v[58:59], v2 offset:6144
v_mfma_f32_16x16x32_bf16 v[108:111], v[64:67], a[108:111], v[108:111]
s_add_u32 s72, s72, s73
ds_read_b64_tr_b16 v[60:61], v3 offset:4096
ds_read_b64_tr_b16 v[62:63], v3 offset:6144
v_mfma_f32_16x16x32_bf16 v[124:127], v[68:71], a[108:111], v[124:127]
ds_read_b64_tr_b16 v[64:65], v2 offset:8192
ds_read_b64_tr_b16 v[66:67], v2 offset:10240
v_mfma_f32_16x16x32_bf16 v[120:123], v[68:71], a[104:107], v[120:123]
v_cvt_pk_bf16_f32 v90, v248, v249
v_cvt_pk_bf16_f32 v95, v254, v255
v_mfma_f32_16x16x32_bf16 v[116:119], v[68:71], a[100:103], v[116:119]
buffer_store_dwordx4 v[92:95], v11, s[28:31], s49 offen offset:0 sc1
v_cvt_pk_bf16_f32 v91, v250, v251
v_mfma_f32_16x16x32_bf16 v[112:115], v[68:71], a[96:99], v[112:115]
s_waitcnt lgkmcnt(10)
ds_read_b64_tr_b16 v[68:69], v3 offset:8192
buffer_store_dwordx4 v[88:91], v11, s[28:31], s46 offen offset:0 sc1
v_mfma_f32_16x16x32_bf16 v[96:99], v[72:75], a[112:115], v[96:99]
ds_read_b64_tr_b16 v[70:71], v3 offset:10240
v_cvt_pk_bf16_f32 v86, v244, v245
v_mfma_f32_16x16x32_bf16 v[100:103], v[72:75], a[116:119], v[100:103]
v_cvt_pk_bf16_f32 v82, v240, v241
v_cvt_pk_bf16_f32 v87, v246, v247
v_mfma_f32_16x16x32_bf16 v[104:107], v[72:75], a[120:123], v[104:107]
buffer_store_dwordx4 v[84:87], v11, s[28:31], s43 offen offset:0 sc1
v_cvt_pk_bf16_f32 v83, v242, v243
v_mfma_f32_16x16x32_bf16 v[108:111], v[72:75], a[124:127], v[108:111]
ds_read_b64_tr_b16 v[72:73], v2 offset:12288
buffer_store_dwordx4 v[80:83], v11, s[28:31], s40 offen offset:0 sc1
v_mfma_f32_16x16x32_bf16 v[124:127], v[76:79], a[124:127], v[124:127]
ds_read_b64_tr_b16 v[74:75], v2 offset:14336
v_cvt_pk_bf16_f32 v80, v96, v97
v_mfma_f32_16x16x32_bf16 v[120:123], v[76:79], a[120:123], v[120:123]
v_cvt_pk_bf16_f32 v81, v98, v99
v_cvt_pk_bf16_f32 v84, v100, v101
v_mfma_f32_16x16x32_bf16 v[116:119], v[76:79], a[116:119], v[116:119]
v_cvt_pk_bf16_f32 v85, v102, v103
v_mfma_f32_16x16x32_bf16 v[112:115], v[76:79], a[112:115], v[112:115]
s_waitcnt lgkmcnt(4)
ds_read_b64_tr_b16 v[76:77], v3 offset:12288
buffer_load_dwordx4 v10, s[16:19], s59 offen lds
v_mfma_f32_16x16x32_bf16 v[128:131], v[48:51], a[0:3], 0
s_add_u32 m0, s4, 36864
s_add_u32 s59, s62, 258432
ds_read_b64_tr_b16 v[78:79], v3 offset:14336
v_mfma_f32_16x16x32_bf16 v[132:135], v[48:51], a[4:7], 0
buffer_load_dwordx4 v10, s[16:19], s56 offen lds
v_cvt_pk_bf16_f32 v88, v104, v105
v_mfma_f32_16x16x32_bf16 v[136:139], v[48:51], a[8:11], 0
s_add_u32 m0, s4, 40960
s_add_u32 s56, s63, 384
v_cvt_pk_bf16_f32 v89, v106, v107
v_mfma_f32_16x16x32_bf16 v[140:143], v[48:51], a[12:15], 0
buffer_load_dwordx4 v10, s[16:19], s57 offen lds
v_cvt_pk_bf16_f32 v92, v108, v109
v_mfma_f32_16x16x32_bf16 v[156:159], v[52:55], a[12:15], 0
s_add_u32 m0, s4, 45056
s_add_u32 s57, s62, 512
v_cvt_pk_bf16_f32 v93, v110, v111
v_mfma_f32_16x16x32_bf16 v[152:155], v[52:55], a[8:11], 0
buffer_load_dwordx4 v10, s[16:19], s58 offen lds
v_cvt_pk_bf16_f32 v94, v124, v125
v_mfma_f32_16x16x32_bf16 v[148:151], v[52:55], a[4:7], 0
s_add_u32 m0, s4, 49152
s_add_u32 s58, s62, 37376
v_cvt_pk_bf16_f32 v95, v126, v127
v_mfma_f32_16x16x32_bf16 v[144:147], v[52:55], a[0:3], 0
buffer_store_dwordx4 v[92:95], v11, s[28:31], s49 offen offset:1024 sc1
v_cvt_pk_bf16_f32 v90, v120, v121
v_mfma_f32_16x16x32_bf16 v[128:131], v[56:59], a[16:19], v[128:131]
v_cvt_pk_bf16_f32 v86, v116, v117
v_cvt_pk_bf16_f32 v91, v122, v123
v_mfma_f32_16x16x32_bf16 v[132:135], v[56:59], a[20:23], v[132:135]
buffer_store_dwordx4 v[88:91], v11, s[28:31], s46 offen offset:1024 sc1
v_cvt_pk_bf16_f32 v87, v118, v119
v_mfma_f32_16x16x32_bf16 v[136:139], v[56:59], a[24:27], v[136:139]
buffer_store_dwordx4 v[84:87], v11, s[28:31], s43 offen offset:1024 sc1
v_cvt_pk_bf16_f32 v82, v112, v113
v_mfma_f32_16x16x32_bf16 v[140:143], v[56:59], a[28:31], v[140:143]
v_mbcnt_lo_u32_b32 v44, -1, 0
v_cvt_pk_bf16_f32 v83, v114, v115
v_mfma_f32_16x16x32_bf16 v[156:159], v[60:63], a[28:31], v[156:159]
buffer_store_dwordx4 v[80:83], v11, s[28:31], s40 offen offset:1024 sc1
v_mbcnt_hi_u32_b32 v44, -1, v44
v_mfma_f32_16x16x32_bf16 v[152:155], v[60:63], a[24:27], v[152:155]
v_lshrrev_b32 v46, 4, v44
v_and_b32 v47, 1, v46
v_mfma_f32_16x16x32_bf16 v[148:151], v[60:63], a[20:23], v[148:151]
v_and_b32_e64 v45, 15, v44
v_mfma_f32_16x16x32_bf16 v[144:147], v[60:63], a[16:19], v[144:147]
v_mul_u32_u24 v47, 9216, v47
v_lshl_add_u32 v47, v45, 4, v47
v_mfma_f32_16x16x32_bf16 v[128:131], v[64:67], a[32:35], v[128:131]
s_waitcnt vmcnt(16)
s_barrier
ds_read_b64_tr_b16 v[48:49], v0 offset:0
ds_read_b64_tr_b16 v[50:51], v0 offset:2048
v_mfma_f32_16x16x32_bf16 v[132:135], v[64:67], a[36:39], v[132:135]
ds_read_b64_tr_b16 v[52:53], v1 offset:0
ds_read_b64_tr_b16 v[54:55], v1 offset:2048
v_mfma_f32_16x16x32_bf16 v[136:139], v[64:67], a[40:43], v[136:139]
ds_read_b64_tr_b16 v[56:57], v0 offset:4096
ds_read_b64_tr_b16 v[58:59], v0 offset:6144
v_mfma_f32_16x16x32_bf16 v[140:143], v[64:67], a[44:47], v[140:143]
s_waitcnt lgkmcnt(6)
ds_read_b64_tr_b16 v[60:61], v1 offset:4096
ds_read_b64_tr_b16 v[62:63], v1 offset:6144
v_mfma_f32_16x16x32_bf16 v[156:159], v[68:71], a[44:47], v[156:159]
ds_read_b64_tr_b16 v[64:65], v0 offset:8192
ds_read_b64_tr_b16 v[66:67], v0 offset:10240
v_mfma_f32_16x16x32_bf16 v[152:155], v[68:71], a[40:43], v[152:155]
v_lshrrev_b32 v8, 5, v44
v_lshl_add_u32 v8, v8, 8, v47
v_mfma_f32_16x16x32_bf16 v[148:151], v[68:71], a[36:39], v[148:151]
v_add_u32 v8, s72, v8
v_mfma_f32_16x16x32_bf16 v[144:147], v[68:71], a[32:35], v[144:147]
s_lshr_b32 s72, s3, 1
ds_read_b64_tr_b16 v[68:69], v1 offset:8192
ds_read_b64_tr_b16 v[70:71], v1 offset:10240
v_mfma_f32_16x16x32_bf16 v[128:131], v[72:75], a[48:51], v[128:131]
s_lshl_b32 s72, s72, 30
v_add_u32 v9, s72, v8
v_and_b32_e64 v39, 1, v44
v_mfma_f32_16x16x32_bf16 v[132:135], v[72:75], a[52:55], v[132:135]
s_movk_i32 s72, 0x3f80
s_lshl_b32 s73, s3, 9
v_lshlrev_b32_e64 v39, 4, v39
v_mfma_f32_16x16x32_bf16 v[136:139], v[72:75], a[56:59], v[136:139]
v_lshrrev_b32_e64 v47, 2, v44
v_lshlrev_b32_e64 v39, v39, s72
v_mfma_f32_16x16x32_bf16 v[140:143], v[72:75], a[60:63], v[140:143]
s_mul_i32 s72, s2, 9216
ds_read_b64_tr_b16 v[72:73], v0 offset:12288
ds_read_b64_tr_b16 v[74:75], v0 offset:14336
v_mfma_f32_16x16x32_bf16 v[156:159], v[76:79], a[60:63], v[156:159]
s_add_u32 s73, s72, s73
v_xor_b32 v47, v47, v44
v_and_b32_e64 v47, 8, v47
v_mfma_f32_16x16x32_bf16 v[152:155], v[76:79], a[56:59], v[152:155]
v_and_or_b32 v47, v44, 6, v47
v_mfma_f32_16x16x32_bf16 v[148:151], v[76:79], a[52:55], v[148:151]
v_cmp_eq_u32_e64 s[64:65], 0, v47
s_nop 1
v_cndmask_b32_e64 v36, 0, v39, s[64:65]
v_mfma_f32_16x16x32_bf16 v[144:147], v[76:79], a[48:51], v[144:147]
s_waitcnt lgkmcnt(4)
ds_read_b64_tr_b16 v[76:77], v1 offset:12288
buffer_load_dwordx4 v10, s[16:19], s59 offen lds
v_mfma_f32_16x16x32_bf16 v[128:131], v[48:51], a[64:67], v[128:131]
s_add_u32 m0, s4, 53248
s_add_u32 s59, s62, 74240
ds_read_b64_tr_b16 v[78:79], v1 offset:14336
v_mfma_f32_16x16x32_bf16 v[132:135], v[48:51], a[68:71], v[132:135]
buffer_load_dwordx4 v10, s[16:19], s56 offen lds
v_cmp_eq_u32_e64 s[64:65], 2, v47
v_mfma_f32_16x16x32_bf16 v[136:139], v[48:51], a[72:75], v[136:139]
s_add_u32 m0, s4, 57344
s_add_u32 s56, s62, 111104
v_cndmask_b32_e64 v37, 0, v39, s[64:65]
v_mfma_f32_16x16x32_bf16 v[140:143], v[48:51], a[76:79], v[140:143]
buffer_load_dwordx4 v10, s[16:19], s57 offen lds
v_cmp_eq_u32_e64 s[64:65], 4, v47
v_mfma_f32_16x16x32_bf16 v[156:159], v[52:55], a[76:79], v[156:159]
s_add_u32 m0, s4, 61440
s_add_u32 s57, s62, 147968
v_cndmask_b32_e64 v38, 0, v39, s[64:65]
v_mfma_f32_16x16x32_bf16 v[152:155], v[52:55], a[72:75], v[152:155]
buffer_load_dwordx4 v10, s[16:19], s58 offen lds
v_cmp_eq_u32_e64 s[64:65], 6, v47
v_mfma_f32_16x16x32_bf16 v[148:151], v[52:55], a[68:71], v[148:151]
s_add_u32 m0, s4, 65536
s_add_u32 s58, s62, 184832
v_lshrrev_b32_e64 v47, 5, v44
v_mfma_f32_16x16x32_bf16 v[144:147], v[52:55], a[64:67], v[144:147]
v_bfe_u32 v42, v44, 3, 1
v_lshl_add_u32 v47, v47, 1, v42
v_mfma_f32_16x16x32_bf16 v[128:131], v[56:59], a[80:83], v[128:131]
v_and_b32_e64 v45, 7, v45
v_mfma_f32_16x16x32_bf16 v[132:135], v[56:59], a[84:87], v[132:135]
v_and_b32 v46, 1, v46
v_lshlrev_b32 v14, 7, v47
v_mfma_f32_16x16x32_bf16 v[136:139], v[56:59], a[88:91], v[136:139]
v_lshl_add_u32 v14, v45, 4, v14
v_mfma_f32_16x16x32_bf16 v[140:143], v[56:59], a[92:95], v[140:143]
v_lshl_add_u32 v14, v46, 3, v14
v_add_u32 v14, s73, v14
v_mfma_f32_16x16x32_bf16 v[156:159], v[60:63], a[92:95], v[156:159]
s_lshl_b32 s73, s3, 6
s_add_u32 s73, s72, s73
v_mul_u32_u24 v6, 1152, v45
v_mfma_f32_16x16x32_bf16 v[152:155], v[60:63], a[88:91], v[152:155]
s_lshr_b32 s72, s3, 1
v_lshl_add_u32 v6, v47, 3, v6
v_lshl_add_u32 v6, v46, 5, v6
v_mfma_f32_16x16x32_bf16 v[148:151], v[60:63], a[84:87], v[148:151]
s_lshl_b32 s72, s72, 30
v_add_u32 v6, s73, v6
v_mfma_f32_16x16x32_bf16 v[144:147], v[60:63], a[80:83], v[144:147]
v_lshlrev_b32_e64 v15, 5, v47
v_add_u32 v7, s72, v6
v_mfma_f32_16x16x32_bf16 v[128:131], v[64:67], a[96:99], v[128:131]
s_mul_i32 s72, s2, 12288
s_add_u32 s72, s72, s4
v_lshl_add_u32 v15, v46, 4, v15
v_mfma_f32_16x16x32_bf16 v[132:135], v[64:67], a[100:103], v[132:135]
v_lshl_add_u32 v15, s3, 7, v15
v_add_u32 v15, 156928, v15
v_mfma_f32_16x16x32_bf16 v[136:139], v[64:67], a[104:107], v[136:139]
v_lshl_add_u32 v14, v44, 4, s72
v_mfma_f32_16x16x32_bf16 v[140:143], v[64:67], a[108:111], v[140:143]
s_waitcnt vmcnt(16)
s_barrier
ds_read_b64_tr_b16 v[48:49], v0 offset:16384
ds_read_b64_tr_b16 v[50:51], v0 offset:18432
s_waitcnt lgkmcnt(2)
v_mfma_f32_16x16x32_bf16 v[156:159], v[68:71], a[108:111], v[156:159]
ds_read_b64_tr_b16 v[52:53], v1 offset:16384
ds_read_b64_tr_b16 v[54:55], v1 offset:18432
v_mfma_f32_16x16x32_bf16 v[152:155], v[68:71], a[104:107], v[152:155]
ds_read_b64_tr_b16 v[56:57], v0 offset:20480
ds_read_b64_tr_b16 v[58:59], v0 offset:22528
v_mfma_f32_16x16x32_bf16 v[148:151], v[68:71], a[100:103], v[148:151]
ds_read_b64_tr_b16 v[60:61], v1 offset:20480
ds_read_b64_tr_b16 v[62:63], v1 offset:22528
v_mfma_f32_16x16x32_bf16 v[144:147], v[68:71], a[96:99], v[144:147]
ds_read_b64_tr_b16 v[64:65], v0 offset:24576
ds_read_b64_tr_b16 v[66:67], v0 offset:26624
v_mfma_f32_16x16x32_bf16 v[128:131], v[72:75], a[112:115], v[128:131]
ds_read_b64_tr_b16 v[68:69], v1 offset:24576
ds_read_b64_tr_b16 v[70:71], v1 offset:26624
v_mfma_f32_16x16x32_bf16 v[132:135], v[72:75], a[116:119], v[132:135]
v_cndmask_b32_e64 v39, 0, v39, s[64:65]
v_mfma_f32_16x16x32_bf16 v[136:139], v[72:75], a[120:123], v[136:139]
v_mfma_f32_16x16x32_bf16 v[140:143], v[72:75], a[124:127], v[140:143]
ds_read_b64_tr_b16 v[72:73], v0 offset:28672
ds_read_b64_tr_b16 v[74:75], v0 offset:30720
v_mfma_f32_16x16x32_bf16 v[156:159], v[76:79], a[124:127], v[156:159]
v_mfma_f32_16x16x32_bf16 v[152:155], v[76:79], a[120:123], v[152:155]
v_mfma_f32_16x16x32_bf16 v[148:151], v[76:79], a[116:119], v[148:151]
v_mfma_f32_16x16x32_bf16 v[144:147], v[76:79], a[112:115], v[144:147]
s_waitcnt lgkmcnt(6)
ds_read_b64_tr_b16 v[76:77], v1 offset:28672
buffer_load_dwordx4 v10, s[16:19], s59 offen lds
v_mfma_f32_16x16x32_bf16 v[128:131], v[48:51], a[128:131], v[128:131]
s_add_u32 m0, s4, 69632
s_add_u32 s59, s62, 221696
ds_read_b64_tr_b16 v[78:79], v1 offset:30720
v_mfma_f32_16x16x32_bf16 v[132:135], v[48:51], a[132:135], v[132:135]
buffer_load_dwordx4 v10, s[16:19], s56 offen lds
v_mfma_f32_16x16x32_bf16 v[136:139], v[48:51], a[136:139], v[136:139]
s_add_u32 m0, s4, 73728
s_add_u32 s56, s62, 258560
v_cvt_pk_bf16_f32 v80, v128, v129
v_mfma_f32_16x16x32_bf16 v[140:143], v[48:51], a[140:143], v[140:143]
buffer_load_dwordx4 v10, s[16:19], s57 offen lds
v_cvt_pk_bf16_f32 v81, v130, v131
v_mfma_f32_16x16x32_bf16 v[156:159], v[52:55], a[140:143], v[156:159]
s_add_u32 m0, s4, 77824
s_add_u32 s57, s63, 512
v_cvt_pk_bf16_f32 v84, v132, v133
v_mfma_f32_16x16x32_bf16 v[152:155], v[52:55], a[136:139], v[152:155]
buffer_load_dwordx4 v10, s[16:19], s58 offen lds
v_cvt_pk_bf16_f32 v85, v134, v135
v_mfma_f32_16x16x32_bf16 v[148:151], v[52:55], a[132:135], v[148:151]
s_add_u32 m0, s4, 0
s_add_u32 s58, s62, 640
v_cvt_pk_bf16_f32 v88, v136, v137
v_mfma_f32_16x16x32_bf16 v[144:147], v[52:55], a[128:131], v[144:147]
v_cvt_pk_bf16_f32 v89, v138, v139
v_cvt_pk_bf16_f32 v90, v152, v153
v_mfma_f32_16x16x32_bf16 v[224:227], v[56:59], a[0:3], 0
s_nop 0
v_cvt_pk_bf16_f32 v86, v148, v149
v_mfma_f32_16x16x32_bf16 v[228:231], v[56:59], a[4:7], 0
s_nop 1
v_cvt_pk_bf16_f32 v82, v144, v145
v_cvt_pk_bf16_f32 v83, v146, v147
v_mfma_f32_16x16x32_bf16 v[232:235], v[56:59], a[8:11], 0
v_cvt_pk_bf16_f32 v87, v150, v151
v_mfma_f32_16x16x32_bf16 v[236:239], v[56:59], a[12:15], 0
buffer_store_dwordx4 v[80:83], v11, s[28:31], s40 offen offset:2048 sc1
buffer_store_dwordx4 v[84:87], v11, s[28:31], s43 offen offset:2048 sc1
v_mfma_f32_16x16x32_bf16 v[252:255], v[60:63], a[12:15], 0
v_cvt_pk_bf16_f32 v91, v154, v155
v_cvt_pk_bf16_f32 v92, v140, v141
v_mfma_f32_16x16x32_bf16 v[248:251], v[60:63], a[8:11], 0
buffer_store_dwordx4 v[88:91], v11, s[28:31], s46 offen offset:2048 sc1
v_cvt_pk_bf16_f32 v93, v142, v143
v_mfma_f32_16x16x32_bf16 v[244:247], v[60:63], a[4:7], 0
v_cvt_pk_bf16_f32 v94, v156, v157
v_cvt_pk_bf16_f32 v95, v158, v159
v_mfma_f32_16x16x32_bf16 v[240:243], v[60:63], a[0:3], 0
s_waitcnt lgkmcnt(0)
buffer_store_dwordx4 v[92:95], v11, s[28:31], s49 offen offset:2048 sc1
v_mfma_f32_16x16x32_bf16 v[224:227], v[64:67], a[16:19], v[224:227]
v_mfma_f32_16x16x32_bf16 v[228:231], v[64:67], a[20:23], v[228:231]
v_mfma_f32_16x16x32_bf16 v[232:235], v[64:67], a[24:27], v[232:235]
v_mfma_f32_16x16x32_bf16 v[236:239], v[64:67], a[28:31], v[236:239]
v_mfma_f32_16x16x32_bf16 v[252:255], v[68:71], a[28:31], v[252:255]
v_mfma_f32_16x16x32_bf16 v[248:251], v[68:71], a[24:27], v[248:251]
s_waitcnt vmcnt(16)
s_barrier
ds_read_b64_tr_b16 v[48:49], v0 offset:32768
ds_read_b64_tr_b16 v[50:51], v0 offset:34816
v_mfma_f32_16x16x32_bf16 v[244:247], v[68:71], a[20:23], v[244:247]
ds_read_b64_tr_b16 v[52:53], v1 offset:32768
ds_read_b64_tr_b16 v[54:55], v1 offset:34816
v_mfma_f32_16x16x32_bf16 v[240:243], v[68:71], a[16:19], v[240:243]
ds_read_b64_tr_b16 v[56:57], v0 offset:36864
ds_read_b64_tr_b16 v[58:59], v0 offset:38912
v_mfma_f32_16x16x32_bf16 v[224:227], v[72:75], a[32:35], v[224:227]
ds_read_b64_tr_b16 v[60:61], v1 offset:36864
ds_read_b64_tr_b16 v[62:63], v1 offset:38912
v_mfma_f32_16x16x32_bf16 v[228:231], v[72:75], a[36:39], v[228:231]
ds_read_b64_tr_b16 v[64:65], v0 offset:40960
ds_read_b64_tr_b16 v[66:67], v0 offset:43008
v_mfma_f32_16x16x32_bf16 v[232:235], v[72:75], a[40:43], v[232:235]
ds_read_b64_tr_b16 v[68:69], v1 offset:40960
ds_read_b64_tr_b16 v[70:71], v1 offset:43008
v_mfma_f32_16x16x32_bf16 v[236:239], v[72:75], a[44:47], v[236:239]
ds_read_b64_tr_b16 v[72:73], v0 offset:45056
ds_read_b64_tr_b16 v[74:75], v0 offset:47104
v_mfma_f32_16x16x32_bf16 v[252:255], v[76:79], a[44:47], v[252:255]
v_mfma_f32_16x16x32_bf16 v[248:251], v[76:79], a[40:43], v[248:251]
v_mfma_f32_16x16x32_bf16 v[244:247], v[76:79], a[36:39], v[244:247]
v_mfma_f32_16x16x32_bf16 v[240:243], v[76:79], a[32:35], v[240:243]
s_waitcnt lgkmcnt(10)
ds_read_b64_tr_b16 v[76:77], v1 offset:45056
buffer_load_dwordx4 v10, s[16:19], s59 offen lds
v_mfma_f32_16x16x32_bf16 v[224:227], v[48:51], a[48:51], v[224:227]
s_add_u32 m0, s4, 4096
s_add_u32 s59, s62, 37504
ds_read_b64_tr_b16 v[78:79], v1 offset:47104
v_mfma_f32_16x16x32_bf16 v[228:231], v[48:51], a[52:55], v[228:231]
buffer_load_dwordx4 v10, s[16:19], s56 offen lds
v_mfma_f32_16x16x32_bf16 v[232:235], v[48:51], a[56:59], v[232:235]
s_add_u32 m0, s4, 8192
s_add_u32 s56, s62, 74368
v_mfma_f32_16x16x32_bf16 v[236:239], v[48:51], a[60:63], v[236:239]
buffer_load_dwordx4 v10, s[16:19], s57 offen lds
v_mfma_f32_16x16x32_bf16 v[252:255], v[52:55], a[60:63], v[252:255]
s_add_u32 m0, s4, 12288
s_add_u32 s57, s62, 111232
v_mfma_f32_16x16x32_bf16 v[248:251], v[52:55], a[56:59], v[248:251]
buffer_load_dwordx4 v10, s[16:19], s58 offen lds
v_mfma_f32_16x16x32_bf16 v[244:247], v[52:55], a[52:55], v[244:247]
s_add_u32 m0, s4, 16384
s_add_u32 s58, s62, 148096
v_mfma_f32_16x16x32_bf16 v[240:243], v[52:55], a[48:51], v[240:243]
s_waitcnt lgkmcnt(2)
v_mfma_f32_16x16x32_bf16 v[224:227], v[56:59], a[64:67], v[224:227]
v_mfma_f32_16x16x32_bf16 v[228:231], v[56:59], a[68:71], v[228:231]
v_mfma_f32_16x16x32_bf16 v[232:235], v[56:59], a[72:75], v[232:235]
v_mfma_f32_16x16x32_bf16 v[236:239], v[56:59], a[76:79], v[236:239]
v_mfma_f32_16x16x32_bf16 v[252:255], v[60:63], a[76:79], v[252:255]
v_mfma_f32_16x16x32_bf16 v[248:251], v[60:63], a[72:75], v[248:251]
v_mfma_f32_16x16x32_bf16 v[244:247], v[60:63], a[68:71], v[244:247]
v_mfma_f32_16x16x32_bf16 v[240:243], v[60:63], a[64:67], v[240:243]
v_mov_b32 v41, 1
v_mfma_f32_16x16x32_bf16 v[224:227], v[64:67], a[80:83], v[224:227]
v_mfma_f32_16x16x32_bf16 v[228:231], v[64:67], a[84:87], v[228:231]
v_mfma_f32_16x16x32_bf16 v[232:235], v[64:67], a[88:91], v[232:235]
v_mfma_f32_16x16x32_bf16 v[236:239], v[64:67], a[92:95], v[236:239]
s_waitcnt vmcnt(16)
buffer_store_dword v41, v13, s[32:35], s69 offen sc1
v_mfma_f32_16x16x32_bf16 v[252:255], v[68:71], a[92:95], v[252:255]
v_mfma_f32_16x16x32_bf16 v[248:251], v[68:71], a[88:91], v[248:251]
s_waitcnt vmcnt(13)
s_barrier
ds_read_b64_tr_b16 v[48:49], v0 offset:49152
ds_read_b64_tr_b16 v[50:51], v0 offset:51200
v_mfma_f32_16x16x32_bf16 v[244:247], v[68:71], a[84:87], v[244:247]
ds_read_b64_tr_b16 v[52:53], v1 offset:49152
ds_read_b64_tr_b16 v[54:55], v1 offset:51200
v_mfma_f32_16x16x32_bf16 v[240:243], v[68:71], a[80:83], v[240:243]
ds_read_b64_tr_b16 v[56:57], v0 offset:53248
ds_read_b64_tr_b16 v[58:59], v0 offset:55296
v_mfma_f32_16x16x32_bf16 v[224:227], v[72:75], a[96:99], v[224:227]
ds_read_b64_tr_b16 v[60:61], v1 offset:53248
ds_read_b64_tr_b16 v[62:63], v1 offset:55296
v_mfma_f32_16x16x32_bf16 v[228:231], v[72:75], a[100:103], v[228:231]
ds_read_b64_tr_b16 v[64:65], v0 offset:57344
ds_read_b64_tr_b16 v[66:67], v0 offset:59392
v_mfma_f32_16x16x32_bf16 v[232:235], v[72:75], a[104:107], v[232:235]
ds_read_b64_tr_b16 v[68:69], v1 offset:57344
ds_read_b64_tr_b16 v[70:71], v1 offset:59392
v_mfma_f32_16x16x32_bf16 v[236:239], v[72:75], a[108:111], v[236:239]
s_waitcnt lgkmcnt(12)
ds_read_b64_tr_b16 v[72:73], v0 offset:61440
ds_read_b64_tr_b16 v[74:75], v0 offset:63488
v_mfma_f32_16x16x32_bf16 v[252:255], v[76:79], a[108:111], v[252:255]
v_mfma_f32_16x16x32_bf16 v[248:251], v[76:79], a[104:107], v[248:251]
v_mfma_f32_16x16x32_bf16 v[244:247], v[76:79], a[100:103], v[244:247]
v_mfma_f32_16x16x32_bf16 v[240:243], v[76:79], a[96:99], v[240:243]
s_waitcnt lgkmcnt(10)
ds_read_b64_tr_b16 v[76:77], v1 offset:61440
buffer_load_dwordx4 v10, s[16:19], s59 offen lds
v_mfma_f32_16x16x32_bf16 v[224:227], v[48:51], a[112:115], v[224:227]
s_add_u32 m0, s4, 20480
s_add_u32 s59, s62, 184960
ds_read_b64_tr_b16 v[78:79], v1 offset:63488
v_mfma_f32_16x16x32_bf16 v[228:231], v[48:51], a[116:119], v[228:231]
buffer_load_dwordx4 v10, s[16:19], s56 offen lds
v_mfma_f32_16x16x32_bf16 v[232:235], v[48:51], a[120:123], v[232:235]
s_add_u32 m0, s4, 24576
s_add_u32 s56, s62, 221824
v_mfma_f32_16x16x32_bf16 v[236:239], v[48:51], a[124:127], v[236:239]
buffer_load_dwordx4 v10, s[16:19], s57 offen lds
v_mfma_f32_16x16x32_bf16 v[252:255], v[52:55], a[124:127], v[252:255]
s_add_u32 m0, s4, 28672
s_add_u32 s57, s62, 258688
v_mfma_f32_16x16x32_bf16 v[248:251], v[52:55], a[120:123], v[248:251]
buffer_load_dwordx4 v10, s[16:19], s58 offen lds
v_mfma_f32_16x16x32_bf16 v[244:247], v[52:55], a[116:119], v[244:247]
s_add_u32 m0, s4, 32768
s_add_u32 s58, s63, 640
v_mfma_f32_16x16x32_bf16 v[240:243], v[52:55], a[112:115], v[240:243]
s_waitcnt lgkmcnt(2)
v_mfma_f32_16x16x32_bf16 v[224:227], v[56:59], a[128:131], v[224:227]
v_mfma_f32_16x16x32_bf16 v[228:231], v[56:59], a[132:135], v[228:231]
v_mfma_f32_16x16x32_bf16 v[232:235], v[56:59], a[136:139], v[232:235]
s_nop 5
v_cvt_pk_bf16_f32 v80, v224, v225
v_cvt_pk_bf16_f32 v81, v226, v227
v_mfma_f32_16x16x32_bf16 v[236:239], v[56:59], a[140:143], v[236:239]
v_cvt_pk_bf16_f32 v84, v228, v229
v_mfma_f32_16x16x32_bf16 v[252:255], v[60:63], a[140:143], v[252:255]
v_cvt_pk_bf16_f32 v85, v230, v231
v_cvt_pk_bf16_f32 v88, v232, v233
v_mfma_f32_16x16x32_bf16 v[248:251], v[60:63], a[136:139], v[248:251]
v_cvt_pk_bf16_f32 v89, v234, v235
v_mfma_f32_16x16x32_bf16 v[244:247], v[60:63], a[132:135], v[244:247]
s_nop 0
v_cvt_pk_bf16_f32 v92, v236, v237
v_cvt_pk_bf16_f32 v93, v238, v239
v_mfma_f32_16x16x32_bf16 v[240:243], v[60:63], a[128:131], v[240:243]
v_cvt_pk_bf16_f32 v94, v252, v253
v_mfma_f32_16x16x32_bf16 v[96:99], v[64:67], a[0:3], 0
v_cvt_pk_bf16_f32 v90, v248, v249
v_cvt_pk_bf16_f32 v95, v254, v255
v_mfma_f32_16x16x32_bf16 v[100:103], v[64:67], a[4:7], 0
v_cvt_pk_bf16_f32 v91, v250, v251
v_mfma_f32_16x16x32_bf16 v[104:107], v[64:67], a[8:11], 0
v_cvt_pk_bf16_f32 v86, v244, v245
v_cvt_pk_bf16_f32 v87, v246, v247
v_mfma_f32_16x16x32_bf16 v[108:111], v[64:67], a[12:15], 0
buffer_store_dwordx4 v[84:87], v11, s[28:31], s43 offen offset:3072 sc1
buffer_store_dwordx4 v[88:91], v11, s[28:31], s46 offen offset:3072 sc1
v_mfma_f32_16x16x32_bf16 v[124:127], v[68:71], a[12:15], 0
buffer_store_dwordx4 v[92:95], v11, s[28:31], s49 offen offset:3072 sc1
v_cvt_pk_bf16_f32 v82, v240, v241
v_mfma_f32_16x16x32_bf16 v[120:123], v[68:71], a[8:11], 0
s_waitcnt vmcnt(16)
s_barrier
ds_read_b64_tr_b16 v[48:49], v2 offset:0
ds_read_b64_tr_b16 v[50:51], v2 offset:2048
v_mfma_f32_16x16x32_bf16 v[116:119], v[68:71], a[4:7], 0
ds_read_b64_tr_b16 v[52:53], v3 offset:0
ds_read_b64_tr_b16 v[54:55], v3 offset:2048
v_mfma_f32_16x16x32_bf16 v[112:115], v[68:71], a[0:3], 0
ds_read_b64_tr_b16 v[56:57], v2 offset:4096
ds_read_b64_tr_b16 v[58:59], v2 offset:6144
v_mfma_f32_16x16x32_bf16 v[96:99], v[72:75], a[16:19], v[96:99]
ds_read_b64_tr_b16 v[60:61], v3 offset:4096
ds_read_b64_tr_b16 v[62:63], v3 offset:6144
v_mfma_f32_16x16x32_bf16 v[100:103], v[72:75], a[20:23], v[100:103]
ds_read_b64_tr_b16 v[64:65], v2 offset:8192
ds_read_b64_tr_b16 v[66:67], v2 offset:10240
v_mfma_f32_16x16x32_bf16 v[104:107], v[72:75], a[24:27], v[104:107]
ds_read_b64_tr_b16 v[68:69], v3 offset:8192
ds_read_b64_tr_b16 v[70:71], v3 offset:10240
v_mfma_f32_16x16x32_bf16 v[108:111], v[72:75], a[28:31], v[108:111]
s_waitcnt lgkmcnt(12)
ds_read_b64_tr_b16 v[72:73], v2 offset:12288
ds_read_b64_tr_b16 v[74:75], v2 offset:14336
v_mfma_f32_16x16x32_bf16 v[124:127], v[76:79], a[28:31], v[124:127]
v_cvt_pk_bf16_f32 v83, v242, v243
v_mfma_f32_16x16x32_bf16 v[120:123], v[76:79], a[24:27], v[120:123]
buffer_store_dwordx4 v[80:83], v11, s[28:31], s40 offen offset:3072 sc1
v_mfma_f32_16x16x32_bf16 v[116:119], v[76:79], a[20:23], v[116:119]
v_mfma_f32_16x16x32_bf16 v[112:115], v[76:79], a[16:19], v[112:115]
s_waitcnt lgkmcnt(10)
ds_read_b64_tr_b16 v[76:77], v3 offset:12288
buffer_load_dwordx4 v10, s[16:19], s59 offen lds
v_mfma_f32_16x16x32_bf16 v[96:99], v[48:51], a[32:35], v[96:99]
s_add_u32 m0, s4, 36864
s_add_u32 s59, s62, 768
ds_read_b64_tr_b16 v[78:79], v3 offset:14336
v_mfma_f32_16x16x32_bf16 v[100:103], v[48:51], a[36:39], v[100:103]
buffer_load_dwordx4 v10, s[16:19], s56 offen lds
v_mfma_f32_16x16x32_bf16 v[104:107], v[48:51], a[40:43], v[104:107]
s_add_u32 m0, s4, 40960
s_add_u32 s56, s62, 37632
v_mfma_f32_16x16x32_bf16 v[108:111], v[48:51], a[44:47], v[108:111]
buffer_load_dwordx4 v10, s[16:19], s57 offen lds
v_mfma_f32_16x16x32_bf16 v[124:127], v[52:55], a[44:47], v[124:127]
s_add_u32 m0, s4, 45056
s_add_u32 s57, s62, 74496
v_mfma_f32_16x16x32_bf16 v[120:123], v[52:55], a[40:43], v[120:123]
buffer_load_dwordx4 v10, s[16:19], s58 offen lds
v_mfma_f32_16x16x32_bf16 v[116:119], v[52:55], a[36:39], v[116:119]
s_add_u32 m0, s4, 49152
s_add_u32 s58, s62, 111360
v_mfma_f32_16x16x32_bf16 v[112:115], v[52:55], a[32:35], v[112:115]
s_waitcnt lgkmcnt(2)
v_mfma_f32_16x16x32_bf16 v[96:99], v[56:59], a[48:51], v[96:99]
v_mfma_f32_16x16x32_bf16 v[100:103], v[56:59], a[52:55], v[100:103]
v_mfma_f32_16x16x32_bf16 v[104:107], v[56:59], a[56:59], v[104:107]
v_mfma_f32_16x16x32_bf16 v[108:111], v[56:59], a[60:63], v[108:111]
v_mfma_f32_16x16x32_bf16 v[124:127], v[60:63], a[60:63], v[124:127]
v_mfma_f32_16x16x32_bf16 v[120:123], v[60:63], a[56:59], v[120:123]
v_mfma_f32_16x16x32_bf16 v[116:119], v[60:63], a[52:55], v[116:119]
v_mfma_f32_16x16x32_bf16 v[112:115], v[60:63], a[48:51], v[112:115]
v_mfma_f32_16x16x32_bf16 v[96:99], v[64:67], a[64:67], v[96:99]
v_mfma_f32_16x16x32_bf16 v[100:103], v[64:67], a[68:71], v[100:103]
v_mfma_f32_16x16x32_bf16 v[104:107], v[64:67], a[72:75], v[104:107]
v_mfma_f32_16x16x32_bf16 v[108:111], v[64:67], a[76:79], v[108:111]
v_mfma_f32_16x16x32_bf16 v[124:127], v[68:71], a[76:79], v[124:127]
v_mfma_f32_16x16x32_bf16 v[120:123], v[68:71], a[72:75], v[120:123]
s_waitcnt vmcnt(13)
s_barrier
ds_read_b64_tr_b16 v[48:49], v0 offset:0
ds_read_b64_tr_b16 v[50:51], v0 offset:2048
v_mfma_f32_16x16x32_bf16 v[116:119], v[68:71], a[68:71], v[116:119]
ds_read_b64_tr_b16 v[52:53], v1 offset:0
ds_read_b64_tr_b16 v[54:55], v1 offset:2048
v_mfma_f32_16x16x32_bf16 v[112:115], v[68:71], a[64:67], v[112:115]
ds_read_b64_tr_b16 v[56:57], v0 offset:4096
ds_read_b64_tr_b16 v[58:59], v0 offset:6144
v_mfma_f32_16x16x32_bf16 v[96:99], v[72:75], a[80:83], v[96:99]
ds_read_b64_tr_b16 v[60:61], v1 offset:4096
ds_read_b64_tr_b16 v[62:63], v1 offset:6144
v_mfma_f32_16x16x32_bf16 v[100:103], v[72:75], a[84:87], v[100:103]
ds_read_b64_tr_b16 v[64:65], v0 offset:8192
ds_read_b64_tr_b16 v[66:67], v0 offset:10240
v_mfma_f32_16x16x32_bf16 v[104:107], v[72:75], a[88:91], v[104:107]
ds_read_b64_tr_b16 v[68:69], v1 offset:8192
ds_read_b64_tr_b16 v[70:71], v1 offset:10240
v_mfma_f32_16x16x32_bf16 v[108:111], v[72:75], a[92:95], v[108:111]
s_waitcnt lgkmcnt(12)
ds_read_b64_tr_b16 v[72:73], v0 offset:12288
ds_read_b64_tr_b16 v[74:75], v0 offset:14336
v_mfma_f32_16x16x32_bf16 v[124:127], v[76:79], a[92:95], v[124:127]
v_mfma_f32_16x16x32_bf16 v[120:123], v[76:79], a[88:91], v[120:123]
v_mfma_f32_16x16x32_bf16 v[116:119], v[76:79], a[84:87], v[116:119]
v_mfma_f32_16x16x32_bf16 v[112:115], v[76:79], a[80:83], v[112:115]
s_waitcnt lgkmcnt(10)
ds_read_b64_tr_b16 v[76:77], v1 offset:12288
buffer_load_dwordx4 v10, s[16:19], s59 offen lds
v_mfma_f32_16x16x32_bf16 v[96:99], v[48:51], a[96:99], v[96:99]
s_add_u32 m0, s4, 53248
s_add_u32 s59, s62, 148224
ds_read_b64_tr_b16 v[78:79], v1 offset:14336
v_mfma_f32_16x16x32_bf16 v[100:103], v[48:51], a[100:103], v[100:103]
buffer_load_dwordx4 v10, s[16:19], s56 offen lds
v_mfma_f32_16x16x32_bf16 v[104:107], v[48:51], a[104:107], v[104:107]
s_add_u32 m0, s4, 57344
s_add_u32 s56, s62, 185088
v_mfma_f32_16x16x32_bf16 v[108:111], v[48:51], a[108:111], v[108:111]
buffer_load_dwordx4 v10, s[16:19], s57 offen lds
buffer_load_dword v40, v12, s[32:35], s69 offen sc1
v_mfma_f32_16x16x32_bf16 v[124:127], v[52:55], a[108:111], v[124:127]
s_add_u32 m0, s4, 61440
s_add_u32 s57, s62, 221952
ds_read_b128 v[128:131], v15 offset:0
v_mfma_f32_16x16x32_bf16 v[120:123], v[52:55], a[104:107], v[120:123]
buffer_load_dwordx4 v10, s[16:19], s58 offen lds
v_mfma_f32_16x16x32_bf16 v[116:119], v[52:55], a[100:103], v[116:119]
s_add_u32 m0, s4, 65536
s_add_u32 s58, s62, 258816
v_mfma_f32_16x16x32_bf16 v[112:115], v[52:55], a[96:99], v[112:115]
s_waitcnt lgkmcnt(3)
buffer_load_dwordx4 v[148:151], v14, s[20:23], s40 offen
v_mfma_f32_16x16x32_bf16 v[96:99], v[56:59], a[112:115], v[96:99]
v_mfma_f32_16x16x32_bf16 v[100:103], v[56:59], a[116:119], v[100:103]
v_mfma_f32_16x16x32_bf16 v[104:107], v[56:59], a[120:123], v[104:107]
v_mfma_f32_16x16x32_bf16 v[108:111], v[56:59], a[124:127], v[108:111]
ds_read_b128 v[132:135], v15 offset:512
v_mfma_f32_16x16x32_bf16 v[124:127], v[60:63], a[124:127], v[124:127]
v_mfma_f32_16x16x32_bf16 v[120:123], v[60:63], a[120:123], v[120:123]
v_mfma_f32_16x16x32_bf16 v[116:119], v[60:63], a[116:119], v[116:119]
v_mfma_f32_16x16x32_bf16 v[112:115], v[60:63], a[112:115], v[112:115]
buffer_load_dwordx4 v[152:155], v14, s[20:23], s41 offen
v_mfma_f32_16x16x32_bf16 v[96:99], v[64:67], a[128:131], v[96:99]
v_mfma_f32_16x16x32_bf16 v[100:103], v[64:67], a[132:135], v[100:103]
v_mfma_f32_16x16x32_bf16 v[104:107], v[64:67], a[136:139], v[104:107]
s_nop 5
v_cvt_pk_bf16_f32 v80, v96, v97
v_cvt_pk_bf16_f32 v81, v98, v99
v_mfma_f32_16x16x32_bf16 v[108:111], v[64:67], a[140:143], v[108:111]
ds_read_b128 v[136:139], v15 offset:1024
v_cvt_pk_bf16_f32 v84, v100, v101
v_mfma_f32_16x16x32_bf16 v[124:127], v[68:71], a[140:143], v[124:127]
v_cvt_pk_bf16_f32 v85, v102, v103
v_cvt_pk_bf16_f32 v88, v104, v105
v_mfma_f32_16x16x32_bf16 v[120:123], v[68:71], a[136:139], v[120:123]
s_waitcnt vmcnt(15)
s_barrier
ds_read_b64_tr_b16 v[48:49], v0 offset:16384
ds_read_b64_tr_b16 v[50:51], v0 offset:18432
v_mfma_f32_16x16x32_bf16 v[116:119], v[68:71], a[132:135], v[116:119]
ds_read_b64_tr_b16 v[52:53], v1 offset:16384
ds_read_b64_tr_b16 v[54:55], v1 offset:18432
v_mfma_f32_16x16x32_bf16 v[112:115], v[68:71], a[128:131], v[112:115]
ds_read_b64_tr_b16 v[56:57], v0 offset:20480
buffer_load_dwordx2 v[156:157], v14, s[20:23], s42 offen
v_mfma_f32_16x16x32_bf16 v[224:227], v[72:75], a[0:3], 0
ds_read_b64_tr_b16 v[58:59], v0 offset:22528
ds_read_b64_tr_b16 v[60:61], v1 offset:20480
v_mfma_f32_16x16x32_bf16 v[228:231], v[72:75], a[4:7], 0
ds_read_b64_tr_b16 v[62:63], v1 offset:22528
ds_read_b64_tr_b16 v[64:65], v0 offset:24576
v_mfma_f32_16x16x32_bf16 v[232:235], v[72:75], a[8:11], 0
ds_read_b64_tr_b16 v[66:67], v0 offset:26624
ds_read_b64_tr_b16 v[68:69], v1 offset:24576
v_mfma_f32_16x16x32_bf16 v[236:239], v[72:75], a[12:15], 0
s_waitcnt lgkmcnt(12)
ds_read_b64_tr_b16 v[70:71], v1 offset:26624
ds_read_b64_tr_b16 v[72:73], v0 offset:28672
v_mfma_f32_16x16x32_bf16 v[252:255], v[76:79], a[12:15], 0
ds_read_b64_tr_b16 v[74:75], v0 offset:30720
v_cvt_pk_bf16_f32 v89, v106, v107
v_mfma_f32_16x16x32_bf16 v[248:251], v[76:79], a[8:11], 0
v_cvt_pk_bf16_f32 v92, v108, v109
v_cvt_pk_bf16_f32 v93, v110, v111
v_mfma_f32_16x16x32_bf16 v[244:247], v[76:79], a[4:7], 0
ds_read_b128 v[140:143], v15 offset:1536
v_cvt_pk_bf16_f32 v94, v124, v125
v_mfma_f32_16x16x32_bf16 v[240:243], v[76:79], a[0:3], 0
s_waitcnt lgkmcnt(11)
ds_read_b64_tr_b16 v[76:77], v1 offset:28672
buffer_load_dwordx4 v10, s[16:19], s59 offen lds
v_mfma_f32_16x16x32_bf16 v[224:227], v[48:51], a[16:19], v[224:227]
s_add_u32 m0, s4, 69632
s_add_u32 s59, s63, 768
ds_read_b64_tr_b16 v[78:79], v1 offset:30720
v_mfma_f32_16x16x32_bf16 v[228:231], v[48:51], a[20:23], v[228:231]
buffer_load_dwordx4 v10, s[16:19], s56 offen lds
v_cvt_pk_bf16_f32 v95, v126, v127
v_mfma_f32_16x16x32_bf16 v[232:235], v[48:51], a[24:27], v[232:235]
s_add_u32 m0, s4, 73728
s_add_u32 s56, s62, 896
buffer_store_dwordx4 v[92:95], v11, s[28:31], s50 offen offset:0 sc1
v_mfma_f32_16x16x32_bf16 v[236:239], v[48:51], a[28:31], v[236:239]
buffer_load_dwordx4 v10, s[16:19], s57 offen lds
v_cvt_pk_bf16_f32 v90, v120, v121
v_mfma_f32_16x16x32_bf16 v[252:255], v[52:55], a[28:31], v[252:255]
s_add_u32 m0, s4, 77824
s_add_u32 s57, s62, 37760
v_cvt_pk_bf16_f32 v91, v122, v123
v_mfma_f32_16x16x32_bf16 v[248:251], v[52:55], a[24:27], v[248:251]
buffer_store_dwordx4 v[88:91], v11, s[28:31], s47 offen offset:0 sc1
buffer_load_dwordx4 v10, s[16:19], s58 offen lds
v_mfma_f32_16x16x32_bf16 v[244:247], v[52:55], a[20:23], v[244:247]
s_add_u32 m0, s4, 0
s_add_u32 s58, s62, 74624
v_cvt_pk_bf16_f32 v86, v116, v117
v_mfma_f32_16x16x32_bf16 v[240:243], v[52:55], a[16:19], v[240:243]
s_waitcnt lgkmcnt(2)
v_cvt_pk_bf16_f32 v82, v112, v113
v_cvt_pk_bf16_f32 v87, v118, v119
v_mfma_f32_16x16x32_bf16 v[224:227], v[56:59], a[32:35], v[224:227]
buffer_store_dwordx4 v[84:87], v11, s[28:31], s44 offen offset:0 sc1
v_cvt_pk_bf16_f32 v83, v114, v115
v_mfma_f32_16x16x32_bf16 v[228:231], v[56:59], a[36:39], v[228:231]
ds_read_b128 v[144:147], v15 offset:2048
buffer_store_dwordx4 v[80:83], v11, s[28:31], s41 offen offset:0 sc1
v_mfma_f32_16x16x32_bf16 v[232:235], v[56:59], a[40:43], v[232:235]
v_mfma_f32_16x16x32_bf16 v[236:239], v[56:59], a[44:47], v[236:239]
v_mfma_f32_16x16x32_bf16 v[252:255], v[60:63], a[44:47], v[252:255]
v_mfma_f32_16x16x32_bf16 v[248:251], v[60:63], a[40:43], v[248:251]
v_mfma_f32_16x16x32_bf16 v[244:247], v[60:63], a[36:39], v[244:247]
v_mfma_f32_16x16x32_bf16 v[240:243], v[60:63], a[32:35], v[240:243]
v_mfma_f32_16x16x32_bf16 v[224:227], v[64:67], a[48:51], v[224:227]
v_mfma_f32_16x16x32_bf16 v[228:231], v[64:67], a[52:55], v[228:231]
v_mfma_f32_16x16x32_bf16 v[232:235], v[64:67], a[56:59], v[232:235]
v_mfma_f32_16x16x32_bf16 v[236:239], v[64:67], a[60:63], v[236:239]
v_mfma_f32_16x16x32_bf16 v[252:255], v[68:71], a[60:63], v[252:255]
v_mfma_f32_16x16x32_bf16 v[248:251], v[68:71], a[56:59], v[248:251]
s_waitcnt vmcnt(16)
s_barrier
ds_read_b64_tr_b16 v[48:49], v0 offset:32768
ds_read_b64_tr_b16 v[50:51], v0 offset:34816
v_mfma_f32_16x16x32_bf16 v[244:247], v[68:71], a[52:55], v[244:247]
ds_read_b64_tr_b16 v[52:53], v1 offset:32768
ds_read_b64_tr_b16 v[54:55], v1 offset:34816
v_mfma_f32_16x16x32_bf16 v[240:243], v[68:71], a[48:51], v[240:243]
ds_read_b64_tr_b16 v[56:57], v0 offset:36864
ds_read_b64_tr_b16 v[58:59], v0 offset:38912
v_mfma_f32_16x16x32_bf16 v[224:227], v[72:75], a[64:67], v[224:227]
ds_read_b64_tr_b16 v[60:61], v1 offset:36864
ds_read_b64_tr_b16 v[62:63], v1 offset:38912
v_mfma_f32_16x16x32_bf16 v[228:231], v[72:75], a[68:71], v[228:231]
ds_read_b64_tr_b16 v[64:65], v0 offset:40960
ds_read_b64_tr_b16 v[66:67], v0 offset:43008
v_mfma_f32_16x16x32_bf16 v[232:235], v[72:75], a[72:75], v[232:235]
ds_read_b64_tr_b16 v[68:69], v1 offset:40960
ds_read_b64_tr_b16 v[70:71], v1 offset:43008
v_mfma_f32_16x16x32_bf16 v[236:239], v[72:75], a[76:79], v[236:239]
s_waitcnt lgkmcnt(12)
ds_read_b64_tr_b16 v[72:73], v0 offset:45056
ds_read_b64_tr_b16 v[74:75], v0 offset:47104
v_mfma_f32_16x16x32_bf16 v[252:255], v[76:79], a[76:79], v[252:255]
v_mov_b32 v41, 2
v_mfma_f32_16x16x32_bf16 v[248:251], v[76:79], a[72:75], v[248:251]
v_mfma_f32_16x16x32_bf16 v[244:247], v[76:79], a[68:71], v[244:247]
v_mfma_f32_16x16x32_bf16 v[240:243], v[76:79], a[64:67], v[240:243]
s_waitcnt lgkmcnt(10)
buffer_store_dword v41, v13, s[32:35], s69 offen sc1
buffer_load_dwordx4 v10, s[16:19], s59 offen lds
v_mfma_f32_16x16x32_bf16 v[224:227], v[48:51], a[80:83], v[224:227]
s_add_u32 m0, s4, 4096
s_mov_b32 s59, 0
ds_read_b64_tr_b16 v[76:77], v1 offset:45056
v_mfma_f32_16x16x32_bf16 v[228:231], v[48:51], a[84:87], v[228:231]
ds_read_b64_tr_b16 v[78:79], v1 offset:47104
buffer_load_dwordx4 v10, s[16:19], s56 offen lds
v_mfma_f32_16x16x32_bf16 v[232:235], v[48:51], a[88:91], v[232:235]
s_add_u32 m0, s4, 8192
s_mov_b32 s56, 18432
v_mfma_f32_16x16x32_bf16 v[236:239], v[48:51], a[92:95], v[236:239]
buffer_load_dwordx4 v10, s[16:19], s57 offen lds
v_mfma_f32_16x16x32_bf16 v[252:255], v[52:55], a[92:95], v[252:255]
s_add_u32 m0, s4, 12288
s_mov_b32 s57, 36864
v_mfma_f32_16x16x32_bf16 v[248:251], v[52:55], a[88:91], v[248:251]
buffer_load_dwordx4 v10, s[16:19], s58 offen lds
v_mfma_f32_16x16x32_bf16 v[244:247], v[52:55], a[84:87], v[244:247]
s_mov_b32 s58, 55296
s_add_u32 m0, s4, 16384
v_mfma_f32_16x16x32_bf16 v[240:243], v[52:55], a[80:83], v[240:243]
s_waitcnt lgkmcnt(2)
v_mfma_f32_16x16x32_bf16 v[224:227], v[56:59], a[96:99], v[224:227]
v_mfma_f32_16x16x32_bf16 v[228:231], v[56:59], a[100:103], v[228:231]
v_mfma_f32_16x16x32_bf16 v[232:235], v[56:59], a[104:107], v[232:235]
v_mfma_f32_16x16x32_bf16 v[236:239], v[56:59], a[108:111], v[236:239]
v_mfma_f32_16x16x32_bf16 v[252:255], v[60:63], a[108:111], v[252:255]
v_mfma_f32_16x16x32_bf16 v[248:251], v[60:63], a[104:107], v[248:251]
v_mfma_f32_16x16x32_bf16 v[244:247], v[60:63], a[100:103], v[244:247]
v_mfma_f32_16x16x32_bf16 v[240:243], v[60:63], a[96:99], v[240:243]
v_mfma_f32_16x16x32_bf16 v[224:227], v[64:67], a[112:115], v[224:227]
v_mfma_f32_16x16x32_bf16 v[228:231], v[64:67], a[116:119], v[228:231]
v_mfma_f32_16x16x32_bf16 v[232:235], v[64:67], a[120:123], v[232:235]
v_mfma_f32_16x16x32_bf16 v[236:239], v[64:67], a[124:127], v[236:239]
s_waitcnt vmcnt(17)
v_cmp_gt_u32 vcc, 1, v40
v_mfma_f32_16x16x32_bf16 v[252:255], v[68:71], a[124:127], v[252:255]
s_and_b32 vcc_lo, vcc_lo, 0xffff
s_cbranch_scc1 k3_p1
k3_p1r:
buffer_load_dwordx4 a[144:147], v8, s[28:31], s59 offen sc1
v_mfma_f32_16x16x32_bf16 v[248:251], v[68:71], a[120:123], v[248:251]
s_mov_b32 s59, 73728
buffer_load_dwordx4 a[148:151], v8, s[28:31], s56 offen sc1
buffer_load_dwordx4 a[152:155], v8, s[28:31], s57 offen sc1
v_mfma_f32_16x16x32_bf16 v[244:247], v[68:71], a[116:119], v[244:247]
s_waitcnt vmcnt(19)
s_mov_b32 s56, 92160
s_mov_b32 s57, 110592
s_barrier
v_mfma_f32_16x16x32_bf16 v[240:243], v[68:71], a[112:115], v[240:243]
ds_read_b64_tr_b16 v[48:49], v0 offset:49152
ds_read_b64_tr_b16 v[50:51], v0 offset:51200
v_mfma_f32_16x16x32_bf16 v[224:227], v[72:75], a[128:131], v[224:227]
ds_read_b64_tr_b16 v[52:53], v1 offset:49152
ds_read_b64_tr_b16 v[54:55], v1 offset:51200
v_mfma_f32_16x16x32_bf16 v[228:231], v[72:75], a[132:135], v[228:231]
ds_read_b64_tr_b16 v[56:57], v0 offset:53248
ds_read_b64_tr_b16 v[58:59], v0 offset:55296
v_mfma_f32_16x16x32_bf16 v[232:235], v[72:75], a[136:139], v[232:235]
ds_read_b64_tr_b16 v[60:61], v1 offset:53248
ds_read_b64_tr_b16 v[62:63], v1 offset:55296
v_mfma_f32_16x16x32_bf16 v[236:239], v[72:75], a[140:143], v[236:239]
s_waitcnt lgkmcnt(8)
ds_read_b64_tr_b16 v[64:65], v0 offset:57344
buffer_load_dwordx4 a[156:159], v8, s[28:31], s58 offen sc1
v_mfma_f32_16x16x32_bf16 v[252:255], v[76:79], a[140:143], v[252:255]
s_mov_b32 s58, 129024
ds_read_b64_tr_b16 v[66:67], v0 offset:59392
ds_read_b64_tr_b16 v[68:69], v1 offset:57344
v_mfma_f32_16x16x32_bf16 v[248:251], v[76:79], a[136:139], v[248:251]
ds_read_b64_tr_b16 v[70:71], v1 offset:59392
ds_read_b64_tr_b16 v[72:73], v0 offset:61440
v_mfma_f32_16x16x32_bf16 v[244:247], v[76:79], a[132:135], v[244:247]
ds_read_b64_tr_b16 v[74:75], v0 offset:63488
v_cvt_pk_bf16_f32 v80, v224, v225
v_mfma_f32_16x16x32_bf16 v[240:243], v[76:79], a[128:131], v[240:243]
s_waitcnt lgkmcnt(12)
ds_read_b64_tr_b16 v[76:77], v1 offset:61440
ds_read_b64_tr_b16 v[78:79], v1 offset:63488
v_mfma_f32_16x16x32_bf16 v[96:99], v[48:51], a[0:3], 0
buffer_load_dwordx4 a[160:163], v8, s[28:31], s59 offen sc1
v_cvt_pk_bf16_f32 v81, v226, v227
v_mfma_f32_16x16x32_bf16 v[100:103], v[48:51], a[4:7], 0
s_add_u32 s59, s62, 111488
v_cvt_pk_bf16_f32 v84, v228, v229
v_cvt_pk_bf16_f32 v85, v230, v231
v_mfma_f32_16x16x32_bf16 v[104:107], v[48:51], a[8:11], 0
buffer_load_dwordx4 a[164:167], v8, s[28:31], s56 offen sc1
buffer_load_dwordx4 v10, s[16:19], s59 offen lds
v_mfma_f32_16x16x32_bf16 v[108:111], v[48:51], a[12:15], 0
s_waitcnt lgkmcnt(8)
s_add_u32 m0, s4, 20480
s_add_u32 s56, s62, 148352
s_add_u32 s59, s62, 258944
v_mfma_f32_16x16x32_bf16 v[124:127], v[52:55], a[12:15], 0
buffer_load_dwordx4 a[168:171], v8, s[28:31], s57 offen sc1
buffer_load_dwordx4 v10, s[16:19], s56 offen lds
v_mfma_f32_16x16x32_bf16 v[120:123], v[52:55], a[8:11], 0
s_add_u32 m0, s4, 24576
s_add_u32 s57, s62, 185216
s_add_u32 s56, s63, 896
v_mfma_f32_16x16x32_bf16 v[116:119], v[52:55], a[4:7], 0
buffer_load_dwordx4 a[172:175], v8, s[28:31], s58 offen sc1
buffer_load_dwordx4 v10, s[16:19], s57 offen lds
v_mfma_f32_16x16x32_bf16 v[112:115], v[52:55], a[0:3], 0
s_add_u32 m0, s4, 28672
s_add_u32 s58, s62, 222080
s_add_u32 s57, s62, 1024
v_mfma_f32_16x16x32_bf16 v[96:99], v[56:59], a[16:19], v[96:99]
buffer_load_dwordx4 v10, s[16:19], s58 offen lds
v_cvt_pk_bf16_f32 v88, v232, v233
v_mfma_f32_16x16x32_bf16 v[100:103], v[56:59], a[20:23], v[100:103]
s_add_u32 m0, s4, 32768
s_add_u32 s58, s62, 37888
v_cvt_pk_bf16_f32 v89, v234, v235
v_mfma_f32_16x16x32_bf16 v[104:107], v[56:59], a[24:27], v[104:107]
v_cvt_pk_bf16_f32 v92, v236, v237
v_cvt_pk_bf16_f32 v93, v238, v239
v_mfma_f32_16x16x32_bf16 v[108:111], v[56:59], a[28:31], v[108:111]
v_cvt_pk_bf16_f32 v94, v252, v253
v_mfma_f32_16x16x32_bf16 v[124:127], v[60:63], a[28:31], v[124:127]
v_cvt_pk_bf16_f32 v90, v248, v249
v_cvt_pk_bf16_f32 v95, v254, v255
v_mfma_f32_16x16x32_bf16 v[120:123], v[60:63], a[24:27], v[120:123]
buffer_store_dwordx4 v[92:95], v11, s[28:31], s50 offen offset:1024 sc1
v_cvt_pk_bf16_f32 v91, v250, v251
v_mfma_f32_16x16x32_bf16 v[116:119], v[60:63], a[20:23], v[116:119]
buffer_store_dwordx4 v[88:91], v11, s[28:31], s47 offen offset:1024 sc1
v_cvt_pk_bf16_f32 v86, v244, v245
v_mfma_f32_16x16x32_bf16 v[112:115], v[60:63], a[16:19], v[112:115]
s_waitcnt lgkmcnt(0)
v_cvt_pk_bf16_f32 v82, v240, v241
v_cvt_pk_bf16_f32 v87, v246, v247
v_mfma_f32_16x16x32_bf16 v[96:99], v[64:67], a[32:35], v[96:99]
buffer_store_dwordx4 v[84:87], v11, s[28:31], s44 offen offset:1024 sc1
v_cvt_pk_bf16_f32 v83, v242, v243
v_mfma_f32_16x16x32_bf16 v[100:103], v[64:67], a[36:39], v[100:103]
buffer_store_dwordx4 v[80:83], v11, s[28:31], s41 offen offset:1024 sc1
v_mfma_f32_16x16x32_bf16 v[104:107], v[64:67], a[40:43], v[104:107]
v_mfma_f32_16x16x32_bf16 v[108:111], v[64:67], a[44:47], v[108:111]
v_mfma_f32_16x16x32_bf16 v[124:127], v[68:71], a[44:47], v[124:127]
v_mfma_f32_16x16x32_bf16 v[120:123], v[68:71], a[40:43], v[120:123]
s_waitcnt vmcnt(23)
s_barrier
ds_read_b64_tr_b16 v[48:49], v2 offset:0
ds_read_b64_tr_b16 v[50:51], v2 offset:2048
v_mfma_f32_16x16x32_bf16 v[116:119], v[68:71], a[36:39], v[116:119]
ds_read_b64_tr_b16 v[52:53], v3 offset:0
ds_read_b64_tr_b16 v[54:55], v3 offset:2048
v_mfma_f32_16x16x32_bf16 v[112:115], v[68:71], a[32:35], v[112:115]
ds_read_b64_tr_b16 v[56:57], v2 offset:4096
ds_read_b64_tr_b16 v[58:59], v2 offset:6144
v_mfma_f32_16x16x32_bf16 v[96:99], v[72:75], a[48:51], v[96:99]
ds_read_b64_tr_b16 v[60:61], v3 offset:4096
ds_read_b64_tr_b16 v[62:63], v3 offset:6144
v_mfma_f32_16x16x32_bf16 v[100:103], v[72:75], a[52:55], v[100:103]
ds_read_b64_tr_b16 v[64:65], v2 offset:8192
ds_read_b64_tr_b16 v[66:67], v2 offset:10240
v_mfma_f32_16x16x32_bf16 v[104:107], v[72:75], a[56:59], v[104:107]
ds_read_b64_tr_b16 v[68:69], v3 offset:8192
ds_read_b64_tr_b16 v[70:71], v3 offset:10240
v_mfma_f32_16x16x32_bf16 v[108:111], v[72:75], a[60:63], v[108:111]
ds_read_b64_tr_b16 v[72:73], v2 offset:12288
ds_read_b64_tr_b16 v[74:75], v2 offset:14336
v_mfma_f32_16x16x32_bf16 v[124:127], v[76:79], a[60:63], v[124:127]
v_mfma_f32_16x16x32_bf16 v[120:123], v[76:79], a[56:59], v[120:123]
v_mfma_f32_16x16x32_bf16 v[116:119], v[76:79], a[52:55], v[116:119]
v_mfma_f32_16x16x32_bf16 v[112:115], v[76:79], a[48:51], v[112:115]
s_waitcnt lgkmcnt(10)
ds_read_b64_tr_b16 v[76:77], v3 offset:12288
buffer_load_dwordx4 v10, s[16:19], s59 offen lds
v_mfma_f32_16x16x32_bf16 v[96:99], v[48:51], a[64:67], v[96:99]
s_add_u32 m0, s4, 36864
s_add_u32 s59, s62, 74752
ds_read_b64_tr_b16 v[78:79], v3 offset:14336
v_mfma_f32_16x16x32_bf16 v[100:103], v[48:51], a[68:71], v[100:103]
buffer_load_dwordx4 v10, s[16:19], s56 offen lds
v_mfma_f32_16x16x32_bf16 v[104:107], v[48:51], a[72:75], v[104:107]
s_add_u32 m0, s4, 40960
s_add_u32 s56, s62, 111616
v_mfma_f32_16x16x32_bf16 v[108:111], v[48:51], a[76:79], v[108:111]
buffer_load_dwordx4 v10, s[16:19], s57 offen lds
v_mfma_f32_16x16x32_bf16 v[124:127], v[52:55], a[76:79], v[124:127]
s_add_u32 m0, s4, 45056
s_add_u32 s57, s62, 148480
v_mfma_f32_16x16x32_bf16 v[120:123], v[52:55], a[72:75], v[120:123]
buffer_load_dwordx4 v10, s[16:19], s58 offen lds
v_mfma_f32_16x16x32_bf16 v[116:119], v[52:55], a[68:71], v[116:119]
s_add_u32 m0, s4, 49152
s_add_u32 s58, s62, 185344
v_mfma_f32_16x16x32_bf16 v[112:115], v[52:55], a[64:67], v[112:115]
s_waitcnt lgkmcnt(2)
v_mfma_f32_16x16x32_bf16 v[96:99], v[56:59], a[80:83], v[96:99]
v_mfma_f32_16x16x32_bf16 v[100:103], v[56:59], a[84:87], v[100:103]
v_mfma_f32_16x16x32_bf16 v[104:107], v[56:59], a[88:91], v[104:107]
v_mfma_f32_16x16x32_bf16 v[108:111], v[56:59], a[92:95], v[108:111]
v_mfma_f32_16x16x32_bf16 v[124:127], v[60:63], a[92:95], v[124:127]
v_mfma_f32_16x16x32_bf16 v[120:123], v[60:63], a[88:91], v[120:123]
v_mfma_f32_16x16x32_bf16 v[116:119], v[60:63], a[84:87], v[116:119]
v_mfma_f32_16x16x32_bf16 v[112:115], v[60:63], a[80:83], v[112:115]
buffer_load_dword v40, v12, s[32:35], s69 offen sc1
v_mfma_f32_16x16x32_bf16 v[96:99], v[64:67], a[96:99], v[96:99]
v_mfma_f32_16x16x32_bf16 v[100:103], v[64:67], a[100:103], v[100:103]
v_mfma_f32_16x16x32_bf16 v[104:107], v[64:67], a[104:107], v[104:107]
v_mfma_f32_16x16x32_bf16 v[108:111], v[64:67], a[108:111], v[108:111]
v_mfma_f32_16x16x32_bf16 v[124:127], v[68:71], a[108:111], v[124:127]
v_mfma_f32_16x16x32_bf16 v[120:123], v[68:71], a[104:107], v[120:123]
s_waitcnt vmcnt(21)
s_barrier
ds_read_b64_tr_b16 v[48:49], v0 offset:0
ds_read_b64_tr_b16 v[50:51], v0 offset:2048
v_mfma_f32_16x16x32_bf16 v[116:119], v[68:71], a[100:103], v[116:119]
ds_read_b64_tr_b16 v[52:53], v1 offset:0
ds_read_b64_tr_b16 v[54:55], v1 offset:2048
v_mfma_f32_16x16x32_bf16 v[112:115], v[68:71], a[96:99], v[112:115]
ds_read_b64_tr_b16 v[56:57], v0 offset:4096
ds_read_b64_tr_b16 v[58:59], v0 offset:6144
v_mfma_f32_16x16x32_bf16 v[96:99], v[72:75], a[112:115], v[96:99]
ds_read_b64_tr_b16 v[60:61], v1 offset:4096
ds_read_b64_tr_b16 v[62:63], v1 offset:6144
v_mfma_f32_16x16x32_bf16 v[100:103], v[72:75], a[116:119], v[100:103]
ds_read_b64_tr_b16 v[64:65], v0 offset:8192
ds_read_b64_tr_b16 v[66:67], v0 offset:10240
v_mfma_f32_16x16x32_bf16 v[104:107], v[72:75], a[120:123], v[104:107]
ds_read_b64_tr_b16 v[68:69], v1 offset:8192
ds_read_b64_tr_b16 v[70:71], v1 offset:10240
v_mfma_f32_16x16x32_bf16 v[108:111], v[72:75], a[124:127], v[108:111]
s_waitcnt lgkmcnt(12)
ds_read_b64_tr_b16 v[72:73], v0 offset:12288
ds_read_b64_tr_b16 v[74:75], v0 offset:14336
v_mfma_f32_16x16x32_bf16 v[124:127], v[76:79], a[124:127], v[124:127]
v_mfma_f32_16x16x32_bf16 v[120:123], v[76:79], a[120:123], v[120:123]
v_mfma_f32_16x16x32_bf16 v[116:119], v[76:79], a[116:119], v[116:119]
v_mfma_f32_16x16x32_bf16 v[112:115], v[76:79], a[112:115], v[112:115]
s_waitcnt lgkmcnt(10)
ds_read_b64_tr_b16 v[76:77], v1 offset:12288
buffer_load_dwordx4 v10, s[16:19], s59 offen lds
v_mfma_f32_16x16x32_bf16 v[96:99], v[48:51], a[128:131], v[96:99]
s_add_u32 m0, s4, 53248
s_add_u32 s59, s62, 222208
ds_read_b64_tr_b16 v[78:79], v1 offset:14336
v_mfma_f32_16x16x32_bf16 v[100:103], v[48:51], a[132:135], v[100:103]
buffer_load_dwordx4 v10, s[16:19], s56 offen lds
v_mfma_f32_16x16x32_bf16 v[104:107], v[48:51], a[136:139], v[104:107]
s_add_u32 m0, s4, 57344
s_add_u32 s56, s62, 259072
v_cvt_pk_bf16_f32 v80, v96, v97
v_mfma_f32_16x16x32_bf16 v[108:111], v[48:51], a[140:143], v[108:111]
buffer_load_dwordx4 v10, s[16:19], s57 offen lds
v_cvt_pk_bf16_f32 v81, v98, v99
v_mfma_f32_16x16x32_bf16 v[124:127], v[52:55], a[140:143], v[124:127]
s_add_u32 m0, s4, 61440
s_add_u32 s57, s63, 1024
v_cvt_pk_bf16_f32 v84, v100, v101
v_mfma_f32_16x16x32_bf16 v[120:123], v[52:55], a[136:139], v[120:123]
buffer_load_dwordx4 v10, s[16:19], s58 offen lds
v_cvt_pk_bf16_f32 v85, v102, v103
v_mfma_f32_16x16x32_bf16 v[116:119], v[52:55], a[132:135], v[116:119]
s_add_u32 m0, s4, 65536
s_movk_i32 s58, 2048
v_cvt_pk_bf16_f32 v88, v104, v105
v_mfma_f32_16x16x32_bf16 v[112:115], v[52:55], a[128:131], v[112:115]
s_waitcnt lgkmcnt(2)
v_cvt_pk_bf16_f32 v89, v106, v107
v_cvt_pk_bf16_f32 v92, v108, v109
v_mfma_f32_16x16x32_bf16 v[224:227], v[56:59], a[0:3], 0
v_cvt_pk_bf16_f32 v93, v110, v111
v_mfma_f32_16x16x32_bf16 v[228:231], v[56:59], a[4:7], 0
v_cvt_pk_bf16_f32 v94, v124, v125
v_cvt_pk_bf16_f32 v95, v126, v127
v_mfma_f32_16x16x32_bf16 v[232:235], v[56:59], a[8:11], 0
v_cvt_pk_bf16_f32 v90, v120, v121
v_mfma_f32_16x16x32_bf16 v[236:239], v[56:59], a[12:15], 0
buffer_store_dwordx4 v[92:95], v11, s[28:31], s50 offen offset:2048 sc1
v_cvt_pk_bf16_f32 v91, v122, v123
v_mfma_f32_16x16x32_bf16 v[252:255], v[60:63], a[12:15], 0
buffer_store_dwordx4 v[88:91], v11, s[28:31], s47 offen offset:2048 sc1
v_cvt_pk_bf16_f32 v86, v116, v117
v_mfma_f32_16x16x32_bf16 v[248:251], v[60:63], a[8:11], 0
v_cvt_pk_bf16_f32 v82, v112, v113
v_cvt_pk_bf16_f32 v87, v118, v119
v_mfma_f32_16x16x32_bf16 v[244:247], v[60:63], a[4:7], 0
buffer_store_dwordx4 v[84:87], v11, s[28:31], s44 offen offset:2048 sc1
v_cvt_pk_bf16_f32 v83, v114, v115
v_mfma_f32_16x16x32_bf16 v[240:243], v[60:63], a[0:3], 0
buffer_store_dwordx4 v[80:83], v11, s[28:31], s41 offen offset:2048 sc1
v_mfma_f32_16x16x32_bf16 v[224:227], v[64:67], a[16:19], v[224:227]
v_mfma_f32_16x16x32_bf16 v[228:231], v[64:67], a[20:23], v[228:231]
v_mfma_f32_16x16x32_bf16 v[232:235], v[64:67], a[24:27], v[232:235]
v_mfma_f32_16x16x32_bf16 v[236:239], v[64:67], a[28:31], v[236:239]
v_mfma_f32_16x16x32_bf16 v[252:255], v[68:71], a[28:31], v[252:255]
v_mfma_f32_16x16x32_bf16 v[248:251], v[68:71], a[24:27], v[248:251]
v_mfma_f32_16x16x32_bf16 v[244:247], v[68:71], a[20:23], v[244:247]
v_mfma_f32_16x16x32_bf16 v[240:243], v[68:71], a[16:19], v[240:243]
v_mfma_f32_16x16x32_bf16 v[224:227], v[72:75], a[32:35], v[224:227]
s_waitcnt vmcnt(17)
s_barrier
ds_read_b64_tr_b16 v[48:49], v0 offset:16384
ds_read_b64_tr_b16 v[50:51], v0 offset:18432
v_mfma_f32_16x16x32_bf16 v[228:231], v[72:75], a[36:39], v[228:231]
ds_read_b64_tr_b16 v[52:53], v1 offset:16384
ds_read_b64_tr_b16 v[54:55], v1 offset:18432
v_mfma_f32_16x16x32_bf16 v[232:235], v[72:75], a[40:43], v[232:235]
ds_read_b64_tr_b16 v[56:57], v0 offset:20480
ds_read_b64_tr_b16 v[58:59], v0 offset:22528
v_mfma_f32_16x16x32_bf16 v[236:239], v[72:75], a[44:47], v[236:239]
s_waitcnt lgkmcnt(6)
ds_read_b64_tr_b16 v[60:61], v1 offset:20480
ds_read_b64_tr_b16 v[62:63], v1 offset:22528
v_mfma_f32_16x16x32_bf16 v[252:255], v[76:79], a[44:47], v[252:255]
ds_read_b64_tr_b16 v[64:65], v0 offset:24576
ds_read_b64_tr_b16 v[66:67], v0 offset:26624
v_mfma_f32_16x16x32_bf16 v[248:251], v[76:79], a[40:43], v[248:251]
ds_read_b64_tr_b16 v[68:69], v1 offset:24576
ds_read_b64_tr_b16 v[70:71], v1 offset:26624
v_mfma_f32_16x16x32_bf16 v[244:247], v[76:79], a[36:39], v[244:247]
ds_read_b64_tr_b16 v[72:73], v0 offset:28672
ds_read_b64_tr_b16 v[74:75], v0 offset:30720
v_mfma_f32_16x16x32_bf16 v[240:243], v[76:79], a[32:35], v[240:243]
s_waitcnt lgkmcnt(12)
ds_read_b64_tr_b16 v[76:77], v1 offset:28672
buffer_load_dwordx4 v10, s[16:19], s59 offen lds
v_mfma_f32_16x16x32_bf16 v[224:227], v[48:51], a[48:51], v[224:227]
s_add_u32 m0, s4, 69632
s_movk_i32 s59, 20480
ds_read_b64_tr_b16 v[78:79], v1 offset:30720
v_mfma_f32_16x16x32_bf16 v[228:231], v[48:51], a[52:55], v[228:231]
buffer_load_dwordx4 v10, s[16:19], s56 offen lds
v_mfma_f32_16x16x32_bf16 v[232:235], v[48:51], a[56:59], v[232:235]
s_add_u32 m0, s4, 73728
s_mov_b32 s56, 38912
v_mfma_f32_16x16x32_bf16 v[236:239], v[48:51], a[60:63], v[236:239]
s_waitcnt lgkmcnt(10)
buffer_load_dwordx4 v10, s[16:19], s57 offen lds
v_mfma_f32_16x16x32_bf16 v[252:255], v[52:55], a[60:63], v[252:255]
s_mov_b32 s57, 57344
v_mfma_f32_16x16x32_bf16 v[248:251], v[52:55], a[56:59], v[248:251]
v_mfma_f32_16x16x32_bf16 v[244:247], v[52:55], a[52:55], v[244:247]
v_mfma_f32_16x16x32_bf16 v[240:243], v[52:55], a[48:51], v[240:243]
v_mov_b32 v41, 3
v_mfma_f32_16x16x32_bf16 v[224:227], v[56:59], a[64:67], v[224:227]
v_mfma_f32_16x16x32_bf16 v[228:231], v[56:59], a[68:71], v[228:231]
v_mfma_f32_16x16x32_bf16 v[232:235], v[56:59], a[72:75], v[232:235]
v_mfma_f32_16x16x32_bf16 v[236:239], v[56:59], a[76:79], v[236:239]
s_waitcnt vmcnt(16) lgkmcnt(0)
buffer_store_dword v41, v13, s[32:35], s69 offen sc1
v_mfma_f32_16x16x32_bf16 v[252:255], v[60:63], a[76:79], v[252:255]
v_mfma_f32_16x16x32_bf16 v[248:251], v[60:63], a[72:75], v[248:251]
v_mfma_f32_16x16x32_bf16 v[244:247], v[60:63], a[68:71], v[244:247]
v_mfma_f32_16x16x32_bf16 v[240:243], v[60:63], a[64:67], v[240:243]
v_mfma_f32_16x16x32_bf16 v[224:227], v[64:67], a[80:83], v[224:227]
v_mfma_f32_16x16x32_bf16 v[228:231], v[64:67], a[84:87], v[228:231]
v_mfma_f32_16x16x32_bf16 v[232:235], v[64:67], a[88:91], v[232:235]
v_mfma_f32_16x16x32_bf16 v[236:239], v[64:67], a[92:95], v[236:239]
v_mfma_f32_16x16x32_bf16 v[252:255], v[68:71], a[92:95], v[252:255]
v_mfma_f32_16x16x32_bf16 v[248:251], v[68:71], a[88:91], v[248:251]
s_waitcnt vmcnt(13)
s_barrier
ds_read_b64_tr_b16 v[48:49], v0 offset:32768
ds_read_b64_tr_b16 v[50:51], v0 offset:34816
v_mfma_f32_16x16x32_bf16 v[244:247], v[68:71], a[84:87], v[244:247]
ds_read_b64_tr_b16 v[52:53], v1 offset:32768
ds_read_b64_tr_b16 v[54:55], v1 offset:34816
v_mfma_f32_16x16x32_bf16 v[240:243], v[68:71], a[80:83], v[240:243]
ds_read_b64_tr_b16 v[56:57], v0 offset:36864
ds_read_b64_tr_b16 v[58:59], v0 offset:38912
v_mfma_f32_16x16x32_bf16 v[224:227], v[72:75], a[96:99], v[224:227]
ds_read_b64_tr_b16 v[60:61], v1 offset:36864
ds_read_b64_tr_b16 v[62:63], v1 offset:38912
v_mfma_f32_16x16x32_bf16 v[228:231], v[72:75], a[100:103], v[228:231]
ds_read_b64_tr_b16 v[64:65], v0 offset:40960
ds_read_b64_tr_b16 v[66:67], v0 offset:43008
v_mfma_f32_16x16x32_bf16 v[232:235], v[72:75], a[104:107], v[232:235]
ds_read_b64_tr_b16 v[68:69], v1 offset:40960
ds_read_b64_tr_b16 v[70:71], v1 offset:43008
v_mfma_f32_16x16x32_bf16 v[236:239], v[72:75], a[108:111], v[236:239]
ds_read_b64_tr_b16 v[72:73], v0 offset:45056
ds_read_b64_tr_b16 v[74:75], v0 offset:47104
v_mfma_f32_16x16x32_bf16 v[252:255], v[76:79], a[108:111], v[252:255]
v_mfma_f32_16x16x32_bf16 v[248:251], v[76:79], a[104:107], v[248:251]
v_mfma_f32_16x16x32_bf16 v[244:247], v[76:79], a[100:103], v[244:247]
v_mfma_f32_16x16x32_bf16 v[240:243], v[76:79], a[96:99], v[240:243]
s_waitcnt vmcnt(12) lgkmcnt(10)
ds_read_b64_tr_b16 v[76:77], v1 offset:45056
v_cmp_gt_u32_e64 vcc, 2, v40
v_mfma_f32_16x16x32_bf16 v[224:227], v[48:51], a[112:115], v[224:227]
s_and_b32 vcc_lo, vcc_lo, 0xffff
s_cbranch_scc1 k3_p2
k3_p2r:
buffer_load_dwordx4 a[176:179], v8, s[28:31], s58 offen sc1
v_mfma_f32_16x16x32_bf16 v[228:231], v[48:51], a[116:119], v[228:231]
s_mov_b32 s58, 75776
buffer_load_dwordx4 a[180:183], v8, s[28:31], s59 offen sc1
buffer_load_dwordx4 a[184:187], v8, s[28:31], s56 offen sc1
v_mfma_f32_16x16x32_bf16 v[232:235], v[48:51], a[120:123], v[232:235]
s_mov_b32 s59, 94208
s_mov_b32 s56, 112640
ds_read_b64_tr_b16 v[78:79], v1 offset:47104
v_mfma_f32_16x16x32_bf16 v[236:239], v[48:51], a[124:127], v[236:239]
v_mfma_f32_16x16x32_bf16 v[252:255], v[52:55], a[124:127], v[252:255]
v_mfma_f32_16x16x32_bf16 v[248:251], v[52:55], a[120:123], v[248:251]
v_mfma_f32_16x16x32_bf16 v[244:247], v[52:55], a[116:119], v[244:247]
v_mfma_f32_16x16x32_bf16 v[240:243], v[52:55], a[112:115], v[240:243]
s_waitcnt lgkmcnt(2)
buffer_load_dwordx4 a[188:191], v8, s[28:31], s57 offen sc1
v_mfma_f32_16x16x32_bf16 v[224:227], v[56:59], a[128:131], v[224:227]
s_mov_b32 s57, 131072
v_mfma_f32_16x16x32_bf16 v[228:231], v[56:59], a[132:135], v[228:231]
v_mfma_f32_16x16x32_bf16 v[232:235], v[56:59], a[136:139], v[232:235]
s_nop 4
v_cvt_pk_bf16_f32 v80, v224, v225
v_cvt_pk_bf16_f32 v81, v226, v227
v_mfma_f32_16x16x32_bf16 v[236:239], v[56:59], a[140:143], v[236:239]
v_cvt_pk_bf16_f32 v84, v228, v229
v_mfma_f32_16x16x32_bf16 v[252:255], v[60:63], a[140:143], v[252:255]
v_cvt_pk_bf16_f32 v85, v230, v231
v_cvt_pk_bf16_f32 v88, v232, v233
v_mfma_f32_16x16x32_bf16 v[248:251], v[60:63], a[136:139], v[248:251]
buffer_load_dwordx4 a[192:195], v8, s[28:31], s58 offen sc1
v_cvt_pk_bf16_f32 v89, v234, v235
v_mfma_f32_16x16x32_bf16 v[244:247], v[60:63], a[132:135], v[244:247]
v_cvt_pk_bf16_f32 v92, v236, v237
v_cvt_pk_bf16_f32 v93, v238, v239
v_mfma_f32_16x16x32_bf16 v[240:243], v[60:63], a[128:131], v[240:243]
s_nop 1
v_cvt_pk_bf16_f32 v90, v248, v249
v_mfma_f32_16x16x32_bf16 v[96:99], v[64:67], a[0:3], 0
s_nop 0
v_cvt_pk_bf16_f32 v86, v244, v245
v_cvt_pk_bf16_f32 v87, v246, v247
v_mfma_f32_16x16x32_bf16 v[100:103], v[64:67], a[4:7], 0
v_cvt_pk_bf16_f32 v82, v240, v241
v_mfma_f32_16x16x32_bf16 v[104:107], v[64:67], a[8:11], 0
v_cvt_pk_bf16_f32 v83, v242, v243
v_cvt_pk_bf16_f32 v91, v250, v251
v_mfma_f32_16x16x32_bf16 v[108:111], v[64:67], a[12:15], 0
buffer_store_dwordx4 v[80:83], v11, s[28:31], s41 offen offset:3072 sc1
buffer_store_dwordx4 v[84:87], v11, s[28:31], s44 offen offset:3072 sc1
v_mfma_f32_16x16x32_bf16 v[124:127], v[68:71], a[12:15], 0
buffer_load_dwordx4 a[196:199], v8, s[28:31], s59 offen sc1
buffer_store_dwordx4 v[88:91], v11, s[28:31], s47 offen offset:3072 sc1
v_mfma_f32_16x16x32_bf16 v[120:123], v[68:71], a[8:11], 0
s_waitcnt vmcnt(17)
s_barrier
ds_read_b64_tr_b16 v[48:49], v0 offset:49152
ds_read_b64_tr_b16 v[50:51], v0 offset:51200
v_mfma_f32_16x16x32_bf16 v[116:119], v[68:71], a[4:7], 0
ds_read_b64_tr_b16 v[52:53], v1 offset:49152
ds_read_b64_tr_b16 v[54:55], v1 offset:51200
v_mfma_f32_16x16x32_bf16 v[112:115], v[68:71], a[0:3], 0
ds_read_b64_tr_b16 v[56:57], v0 offset:53248
ds_read_b64_tr_b16 v[58:59], v0 offset:55296
v_mfma_f32_16x16x32_bf16 v[96:99], v[72:75], a[16:19], v[96:99]
ds_read_b64_tr_b16 v[60:61], v1 offset:53248
ds_read_b64_tr_b16 v[62:63], v1 offset:55296
v_mfma_f32_16x16x32_bf16 v[100:103], v[72:75], a[20:23], v[100:103]
ds_read_b64_tr_b16 v[64:65], v0 offset:57344
buffer_load_dwordx4 a[200:203], v8, s[28:31], s56 offen sc1
v_mfma_f32_16x16x32_bf16 v[104:107], v[72:75], a[24:27], v[104:107]
ds_read_b64_tr_b16 v[66:67], v0 offset:59392
ds_read_b64_tr_b16 v[68:69], v1 offset:57344
v_mfma_f32_16x16x32_bf16 v[108:111], v[72:75], a[28:31], v[108:111]
s_waitcnt lgkmcnt(11)
ds_read_b64_tr_b16 v[70:71], v1 offset:59392
ds_read_b64_tr_b16 v[72:73], v0 offset:61440
v_mfma_f32_16x16x32_bf16 v[124:127], v[76:79], a[28:31], v[124:127]
ds_read_b64_tr_b16 v[74:75], v0 offset:63488
v_cvt_pk_bf16_f32 v94, v252, v253
v_mfma_f32_16x16x32_bf16 v[120:123], v[76:79], a[24:27], v[120:123]
v_cvt_pk_bf16_f32 v95, v254, v255
v_mfma_f32_16x16x32_bf16 v[116:119], v[76:79], a[20:23], v[116:119]
buffer_store_dwordx4 v[92:95], v11, s[28:31], s50 offen offset:3072 sc1
v_mfma_f32_16x16x32_bf16 v[112:115], v[76:79], a[16:19], v[112:115]
s_waitcnt lgkmcnt(10)
ds_read_b64_tr_b16 v[76:77], v1 offset:61440
buffer_load_dwordx4 a[204:207], v8, s[28:31], s57 offen sc1
v_mfma_f32_16x16x32_bf16 v[96:99], v[48:51], a[32:35], v[96:99]
ds_read_b64_tr_b16 v[78:79], v1 offset:63488
v_mfma_f32_16x16x32_bf16 v[100:103], v[48:51], a[36:39], v[100:103]
v_mfma_f32_16x16x32_bf16 v[104:107], v[48:51], a[40:43], v[104:107]
v_mfma_f32_16x16x32_bf16 v[108:111], v[48:51], a[44:47], v[108:111]
v_mfma_f32_16x16x32_bf16 v[124:127], v[52:55], a[44:47], v[124:127]
v_mfma_f32_16x16x32_bf16 v[120:123], v[52:55], a[40:43], v[120:123]
v_mfma_f32_16x16x32_bf16 v[116:119], v[52:55], a[36:39], v[116:119]
v_mfma_f32_16x16x32_bf16 v[112:115], v[52:55], a[32:35], v[112:115]
s_waitcnt lgkmcnt(2)
buffer_load_dword v40, v12, s[32:35], s69 offen sc1
v_mfma_f32_16x16x32_bf16 v[96:99], v[56:59], a[48:51], v[96:99]
v_mfma_f32_16x16x32_bf16 v[100:103], v[56:59], a[52:55], v[100:103]
v_mfma_f32_16x16x32_bf16 v[104:107], v[56:59], a[56:59], v[104:107]
v_mfma_f32_16x16x32_bf16 v[108:111], v[56:59], a[60:63], v[108:111]
v_mfma_f32_16x16x32_bf16 v[124:127], v[60:63], a[60:63], v[124:127]
v_mfma_f32_16x16x32_bf16 v[120:123], v[60:63], a[56:59], v[120:123]
v_mfma_f32_16x16x32_bf16 v[116:119], v[60:63], a[52:55], v[116:119]
v_mfma_f32_16x16x32_bf16 v[112:115], v[60:63], a[48:51], v[112:115]
v_mfma_f32_16x16x32_bf16 v[96:99], v[64:67], a[64:67], v[96:99]
v_mfma_f32_16x16x32_bf16 v[100:103], v[64:67], a[68:71], v[100:103]
v_mfma_f32_16x16x32_bf16 v[104:107], v[64:67], a[72:75], v[104:107]
v_mfma_f32_16x16x32_bf16 v[108:111], v[64:67], a[76:79], v[108:111]
s_waitcnt vmcnt(14)
s_barrier
ds_read_b64_tr_b16 v[48:49], v2 offset:0
ds_read_b64_tr_b16 v[50:51], v2 offset:2048
v_mfma_f32_16x16x32_bf16 v[124:127], v[68:71], a[76:79], v[124:127]
ds_read_b64_tr_b16 v[52:53], v3 offset:0
ds_read_b64_tr_b16 v[54:55], v3 offset:2048
v_mfma_f32_16x16x32_bf16 v[120:123], v[68:71], a[72:75], v[120:123]
ds_read_b64_tr_b16 v[56:57], v2 offset:4096
ds_read_b64_tr_b16 v[58:59], v2 offset:6144
v_mfma_f32_16x16x32_bf16 v[116:119], v[68:71], a[68:71], v[116:119]
ds_read_b64_tr_b16 v[60:61], v3 offset:4096
ds_read_b64_tr_b16 v[62:63], v3 offset:6144
v_mfma_f32_16x16x32_bf16 v[112:115], v[68:71], a[64:67], v[112:115]
ds_read_b64_tr_b16 v[64:65], v2 offset:8192
ds_read_b64_tr_b16 v[66:67], v2 offset:10240
v_mfma_f32_16x16x32_bf16 v[96:99], v[72:75], a[80:83], v[96:99]
ds_read_b64_tr_b16 v[68:69], v3 offset:8192
ds_read_b64_tr_b16 v[70:71], v3 offset:10240
v_mfma_f32_16x16x32_bf16 v[100:103], v[72:75], a[84:87], v[100:103]
v_mfma_f32_16x16x32_bf16 v[104:107], v[72:75], a[88:91], v[104:107]
v_mfma_f32_16x16x32_bf16 v[108:111], v[72:75], a[92:95], v[108:111]
s_waitcnt lgkmcnt(12)
v_mfma_f32_16x16x32_bf16 v[124:127], v[76:79], a[92:95], v[124:127]
v_mfma_f32_16x16x32_bf16 v[120:123], v[76:79], a[88:91], v[120:123]
v_mfma_f32_16x16x32_bf16 v[116:119], v[76:79], a[84:87], v[116:119]
v_mfma_f32_16x16x32_bf16 v[112:115], v[76:79], a[80:83], v[112:115]
s_waitcnt lgkmcnt(4)
v_mfma_f32_16x16x32_bf16 v[96:99], v[48:51], a[96:99], v[96:99]
v_mfma_f32_16x16x32_bf16 v[100:103], v[48:51], a[100:103], v[100:103]
v_mfma_f32_16x16x32_bf16 v[104:107], v[48:51], a[104:107], v[104:107]
v_mfma_f32_16x16x32_bf16 v[108:111], v[48:51], a[108:111], v[108:111]
v_mfma_f32_16x16x32_bf16 v[124:127], v[52:55], a[108:111], v[124:127]
v_mfma_f32_16x16x32_bf16 v[120:123], v[52:55], a[104:107], v[120:123]
v_mfma_f32_16x16x32_bf16 v[116:119], v[52:55], a[100:103], v[116:119]
v_mfma_f32_16x16x32_bf16 v[112:115], v[52:55], a[96:99], v[112:115]
v_mfma_f32_16x16x32_bf16 v[96:99], v[56:59], a[112:115], v[96:99]
v_mfma_f32_16x16x32_bf16 v[100:103], v[56:59], a[116:119], v[100:103]
v_mfma_f32_16x16x32_bf16 v[104:107], v[56:59], a[120:123], v[104:107]
v_mfma_f32_16x16x32_bf16 v[108:111], v[56:59], a[124:127], v[108:111]
v_mfma_f32_16x16x32_bf16 v[124:127], v[60:63], a[124:127], v[124:127]
v_mfma_f32_16x16x32_bf16 v[120:123], v[60:63], a[120:123], v[120:123]
v_mfma_f32_16x16x32_bf16 v[116:119], v[60:63], a[116:119], v[116:119]
v_mfma_f32_16x16x32_bf16 v[112:115], v[60:63], a[112:115], v[112:115]
s_waitcnt lgkmcnt(0)
v_mfma_f32_16x16x32_bf16 v[96:99], v[64:67], a[128:131], v[96:99]
v_mfma_f32_16x16x32_bf16 v[100:103], v[64:67], a[132:135], v[100:103]
v_mfma_f32_16x16x32_bf16 v[104:107], v[64:67], a[136:139], v[104:107]
s_nop 5
v_cvt_pk_bf16_f32 v80, v96, v97
v_cvt_pk_bf16_f32 v81, v98, v99
v_mfma_f32_16x16x32_bf16 v[108:111], v[64:67], a[140:143], v[108:111]
v_cvt_pk_bf16_f32 v84, v100, v101
v_mfma_f32_16x16x32_bf16 v[124:127], v[68:71], a[140:143], v[124:127]
v_cvt_pk_bf16_f32 v85, v102, v103
v_cvt_pk_bf16_f32 v88, v104, v105
v_mfma_f32_16x16x32_bf16 v[120:123], v[68:71], a[136:139], v[120:123]
v_cvt_pk_bf16_f32 v89, v106, v107
v_mfma_f32_16x16x32_bf16 v[116:119], v[68:71], a[132:135], v[116:119]
s_nop 0
v_cvt_pk_bf16_f32 v92, v108, v109
v_cvt_pk_bf16_f32 v93, v110, v111
v_mfma_f32_16x16x32_bf16 v[112:115], v[68:71], a[128:131], v[112:115]
s_nop 1
v_cvt_pk_bf16_f32 v90, v120, v121
s_nop 0
v_cvt_pk_bf16_f32 v86, v116, v117
v_cvt_pk_bf16_f32 v87, v118, v119
v_cvt_pk_bf16_f32 v91, v122, v123
v_cvt_pk_bf16_f32 v94, v124, v125
buffer_store_dwordx4 v[84:87], v11, s[28:31], s45 offen offset:0 sc1
buffer_store_dwordx4 v[88:91], v11, s[28:31], s48 offen offset:0 sc1
v_cvt_pk_bf16_f32 v82, v112, v113
v_cvt_pk_bf16_f32 v83, v114, v115
buffer_store_dwordx4 v[80:83], v11, s[28:31], s42 offen offset:0 sc1
v_cvt_pk_bf16_f32 v95, v126, v127
buffer_store_dwordx4 v[92:95], v11, s[28:31], s51 offen offset:0 sc1
v_mov_b32 v41, 4
s_waitcnt vmcnt(6)
buffer_store_dword v41, v13, s[32:35], s69 offen sc1
s_waitcnt vmcnt(5)
v_cmp_gt_u32 vcc, 3, v40
s_nop 0
s_and_b32 vcc_lo, vcc_lo, 0xffff
s_cbranch_scc1 k3_p3
k3_p3r:
s_mov_b32 s58, 4096
buffer_load_dwordx4 a[208:211], v8, s[28:31], s58 offen sc1
s_mov_b32 s59, 22528
buffer_load_dwordx4 a[212:215], v8, s[28:31], s59 offen sc1
s_mov_b32 s56, 40960
buffer_load_dwordx4 a[216:219], v8, s[28:31], s56 offen sc1
s_mov_b32 s57, 59392
buffer_load_dwordx4 a[220:223], v8, s[28:31], s57 offen sc1
s_mov_b32 s58, 77824
buffer_load_dwordx4 a[224:227], v8, s[28:31], s58 offen sc1
s_mov_b32 s59, 96256
buffer_load_dwordx4 a[228:231], v8, s[28:31], s59 offen sc1
s_mov_b32 s56, 114688
buffer_load_dwordx4 a[232:235], v8, s[28:31], s56 offen sc1
s_mov_b32 s57, 133120
buffer_load_dwordx4 a[236:239], v8, s[28:31], s57 offen sc1
v_mfma_f32_16x16x32_bf16 v[16:19], v[36:39], a[144:147], 0
v_mfma_f32_16x16x32_bf16 v[16:19], v[36:39], a[148:151], v[16:19]
v_mfma_f32_16x16x32_bf16 v[16:19], v[36:39], a[152:155], v[16:19]
v_mfma_f32_16x16x32_bf16 v[16:19], v[36:39], a[156:159], v[16:19]
v_mfma_f32_16x16x32_bf16 v[16:19], v[36:39], a[160:163], v[16:19]
v_mfma_f32_16x16x32_bf16 v[16:19], v[36:39], a[164:167], v[16:19]
v_mfma_f32_16x16x32_bf16 v[16:19], v[36:39], a[168:171], v[16:19]
v_mfma_f32_16x16x32_bf16 v[16:19], v[36:39], a[172:175], v[16:19]
v_lshlrev_b32_e64 v48, 16, v148
v_and_b32 v49, 0xffff0000, v148
v_lshlrev_b32_e64 v50, 16, v149
v_and_b32 v51, 0xffff0000, v149
s_nop 3
v_fmac_f32 v48, v16, v128
v_fmac_f32 v49, v17, v129
v_fmac_f32 v50, v18, v130
v_fmac_f32_e64 v51, v19, v131
v_cvt_pk_bf16_f32 v48, v48, v49
v_cvt_pk_bf16_f32 v49, v50, v51
buffer_store_dwordx2 v[48:49], v6, s[52:55], 0 offen offset:0
v_mfma_f32_16x16x32_bf16 v[20:23], v[36:39], a[176:179], 0
v_mfma_f32_16x16x32_bf16 v[20:23], v[36:39], a[180:183], v[20:23]
v_mfma_f32_16x16x32_bf16 v[20:23], v[36:39], a[184:187], v[20:23]
v_mfma_f32_16x16x32_bf16 v[20:23], v[36:39], a[188:191], v[20:23]
v_mfma_f32_16x16x32_bf16 v[20:23], v[36:39], a[192:195], v[20:23]
v_mfma_f32_16x16x32_bf16 v[20:23], v[36:39], a[196:199], v[20:23]
v_mfma_f32_16x16x32_bf16 v[20:23], v[36:39], a[200:203], v[20:23]
v_mfma_f32_16x16x32_bf16 v[20:23], v[36:39], a[204:207], v[20:23]
v_lshlrev_b32_e64 v52, 16, v150
v_and_b32 v53, 0xffff0000, v150
v_lshlrev_b32_e64 v54, 16, v151
v_and_b32 v55, 0xffff0000, v151
s_nop 3
v_fmac_f32 v52, v20, v132
v_fmac_f32 v53, v21, v133
v_fmac_f32 v54, v22, v134
v_fmac_f32_e64 v55, v23, v135
v_cvt_pk_bf16_f32 v52, v52, v53
v_cvt_pk_bf16_f32 v53, v54, v55
buffer_store_dwordx2 v[52:53], v6, s[52:55], 0 offen offset:256
buffer_load_dword v40, v12, s[32:35], s69 offen sc1
s_waitcnt vmcnt(10)
v_mfma_f32_16x16x32_bf16 v[24:27], v[36:39], a[208:211], 0
s_waitcnt vmcnt(9)
v_mfma_f32_16x16x32_bf16 v[24:27], v[36:39], a[212:215], v[24:27]
s_waitcnt vmcnt(8)
v_mfma_f32_16x16x32_bf16 v[24:27], v[36:39], a[216:219], v[24:27]
s_waitcnt vmcnt(7)
v_mfma_f32_16x16x32_bf16 v[24:27], v[36:39], a[220:223], v[24:27]
s_waitcnt vmcnt(6)
v_mfma_f32_16x16x32_bf16 v[24:27], v[36:39], a[224:227], v[24:27]
s_waitcnt vmcnt(5)
v_mfma_f32_16x16x32_bf16 v[24:27], v[36:39], a[228:231], v[24:27]
s_waitcnt vmcnt(4)
v_mfma_f32_16x16x32_bf16 v[24:27], v[36:39], a[232:235], v[24:27]
s_waitcnt vmcnt(3)
v_mfma_f32_16x16x32_bf16 v[24:27], v[36:39], a[236:239], v[24:27]
v_lshlrev_b32_e64 v56, 16, v152
v_and_b32 v57, 0xffff0000, v152
v_lshlrev_b32_e64 v58, 16, v153
v_and_b32 v59, 0xffff0000, v153
s_nop 3
v_fmac_f32 v56, v24, v136
v_fmac_f32 v57, v25, v137
v_fmac_f32 v58, v26, v138
v_fmac_f32_e64 v59, v27, v139
v_cvt_pk_bf16_f32 v56, v56, v57
v_cvt_pk_bf16_f32 v57, v58, v59
buffer_store_dwordx2 v[56:57], v6, s[52:55], 0 offen offset:512
s_waitcnt vmcnt(1)
v_cmp_gt_u32 vcc, 4, v40
s_nop 0
s_and_b32 vcc_lo, vcc_lo, 0xffff
s_cbranch_scc1 k3_p4
k3_p4r:
s_mov_b32 s58, 6144
buffer_load_dwordx4 v[160:163], v8, s[28:31], s58 offen sc1
s_mov_b32 s59, 24576
buffer_load_dwordx4 v[164:167], v8, s[28:31], s59 offen sc1
s_mov_b32 s56, 43008
buffer_load_dwordx4 v[168:171], v8, s[28:31], s56 offen sc1
s_mov_b32 s57, 61440
buffer_load_dwordx4 v[172:175], v8, s[28:31], s57 offen sc1
s_mov_b32 s58, 79872
buffer_load_dwordx4 v[176:179], v8, s[28:31], s58 offen sc1
s_mov_b32 s59, 98304
buffer_load_dwordx4 v[180:183], v8, s[28:31], s59 offen sc1
s_mov_b32 s56, 116736
buffer_load_dwordx4 v[184:187], v8, s[28:31], s56 offen sc1
s_mov_b32 s57, 135168
buffer_load_dwordx4 v[188:191], v8, s[28:31], s57 offen sc1
s_mov_b32 s58, 8192
buffer_load_dwordx4 v[192:195], v9, s[28:31], s58 offen sc1
s_mov_b32 s59, 26624
buffer_load_dwordx4 v[196:199], v9, s[28:31], s59 offen sc1
s_mov_b32 s56, 45056
buffer_load_dwordx4 v[200:203], v9, s[28:31], s56 offen sc1
s_mov_b32 s57, 63488
buffer_load_dwordx4 v[204:207], v9, s[28:31], s57 offen sc1
s_mov_b32 s58, 81920
buffer_load_dwordx4 v[208:211], v9, s[28:31], s58 offen sc1
s_mov_b32 s59, 100352
buffer_load_dwordx4 v[212:215], v9, s[28:31], s59 offen sc1
s_mov_b32 s56, 118784
buffer_load_dwordx4 v[216:219], v9, s[28:31], s56 offen sc1
s_mov_b32 s57, 137216
buffer_load_dwordx4 v[220:223], v9, s[28:31], s57 offen sc1
s_waitcnt vmcnt(15)
v_mfma_f32_16x16x32_bf16 v[28:31], v[36:39], v[160:163], 0
s_waitcnt vmcnt(14)
v_mfma_f32_16x16x32_bf16 v[28:31], v[36:39], v[164:167], v[28:31]
s_waitcnt vmcnt(13)
v_mfma_f32_16x16x32_bf16 v[28:31], v[36:39], v[168:171], v[28:31]
s_waitcnt vmcnt(12)
v_mfma_f32_16x16x32_bf16 v[28:31], v[36:39], v[172:175], v[28:31]
s_waitcnt vmcnt(11)
v_mfma_f32_16x16x32_bf16 v[28:31], v[36:39], v[176:179], v[28:31]
s_waitcnt vmcnt(10)
v_mfma_f32_16x16x32_bf16 v[28:31], v[36:39], v[180:183], v[28:31]
s_waitcnt vmcnt(9)
v_mfma_f32_16x16x32_bf16 v[28:31], v[36:39], v[184:187], v[28:31]
s_waitcnt vmcnt(8)
v_mfma_f32_16x16x32_bf16 v[28:31], v[36:39], v[188:191], v[28:31]
v_lshlrev_b32_e64 v60, 16, v154
v_and_b32 v61, 0xffff0000, v154
v_lshlrev_b32_e64 v62, 16, v155
v_and_b32 v63, 0xffff0000, v155
s_nop 3
v_fmac_f32 v60, v28, v140
v_fmac_f32 v61, v29, v141
v_fmac_f32 v62, v30, v142
v_fmac_f32_e64 v63, v31, v143
v_cvt_pk_bf16_f32 v60, v60, v61
v_cvt_pk_bf16_f32 v61, v62, v63
buffer_store_dwordx2 v[60:61], v6, s[52:55], 0 offen offset:768
s_waitcnt vmcnt(8)
v_mfma_f32_16x16x32_bf16 v[32:35], v[36:39], v[192:195], 0
s_waitcnt vmcnt(7)
v_mfma_f32_16x16x32_bf16 v[32:35], v[36:39], v[196:199], v[32:35]
s_waitcnt vmcnt(6)
v_mfma_f32_16x16x32_bf16 v[32:35], v[36:39], v[200:203], v[32:35]
s_waitcnt vmcnt(5)
v_mfma_f32_16x16x32_bf16 v[32:35], v[36:39], v[204:207], v[32:35]
s_waitcnt vmcnt(4)
v_mfma_f32_16x16x32_bf16 v[32:35], v[36:39], v[208:211], v[32:35]
s_waitcnt vmcnt(3)
v_mfma_f32_16x16x32_bf16 v[32:35], v[36:39], v[212:215], v[32:35]
s_waitcnt vmcnt(2)
v_mfma_f32_16x16x32_bf16 v[32:35], v[36:39], v[216:219], v[32:35]
s_waitcnt vmcnt(1)
v_mfma_f32_16x16x32_bf16 v[32:35], v[36:39], v[220:223], v[32:35]
s_nop 7
v_cmp_u_f32 vcc, v32, v32
s_nop 0
s_cbranch_vccnz k3_p5
k3_p5r:
v_lshlrev_b32_e64 v64, 16, v156
v_and_b32 v65, 0xffff0000, v156
v_lshlrev_b32_e64 v66, 16, v157
v_and_b32 v67, 0xffff0000, v157
v_fmac_f32 v64, v32, v144
v_fmac_f32 v65, v33, v145
v_fmac_f32 v66, v34, v146
v_fmac_f32 v67, v35, v147
v_cvt_pk_bf16_f32 v64, v64, v65
v_cvt_pk_bf16_f32 v65, v66, v67
buffer_store_dwordx2 v[64:65], v7, s[52:55], 0 offen offset:1024
s_branch k3_fin
k3_p1:
s_sub_u32 s68, s68, 1
s_cbranch_scc1 k3_p1x
buffer_load_dword v40, v12, s[32:35], s69 offen sc1
s_waitcnt vmcnt(0)
v_cmp_gt_u32 vcc, 1, v40
s_nop 1
s_and_b32 vcc_lo, vcc_lo, 0xffff
s_cbranch_scc1 k3_p1
s_branch k3_p1r
k3_p1x:
s_mov_b32 s68, 0
s_branch k3_p1r
k3_p2:
s_sub_u32 s68, s68, 1
s_cbranch_scc1 k3_p2x
buffer_load_dword v40, v12, s[32:35], s69 offen sc1
s_waitcnt vmcnt(0)
v_cmp_gt_u32 vcc, 2, v40
s_nop 1
s_and_b32 vcc_lo, vcc_lo, 0xffff
s_cbranch_scc1 k3_p2
s_branch k3_p2r
k3_p2x:
s_mov_b32 s68, 0
s_branch k3_p2r
k3_p3:
s_sub_u32 s68, s68, 1
s_cbranch_scc1 k3_p3x
buffer_load_dword v40, v12, s[32:35], s69 offen sc1
s_waitcnt vmcnt(0)
v_cmp_gt_u32 vcc, 3, v40
s_nop 1
s_and_b32 vcc_lo, vcc_lo, 0xffff
s_cbranch_scc1 k3_p3
s_branch k3_p3r
k3_p3x:
s_mov_b32 s68, 0
s_branch k3_p3r
k3_p4:
s_sub_u32 s68, s68, 1
s_cbranch_scc1 k3_p4x
buffer_load_dword v40, v12, s[32:35], s69 offen sc1
s_waitcnt vmcnt(0)
v_cmp_gt_u32 vcc, 4, v40
s_nop 1
s_and_b32 vcc_lo, vcc_lo, 0xffff
s_cbranch_scc1 k3_p4
s_branch k3_p4r
k3_p4x:
s_mov_b32 s68, 0
s_branch k3_p4r
k3_p5:
s_sub_u32 s68, s68, 1
s_cbranch_scc1 k3_p5x
s_movk_i32 s56, 8192
buffer_load_dwordx4 v[192:195], v9, s[28:31], s56 offen sc1
s_mov_b32 s57, 26624
buffer_load_dwordx4 v[196:199], v9, s[28:31], s57 offen sc1
s_mov_b32 s58, 45056
buffer_load_dwordx4 v[200:203], v9, s[28:31], s58 offen sc1
s_mov_b32 s59, 63488
buffer_load_dwordx4 v[204:207], v9, s[28:31], s59 offen sc1
s_mov_b32 s56, 81920
buffer_load_dwordx4 v[208:211], v9, s[28:31], s56 offen sc1
s_mov_b32 s57, 100352
buffer_load_dwordx4 v[212:215], v9, s[28:31], s57 offen sc1
s_mov_b32 s58, 118784
buffer_load_dwordx4 v[216:219], v9, s[28:31], s58 offen sc1
s_mov_b32 s59, 137216
buffer_load_dwordx4 v[220:223], v9, s[28:31], s59 offen sc1
s_waitcnt vmcnt(0)
v_mfma_f32_16x16x32_bf16 v[32:35], v[36:39], v[192:195], 0
v_mfma_f32_16x16x32_bf16 v[32:35], v[36:39], v[196:199], v[32:35]
v_mfma_f32_16x16x32_bf16 v[32:35], v[36:39], v[200:203], v[32:35]
v_mfma_f32_16x16x32_bf16 v[32:35], v[36:39], v[204:207], v[32:35]
v_mfma_f32_16x16x32_bf16 v[32:35], v[36:39], v[208:211], v[32:35]
v_mfma_f32_16x16x32_bf16 v[32:35], v[36:39], v[212:215], v[32:35]
v_mfma_f32_16x16x32_bf16 v[32:35], v[36:39], v[216:219], v[32:35]
v_mfma_f32_16x16x32_bf16 v[32:35], v[36:39], v[220:223], v[32:35]
s_nop 7
v_cmp_u_f32 vcc, v32, v32
s_nop 1
s_cbranch_vccnz k3_p5
s_branch k3_p5r
k3_p5x:
s_mov_b32 s68, 0
s_branch k3_p5r
k2_p1:
s_sub_u32 s68, s68, 1
s_cbranch_scc1 k2_p1x
buffer_load_dword v18, v16, s[32:35], s69 offen sc1
s_waitcnt vmcnt(0)
v_cmp_gt_u32 vcc, 1, v18
s_nop 1
s_and_b32 vcc_lo, vcc_lo, 0xffff
s_cbranch_scc1 k2_p1
s_branch k2_p1r
k2_p1x:
s_mov_b32 s68, 0
s_branch k2_p1r
k1_p1:
s_sub_u32 s69, s69, 1
s_cbranch_scc1 k1_p1x
buffer_load_dword v16, v10, s[12:15], s49 offen sc1
s_waitcnt vmcnt(0)
v_cmp_gt_u32 vcc, 1, v16
s_nop 1
s_and_b32 vcc_lo, vcc_lo, 0xffff
s_cbranch_scc1 k1_p1
s_branch k1_p1r
k1_p1x:
s_mov_b32 s69, 0
s_branch k1_p1r
k1_p2:
s_sub_u32 s69, s69, 1
s_cbranch_scc1 k1_p2x
buffer_load_dword v16, v10, s[12:15], s49 offen sc1
s_waitcnt vmcnt(0)
v_cmp_gt_u32 vcc, 2, v16
s_nop 1
s_and_b32 vcc_lo, vcc_lo, 0xffff
s_cbranch_scc1 k1_p2
s_branch k1_p2r
k1_p2x:
s_mov_b32 s69, 0
s_branch k1_p2r
k1_p3:
s_sub_u32 s69, s69, 1
s_cbranch_scc1 k1_p3x
buffer_load_dword v16, v10, s[12:15], s49 offen sc1
s_waitcnt vmcnt(0)
v_cmp_gt_u32 vcc, 3, v16
s_nop 1
s_and_b32 vcc_lo, vcc_lo, 0xffff
s_cbranch_scc1 k1_p3
s_branch k1_p3r
k1_p3x:
s_mov_b32 s69, 0
s_branch k1_p3r
k1_p4:
s_sub_u32 s69, s69, 1
s_cbranch_scc1 k1_p4x
buffer_load_dword v16, v10, s[12:15], s49 offen sc1
s_waitcnt vmcnt(0)
v_cmp_gt_u32 vcc, 4, v16
s_nop 1
s_and_b32 vcc_lo, vcc_lo, 0xffff
s_cbranch_scc1 k1_p4
s_branch k1_p4r
k1_p4x:
s_mov_b32 s69, 0
s_branch k1_p4r
k1_p5:
s_sub_u32 s69, s69, 1
s_cbranch_scc1 k1_p5x
s_movk_i32 s56, 8192
buffer_load_dwordx4 a[200:203], v9, s[28:31], s56 offen sc1
s_mov_b32 s57, 26624
buffer_load_dwordx4 a[204:207], v9, s[28:31], s57 offen sc1
s_mov_b32 s58, 45056
buffer_load_dwordx4 a[208:211], v9, s[28:31], s58 offen sc1
s_mov_b32 s59, 63488
buffer_load_dwordx4 a[212:215], v9, s[28:31], s59 offen sc1
s_mov_b32 s56, 81920
buffer_load_dwordx4 a[216:219], v9, s[28:31], s56 offen sc1
s_mov_b32 s57, 100352
buffer_load_dwordx4 a[220:223], v9, s[28:31], s57 offen sc1
s_mov_b32 s58, 118784
buffer_load_dwordx4 a[224:227], v9, s[28:31], s58 offen sc1
s_mov_b32 s59, 137216
buffer_load_dwordx4 a[228:231], v9, s[28:31], s59 offen sc1
s_waitcnt vmcnt(0)
v_mfma_f32_16x16x32_bf16 v[176:179], v[12:15], a[200:203], 0
v_mfma_f32_16x16x32_bf16 v[176:179], v[12:15], a[204:207], v[176:179]
v_mfma_f32_16x16x32_bf16 v[176:179], v[12:15], a[208:211], v[176:179]
v_mfma_f32_16x16x32_bf16 v[176:179], v[12:15], a[212:215], v[176:179]
v_mfma_f32_16x16x32_bf16 v[176:179], v[12:15], a[216:219], v[176:179]
v_mfma_f32_16x16x32_bf16 v[176:179], v[12:15], a[220:223], v[176:179]
v_mfma_f32_16x16x32_bf16 v[176:179], v[12:15], a[224:227], v[176:179]
v_mfma_f32_16x16x32_bf16 v[176:179], v[12:15], a[228:231], v[176:179]
s_nop 7
v_cmp_u_f32 vcc, v176, v176
s_nop 1
s_cbranch_vccnz k1_p5
s_branch k1_p5r
k1_p5x:
s_mov_b32 s69, 0
s_branch k1_p5r
k1_redo:
s_cmp_lg_u32 s60, 0
s_cbranch_scc1 k1_redor
s_mov_b32 s60, 1
s_waitcnt vmcnt(0) lgkmcnt(0)
s_barrier
s_nop 7
s_nop 7
s_branch k1_restart
k1_fb:
s_nop 7
s_nop 7
v_mbcnt_lo_u32_b32 v161, -1, 0
v_mbcnt_hi_u32_b32 v161, -1, v161
v_lshrrev_b32 v162, 5, v161
v_lshrrev_b32 v163, 3, v161
v_and_b32 v163, 2, v163
v_or_b32 v162, v162, v163
v_lshlrev_b32 v162, 4, v162
v_and_b32 v161, 15, v161
v_lshl_add_u32 v160, v161, 8, v162
v_add_u32_e64 v160, s61, v160
s_mov_b32 s69, 0
k1_fbl:
buffer_load_dwordx4 v[128:131], v160, s[12:15], s69 offen offset:0
buffer_load_dwordx4 v[132:135], v160, s[12:15], s69 offen offset:64
buffer_load_dwordx4 v[136:139], v160, s[12:15], s69 offen offset:128
buffer_load_dwordx4 v[140:143], v160, s[12:15], s69 offen offset:192
s_waitcnt vmcnt(0)
v_mfma_f32_16x16x32_bf16 v[144:147], v[128:131], a[0:3], 0
v_mfma_f32_16x16x32_bf16 v[148:151], v[128:131], a[16:19], 0
v_mfma_f32_16x16x32_bf16 v[152:155], v[128:131], a[32:35], 0
v_mfma_f32_16x16x32_bf16 v[156:159], v[128:131], a[48:51], 0
v_mfma_f32_16x16x32_bf16 v[144:147], v[132:135], a[4:7], v[144:147]
v_mfma_f32_16x16x32_bf16 v[148:151], v[132:135], a[20:23], v[148:151]
v_mfma_f32_16x16x32_bf16 v[152:155], v[132:135], a[36:39], v[152:155]
v_mfma_f32_16x16x32_bf16 v[156:159], v[132:135], a[52:55], v[156:159]
v_mfma_f32_16x16x32_bf16 v[144:147], v[136:139], a[8:11], v[144:147]
v_mfma_f32_16x16x32_bf16 v[148:151], v[136:139], a[24:27], v[148:151]
v_mfma_f32_16x16x32_bf16 v[152:155], v[136:139], a[40:43], v[152:155]
v_mfma_f32_16x16x32_bf16 v[156:159], v[136:139], a[56:59], v[156:159]
v_mfma_f32_16x16x32_bf16 v[144:147], v[140:143], a[12:15], v[144:147]
v_mfma_f32_16x16x32_bf16 v[148:151], v[140:143], a[28:31], v[148:151]
v_mfma_f32_16x16x32_bf16 v[152:155], v[140:143], a[44:47], v[152:155]
v_mfma_f32_16x16x32_bf16 v[156:159], v[140:143], a[60:63], v[156:159]
s_nop 7
s_nop 7
v_max3_f32 v24, v24, v144, v145
v_max3_f32 v24, v24, v146, v147
v_max3_f32 v28, v28, v148, v149
v_max3_f32 v28, v28, v150, v151
v_max3_f32 v32, v32, v152, v153
v_max3_f32 v32, v32, v154, v155
v_max3_f32 v36, v36, v156, v157
v_max3_f32 v36, v36, v158, v159
s_add_u32 s69, s69, 4096
s_cmp_lt_u32 s69, 0x20000
s_cbranch_scc1 k1_fbl
s_nop 7
s_branch k1_fbret
k3_fin:
k1_end:
s_endpgm
.section .rodata,"a"
.p2align 6
.amdhsa_kernel k1_kernel
  .amdhsa_next_free_vgpr 512
  .amdhsa_next_free_sgpr 102
  .amdhsa_accum_offset 256
  .amdhsa_group_segment_fixed_size 0
  .amdhsa_kernarg_size 112
  .amdhsa_user_sgpr_count 2
  .amdhsa_user_sgpr_kernarg_segment_ptr 1
  .amdhsa_system_sgpr_workgroup_id_x 1
  .amdhsa_float_denorm_mode_32 3
.end_amdhsa_kernel
```
